```python
import torch

def _softmax(x, axis=-1):
    return torch.softmax(x, dim=axis)
def _gelu(x):
    return torch.nn.functional.gelu(x, approximate="tanh")
def _silu(x):
    return torch.nn.functional.silu(x)
def _sigmoid(x):
    return torch.sigmoid(x)
def _layernorm(x, axis=-1, eps=1e-5):
    m = x.mean(dim=axis, keepdim=True)
    v = x.var(dim=axis, keepdim=True, unbiased=False)
    return (x - m) / torch.sqrt(v + eps)
def _scatter_add(tgt, idx, src, axis=0):
    return tgt.clone().index_add_(axis, idx, src)
def _segment_sum(src, seg, n):
    out = torch.zeros((n,) + src.shape[1:], dtype=src.dtype)
    return out.index_add_(0, seg, src)
def _pad(x, pw):
    flat = tuple(v for pair in reversed(pw) for v in pair)
    return torch.nn.functional.pad(x, flat)

kernel_name = 'gated_mix__grouped_kv_mqa__glu_gated_geglu__prompt'

def setup_inputs():

    _w = (lambda a: (lambda t: t.to(torch.bfloat16) if t.is_floating_point() else t)(torch.as_tensor(a)))
    def _A_setup():
        B, S, D, H = 1, 2048, 576, 32
        Dh = D // H
        return {
            "x": _w((lambda *s: torch.randn(*s, dtype=torch.bfloat16) * 0.05)(B, S, D)),
            "wq": _w((lambda *s: torch.randn(*s, dtype=torch.bfloat16) * 0.8)(D, H * Dh)),
            "wk": _w((lambda *s: torch.randn(*s, dtype=torch.bfloat16) * 0.8)(D, Dh)),
            "wv": _w((lambda *s: torch.randn(*s, dtype=torch.bfloat16) * 0.05)(D, Dh)),
            "wo": _w((lambda *s: torch.randn(*s, dtype=torch.bfloat16) * 0.05)(H * Dh, D)),
        }
    _A_in = _A_setup()

    def _B_setup():
        B, S, Dm, Df = 1, 2048, 576, 4608
        return {
            "x": _w((lambda *s: torch.randn(*s, dtype=torch.bfloat16) * 0.05)(B, S, Dm)),
            "w_gate": _w((lambda *s: torch.randn(*s, dtype=torch.bfloat16) * 0.8)(Dm, Df) * (Dm ** -0.5)),
            "w_up": _w((lambda *s: torch.randn(*s, dtype=torch.bfloat16) * 0.8)(Dm, Df) * (Dm ** -0.5)),
            "w_down": _w((lambda *s: torch.randn(*s, dtype=torch.bfloat16) * 0.8)(Df, Dm) * (Df ** -0.5)),
        }
    _B_in = _B_setup()

    return {
        "A_x": _A_in["x"],
        "A_wq": _A_in["wq"],
        "A_wk": _A_in["wk"],
        "A_wv": _A_in["wv"],
        "A_wo": _A_in["wo"],
        "B_x": _B_in["x"],
        "B_w_gate": _B_in["w_gate"],
        "B_w_up": _B_in["w_up"],
        "B_w_down": _B_in["w_down"],
        "gate_w": _w((lambda *s: torch.randn(*s, dtype=torch.bfloat16) * 0.05)(576) * 16.0),
    }

def reference(A_x, A_wq, A_wk, A_wv, A_wo, B_x, B_w_gate, B_w_up, B_w_down, gate_w):
    def _A_ref(x, wq, wk, wv, wo):
        B, S, D = x.shape
        H = 32
        Dh = D // H
        q = (lambda x, *d: x.permute(*d))((x @ wq).reshape(B, S, H, Dh), 0, 2, 1, 3)
        k = x @ wk
        v = x @ wv
        scores = torch.einsum("bhqd,bkd->bhqk", q, k) * (Dh ** -0.5)
        p = _softmax(scores, axis=-1)
        o = torch.einsum("bhqk,bkd->bhqd", p, v)
        return (lambda x, *d: x.permute(*d))(o, 0, 2, 1, 3).reshape(B, S, H * Dh) @ wo

    def _B_ref(x, w_gate, w_up, w_down):
        g = torch.einsum("bsd,df->bsf", x, w_gate)
        u = torch.einsum("bsd,df->bsf", x, w_up)
        h = _gelu(g) * u
        return torch.einsum("bsf,fd->bsd", h, w_down)

    x = A_x
    g = _sigmoid((x * gate_w).sum(-1, keepdims=True))
    a = _A_ref(x, A_wq, A_wk, A_wv, A_wo)
    b = _B_ref(x, B_w_gate, B_w_up, B_w_down)
    return g * a + (1 - g) * b
```

```asm
; @launch grid=(256,1,1) block=(256,1,1) lds=163840
.amdgcn_target "amdgcn-amd-amdhsa--gfx950"
.text
.globl gated_mix__grouped_kv_mqa__glu_gated_geglu__prompt_kernel
.p2align 12
.p2align 8
.type gated_mix__grouped_kv_mqa__glu_gated_geglu__prompt_kernel,@function
gated_mix__grouped_kv_mqa__glu_gated_geglu__prompt_kernel:
    s_cmp_ge_u32 s2, 256
    s_cbranch_scc1 L_end
    s_load_dwordx16 s[4:19], s[0:1], 0
    s_load_dwordx8 s[20:27], s[0:1], 64
    s_load_dwordx2 s[28:29], s[0:1], 96
    s_getpc_b64 s[82:83]
L_pc1:
    s_and_b32 s94, s2, 3
    s_lshr_b32 s95, s2, 6
    s_lshl_b32 s76, s94, 2
    s_add_u32 s76, s76, s95
    s_lshl_b32 s77, s76, 3
    s_add_u32 s77, s77, L_jobtab-L_pc1
    s_load_dwordx2 s[66:67], s[82:83], s77
    s_mov_b64 s[48:49], s[82:83]
    s_mov_b32 s50, L_codeend-L_pc1
    s_mov_b32 s51, 131072
    v_lshrrev_b32 v2, 4, v0
    v_and_b32 v3, 15, v0
    v_lshlrev_b32 v2, 7, v2
    v_lshl_add_u32 v2, v3, 28, v2
    s_lshr_b32 s77, s2, 3
    s_lshl_b32 s77, s77, 11
    buffer_load_dword v4, v2, s[48:51], s77 offen
    v_lshrrev_b32 v1, 6, v0
    v_and_b32 v241, 63, v0
    v_readfirstlane_b32 s60, v1
    v_lshlrev_b32 v233, 4, v241
    s_and_b32 s76, s76, 7
    s_cmp_eq_u32 s76, 7
    s_cselect_b32 s86, 1, 0
    s_and_b32 s76, s2, 4
    s_lshl_b32 s76, s76, 1
    s_bfe_u32 s77, s2, 0x30003
    s_add_u32 s87, s76, s77
    s_lshl1_add_u32 s76, s95, s77
    s_and_b32 s3, s76, 7
    v_lshrrev_b32 v237, 3, v241
    v_and_b32 v1, 7, v241
    s_lshl_b32 s68, s60, 12
    s_lshr_b32 s78, s60, 1
    s_and_b32 s79, s60, 1
    v_and_b32 v2, 2, v237
    v_xor_b32 v2, v1, v2
    s_lshl_b32 s80, s79, 2
    v_xor_b32 v2, s80, v2
    v_lshlrev_b32 v238, 4, v2
    v_lshrrev_b32 v2, 1, v237
    v_xor_b32 v2, v1, v2
    v_lshlrev_b32 v2, 4, v2
    v_mul_u32_u24 v3, 1152, v237
    v_add_u32 v76, v2, v3
    v_xor_b32 v2, 64, v76
    v_add_u32 v77, 8192, v2
    v_add_u32 v78, 16384, v76
    v_add_u32 v79, 24576, v2
    s_lshl_b32 s80, s87, 2
    s_add_u32 s80, s80, s60
    s_mul_i32 s64, s80, 36864
    s_lshl_b32 s81, s3, 7
    s_add_u32 s74, s64, s81
    s_mov_b32 s42, 2359296
    s_mov_b32 s43, 131072
    s_mov_b32 s35, s43
    s_mov_b32 s34, 5308416
    s_movk_i32 s80, 9216
    v_mad_u32_u24 v220, v237, s80, v238
    s_mov_b32 s75, 146432
    s_mov_b32 s62, 589824
    v_add_u32 v221, s75, v220
    s_mul_i32 s69, s79, 73728
    v_add_u32 v222, s75, v221
    s_mul_i32 s31, s3, s62
    v_add_u32 v223, s75, v222
    s_add_u32 s85, s64, 1024
    s_waitcnt lgkmcnt(0)
    s_mov_b64 s[40:41], s[4:5]
    s_add_u32 m0, s68, 32768
    s_nop 0
    buffer_load_dwordx4 v76, s[40:43], s85 offen offset:0 lds
    buffer_load_dwordx4 v77, s[40:43], s85 offen offset:1024 lds
    buffer_load_dwordx4 v78, s[40:43], s85 offen offset:2048 lds
    buffer_load_dwordx4 v79, s[40:43], s85 offen offset:3072 lds
    s_add_u32 m0, s68, 65536
    s_nop 0
    buffer_load_dwordx4 v76, s[40:43], s74 offen offset:0 lds
    buffer_load_dwordx4 v77, s[40:43], s74 offen offset:1024 lds
    buffer_load_dwordx4 v78, s[40:43], s74 offen offset:2048 lds
    buffer_load_dwordx4 v79, s[40:43], s74 offen offset:3072 lds
    s_cmp_lt_u32 s60, 2
    s_cselect_b64 s[90:91], s[16:17], s[18:19]
    s_cselect_b64 s[32:33], s[16:17], s[18:19]
    s_bfe_u32 s76, s66, 0x80008
    s_lshl_b32 s77, s76, 7
    s_add_u32 s100, s77, s69
    s_add_u32 s61, s100, s31
    s_lshl3_add_u32 s101, s62, s100
    v_mov_b32 v232, v220
    s_cmp_eq_u32 s86, 0
    s_cbranch_scc0 L_sp_first
L_sp_first_ret:
    s_add_u32 m0, s68, 49152
    s_nop 0
    buffer_load_dwordx4 v220, s[32:35], s101 offen offset:0 sc1 lds
    buffer_load_dwordx4 v221, s[32:35], s101 offen offset:1024 sc1 lds
    buffer_load_dwordx4 v222, s[32:35], s101 offen offset:2048 sc1 lds
    buffer_load_dwordx4 v223, s[32:35], s101 offen offset:3072 sc1 lds
    s_cmp_eq_u32 s86, 0
    s_cbranch_scc0 L_sp_skip
    s_bfe_u32 s76, s66, 0x80010
    s_lshl_b32 s77, s76, 7
    s_add_u32 s88, s77, s69
    s_add_u32 s31, s31, s88
    s_mov_b32 s63, s62
    s_mov_b64 s[36:37], s[90:91]
    s_mov_b32 s38, s34
    v_mov_b32 v231, v232
    s_branch L_sp_skip
L_sp_first:
    s_call_b64 s[84:85], L_setup
    s_mov_b64 s[32:33], s[36:37]
    s_mov_b32 s34, s38
    s_mov_b32 s62, s63
    v_mov_b32 v220, v231
    s_mov_b32 s100, s88
    s_lshl3_add_u32 s101, s63, s88
    v_add_u32 v221, s75, v220
    v_add_u32 v222, s75, v221
    v_add_u32 v223, s75, v222
    s_mov_b32 s61, s31
    s_bfe_u32 s76, s66, 0x80010
    s_call_b64 s[84:85], L_setup
    s_add_u32 s85, s64, 1024
    s_branch L_sp_first_ret
L_setup:
    s_mov_b64 s[36:37], s[90:91]
    s_mov_b32 s38, 5308416
    s_movk_i32 s77, 9216
    s_lshl_b32 s78, s76, 7
    s_mov_b32 s80, 0
    s_cmp_lt_u32 s76, 72
    s_cbranch_scc1 L_setup_fin
    s_cmp_lt_u32 s76, 77
    s_cbranch_scc0 L_setup_kv
    s_mov_b64 s[36:37], s[6:7]
    s_movk_i32 s77, 1152
    s_sub_u32 s78, s76, 72
    s_lshl_b32 s78, s78, 1
    s_lshr_b32 s79, s60, 1
    s_add_u32 s78, s78, s79
    s_lshl_b32 s78, s78, 7
    s_cmp_lt_u32 s78, 1152
    s_cselect_b32 s38, 663552, 0
    s_branch L_setup_fin
L_setup_kv:
    s_cmp_eq_u32 s76, 77
    s_cbranch_scc0 L_setup_ret
    s_cmp_lt_u32 s60, 2
    s_cselect_b64 s[36:37], s[8:9], s[10:11]
    s_sub_u32 s36, s36, 3072
    s_subb_u32 s37, s37, 0
    s_movk_i32 s38, 23808
    s_movk_i32 s77, 36
    s_mov_b32 s78, 0
    s_movk_i32 s80, 3072
L_setup_fin:
    s_lshl_b32 s63, s77, 6
    s_lshl_b32 s75, s77, 4
    s_sub_u32 s75, s75, 1024
    s_and_b32 s79, s60, 1
    s_mul_i32 s79, s79, s77
    s_lshl_b32 s79, s79, 3
    s_add_u32 s88, s78, s79
    s_mul_i32 s79, s3, s63
    s_add_u32 s31, s88, s79
    v_mad_u32_u24 v231, v237, s77, v238
    v_add_u32 v231, s80, v231
    s_setpc_b64 s[84:85]
L_setup_ret:
    s_mov_b64 s[36:37], s[28:29]
    s_mov_b32 s38, 41943040
    v_mov_b32 v231, v233
    s_setpc_b64 s[84:85]
L_sp_skip:
    s_mov_b64 s[44:45], s[28:29]
    s_mov_b32 s46, 41943040
    s_mov_b32 s47, 131072
    s_mov_b64 s[96:97], s[26:27]
    s_movk_i32 s98, 256
    s_mov_b32 s99, 131072
    s_mov_b32 s26, 2359296
    s_mov_b32 s27, 131072
    s_mov_b64 s[48:49], s[28:29]
    s_mov_b32 s50, 41943040
    s_mov_b32 s51, 131072
    s_mov_b64 s[56:57], s[28:29]
    s_mov_b32 s59, 131072
    s_mov_b32 s55, 131072
    s_mov_b32 s89, 0xbdd2d3e8
    v_mov_b32 v234, 0xc0135761
    s_lshl_b32 s93, s2, 2
    s_add_u32 s93, s93, s60
    s_lshr_b32 s78, s60, 1
    s_and_b32 s79, s60, 1
    s_lshl_b32 s76, s87, 1
    s_add_u32 s76, s76, s78
    s_mul_i32 s65, s76, 663552
    s_lshl_b32 s76, s79, 12
    s_add_u32 s65, s65, s76
    v_and_b32 v32, 3, v241
    v_lshrrev_b32 v33, 1, v32
    v_and_b32 v32, 1, v32
    v_lshl_add_u32 v32, v32, 1, v33
    v_lshlrev_b32 v32, 3, v32
    v_bfe_u32 v33, v241, 2, 2
    v_lshl_add_u32 v32, v33, 7, v32
    v_bfe_u32 v34, v241, 4, 1
    v_lshrrev_b32 v35, 5, v241
    v_lshl_add_u32 v36, v34, 5, v32
    v_lshl_add_u32 v36, v35, 10, v36
    s_add_u32 s76, s68, 131072
    v_add_u32 v236, s76, v36
    v_and_b32 v32, 3, v241
    v_lshlrev_b32 v32, 3, v32
    v_lshl_add_u32 v32, v33, 7, v32
    v_lshrrev_b32 v33, 1, v33
    v_lshl_add_u32 v33, v34, 1, v33
    s_lshl_b32 s76, s79, 1
    v_xor_b32 v33, s76, v33
    v_lshl_add_u32 v32, v33, 5, v32
    v_lshl_add_u32 v32, v34, 12, v32
    v_lshl_add_u32 v224, v35, 10, v32
    v_xor_b32 v225, 32, v224
    v_add_u32 v226, 49152, v224
    v_add_u32 v227, 49152, v225
    v_add_u32 v228, 98304, v224
    v_add_u32 v229, 98304, v225
    v_and_b32 v37, 31, v241
    v_and_b32 v38, 15, v241
    v_bfe_u32 v33, v241, 1, 3
    v_lshrrev_b32 v39, 4, v241
    v_xor_b32 v33, v33, v39
    v_lshlrev_b32 v33, 4, v33
    v_lshl_add_u32 v32, v38, 7, v33
    s_lshl_b32 s76, s78, 13
    v_add_u32 v64, s76, v32
    v_xor_b32 v65, 64, v64
    v_lshlrev_b32 v32, 4, v38
    v_lshl_add_u32 v32, v35, 9, v32
    v_lshl_add_u32 v254, v34, 11, v32
    v_add_u32 v66, 57344, v64
    v_add_u32 v67, 57344, v65
    v_add_u32 v68, 114688, v64
    v_add_u32 v69, 114688, v65
    v_mul_u32_u24 v242, 1152, v37
    v_lshl_add_u32 v242, v35, 4, v242
    v_lshlrev_b32 v250, 2, v241
    v_bfe_u32 v32, v241, 2, 1
    v_bfe_u32 v33, v241, 3, 1
    v_lshlrev_b32 v32, 3, v32
    v_lshl_add_u32 v32, v33, 2, v32
    v_and_b32 v33, 0x13, v241
    v_or_b32 v32, v32, v33
    v_mul_u32_u24 v33, 18, v35
    v_cmp_gt_u32 vcc, 18, v37
    v_add_u32 v32, v32, v33
    v_and_b32 v33, 27, v37
    v_cndmask_b32 v32, 37, v32, vcc
    v_cmp_ne_u32 vcc, 18, v33
    v_mul_u32_u24 v115, 12, v37
    s_lshl_b32 s81, s87, 2
    s_add_u32 s81, s81, s94
    s_lshl_b32 s81, s81, 2
    s_add_u32 s81, s81, s95
    s_lshl_b32 s81, s81, 2
    s_add_u32 s81, s81, s60
    s_lshl_b32 s81, s81, 1
    v_cndmask_b32 v32, 36, v32, vcc
    v_lshlrev_b32 v243, 4, v32
    v_add_u32 v5, s81, v35
    v_mul_u32_u24 v6, 1152, v5
    v_add_u32 v116, v6, v115
    v_cmp_eq_u32 vcc, 0, v37
    v_lshlrev_b32 v5, 2, v5
    v_add_u32 v5, 31719424, v5
    v_mov_b32 v33, 0x40000000
    v_cndmask_b32 v106, v33, v5, vcc
    v_cmp_eq_u32 vcc, 0, v0
    v_mov_b32 v240, 1
    s_mul_i32 s30, s3, 589824
    v_cndmask_b32 v239, v33, 0, vcc
    s_lshl_b32 s76, s87, 2
    s_add_u32 s76, s76, 31784960
    s_bfe_u32 s77, s66, 0x80008
    s_cmp_eq_u32 s77, 77
    s_cselect_b32 s92, s76, 1073741824
    s_mul_i32 s76, s93, 21846
    s_lshr_b32 s76, s76, 16
    s_mul_i32 s77, s76, 3
    s_sub_u32 s77, s93, s77
    s_mul_i32 s72, s77, 1990656
    s_mul_i32 s78, s76, 3072
    s_add_u32 s72, s72, s78
    s_add_u32 s72, s72, 22020096
    s_add_u32 s73, s72, 995328
    s_mov_b32 s58, 41943040
    s_mul_i32 s77, s77, 384
    v_and_b32 v32, 7, v241
    v_lshlrev_b32 v32, 4, v32
    s_movk_i32 s80, 1152
    v_mad_u32_u24 v235, v237, s80, v32
    s_mov_b64 s[52:53], s[20:21]
    s_mov_b32 s54, 5308416
    s_mul_i32 s70, s76, 18432
    s_movk_i32 s79, 9216
    s_cmp_lt_u32 s76, 288
    s_cbranch_scc1 L_pk_done
    s_mov_b64 s[52:53], s[12:13]
    s_mov_b32 s54, 663552
    s_cmp_lt_u32 s76, 324
    s_cselect_b32 s54, s54, 0
    s_cselect_b32 s58, s58, 0
    s_sub_u32 s78, s76, 288
    s_mul_i32 s81, s78, 57
    s_lshr_b32 s81, s81, 9
    s_sub_u32 s78, s78, s81
    s_mul_i32 s70, s78, 20736
    s_lshr_b32 s78, s78, 3
    s_cmp_eq_u32 s78, s81
    s_cbranch_scc1 L_pk_done
    s_mul_i32 s70, s81, 165888
    s_add_u32 s70, s70, 18432
    s_mov_b32 s79, 82944
    v_lshrrev_b32 v34, 1, v237
    v_mul_u32_u24 v34, 18, v34
    v_and_b32 v36, 1, v237
    v_add_u32 v34, v34, v36
    v_mad_u32_u24 v235, v34, s80, v32
L_pk_done:
    s_add_u32 s70, s70, s77
    s_add_u32 s71, s70, s79
    s_sub_u32 s71, s71, 1024
    s_mov_b64 s[82:83], s[22:23]
    v_mul_u32_u24 v32, 9216, v241
    v_cmp_gt_u32 vcc, 36, v241
    s_nop 1
    v_cndmask_b32 v230, v33, v32, vcc
    v_lshrrev_b32 v32, 4, v0
    v_and_b32 v34, 15, v0
    v_lshlrev_b32 v32, 7, v32
    v_lshl_add_u32 v32, v34, 28, v32
    s_lshr_b32 s77, s2, 3
    s_lshl_b32 s77, s77, 11
    v_add_u32 v119, s77, v32
    s_cmp_eq_u32 s93, 775
    s_cbranch_scc1 L_flaginit
L_flaginit_ret:
    s_add_u32 m0, s68, 81920
    s_nop 0
    buffer_load_dwordx4 v220, s[32:35], s61 offen offset:0 sc1 lds
    buffer_load_dwordx4 v221, s[32:35], s61 offen offset:1024 sc1 lds
    buffer_load_dwordx4 v222, s[32:35], s61 offen offset:2048 sc1 lds
    buffer_load_dwordx4 v223, s[32:35], s61 offen offset:3072 sc1 lds
    s_add_u32 m0, s68, 98304
    s_add_u32 s74, s74, 128
    s_cmp_eq_u32 s74, s85
    s_cselect_b32 s74, s64, s74
    buffer_load_dwordx4 v76, s[40:43], s74 offen offset:0 lds
    buffer_load_dwordx4 v77, s[40:43], s74 offen offset:1024 lds
    buffer_load_dwordx4 v78, s[40:43], s74 offen offset:2048 lds
    buffer_load_dwordx4 v79, s[40:43], s74 offen offset:3072 lds
    s_add_u32 m0, s68, 114688
    s_add_u32 s61, s61, s62
    s_cmp_eq_u32 s61, s101
    s_cselect_b32 s61, s100, s61
    buffer_load_dwordx4 v220, s[32:35], s61 offen offset:0 sc1 lds
    buffer_load_dwordx4 v221, s[32:35], s61 offen offset:1024 sc1 lds
    buffer_load_dwordx4 v222, s[32:35], s61 offen offset:2048 sc1 lds
    buffer_load_dwordx4 v223, s[32:35], s61 offen offset:3072 sc1 lds
    s_waitcnt vmcnt(12) lgkmcnt(0)
    s_barrier
    ds_read_b64_tr_b16 v[128:129], v226 offset:0
    ds_read_b64_tr_b16 v[130:131], v226 offset:512
    ds_read_b64_tr_b16 v[132:133], v226 offset:2048
    ds_read_b64_tr_b16 v[134:135], v226 offset:2560
    ds_read_b128 a[0:3], v64 offset:32768
    ds_read_b128 a[4:7], v65 offset:32768
    ds_read_b128 a[8:11], v64 offset:34816
    ds_read_b128 a[12:15], v65 offset:34816
    ds_read_b128 a[16:19], v64 offset:36864
    ds_read_b128 a[20:23], v65 offset:36864
    ds_read_b128 a[24:27], v64 offset:38912
    ds_read_b128 a[28:31], v65 offset:38912
    ds_read_b64_tr_b16 v[136:137], v227 offset:0
    ds_read_b64_tr_b16 v[138:139], v227 offset:512
    ds_read_b64_tr_b16 v[140:141], v227 offset:2048
    ds_read_b64_tr_b16 v[142:143], v227 offset:2560
    s_waitcnt lgkmcnt(4)
    v_mfma_f32_16x16x32_bf16 v[0:3], v[128:131], a[0:3], 0
    ds_read_b64_tr_b16 v[144:145], v226 offset:8192
    s_add_u32 m0, s68, 131072
    s_add_u32 s74, s74, 128
    v_mfma_f32_16x16x32_bf16 v[0:3], v[132:135], a[4:7], v[0:3]
    s_cmp_eq_u32 s74, s85
    s_cselect_b32 s74, s64, s74
    v_mfma_f32_16x16x32_bf16 v[16:19], v[128:131], a[8:11], 0
    buffer_load_dwordx4 v76, s[40:43], s74 offen offset:0 lds
    v_mfma_f32_16x16x32_bf16 v[16:19], v[132:135], a[12:15], v[16:19]
    ds_read_b64_tr_b16 v[146:147], v226 offset:8704
    v_mfma_f32_16x16x32_bf16 v[32:35], v[128:131], a[16:19], 0
    buffer_load_dwordx4 v77, s[40:43], s74 offen offset:1024 lds
    ds_read_b64_tr_b16 v[148:149], v226 offset:10240
    v_mfma_f32_16x16x32_bf16 v[32:35], v[132:135], a[20:23], v[32:35]
    buffer_load_dwordx4 v78, s[40:43], s74 offen offset:2048 lds
    v_mfma_f32_16x16x32_bf16 v[48:51], v[128:131], a[24:27], 0
    ds_read_b64_tr_b16 v[150:151], v226 offset:10752
    v_mfma_f32_16x16x32_bf16 v[48:51], v[132:135], a[28:31], v[48:51]
    buffer_load_dwordx4 v79, s[40:43], s74 offen offset:3072 lds
    s_waitcnt lgkmcnt(4)
    v_mfma_f32_16x16x32_bf16 v[4:7], v[136:139], a[0:3], 0
    ds_read_b64_tr_b16 v[128:129], v227 offset:8192
    s_add_u32 m0, s68, 147456
    s_add_u32 s61, s61, s62
    v_mfma_f32_16x16x32_bf16 v[4:7], v[140:143], a[4:7], v[4:7]
    s_cmp_eq_u32 s61, s101
    s_cselect_b32 s61, s100, s61
    v_mfma_f32_16x16x32_bf16 v[20:23], v[136:139], a[8:11], 0
    buffer_load_dwordx4 v220, s[32:35], s61 offen offset:0 sc1 lds
    v_mfma_f32_16x16x32_bf16 v[20:23], v[140:143], a[12:15], v[20:23]
    ds_read_b64_tr_b16 v[130:131], v227 offset:8704
    v_mfma_f32_16x16x32_bf16 v[36:39], v[136:139], a[16:19], 0
    buffer_load_dwordx4 v221, s[32:35], s61 offen offset:1024 sc1 lds
    ds_read_b64_tr_b16 v[132:133], v227 offset:10240
    v_mfma_f32_16x16x32_bf16 v[36:39], v[140:143], a[20:23], v[36:39]
    buffer_load_dwordx4 v222, s[32:35], s61 offen offset:2048 sc1 lds
    v_mfma_f32_16x16x32_bf16 v[52:55], v[136:139], a[24:27], 0
    ds_read_b64_tr_b16 v[134:135], v227 offset:10752
    v_mfma_f32_16x16x32_bf16 v[52:55], v[140:143], a[28:31], v[52:55]
    buffer_load_dwordx4 v223, s[32:35], s61 offen offset:3072 sc1 lds
    s_lshr_b32 s79, s94, 1
    s_lshl1_add_u32 s76, s87, s79
    s_and_b32 s79, s94, 1
    s_lshl2_add_u32 s78, s79, s95
    s_lshl2_add_u32 s77, s78, s60
    s_mov_b32 s95, s79
    s_lshl_b32 s80, s78, s79
    s_lshl_b32 s81, s79, 2
    s_sub_u32 s4, s80, s81
    s_sub_u32 s81, s77, 24
    s_cmp_ge_u32 s78, 6
    s_cselect_b32 s4, s81, s4
    s_cselect_b32 s95, 3, s95
    s_cmp_eq_u32 s79, 0
    s_cselect_b32 s80, 61, 50
    s_mul_i32 s80, s80, s60
    s_lshr_b32 s81, s60, 1
    s_add_u32 s81, s81, 4
    s_cmp_eq_u32 s78, 6
    s_cselect_b32 s81, s60, s81
    s_cmp_ge_u32 s78, 6
    s_cselect_b32 s78, s81, s78
    s_cselect_b32 s80, 0, s80
    s_mul_i32 s79, s78, 995328
    s_add_u32 s79, s79, 22020096
    s_mul_i32 s81, s80, 3072
    s_add_u32 s81, s81, s79
    s_add_u32 s14, s28, s81
    s_addc_u32 s15, s29, 0
    s_mul_i32 s81, s60, 27648
    s_add_u32 s81, s81, s79
    s_add_u32 s81, s81, 884736
    s_add_u32 s18, s28, s81
    s_addc_u32 s19, s29, 0
    s_mul_i32 s79, s76, 663552
    s_lshl_b32 s81, s80, 11
    s_add_u32 s81, s81, s79
    s_add_u32 s12, s28, s81
    s_addc_u32 s13, s29, 0
    s_mul_i32 s81, s60, 18432
    s_add_u32 s81, s81, s79
    s_add_u32 s81, s81, 589824
    s_add_u32 s16, s28, s81
    s_addc_u32 s17, s29, 0
    s_lshr_b32 s81, s77, 3
    s_mul_i32 s81, s81, 18432
    s_add_u32 s79, s79, s81
    s_add_u32 s79, s79, 589824
    s_and_b32 s81, s77, 7
    s_lshl_b32 s20, s81, 11
    s_add_u32 s20, s20, s79
    s_lshl_b32 s21, s81, 8
    s_add_u32 s21, s21, s79
    s_add_u32 s21, s21, 16384
    s_mul_i32 s22, s76, 73728
    s_mul_i32 s81, s77, 18
    s_lshr_b32 s81, s81, 3
    s_lshl_b32 s81, s81, 9
    s_add_u32 s22, s22, s81
    s_add_u32 s22, s22, 28311552
    s_lshl_b32 s23, s76, 8
    s_add_u32 s23, s23, 31719424
    s_lshl3_add_u32 s4, s76, s4
    s_mul_i32 s4, s4, 24704
    s_add_u32 s4, s4, 32505856
    s_mul_i32 s5, s76, 73728
    s_mul_i32 s81, s78, 192
    s_add_u32 s5, s5, s81
    s_lshl_b32 s81, s60, 5
    s_add_u32 s5, s5, s81
    s_bfe_u32 s76, s2, 0x30003
    s_and_b32 s77, s60, 1
    s_mul_i32 s78, s76, 72
    s_mul_i32 s79, s77, 28
    s_add_u32 s78, s78, s79
    s_mul_i32 s94, s78, 9216
    s_cmp_eq_u32 s86, 0
    s_cselect_b32 s94, s94, 1073741824
    s_waitcnt lgkmcnt(4)
    v_mfma_f32_16x16x32_bf16 v[8:11], v[144:147], a[0:3], 0
    s_waitcnt vmcnt(16)
    s_barrier
    ds_read_b128 a[32:35], v66 offset:8192
    v_mfma_f32_16x16x32_bf16 v[8:11], v[148:151], a[4:7], v[8:11]
    ds_read_b128 a[36:39], v67 offset:8192
    v_mfma_f32_16x16x32_bf16 v[24:27], v[144:147], a[8:11], 0
    ds_read_b128 a[40:43], v66 offset:10240
    ds_read_b128 a[44:47], v67 offset:10240
    s_add_u32 m0, s68, 0
    v_mfma_f32_16x16x32_bf16 v[24:27], v[148:151], a[12:15], v[24:27]
    s_add_u32 s74, s74, 128
    s_cmp_eq_u32 s74, s85
    s_cselect_b32 s74, s64, s74
    v_mfma_f32_16x16x32_bf16 v[40:43], v[144:147], a[16:19], 0
    buffer_load_dwordx4 v76, s[40:43], s74 offen offset:0 lds
    ds_read_b64_tr_b16 v[136:137], v226 offset:32768
    v_mfma_f32_16x16x32_bf16 v[40:43], v[148:151], a[20:23], v[40:43]
    ds_read_b64_tr_b16 v[138:139], v226 offset:33280
    v_mfma_f32_16x16x32_bf16 v[56:59], v[144:147], a[24:27], 0
    ds_read_b64_tr_b16 v[140:141], v226 offset:34816
    ds_read_b64_tr_b16 v[142:143], v226 offset:35328
    v_mfma_f32_16x16x32_bf16 v[56:59], v[148:151], a[28:31], v[56:59]
    buffer_load_dwordx4 v77, s[40:43], s74 offen offset:1024 lds
    s_waitcnt lgkmcnt(8)
    v_mfma_f32_16x16x32_bf16 v[12:15], v[128:131], a[0:3], 0
    ds_read_b128 a[48:51], v66 offset:12288
    ds_read_b128 a[52:55], v67 offset:12288
    v_mfma_f32_16x16x32_bf16 v[12:15], v[132:135], a[4:7], v[12:15]
    v_mfma_f32_16x16x32_bf16 v[28:31], v[128:131], a[8:11], 0
    ds_read_b128 a[56:59], v66 offset:14336
    ds_read_b128 a[60:63], v67 offset:14336
    v_mfma_f32_16x16x32_bf16 v[28:31], v[132:135], a[12:15], v[28:31]
    buffer_load_dwordx4 v78, s[40:43], s74 offen offset:2048 lds
    v_mfma_f32_16x16x32_bf16 v[44:47], v[128:131], a[16:19], 0
    ds_read_b64_tr_b16 v[144:145], v227 offset:32768
    ds_read_b64_tr_b16 v[146:147], v227 offset:33280
    v_mfma_f32_16x16x32_bf16 v[44:47], v[132:135], a[20:23], v[44:47]
    v_mfma_f32_16x16x32_bf16 v[60:63], v[128:131], a[24:27], 0
    ds_read_b64_tr_b16 v[148:149], v227 offset:34816
    ds_read_b64_tr_b16 v[150:151], v227 offset:35328
    v_mfma_f32_16x16x32_bf16 v[60:63], v[132:135], a[28:31], v[60:63]
    buffer_load_dwordx4 v79, s[40:43], s74 offen offset:3072 lds
    s_waitcnt lgkmcnt(4)
    v_mfma_f32_16x16x32_bf16 v[0:3], v[136:139], a[32:35], v[0:3]
    ds_read_b64_tr_b16 v[128:129], v226 offset:40960
    v_mfma_f32_16x16x32_bf16 v[0:3], v[140:143], a[36:39], v[0:3]
    v_mfma_f32_16x16x32_bf16 v[16:19], v[136:139], a[40:43], v[16:19]
    ds_read_b64_tr_b16 v[130:131], v226 offset:41472
    s_add_u32 m0, s68, 16384
    v_mfma_f32_16x16x32_bf16 v[16:19], v[140:143], a[44:47], v[16:19]
    s_add_u32 s61, s61, s62
    s_cmp_eq_u32 s61, s101
    v_mfma_f32_16x16x32_bf16 v[32:35], v[136:139], a[48:51], v[32:35]
    s_cselect_b32 s61, s100, s61
    v_mfma_f32_16x16x32_bf16 v[32:35], v[140:143], a[52:55], v[32:35]
    buffer_load_dwordx4 v220, s[32:35], s61 offen offset:0 sc1 lds
    ds_read_b64_tr_b16 v[132:133], v226 offset:43008
    v_mfma_f32_16x16x32_bf16 v[48:51], v[136:139], a[56:59], v[48:51]
    ds_read_b64_tr_b16 v[134:135], v226 offset:43520
    v_mfma_f32_16x16x32_bf16 v[48:51], v[140:143], a[60:63], v[48:51]
    buffer_load_dwordx4 v221, s[32:35], s61 offen offset:1024 sc1 lds
    s_waitcnt lgkmcnt(4)
    v_mfma_f32_16x16x32_bf16 v[4:7], v[144:147], a[32:35], v[4:7]
    ds_read_b64_tr_b16 v[136:137], v227 offset:40960
    v_mfma_f32_16x16x32_bf16 v[4:7], v[148:151], a[36:39], v[4:7]
    v_mfma_f32_16x16x32_bf16 v[20:23], v[144:147], a[40:43], v[20:23]
    ds_read_b64_tr_b16 v[138:139], v227 offset:41472
    v_mfma_f32_16x16x32_bf16 v[20:23], v[148:151], a[44:47], v[20:23]
    buffer_load_dwordx4 v222, s[32:35], s61 offen offset:2048 sc1 lds
    v_mfma_f32_16x16x32_bf16 v[36:39], v[144:147], a[48:51], v[36:39]
    ds_read_b64_tr_b16 v[140:141], v227 offset:43008
    v_mfma_f32_16x16x32_bf16 v[36:39], v[148:151], a[52:55], v[36:39]
    v_mfma_f32_16x16x32_bf16 v[52:55], v[144:147], a[56:59], v[52:55]
    ds_read_b64_tr_b16 v[142:143], v227 offset:43520
    v_mfma_f32_16x16x32_bf16 v[52:55], v[148:151], a[60:63], v[52:55]
    buffer_load_dwordx4 v223, s[32:35], s61 offen offset:3072 sc1 lds
    s_waitcnt lgkmcnt(4)
    v_mfma_f32_16x16x32_bf16 v[8:11], v[128:131], a[32:35], v[8:11]
    s_waitcnt vmcnt(16)
    s_barrier
    ds_read_b128 a[64:67], v66 offset:40960
    v_mfma_f32_16x16x32_bf16 v[8:11], v[132:135], a[36:39], v[8:11]
    ds_read_b128 a[68:71], v67 offset:40960
    v_mfma_f32_16x16x32_bf16 v[24:27], v[128:131], a[40:43], v[24:27]
    ds_read_b128 a[72:75], v66 offset:43008
    ds_read_b128 a[76:79], v67 offset:43008
    s_add_u32 m0, s68, 32768
    v_mfma_f32_16x16x32_bf16 v[24:27], v[132:135], a[44:47], v[24:27]
    s_add_u32 s74, s74, 128
    s_cmp_eq_u32 s74, s85
    s_cselect_b32 s74, s64, s74
    v_mfma_f32_16x16x32_bf16 v[40:43], v[128:131], a[48:51], v[40:43]
    buffer_load_dwordx4 v76, s[40:43], s74 offen offset:0 lds
    ds_read_b64_tr_b16 v[144:145], v228 offset:16384
    v_mfma_f32_16x16x32_bf16 v[40:43], v[132:135], a[52:55], v[40:43]
    ds_read_b64_tr_b16 v[146:147], v228 offset:16896
    v_mfma_f32_16x16x32_bf16 v[56:59], v[128:131], a[56:59], v[56:59]
    ds_read_b64_tr_b16 v[148:149], v228 offset:18432
    ds_read_b64_tr_b16 v[150:151], v228 offset:18944
    v_mfma_f32_16x16x32_bf16 v[56:59], v[132:135], a[60:63], v[56:59]
    buffer_load_dwordx4 v77, s[40:43], s74 offen offset:1024 lds
    s_waitcnt lgkmcnt(8)
    v_mfma_f32_16x16x32_bf16 v[12:15], v[136:139], a[32:35], v[12:15]
    ds_read_b128 a[80:83], v66 offset:45056
    ds_read_b128 a[84:87], v67 offset:45056
    v_mfma_f32_16x16x32_bf16 v[12:15], v[140:143], a[36:39], v[12:15]
    v_mfma_f32_16x16x32_bf16 v[28:31], v[136:139], a[40:43], v[28:31]
    ds_read_b128 a[88:91], v66 offset:47104
    ds_read_b128 a[92:95], v67 offset:47104
    v_mfma_f32_16x16x32_bf16 v[28:31], v[140:143], a[44:47], v[28:31]
    buffer_load_dwordx4 v78, s[40:43], s74 offen offset:2048 lds
    v_mfma_f32_16x16x32_bf16 v[44:47], v[136:139], a[48:51], v[44:47]
    ds_read_b64_tr_b16 v[128:129], v229 offset:16384
    ds_read_b64_tr_b16 v[130:131], v229 offset:16896
    v_mfma_f32_16x16x32_bf16 v[44:47], v[140:143], a[52:55], v[44:47]
    v_mfma_f32_16x16x32_bf16 v[60:63], v[136:139], a[56:59], v[60:63]
    ds_read_b64_tr_b16 v[132:133], v229 offset:18432
    ds_read_b64_tr_b16 v[134:135], v229 offset:18944
    v_mfma_f32_16x16x32_bf16 v[60:63], v[140:143], a[60:63], v[60:63]
    buffer_load_dwordx4 v79, s[40:43], s74 offen offset:3072 lds
    s_waitcnt lgkmcnt(4)
    v_mfma_f32_16x16x32_bf16 v[0:3], v[144:147], a[64:67], v[0:3]
    ds_read_b64_tr_b16 v[136:137], v228 offset:24576
    v_mfma_f32_16x16x32_bf16 v[0:3], v[148:151], a[68:71], v[0:3]
    v_mfma_f32_16x16x32_bf16 v[16:19], v[144:147], a[72:75], v[16:19]
    ds_read_b64_tr_b16 v[138:139], v228 offset:25088
    s_add_u32 m0, s68, 49152
    s_add_u32 s61, s61, s62
    v_mfma_f32_16x16x32_bf16 v[16:19], v[148:151], a[76:79], v[16:19]
    s_cmp_eq_u32 s61, s101
    s_cselect_b32 s61, s100, s61
    v_mfma_f32_16x16x32_bf16 v[32:35], v[144:147], a[80:83], v[32:35]
    buffer_load_dwordx4 v220, s[32:35], s61 offen offset:0 sc1 lds
    v_mfma_f32_16x16x32_bf16 v[32:35], v[148:151], a[84:87], v[32:35]
    ds_read_b64_tr_b16 v[140:141], v228 offset:26624
    global_load_dwordx3 v[80:82], v116, s[40:41] offset:0
    v_mfma_f32_16x16x32_bf16 v[48:51], v[144:147], a[88:91], v[48:51]
    ds_read_b64_tr_b16 v[142:143], v228 offset:27136
    v_mfma_f32_16x16x32_bf16 v[48:51], v[148:151], a[92:95], v[48:51]
    buffer_load_dwordx4 v221, s[32:35], s61 offen offset:1024 sc1 lds
    s_waitcnt lgkmcnt(4)
    v_mfma_f32_16x16x32_bf16 v[4:7], v[128:131], a[64:67], v[4:7]
    ds_read_b64_tr_b16 v[144:145], v229 offset:24576
    s_cmp_eq_u32 s86, 0
    v_mfma_f32_16x16x32_bf16 v[4:7], v[132:135], a[68:71], v[4:7]
    s_cbranch_scc0 L_sp_touch
L_sp_touch_ret:
    v_mfma_f32_16x16x32_bf16 v[20:23], v[128:131], a[72:75], v[20:23]
    ds_read_b64_tr_b16 v[146:147], v229 offset:25088
    v_mfma_f32_16x16x32_bf16 v[20:23], v[132:135], a[76:79], v[20:23]
    buffer_load_dwordx4 v222, s[32:35], s61 offen offset:2048 sc1 lds
    v_mfma_f32_16x16x32_bf16 v[36:39], v[128:131], a[80:83], v[36:39]
    ds_read_b64_tr_b16 v[148:149], v229 offset:26624
    global_load_dwordx3 v[92:94], v115, s[82:83] offset:0
    v_mfma_f32_16x16x32_bf16 v[36:39], v[132:135], a[84:87], v[36:39]
    v_mfma_f32_16x16x32_bf16 v[52:55], v[128:131], a[88:91], v[52:55]
    ds_read_b64_tr_b16 v[150:151], v229 offset:27136
    v_mfma_f32_16x16x32_bf16 v[52:55], v[132:135], a[92:95], v[52:55]
    buffer_load_dwordx4 v223, s[32:35], s61 offen offset:3072 sc1 lds
    s_waitcnt lgkmcnt(4)
    v_mfma_f32_16x16x32_bf16 v[8:11], v[136:139], a[64:67], v[8:11]
    s_waitcnt vmcnt(18)
    s_barrier
    ds_read_b128 a[96:99], v68 offset:16384
    v_mfma_f32_16x16x32_bf16 v[8:11], v[140:143], a[68:71], v[8:11]
    ds_read_b128 a[100:103], v69 offset:16384
    v_mfma_f32_16x16x32_bf16 v[24:27], v[136:139], a[72:75], v[24:27]
    ds_read_b128 a[104:107], v68 offset:18432
    ds_read_b128 a[108:111], v69 offset:18432
    s_add_u32 m0, s68, 65536
    v_mfma_f32_16x16x32_bf16 v[24:27], v[140:143], a[76:79], v[24:27]
    s_add_u32 s74, s74, 128
    s_cmp_eq_u32 s74, s85
    s_cselect_b32 s74, s64, s74
    v_mfma_f32_16x16x32_bf16 v[40:43], v[136:139], a[80:83], v[40:43]
    buffer_load_dwordx4 v76, s[40:43], s74 offen offset:0 lds
    ds_read_b64_tr_b16 v[128:129], v228 offset:49152
    v_mfma_f32_16x16x32_bf16 v[40:43], v[140:143], a[84:87], v[40:43]
    ds_read_b64_tr_b16 v[130:131], v228 offset:49664
    v_mfma_f32_16x16x32_bf16 v[56:59], v[136:139], a[88:91], v[56:59]
    ds_read_b64_tr_b16 v[132:133], v228 offset:51200
    ds_read_b64_tr_b16 v[134:135], v228 offset:51712
    v_mfma_f32_16x16x32_bf16 v[56:59], v[140:143], a[92:95], v[56:59]
    buffer_load_dwordx4 v77, s[40:43], s74 offen offset:1024 lds
    s_waitcnt lgkmcnt(8)
    v_mfma_f32_16x16x32_bf16 v[12:15], v[144:147], a[64:67], v[12:15]
    ds_read_b128 a[112:115], v68 offset:20480
    ds_read_b128 a[116:119], v69 offset:20480
    v_mfma_f32_16x16x32_bf16 v[12:15], v[148:151], a[68:71], v[12:15]
    v_mfma_f32_16x16x32_bf16 v[28:31], v[144:147], a[72:75], v[28:31]
    ds_read_b128 a[120:123], v68 offset:22528
    ds_read_b128 a[124:127], v69 offset:22528
    v_mfma_f32_16x16x32_bf16 v[28:31], v[148:151], a[76:79], v[28:31]
    buffer_load_dwordx4 v78, s[40:43], s74 offen offset:2048 lds
    v_mfma_f32_16x16x32_bf16 v[44:47], v[144:147], a[80:83], v[44:47]
    ds_read_b64_tr_b16 v[136:137], v229 offset:49152
    ds_read_b64_tr_b16 v[138:139], v229 offset:49664
    v_mfma_f32_16x16x32_bf16 v[44:47], v[148:151], a[84:87], v[44:47]
    v_mfma_f32_16x16x32_bf16 v[60:63], v[144:147], a[88:91], v[60:63]
    ds_read_b64_tr_b16 v[140:141], v229 offset:51200
    ds_read_b64_tr_b16 v[142:143], v229 offset:51712
    v_mfma_f32_16x16x32_bf16 v[60:63], v[148:151], a[92:95], v[60:63]
    buffer_load_dwordx4 v79, s[40:43], s74 offen offset:3072 lds
    s_waitcnt lgkmcnt(4)
    v_mfma_f32_16x16x32_bf16 v[0:3], v[128:131], a[96:99], v[0:3]
    ds_read_b64_tr_b16 v[144:145], v228 offset:57344
    v_mfma_f32_16x16x32_bf16 v[0:3], v[132:135], a[100:103], v[0:3]
    v_mfma_f32_16x16x32_bf16 v[16:19], v[128:131], a[104:107], v[16:19]
    ds_read_b64_tr_b16 v[146:147], v228 offset:57856
    s_add_u32 m0, s68, 81920
    s_add_u32 s61, s61, s62
    v_mfma_f32_16x16x32_bf16 v[16:19], v[132:135], a[108:111], v[16:19]
    s_cmp_eq_u32 s61, s101
    s_cselect_b32 s61, s100, s61
    v_mfma_f32_16x16x32_bf16 v[32:35], v[128:131], a[112:115], v[32:35]
    buffer_load_dwordx4 v220, s[32:35], s61 offen offset:0 sc1 lds
    v_mfma_f32_16x16x32_bf16 v[32:35], v[132:135], a[116:119], v[32:35]
    ds_read_b64_tr_b16 v[148:149], v228 offset:59392
    global_load_dwordx3 v[84:86], v116, s[40:41] offset:384
    v_mfma_f32_16x16x32_bf16 v[48:51], v[128:131], a[120:123], v[48:51]
    ds_read_b64_tr_b16 v[150:151], v228 offset:59904
    v_mfma_f32_16x16x32_bf16 v[48:51], v[132:135], a[124:127], v[48:51]
    buffer_load_dwordx4 v221, s[32:35], s61 offen offset:1024 sc1 lds
    s_waitcnt lgkmcnt(4)
    v_mfma_f32_16x16x32_bf16 v[4:7], v[136:139], a[96:99], v[4:7]
    ds_read_b64_tr_b16 v[128:129], v229 offset:57344
    v_mfma_f32_16x16x32_bf16 v[4:7], v[140:143], a[100:103], v[4:7]
    v_mfma_f32_16x16x32_bf16 v[20:23], v[136:139], a[104:107], v[20:23]
    ds_read_b64_tr_b16 v[130:131], v229 offset:57856
    v_mfma_f32_16x16x32_bf16 v[20:23], v[140:143], a[108:111], v[20:23]
    buffer_load_dwordx4 v222, s[32:35], s61 offen offset:2048 sc1 lds
    v_mfma_f32_16x16x32_bf16 v[36:39], v[136:139], a[112:115], v[36:39]
    ds_read_b64_tr_b16 v[132:133], v229 offset:59392
    global_load_dwordx3 v[96:98], v115, s[82:83] offset:384
    v_mfma_f32_16x16x32_bf16 v[36:39], v[140:143], a[116:119], v[36:39]
    v_mfma_f32_16x16x32_bf16 v[52:55], v[136:139], a[120:123], v[52:55]
    ds_read_b64_tr_b16 v[134:135], v229 offset:59904
    v_mfma_f32_16x16x32_bf16 v[52:55], v[140:143], a[124:127], v[52:55]
    buffer_load_dwordx4 v223, s[32:35], s61 offen offset:3072 sc1 lds
    s_waitcnt lgkmcnt(4)
    v_mfma_f32_16x16x32_bf16 v[8:11], v[144:147], a[96:99], v[8:11]
    s_waitcnt vmcnt(20)
    s_barrier
    ds_read_b128 a[128:131], v64 offset:0
    v_mfma_f32_16x16x32_bf16 v[8:11], v[148:151], a[100:103], v[8:11]
    ds_read_b128 a[132:135], v65 offset:0
    v_mfma_f32_16x16x32_bf16 v[24:27], v[144:147], a[104:107], v[24:27]
    ds_read_b128 a[136:139], v64 offset:2048
    ds_read_b128 a[140:143], v65 offset:2048
    s_add_u32 m0, s68, 98304
    v_mfma_f32_16x16x32_bf16 v[24:27], v[148:151], a[108:111], v[24:27]
    s_add_u32 s74, s74, 128
    s_cmp_eq_u32 s74, s85
    s_cselect_b32 s74, s64, s74
    v_mfma_f32_16x16x32_bf16 v[40:43], v[144:147], a[112:115], v[40:43]
    buffer_load_dwordx4 v76, s[40:43], s74 offen offset:0 lds
    ds_read_b64_tr_b16 v[136:137], v224 offset:16384
    v_mfma_f32_16x16x32_bf16 v[40:43], v[148:151], a[116:119], v[40:43]
    ds_read_b64_tr_b16 v[138:139], v224 offset:16896
    v_mfma_f32_16x16x32_bf16 v[56:59], v[144:147], a[120:123], v[56:59]
    ds_read_b64_tr_b16 v[140:141], v224 offset:18432
    ds_read_b64_tr_b16 v[142:143], v224 offset:18944
    v_mfma_f32_16x16x32_bf16 v[56:59], v[148:151], a[124:127], v[56:59]
    buffer_load_dwordx4 v77, s[40:43], s74 offen offset:1024 lds
    s_waitcnt lgkmcnt(8)
    v_mfma_f32_16x16x32_bf16 v[12:15], v[128:131], a[96:99], v[12:15]
    ds_read_b128 a[144:147], v64 offset:4096
    ds_read_b128 a[148:151], v65 offset:4096
    v_mfma_f32_16x16x32_bf16 v[12:15], v[132:135], a[100:103], v[12:15]
    v_mfma_f32_16x16x32_bf16 v[28:31], v[128:131], a[104:107], v[28:31]
    ds_read_b128 a[152:155], v64 offset:6144
    ds_read_b128 a[156:159], v65 offset:6144
    v_mfma_f32_16x16x32_bf16 v[28:31], v[132:135], a[108:111], v[28:31]
    buffer_load_dwordx4 v78, s[40:43], s74 offen offset:2048 lds
    v_mfma_f32_16x16x32_bf16 v[44:47], v[128:131], a[112:115], v[44:47]
    ds_read_b64_tr_b16 v[144:145], v225 offset:16384
    ds_read_b64_tr_b16 v[146:147], v225 offset:16896
    v_mfma_f32_16x16x32_bf16 v[44:47], v[132:135], a[116:119], v[44:47]
    v_mfma_f32_16x16x32_bf16 v[60:63], v[128:131], a[120:123], v[60:63]
    ds_read_b64_tr_b16 v[148:149], v225 offset:18432
    ds_read_b64_tr_b16 v[150:151], v225 offset:18944
    v_mfma_f32_16x16x32_bf16 v[60:63], v[132:135], a[124:127], v[60:63]
    buffer_load_dwordx4 v79, s[40:43], s74 offen offset:3072 lds
    s_waitcnt lgkmcnt(4)
    v_mfma_f32_16x16x32_bf16 v[0:3], v[136:139], a[128:131], v[0:3]
    ds_read_b64_tr_b16 v[128:129], v224 offset:24576
    v_mfma_f32_16x16x32_bf16 v[0:3], v[140:143], a[132:135], v[0:3]
    v_mfma_f32_16x16x32_bf16 v[16:19], v[136:139], a[136:139], v[16:19]
    ds_read_b64_tr_b16 v[130:131], v224 offset:25088
    s_add_u32 m0, s68, 114688
    s_add_u32 s61, s61, s62
    v_mfma_f32_16x16x32_bf16 v[16:19], v[140:143], a[140:143], v[16:19]
    s_cmp_eq_u32 s61, s101
    s_cselect_b32 s61, s100, s61
    v_mfma_f32_16x16x32_bf16 v[32:35], v[136:139], a[144:147], v[32:35]
    buffer_load_dwordx4 v220, s[32:35], s61 offen offset:0 sc1 lds
    v_mfma_f32_16x16x32_bf16 v[32:35], v[140:143], a[148:151], v[32:35]
    ds_read_b64_tr_b16 v[132:133], v224 offset:26624
    global_load_dwordx3 v[88:90], v116, s[40:41] offset:768
    v_mfma_f32_16x16x32_bf16 v[48:51], v[136:139], a[152:155], v[48:51]
    ds_read_b64_tr_b16 v[134:135], v224 offset:27136
    v_mfma_f32_16x16x32_bf16 v[48:51], v[140:143], a[156:159], v[48:51]
    buffer_load_dwordx4 v221, s[32:35], s61 offen offset:1024 sc1 lds
    s_waitcnt lgkmcnt(4)
    v_mfma_f32_16x16x32_bf16 v[4:7], v[144:147], a[128:131], v[4:7]
    ds_read_b64_tr_b16 v[136:137], v225 offset:24576
    v_mfma_f32_16x16x32_bf16 v[4:7], v[148:151], a[132:135], v[4:7]
    v_mfma_f32_16x16x32_bf16 v[20:23], v[144:147], a[136:139], v[20:23]
    ds_read_b64_tr_b16 v[138:139], v225 offset:25088
    v_mfma_f32_16x16x32_bf16 v[20:23], v[148:151], a[140:143], v[20:23]
    buffer_load_dwordx4 v222, s[32:35], s61 offen offset:2048 sc1 lds
    v_mfma_f32_16x16x32_bf16 v[36:39], v[144:147], a[144:147], v[36:39]
    ds_read_b64_tr_b16 v[140:141], v225 offset:26624
    global_load_dwordx3 v[100:102], v115, s[82:83] offset:768
    v_mfma_f32_16x16x32_bf16 v[36:39], v[148:151], a[148:151], v[36:39]
    v_mfma_f32_16x16x32_bf16 v[52:55], v[144:147], a[152:155], v[52:55]
    ds_read_b64_tr_b16 v[142:143], v225 offset:27136
    v_mfma_f32_16x16x32_bf16 v[52:55], v[148:151], a[156:159], v[52:55]
    buffer_load_dwordx4 v223, s[32:35], s61 offen offset:3072 sc1 lds
    s_waitcnt lgkmcnt(4)
    v_mfma_f32_16x16x32_bf16 v[8:11], v[128:131], a[128:131], v[8:11]
    s_waitcnt vmcnt(20)
    s_barrier
    ds_read_b128 a[160:163], v64 offset:32768
    v_mfma_f32_16x16x32_bf16 v[8:11], v[132:135], a[132:135], v[8:11]
    ds_read_b128 a[164:167], v65 offset:32768
    v_mfma_f32_16x16x32_bf16 v[24:27], v[128:131], a[136:139], v[24:27]
    ds_read_b128 a[168:171], v64 offset:34816
    ds_read_b128 a[172:175], v65 offset:34816
    s_add_u32 m0, s68, 131072
    v_mfma_f32_16x16x32_bf16 v[24:27], v[132:135], a[140:143], v[24:27]
    s_add_u32 s74, s74, 128
    s_cmp_eq_u32 s74, s85
    s_cselect_b32 s74, s64, s74
    v_mfma_f32_16x16x32_bf16 v[40:43], v[128:131], a[144:147], v[40:43]
    buffer_load_dwordx4 v76, s[40:43], s74 offen offset:0 lds
    ds_read_b64_tr_b16 v[144:145], v226 offset:0
    v_mfma_f32_16x16x32_bf16 v[40:43], v[132:135], a[148:151], v[40:43]
    ds_read_b64_tr_b16 v[146:147], v226 offset:512
    v_mfma_f32_16x16x32_bf16 v[56:59], v[128:131], a[152:155], v[56:59]
    ds_read_b64_tr_b16 v[148:149], v226 offset:2048
    ds_read_b64_tr_b16 v[150:151], v226 offset:2560
    v_mfma_f32_16x16x32_bf16 v[56:59], v[132:135], a[156:159], v[56:59]
    buffer_load_dwordx4 v77, s[40:43], s74 offen offset:1024 lds
    s_waitcnt lgkmcnt(8)
    v_mfma_f32_16x16x32_bf16 v[12:15], v[136:139], a[128:131], v[12:15]
    ds_read_b128 a[176:179], v64 offset:36864
    ds_read_b128 a[180:183], v65 offset:36864
    v_mfma_f32_16x16x32_bf16 v[12:15], v[140:143], a[132:135], v[12:15]
    v_mfma_f32_16x16x32_bf16 v[28:31], v[136:139], a[136:139], v[28:31]
    ds_read_b128 a[184:187], v64 offset:38912
    ds_read_b128 a[188:191], v65 offset:38912
    v_mfma_f32_16x16x32_bf16 v[28:31], v[140:143], a[140:143], v[28:31]
    buffer_load_dwordx4 v78, s[40:43], s74 offen offset:2048 lds
    v_mfma_f32_16x16x32_bf16 v[44:47], v[136:139], a[144:147], v[44:47]
    ds_read_b64_tr_b16 v[128:129], v227 offset:0
    ds_read_b64_tr_b16 v[130:131], v227 offset:512
    v_mfma_f32_16x16x32_bf16 v[44:47], v[140:143], a[148:151], v[44:47]
    v_mfma_f32_16x16x32_bf16 v[60:63], v[136:139], a[152:155], v[60:63]
    ds_read_b64_tr_b16 v[132:133], v227 offset:2048
    ds_read_b64_tr_b16 v[134:135], v227 offset:2560
    v_mfma_f32_16x16x32_bf16 v[60:63], v[140:143], a[156:159], v[60:63]
    buffer_load_dwordx4 v79, s[40:43], s74 offen offset:3072 lds
    s_waitcnt lgkmcnt(4)
    v_mfma_f32_16x16x32_bf16 v[0:3], v[144:147], a[160:163], v[0:3]
    ds_read_b64_tr_b16 v[136:137], v226 offset:8192
    v_mfma_f32_16x16x32_bf16 v[0:3], v[148:151], a[164:167], v[0:3]
    v_mfma_f32_16x16x32_bf16 v[16:19], v[144:147], a[168:171], v[16:19]
    ds_read_b64_tr_b16 v[138:139], v226 offset:8704
    s_add_u32 m0, s68, 147456
    v_mfma_f32_16x16x32_bf16 v[16:19], v[148:151], a[172:175], v[16:19]
    s_add_u32 s61, s61, s62
    s_cmp_eq_u32 s61, s101
    v_mfma_f32_16x16x32_bf16 v[32:35], v[144:147], a[176:179], v[32:35]
    s_cselect_b32 s61, s100, s61
    v_mfma_f32_16x16x32_bf16 v[32:35], v[148:151], a[180:183], v[32:35]
    buffer_load_dwordx4 v220, s[32:35], s61 offen offset:0 sc1 lds
    ds_read_b64_tr_b16 v[140:141], v226 offset:10240
    v_mfma_f32_16x16x32_bf16 v[48:51], v[144:147], a[184:187], v[48:51]
    ds_read_b64_tr_b16 v[142:143], v226 offset:10752
    v_mfma_f32_16x16x32_bf16 v[48:51], v[148:151], a[188:191], v[48:51]
    buffer_load_dwordx4 v221, s[32:35], s61 offen offset:1024 sc1 lds
    s_waitcnt lgkmcnt(4)
    v_mfma_f32_16x16x32_bf16 v[4:7], v[128:131], a[160:163], v[4:7]
    ds_read_b64_tr_b16 v[144:145], v227 offset:8192
    v_mfma_f32_16x16x32_bf16 v[4:7], v[132:135], a[164:167], v[4:7]
    v_mfma_f32_16x16x32_bf16 v[20:23], v[128:131], a[168:171], v[20:23]
    ds_read_b64_tr_b16 v[146:147], v227 offset:8704
    v_mfma_f32_16x16x32_bf16 v[20:23], v[132:135], a[172:175], v[20:23]
    buffer_load_dwordx4 v222, s[32:35], s61 offen offset:2048 sc1 lds
    v_mfma_f32_16x16x32_bf16 v[36:39], v[128:131], a[176:179], v[36:39]
    ds_read_b64_tr_b16 v[148:149], v227 offset:10240
    buffer_load_dword v114, off, s[96:99], 0 sc1
    v_mfma_f32_16x16x32_bf16 v[36:39], v[132:135], a[180:183], v[36:39]
    v_mfma_f32_16x16x32_bf16 v[52:55], v[128:131], a[184:187], v[52:55]
    ds_read_b64_tr_b16 v[150:151], v227 offset:10752
    buffer_load_dwordx4 v223, s[32:35], s61 offen offset:3072 sc1 lds
    v_mfma_f32_16x16x32_bf16 v[52:55], v[132:135], a[188:191], v[52:55]
    s_mov_b64 s[32:33], s[36:37]
    s_mov_b32 s34, s38
    s_waitcnt lgkmcnt(4)
    v_mfma_f32_16x16x32_bf16 v[8:11], v[136:139], a[160:163], v[8:11]
    s_waitcnt vmcnt(19)
    s_barrier
    ds_read_b128 a[192:195], v66 offset:8192
    v_mfma_f32_16x16x32_bf16 v[8:11], v[140:143], a[164:167], v[8:11]
    ds_read_b128 a[196:199], v67 offset:8192
    s_mov_b32 s62, s63
    v_mov_b32 v220, v231
    v_mfma_f32_16x16x32_bf16 v[24:27], v[136:139], a[168:171], v[24:27]
    s_mov_b32 s100, s88
    s_lshl3_add_u32 s101, s63, s88
    ds_read_b128 a[200:203], v66 offset:10240
    v_mfma_f32_16x16x32_bf16 v[24:27], v[140:143], a[172:175], v[24:27]
    ds_read_b128 a[204:207], v67 offset:10240
    s_add_u32 m0, s68, 0
    s_mov_b32 s61, s101
    v_mfma_f32_16x16x32_bf16 v[40:43], v[136:139], a[176:179], v[40:43]
    buffer_load_dwordx4 v220, s[32:35], s61 offen offset:0 sc1 lds
    ds_read_b64_tr_b16 v[128:129], v226 offset:32768
    v_mfma_f32_16x16x32_bf16 v[40:43], v[140:143], a[180:183], v[40:43]
    ds_read_b64_tr_b16 v[130:131], v226 offset:33280
    v_add_u32 v221, s75, v220
    v_add_u32 v222, s75, v221
    v_mfma_f32_16x16x32_bf16 v[56:59], v[136:139], a[184:187], v[56:59]
    v_add_u32 v223, s75, v222
    ds_read_b64_tr_b16 v[132:133], v226 offset:34816
    ds_read_b64_tr_b16 v[134:135], v226 offset:35328
    v_mfma_f32_16x16x32_bf16 v[56:59], v[140:143], a[188:191], v[56:59]
    buffer_load_dwordx4 v221, s[32:35], s61 offen offset:1024 sc1 lds
    s_waitcnt vmcnt(12)
    s_waitcnt lgkmcnt(8)
    v_mfma_f32_16x16x32_bf16 v[12:15], v[144:147], a[160:163], v[12:15]
    ds_read_b128 a[208:211], v66 offset:12288
    ds_read_b128 a[212:215], v67 offset:12288
    v_mfma_f32_16x16x32_bf16 v[12:15], v[148:151], a[164:167], v[12:15]
    v_mov_b32 v104, 0
    v_mfma_f32_16x16x32_bf16 v[28:31], v[144:147], a[168:171], v[28:31]
    ds_read_b128 a[216:219], v66 offset:14336
    ds_read_b128 a[220:223], v67 offset:14336
    v_mfma_f32_16x16x32_bf16 v[28:31], v[148:151], a[172:175], v[28:31]
    buffer_load_dwordx4 v222, s[32:35], s61 offen offset:2048 sc1 lds
    v_mfma_f32_16x16x32_bf16 v[44:47], v[144:147], a[176:179], v[44:47]
    s_bfe_u32 s76, s66, 0x80018
    s_lshl_b32 s77, s76, 7
    s_add_u32 s88, s77, s69
    v_mfma_f32_16x16x32_bf16 v[44:47], v[148:151], a[180:183], v[44:47]
    ds_read_b64_tr_b16 v[136:137], v227 offset:32768
    ds_read_b64_tr_b16 v[138:139], v227 offset:33280
    v_mfma_f32_16x16x32_bf16 v[60:63], v[144:147], a[184:187], v[60:63]
    ds_read_b64_tr_b16 v[140:141], v227 offset:34816
    ds_read_b64_tr_b16 v[142:143], v227 offset:35328
    v_mfma_f32_16x16x32_bf16 v[60:63], v[148:151], a[188:191], v[60:63]
    buffer_load_dwordx4 v223, s[32:35], s61 offen offset:3072 sc1 lds
    s_waitcnt lgkmcnt(4)
    v_mfma_f32_16x16x32_bf16 v[0:3], v[128:131], a[192:195], v[0:3]
    ds_read_b64_tr_b16 v[144:145], v226 offset:40960
    v_dot2c_f32_bf16 v104, v80, v92
    v_mfma_f32_16x16x32_bf16 v[0:3], v[132:135], a[196:199], v[0:3]
    v_dot2c_f32_bf16 v104, v81, v93
    v_mfma_f32_16x16x32_bf16 v[16:19], v[128:131], a[200:203], v[16:19]
    ds_read_b64_tr_b16 v[146:147], v226 offset:41472
    s_add_u32 m0, s68, 16384
    v_mfma_f32_16x16x32_bf16 v[16:19], v[132:135], a[204:207], v[16:19]
    s_mov_b32 s61, s31
    v_dot2c_f32_bf16 v104, v82, v94
    v_mfma_f32_16x16x32_bf16 v[32:35], v[128:131], a[208:211], v[32:35]
    buffer_load_dwordx4 v220, s[32:35], s61 offen offset:0 sc1 lds
    v_mfma_f32_16x16x32_bf16 v[32:35], v[132:135], a[212:215], v[32:35]
    ds_read_b64_tr_b16 v[148:149], v226 offset:43008
    v_dot2c_f32_bf16 v104, v84, v96
    v_mfma_f32_16x16x32_bf16 v[48:51], v[128:131], a[216:219], v[48:51]
    ds_read_b64_tr_b16 v[150:151], v226 offset:43520
    v_dot2c_f32_bf16 v104, v85, v97
    v_mfma_f32_16x16x32_bf16 v[48:51], v[132:135], a[220:223], v[48:51]
    buffer_load_dwordx4 v221, s[32:35], s61 offen offset:1024 sc1 lds
    s_waitcnt lgkmcnt(4)
    v_mfma_f32_16x16x32_bf16 v[4:7], v[136:139], a[192:195], v[4:7]
    ds_read_b64_tr_b16 v[128:129], v227 offset:40960
    v_dot2c_f32_bf16 v104, v86, v98
    v_mfma_f32_16x16x32_bf16 v[4:7], v[140:143], a[196:199], v[4:7]
    v_mfma_f32_16x16x32_bf16 v[20:23], v[136:139], a[200:203], v[20:23]
    ds_read_b64_tr_b16 v[130:131], v227 offset:41472
    v_mfma_f32_16x16x32_bf16 v[20:23], v[140:143], a[204:207], v[20:23]
    buffer_load_dwordx4 v222, s[32:35], s61 offen offset:2048 sc1 lds
    v_mfma_f32_16x16x32_bf16 v[36:39], v[136:139], a[208:211], v[36:39]
    s_add_u32 s31, s88, s30
    s_lshr_b64 s[66:67], s[66:67], 8
    v_mfma_f32_16x16x32_bf16 v[36:39], v[140:143], a[212:215], v[36:39]
    ds_read_b64_tr_b16 v[132:133], v227 offset:43008
    v_dot2c_f32_bf16 v104, v88, v100
    v_mfma_f32_16x16x32_bf16 v[52:55], v[136:139], a[216:219], v[52:55]
    ds_read_b64_tr_b16 v[134:135], v227 offset:43520
    v_mfma_f32_16x16x32_bf16 v[52:55], v[140:143], a[220:223], v[52:55]
    buffer_load_dwordx4 v223, s[32:35], s61 offen offset:3072 sc1 lds
    s_waitcnt lgkmcnt(4)
    v_mfma_f32_16x16x32_bf16 v[8:11], v[144:147], a[192:195], v[8:11]
    s_waitcnt vmcnt(17)
    s_barrier
    ds_read_b128 a[224:227], v66 offset:40960
    v_mfma_f32_16x16x32_bf16 v[8:11], v[148:151], a[196:199], v[8:11]
    ds_read_b128 a[228:231], v67 offset:40960
    v_dot2c_f32_bf16 v104, v89, v101
    v_mfma_f32_16x16x32_bf16 v[24:27], v[144:147], a[200:203], v[24:27]
    ds_read_b128 a[232:235], v66 offset:43008
    ds_read_b128 a[236:239], v67 offset:43008
    s_add_u32 m0, s68, 32768
    v_mfma_f32_16x16x32_bf16 v[24:27], v[148:151], a[204:207], v[24:27]
    s_add_u32 s61, s61, s62
    s_cmp_eq_u32 s61, s101
    s_cselect_b32 s61, s100, s61
    v_mfma_f32_16x16x32_bf16 v[40:43], v[144:147], a[208:211], v[40:43]
    buffer_load_dwordx4 v220, s[32:35], s61 offen offset:0 sc1 lds
    ds_read_b64_tr_b16 v[136:137], v228 offset:16384
    v_mfma_f32_16x16x32_bf16 v[40:43], v[148:151], a[212:215], v[40:43]
    ds_read_b64_tr_b16 v[138:139], v228 offset:16896
    v_mfma_f32_16x16x32_bf16 v[56:59], v[144:147], a[216:219], v[56:59]
    ds_read_b64_tr_b16 v[140:141], v228 offset:18432
    ds_read_b64_tr_b16 v[142:143], v228 offset:18944
    v_mfma_f32_16x16x32_bf16 v[56:59], v[148:151], a[220:223], v[56:59]
    buffer_load_dwordx4 v221, s[32:35], s61 offen offset:1024 sc1 lds
    s_waitcnt lgkmcnt(8)
    v_mfma_f32_16x16x32_bf16 v[12:15], v[128:131], a[192:195], v[12:15]
    ds_read_b128 a[240:243], v66 offset:45056
    ds_read_b128 a[244:247], v67 offset:45056
    v_mfma_f32_16x16x32_bf16 v[12:15], v[132:135], a[196:199], v[12:15]
    v_mfma_f32_16x16x32_bf16 v[28:31], v[128:131], a[200:203], v[28:31]
    ds_read_b128 a[248:251], v66 offset:47104
    ds_read_b128 a[252:255], v67 offset:47104
    v_mfma_f32_16x16x32_bf16 v[28:31], v[132:135], a[204:207], v[28:31]
    buffer_load_dwordx4 v222, s[32:35], s61 offen offset:2048 sc1 lds
    v_mfma_f32_16x16x32_bf16 v[44:47], v[128:131], a[208:211], v[44:47]
    ds_read_b64_tr_b16 v[144:145], v229 offset:16384
    ds_read_b64_tr_b16 v[146:147], v229 offset:16896
    v_mfma_f32_16x16x32_bf16 v[44:47], v[132:135], a[212:215], v[44:47]
    v_dot2c_f32_bf16 v104, v90, v102
    v_mfma_f32_16x16x32_bf16 v[60:63], v[128:131], a[216:219], v[60:63]
    ds_read_b64_tr_b16 v[148:149], v229 offset:18432
    ds_read_b64_tr_b16 v[150:151], v229 offset:18944
    v_mfma_f32_16x16x32_bf16 v[60:63], v[132:135], a[220:223], v[60:63]
    buffer_load_dwordx4 v223, s[32:35], s61 offen offset:3072 sc1 lds
    s_waitcnt lgkmcnt(4)
    v_mfma_f32_16x16x32_bf16 v[0:3], v[136:139], a[224:227], v[0:3]
    ds_read_b64_tr_b16 v[128:129], v228 offset:24576
    s_add_u32 s79, s88, s94
    v_mfma_f32_16x16x32_bf16 v[0:3], v[140:143], a[228:231], v[0:3]
    v_mfma_f32_16x16x32_bf16 v[16:19], v[136:139], a[232:235], v[16:19]
    ds_read_b64_tr_b16 v[130:131], v228 offset:25088
    v_add_f32_dpp v104, v104, v104 quad_perm:[1,0,3,2] row_mask:0xf bank_mask:0xf
    v_mfma_f32_16x16x32_bf16 v[16:19], v[140:143], a[236:239], v[16:19]
    buffer_load_dword v251, v230, s[32:35], s79 offen
    v_mfma_f32_16x16x32_bf16 v[32:35], v[136:139], a[240:243], v[32:35]
    ds_read_b64_tr_b16 v[132:133], v228 offset:26624
    s_getpc_b64 s[40:41]
L_pc2:
    v_mfma_f32_16x16x32_bf16 v[32:35], v[140:143], a[244:247], v[32:35]
    s_mov_b32 s42, L_codeend-L_pc2
    v_mfma_f32_16x16x32_bf16 v[48:51], v[136:139], a[248:251], v[48:51]
    ds_read_b64_tr_b16 v[134:135], v228 offset:27136
    v_mfma_f32_16x16x32_bf16 v[48:51], v[140:143], a[252:255], v[48:51]
    buffer_load_dword v251, v119, s[40:43], 0 offen
    s_waitcnt lgkmcnt(4)
    v_mfma_f32_16x16x32_bf16 v[4:7], v[144:147], a[224:227], v[4:7]
    ds_read_b64_tr_b16 v[136:137], v229 offset:24576
    v_add_f32_dpp v104, v104, v104 quad_perm:[2,3,0,1] row_mask:0xf bank_mask:0xf
    v_mfma_f32_16x16x32_bf16 v[4:7], v[148:151], a[228:231], v[4:7]
    v_mfma_f32_16x16x32_bf16 v[20:23], v[144:147], a[232:235], v[20:23]
    ds_read_b64_tr_b16 v[138:139], v229 offset:25088
    v_add_f32_dpp v104, v104, v104 row_half_mirror row_mask:0xf bank_mask:0xf
    v_mfma_f32_16x16x32_bf16 v[20:23], v[148:151], a[236:239], v[20:23]
    v_mfma_f32_16x16x32_bf16 v[36:39], v[144:147], a[240:243], v[36:39]
    ds_read_b64_tr_b16 v[140:141], v229 offset:26624
    v_add_f32_dpp v104, v104, v104 row_mirror row_mask:0xf bank_mask:0xf
    v_mfma_f32_16x16x32_bf16 v[36:39], v[148:151], a[244:247], v[36:39]
    v_mov_b32 v105, v104
    v_mfma_f32_16x16x32_bf16 v[52:55], v[144:147], a[248:251], v[52:55]
    ds_read_b64_tr_b16 v[142:143], v229 offset:27136
    v_mfma_f32_16x16x32_bf16 v[52:55], v[148:151], a[252:255], v[52:55]
    s_waitcnt lgkmcnt(4)
    v_mfma_f32_16x16x32_bf16 v[8:11], v[128:131], a[224:227], v[8:11]
    s_waitcnt vmcnt(14)
    s_barrier
    v_mfma_f32_16x16x32_bf16 v[8:11], v[132:135], a[228:231], v[8:11]
    ds_read_b128 v[152:155], v68 offset:16384
    ds_read_b128 v[156:159], v69 offset:16384
    v_mfma_f32_16x16x32_bf16 v[24:27], v[128:131], a[232:235], v[24:27]
    ds_read_b128 v[160:163], v68 offset:18432
    v_mfma_f32_16x16x32_bf16 v[24:27], v[132:135], a[236:239], v[24:27]
    ds_read_b128 v[164:167], v69 offset:18432
    v_mfma_f32_16x16x32_bf16 v[40:43], v[128:131], a[240:243], v[40:43]
    ds_read_b64_tr_b16 v[144:145], v228 offset:49152
    v_mfma_f32_16x16x32_bf16 v[40:43], v[132:135], a[244:247], v[40:43]
    ds_read_b64_tr_b16 v[146:147], v228 offset:49664
    v_mfma_f32_16x16x32_bf16 v[56:59], v[128:131], a[248:251], v[56:59]
    ds_read_b64_tr_b16 v[148:149], v228 offset:51200
    v_mfma_f32_16x16x32_bf16 v[56:59], v[132:135], a[252:255], v[56:59]
    ds_read_b64_tr_b16 v[150:151], v228 offset:51712
    s_waitcnt lgkmcnt(8)
    v_mfma_f32_16x16x32_bf16 v[12:15], v[136:139], a[224:227], v[12:15]
    ds_read_b128 v[168:171], v68 offset:20480
    v_mfma_f32_16x16x32_bf16 v[12:15], v[140:143], a[228:231], v[12:15]
    ds_read_b128 v[172:175], v69 offset:20480
    v_mfma_f32_16x16x32_bf16 v[28:31], v[136:139], a[232:235], v[28:31]
    ds_read_b128 v[176:179], v68 offset:22528
    v_mfma_f32_16x16x32_bf16 v[28:31], v[140:143], a[236:239], v[28:31]
    ds_read_b128 v[180:183], v69 offset:22528
    v_mfma_f32_16x16x32_bf16 v[44:47], v[136:139], a[240:243], v[44:47]
    ds_read_b64_tr_b16 v[128:129], v229 offset:49152
    v_mfma_f32_16x16x32_bf16 v[44:47], v[140:143], a[244:247], v[44:47]
    ds_read_b64_tr_b16 v[130:131], v229 offset:49664
    v_mfma_f32_16x16x32_bf16 v[60:63], v[136:139], a[248:251], v[60:63]
    ds_read_b64_tr_b16 v[132:133], v229 offset:51200
    v_mfma_f32_16x16x32_bf16 v[60:63], v[140:143], a[252:255], v[60:63]
    ds_read_b64_tr_b16 v[134:135], v229 offset:51712
    s_waitcnt lgkmcnt(4)
    v_mfma_f32_16x16x32_bf16 v[0:3], v[144:147], v[152:155], v[0:3]
    ds_read_b64_tr_b16 v[136:137], v228 offset:57344
    v_mfma_f32_16x16x32_bf16 v[0:3], v[148:151], v[156:159], v[0:3]
    v_permlane16_swap_b32 v104, v105
    v_mfma_f32_16x16x32_bf16 v[16:19], v[144:147], v[160:163], v[16:19]
    ds_read_b64_tr_b16 v[138:139], v228 offset:57856
    v_add_f32 v104, v104, v105
    v_mfma_f32_16x16x32_bf16 v[16:19], v[148:151], v[164:167], v[16:19]
    v_mul_f32 v104, 0xbfb8aa3b, v104
    v_mfma_f32_16x16x32_bf16 v[32:35], v[144:147], v[168:171], v[32:35]
    ds_read_b64_tr_b16 v[140:141], v228 offset:59392
    v_mfma_f32_16x16x32_bf16 v[32:35], v[148:151], v[172:175], v[32:35]
    v_exp_f32 v104, v104
    v_mfma_f32_16x16x32_bf16 v[48:51], v[144:147], v[176:179], v[48:51]
    ds_read_b64_tr_b16 v[142:143], v228 offset:59904
    v_add_f32 v104, 1.0, v104
    v_mfma_f32_16x16x32_bf16 v[48:51], v[148:151], v[180:183], v[48:51]
    s_waitcnt lgkmcnt(4)
    v_mfma_f32_16x16x32_bf16 v[4:7], v[128:131], v[152:155], v[4:7]
    ds_read_b64_tr_b16 v[144:145], v229 offset:57344
    v_mfma_f32_16x16x32_bf16 v[4:7], v[132:135], v[156:159], v[4:7]
    v_rcp_f32 v104, v104
    v_mfma_f32_16x16x32_bf16 v[20:23], v[128:131], v[160:163], v[20:23]
    ds_read_b64_tr_b16 v[146:147], v229 offset:57856
    v_mfma_f32_16x16x32_bf16 v[20:23], v[132:135], v[164:167], v[20:23]
    buffer_store_dword v104, v106, s[44:47], 0 offen sc1
    v_mfma_f32_16x16x32_bf16 v[36:39], v[128:131], v[168:171], v[36:39]
    ds_read_b64_tr_b16 v[148:149], v229 offset:59392
    v_mfma_f32_16x16x32_bf16 v[36:39], v[132:135], v[172:175], v[36:39]
    v_mfma_f32_16x16x32_bf16 v[52:55], v[128:131], v[176:179], v[52:55]
    ds_read_b64_tr_b16 v[150:151], v229 offset:59904
    v_mfma_f32_16x16x32_bf16 v[52:55], v[132:135], v[180:183], v[52:55]
    s_waitcnt lgkmcnt(4)
    v_mfma_f32_16x16x32_bf16 v[8:11], v[136:139], v[152:155], v[8:11]
    s_waitcnt vmcnt(3)
    s_barrier
    v_mfma_f32_16x16x32_bf16 v[8:11], v[140:143], v[156:159], v[8:11]
    ds_read_b64_tr_b16 v[128:129], v224 offset:0
    v_mfma_f32_16x16x32_bf16 v[24:27], v[136:139], v[160:163], v[24:27]
    ds_read_b64_tr_b16 v[130:131], v224 offset:512
    s_add_u32 m0, s68, 131072
    v_mfma_f32_16x16x32_bf16 v[24:27], v[140:143], v[164:167], v[24:27]
    s_nop 0
    v_mfma_f32_16x16x32_bf16 v[40:43], v[136:139], v[168:171], v[40:43]
    buffer_load_dwordx4 v235, s[52:55], s70 offen offset:0 nt lds
    v_mfma_f32_16x16x32_bf16 v[40:43], v[140:143], v[172:175], v[40:43]
    ds_read_b64_tr_b16 v[132:133], v224 offset:2048
    v_mfma_f32_16x16x32_bf16 v[56:59], v[136:139], v[176:179], v[56:59]
    ds_read_b64_tr_b16 v[134:135], v224 offset:2560
    v_mfma_f32_16x16x32_bf16 v[56:59], v[140:143], v[180:183], v[56:59]
    buffer_load_dwordx4 v235, s[52:55], s71 offen offset:1024 nt lds
    s_waitcnt lgkmcnt(4)
    v_mfma_f32_16x16x32_bf16 v[12:15], v[144:147], v[152:155], v[12:15]
    ds_read_b64_tr_b16 v[136:137], v225 offset:0
    v_mfma_f32_16x16x32_bf16 v[12:15], v[148:151], v[156:159], v[12:15]
    v_mfma_f32_16x16x32_bf16 v[28:31], v[144:147], v[160:163], v[28:31]
    ds_read_b64_tr_b16 v[138:139], v225 offset:512
    v_cmp_eq_u32 vcc, 0, v114
    v_mfma_f32_16x16x32_bf16 v[28:31], v[148:151], v[164:167], v[28:31]
    v_mfma_f32_16x16x32_bf16 v[44:47], v[144:147], v[168:171], v[44:47]
    ds_read_b64_tr_b16 v[140:141], v225 offset:2048
    s_cbranch_vccnz L_inispin
L_iniok:
    v_mfma_f32_16x16x32_bf16 v[44:47], v[148:151], v[172:175], v[44:47]
    v_mfma_f32_16x16x32_bf16 v[60:63], v[144:147], v[176:179], v[60:63]
    ds_read_b64_tr_b16 v[142:143], v225 offset:2560
    v_mfma_f32_16x16x32_bf16 v[60:63], v[148:151], v[180:183], v[60:63]
    s_cmp_eq_u32 s86, 0
    s_cbranch_scc0 L_sp1
L_b1:
    s_waitcnt lgkmcnt(4)
    v_mfma_f32_16x16x32_bf16 v[64:67], v[128:131], a[0:3], 0
    ds_read_b64_tr_b16 v[144:145], v224 offset:8192
    s_and_b32 s78, s66, 0xff
    v_mfma_f32_16x16x32_bf16 v[64:67], v[132:135], a[4:7], v[64:67]
    s_lshl_b32 s78, s78, 13
    s_add_u32 s64, s65, s78
    v_mfma_f32_16x16x32_bf16 v[80:83], v[128:131], a[8:11], 0
    ds_read_b64_tr_b16 v[146:147], v224 offset:8704
    s_add_u32 m0, s68, 49152
    v_mfma_f32_16x16x32_bf16 v[80:83], v[132:135], a[12:15], v[80:83]
    s_add_u32 s61, s61, s62
    s_cmp_eq_u32 s61, s101
    v_mfma_f32_16x16x32_bf16 v[96:99], v[128:131], a[16:19], 0
    s_cselect_b32 s61, s100, s61
    ds_read_b64_tr_b16 v[148:149], v224 offset:10240
    v_mfma_f32_16x16x32_bf16 v[96:99], v[132:135], a[20:23], v[96:99]
    buffer_load_dwordx4 v220, s[32:35], s61 offen offset:0 sc1 lds
    v_mfma_f32_16x16x32_bf16 v[112:115], v[128:131], a[24:27], 0
    ds_read_b64_tr_b16 v[150:151], v224 offset:10752
    v_mfma_f32_16x16x32_bf16 v[112:115], v[132:135], a[28:31], v[112:115]
    s_waitcnt lgkmcnt(4)
    v_mfma_f32_16x16x32_bf16 v[68:71], v[136:139], a[0:3], 0
    ds_read_b64_tr_b16 v[128:129], v225 offset:8192
    v_mul_f32 v184, v0, v0
    v_mfma_f32_16x16x32_bf16 v[68:71], v[140:143], a[4:7], v[68:71]
    buffer_load_dwordx4 v221, s[32:35], s61 offen offset:1024 sc1 lds
    v_mfma_f32_16x16x32_bf16 v[84:87], v[136:139], a[8:11], 0
    ds_read_b64_tr_b16 v[130:131], v225 offset:8704
    v_mul_f32 v185, v1, v1
    v_mfma_f32_16x16x32_bf16 v[84:87], v[140:143], a[12:15], v[84:87]
    v_mul_f32 v186, v2, v2
    v_mul_f32 v187, v3, v3
    v_mfma_f32_16x16x32_bf16 v[100:103], v[136:139], a[16:19], 0
    ds_read_b64_tr_b16 v[132:133], v225 offset:10240
    v_mul_f32 v188, v4, v4
    v_mfma_f32_16x16x32_bf16 v[100:103], v[140:143], a[20:23], v[100:103]
    buffer_load_dwordx4 v222, s[32:35], s61 offen offset:2048 sc1 lds
    v_mfma_f32_16x16x32_bf16 v[116:119], v[136:139], a[24:27], 0
    ds_read_b64_tr_b16 v[134:135], v225 offset:10752
    v_mul_f32 v189, v5, v5
    v_mul_f32 v190, v6, v6
    v_mfma_f32_16x16x32_bf16 v[116:119], v[140:143], a[28:31], v[116:119]
    v_mul_f32 v191, v7, v7
    s_waitcnt lgkmcnt(4)
    v_mfma_f32_16x16x32_bf16 v[72:75], v[144:147], a[0:3], 0
    ds_read_b64_tr_b16 v[136:137], v224 offset:16384
    v_fma_f32 v184, v184, s89, v234
    v_mfma_f32_16x16x32_bf16 v[72:75], v[148:151], a[4:7], v[72:75]
    v_fma_f32 v185, v185, s89, v234
    v_fma_f32 v186, v186, s89, v234
    v_mfma_f32_16x16x32_bf16 v[88:91], v[144:147], a[8:11], 0
    ds_read_b64_tr_b16 v[138:139], v224 offset:16896
    v_fma_f32 v187, v187, s89, v234
    v_mfma_f32_16x16x32_bf16 v[88:91], v[148:151], a[12:15], v[88:91]
    v_fma_f32 v188, v188, s89, v234
    v_fma_f32 v189, v189, s89, v234
    v_mfma_f32_16x16x32_bf16 v[104:107], v[144:147], a[16:19], 0
    ds_read_b64_tr_b16 v[140:141], v224 offset:18432
    buffer_load_dwordx4 v223, s[32:35], s61 offen offset:3072 sc1 lds
    v_mfma_f32_16x16x32_bf16 v[104:107], v[148:151], a[20:23], v[104:107]
    v_fma_f32 v190, v190, s89, v234
    v_fma_f32 v191, v191, s89, v234
    v_mfma_f32_16x16x32_bf16 v[120:123], v[144:147], a[24:27], 0
    ds_read_b64_tr_b16 v[142:143], v224 offset:18944
    s_add_u32 m0, s68, 65536
    s_add_u32 s61, s61, s62
    v_mfma_f32_16x16x32_bf16 v[120:123], v[148:151], a[28:31], v[120:123]
    s_cmp_eq_u32 s61, s101
    s_cselect_b32 s61, s100, s61
    s_waitcnt lgkmcnt(4)
    v_mfma_f32_16x16x32_bf16 v[76:79], v[128:131], a[0:3], 0
    ds_read_b64_tr_b16 v[144:145], v225 offset:16384
    v_mul_f32 v184, v184, v0
    v_mfma_f32_16x16x32_bf16 v[76:79], v[132:135], a[4:7], v[76:79]
    buffer_load_dwordx4 v220, s[32:35], s61 offen offset:0 sc1 lds
    v_mfma_f32_16x16x32_bf16 v[92:95], v[128:131], a[8:11], 0
    ds_read_b64_tr_b16 v[146:147], v225 offset:16896
    v_exp_f32 v184, v184
    v_mfma_f32_16x16x32_bf16 v[92:95], v[132:135], a[12:15], v[92:95]
    v_mul_f32 v185, v185, v1
    v_mul_f32 v186, v186, v2
    v_mul_f32 v187, v187, v3
    v_mfma_f32_16x16x32_bf16 v[108:111], v[128:131], a[16:19], 0
    ds_read_b64_tr_b16 v[148:149], v225 offset:18432
    v_mul_f32 v188, v188, v4
    v_mfma_f32_16x16x32_bf16 v[108:111], v[132:135], a[20:23], v[108:111]
    buffer_load_dwordx4 v221, s[32:35], s61 offen offset:1024 sc1 lds
    v_mfma_f32_16x16x32_bf16 v[124:127], v[128:131], a[24:27], 0
    ds_read_b64_tr_b16 v[150:151], v225 offset:18944
    v_mul_f32 v189, v189, v5
    v_mfma_f32_16x16x32_bf16 v[124:127], v[132:135], a[28:31], v[124:127]
    v_exp_f32 v185, v185
    s_waitcnt lgkmcnt(4)
    v_mfma_f32_16x16x32_bf16 v[64:67], v[136:139], a[32:35], v[64:67]
    ds_read_b64_tr_b16 v[128:129], v224 offset:24576
    v_mul_f32 v190, v190, v6
    v_mfma_f32_16x16x32_bf16 v[64:67], v[140:143], a[36:39], v[64:67]
    v_exp_f32 v186, v186
    v_mul_f32 v191, v191, v7
    v_mfma_f32_16x16x32_bf16 v[80:83], v[136:139], a[40:43], v[80:83]
    ds_read_b64_tr_b16 v[130:131], v224 offset:25088
    v_mul_f32 v0, v0, v8
    v_mfma_f32_16x16x32_bf16 v[80:83], v[140:143], a[44:47], v[80:83]
    v_exp_f32 v187, v187
    v_mfma_f32_16x16x32_bf16 v[96:99], v[136:139], a[48:51], v[96:99]
    ds_read_b64_tr_b16 v[132:133], v224 offset:26624
    v_mul_f32 v1, v1, v9
    v_mfma_f32_16x16x32_bf16 v[96:99], v[140:143], a[52:55], v[96:99]
    buffer_load_dwordx4 v222, s[32:35], s61 offen offset:2048 sc1 lds
    v_mul_f32 v2, v2, v10
    v_mfma_f32_16x16x32_bf16 v[112:115], v[136:139], a[56:59], v[112:115]
    ds_read_b64_tr_b16 v[134:135], v224 offset:27136
    v_exp_f32 v188, v188
    v_mfma_f32_16x16x32_bf16 v[112:115], v[140:143], a[60:63], v[112:115]
    v_exp_f32 v189, v189
    s_waitcnt lgkmcnt(4)
    v_mfma_f32_16x16x32_bf16 v[68:71], v[144:147], a[32:35], v[68:71]
    ds_read_b64_tr_b16 v[136:137], v225 offset:24576
    v_mul_f32 v3, v3, v11
    v_mfma_f32_16x16x32_bf16 v[68:71], v[148:151], a[36:39], v[68:71]
    buffer_load_dwordx4 v223, s[32:35], s61 offen offset:3072 sc1 lds
    v_mfma_f32_16x16x32_bf16 v[84:87], v[144:147], a[40:43], v[84:87]
    ds_read_b64_tr_b16 v[138:139], v225 offset:25088
    s_add_u32 m0, s68, 81920
    v_mfma_f32_16x16x32_bf16 v[84:87], v[148:151], a[44:47], v[84:87]
    s_add_u32 s61, s61, s62
    s_cmp_eq_u32 s61, s101
    v_mfma_f32_16x16x32_bf16 v[100:103], v[144:147], a[48:51], v[100:103]
    s_cselect_b32 s61, s100, s61
    ds_read_b64_tr_b16 v[140:141], v225 offset:26624
    v_mul_f32 v4, v4, v12
    v_mfma_f32_16x16x32_bf16 v[100:103], v[148:151], a[52:55], v[100:103]
    buffer_load_dwordx4 v220, s[32:35], s61 offen offset:0 sc1 lds
    v_mfma_f32_16x16x32_bf16 v[116:119], v[144:147], a[56:59], v[116:119]
    ds_read_b64_tr_b16 v[142:143], v225 offset:27136
    v_exp_f32 v190, v190
    v_mfma_f32_16x16x32_bf16 v[116:119], v[148:151], a[60:63], v[116:119]
    v_mul_f32 v5, v5, v13
    s_waitcnt lgkmcnt(4)
    v_mfma_f32_16x16x32_bf16 v[72:75], v[128:131], a[32:35], v[72:75]
    ds_read_b64_tr_b16 v[144:145], v224 offset:32768
    v_mul_f32 v6, v6, v14
    v_mfma_f32_16x16x32_bf16 v[72:75], v[132:135], a[36:39], v[72:75]
    v_exp_f32 v191, v191
    v_mul_f32 v7, v7, v15
    v_mfma_f32_16x16x32_bf16 v[88:91], v[128:131], a[40:43], v[88:91]
    ds_read_b64_tr_b16 v[146:147], v224 offset:33280
    v_add_f32 v184, 1.0, v184
    v_mfma_f32_16x16x32_bf16 v[88:91], v[132:135], a[44:47], v[88:91]
    v_rcp_f32 v184, v184
    v_mfma_f32_16x16x32_bf16 v[104:107], v[128:131], a[48:51], v[104:107]
    ds_read_b64_tr_b16 v[148:149], v224 offset:34816
    v_add_f32 v185, 1.0, v185
    v_mfma_f32_16x16x32_bf16 v[104:107], v[132:135], a[52:55], v[104:107]
    buffer_load_dwordx4 v221, s[32:35], s61 offen offset:1024 sc1 lds
    v_add_f32 v186, 1.0, v186
    v_mfma_f32_16x16x32_bf16 v[120:123], v[128:131], a[56:59], v[120:123]
    ds_read_b64_tr_b16 v[150:151], v224 offset:35328
    v_rcp_f32 v185, v185
    v_mfma_f32_16x16x32_bf16 v[120:123], v[132:135], a[60:63], v[120:123]
    v_rcp_f32 v186, v186
    s_waitcnt lgkmcnt(4)
    v_mfma_f32_16x16x32_bf16 v[76:79], v[136:139], a[32:35], v[76:79]
    ds_read_b64_tr_b16 v[128:129], v225 offset:32768
    v_add_f32 v187, 1.0, v187
    v_mfma_f32_16x16x32_bf16 v[76:79], v[140:143], a[36:39], v[76:79]
    buffer_load_dwordx4 v222, s[32:35], s61 offen offset:2048 sc1 lds
    v_add_f32 v188, 1.0, v188
    v_mfma_f32_16x16x32_bf16 v[92:95], v[136:139], a[40:43], v[92:95]
    ds_read_b64_tr_b16 v[130:131], v225 offset:33280
    v_rcp_f32 v187, v187
    v_mfma_f32_16x16x32_bf16 v[92:95], v[140:143], a[44:47], v[92:95]
    v_rcp_f32 v188, v188
    v_mfma_f32_16x16x32_bf16 v[108:111], v[136:139], a[48:51], v[108:111]
    ds_read_b64_tr_b16 v[132:133], v225 offset:34816
    v_add_f32 v189, 1.0, v189
    v_mfma_f32_16x16x32_bf16 v[108:111], v[140:143], a[52:55], v[108:111]
    buffer_load_dwordx4 v223, s[32:35], s61 offen offset:3072 sc1 lds
    v_mfma_f32_16x16x32_bf16 v[124:127], v[136:139], a[56:59], v[124:127]
    ds_read_b64_tr_b16 v[134:135], v225 offset:35328
    v_rcp_f32 v189, v189
    v_mfma_f32_16x16x32_bf16 v[124:127], v[140:143], a[60:63], v[124:127]
    v_add_f32 v190, 1.0, v190
    s_waitcnt lgkmcnt(4)
    v_mfma_f32_16x16x32_bf16 v[64:67], v[144:147], a[64:67], v[64:67]
    ds_read_b64_tr_b16 v[136:137], v224 offset:40960
    v_add_f32 v191, 1.0, v191
    v_mfma_f32_16x16x32_bf16 v[64:67], v[148:151], a[68:71], v[64:67]
    v_rcp_f32 v190, v190
    v_mfma_f32_16x16x32_bf16 v[80:83], v[144:147], a[72:75], v[80:83]
    ds_read_b64_tr_b16 v[138:139], v224 offset:41472
    s_add_u32 m0, s68, 98304
    v_mfma_f32_16x16x32_bf16 v[80:83], v[148:151], a[76:79], v[80:83]
    s_add_u32 s61, s61, s62
    s_cmp_eq_u32 s61, s101
    v_mfma_f32_16x16x32_bf16 v[96:99], v[144:147], a[80:83], v[96:99]
    s_cselect_b32 s61, s100, s61
    ds_read_b64_tr_b16 v[140:141], v224 offset:43008
    v_mul_f32 v0, v0, v184
    v_mfma_f32_16x16x32_bf16 v[96:99], v[148:151], a[84:87], v[96:99]
    buffer_load_dwordx4 v220, s[32:35], s61 offen offset:0 sc1 lds
    v_mul_f32 v1, v1, v185
    v_mfma_f32_16x16x32_bf16 v[112:115], v[144:147], a[88:91], v[112:115]
    ds_read_b64_tr_b16 v[142:143], v224 offset:43520
    v_rcp_f32 v191, v191
    v_mfma_f32_16x16x32_bf16 v[112:115], v[148:151], a[92:95], v[112:115]
    v_mul_f32 v2, v2, v186
    s_waitcnt lgkmcnt(4)
    v_mfma_f32_16x16x32_bf16 v[68:71], v[128:131], a[64:67], v[68:71]
    ds_read_b64_tr_b16 v[144:145], v225 offset:40960
    v_mul_f32 v3, v3, v187
    v_mfma_f32_16x16x32_bf16 v[68:71], v[132:135], a[68:71], v[68:71]
    buffer_load_dwordx4 v221, s[32:35], s61 offen offset:1024 sc1 lds
    v_mfma_f32_16x16x32_bf16 v[84:87], v[128:131], a[72:75], v[84:87]
    ds_read_b64_tr_b16 v[146:147], v225 offset:41472
    v_mul_f32 v4, v4, v188
    v_mul_f32 v5, v5, v189
    v_mfma_f32_16x16x32_bf16 v[84:87], v[132:135], a[76:79], v[84:87]
    v_mul_f32 v6, v6, v190
    v_mul_f32 v7, v7, v191
    v_cvt_pk_bf16_f32 v200, v0, v1
    v_mfma_f32_16x16x32_bf16 v[100:103], v[128:131], a[80:83], v[100:103]
    ds_read_b64_tr_b16 v[148:149], v225 offset:43008
    v_cvt_pk_bf16_f32 v202, v4, v5
    v_mfma_f32_16x16x32_bf16 v[100:103], v[132:135], a[84:87], v[100:103]
    buffer_load_dwordx4 v222, s[32:35], s61 offen offset:2048 sc1 lds
    v_mfma_f32_16x16x32_bf16 v[116:119], v[128:131], a[88:91], v[116:119]
    ds_read_b64_tr_b16 v[150:151], v225 offset:43520
    v_permlane16_swap_b32 v200, v202
    v_mfma_f32_16x16x32_bf16 v[116:119], v[132:135], a[92:95], v[116:119]
    v_cvt_pk_bf16_f32 v201, v2, v3
    s_waitcnt lgkmcnt(4)
    v_mfma_f32_16x16x32_bf16 v[72:75], v[136:139], a[64:67], v[72:75]
    s_waitcnt vmcnt(7)
    s_barrier
    v_mfma_f32_16x16x32_bf16 v[72:75], v[140:143], a[68:71], v[72:75]
    v_cvt_pk_bf16_f32 v203, v6, v7
    v_mul_f32 v184, v16, v16
    v_mfma_f32_16x16x32_bf16 v[88:91], v[136:139], a[72:75], v[88:91]
    ds_read_b64_tr_b16 v[128:129], v226 offset:0
    ds_read_b64_tr_b16 v[130:131], v226 offset:512
    ds_read_b64_tr_b16 v[208:209], v236 offset:0
    v_mfma_f32_16x16x32_bf16 v[88:91], v[140:143], a[76:79], v[88:91]
    v_permlane16_swap_b32 v201, v203
    v_mfma_f32_16x16x32_bf16 v[104:107], v[136:139], a[80:83], v[104:107]
    ds_read_b64_tr_b16 v[132:133], v226 offset:2048
    buffer_load_dwordx4 v223, s[32:35], s61 offen offset:3072 sc1 lds
    v_mfma_f32_16x16x32_bf16 v[104:107], v[140:143], a[84:87], v[104:107]
    ds_read_b64_tr_b16 v[210:211], v236 offset:512
    v_mul_f32 v185, v17, v17
    v_mfma_f32_16x16x32_bf16 v[120:123], v[136:139], a[88:91], v[120:123]
    ds_read_b64_tr_b16 v[134:135], v226 offset:2560
    s_add_u32 m0, s68, 114688
    s_add_u32 s61, s61, s62
    v_mfma_f32_16x16x32_bf16 v[120:123], v[140:143], a[92:95], v[120:123]
    s_cmp_eq_u32 s61, s101
    s_cselect_b32 s61, s100, s61
    ds_read_b64_tr_b16 v[212:213], v236 offset:64
    ds_read_b64_tr_b16 v[214:215], v236 offset:576
    s_waitcnt lgkmcnt(8)
    v_mfma_f32_16x16x32_bf16 v[76:79], v[144:147], a[64:67], v[76:79]
    ds_read_b64_tr_b16 v[136:137], v227 offset:0
    v_mul_f32 v186, v18, v18
    v_mfma_f32_16x16x32_bf16 v[76:79], v[148:151], a[68:71], v[76:79]
    buffer_load_dwordx4 v220, s[32:35], s61 offen offset:0 sc1 lds
    v_mfma_f32_16x16x32_bf16 v[92:95], v[144:147], a[72:75], v[92:95]
    ds_read_b64_tr_b16 v[138:139], v227 offset:512
    v_mul_f32 v187, v19, v19
    v_mfma_f32_16x16x32_bf16 v[92:95], v[148:151], a[76:79], v[92:95]
    buffer_store_dwordx4 v[200:203], v254, s[48:51], s64 offen offset:0 sc1
    v_mfma_f32_16x16x32_bf16 v[108:111], v[144:147], a[80:83], v[108:111]
    ds_read_b64_tr_b16 v[140:141], v227 offset:2048
    v_mul_f32 v188, v20, v20
    v_mfma_f32_16x16x32_bf16 v[108:111], v[148:151], a[84:87], v[108:111]
    buffer_load_dwordx4 v221, s[32:35], s61 offen offset:1024 sc1 lds
    v_mfma_f32_16x16x32_bf16 v[124:127], v[144:147], a[88:91], v[124:127]
    ds_read_b64_tr_b16 v[142:143], v227 offset:2560
    v_mul_f32 v189, v21, v21
    v_mfma_f32_16x16x32_bf16 v[124:127], v[148:151], a[92:95], v[124:127]
    v_mul_f32 v190, v22, v22
    s_waitcnt lgkmcnt(6)
    v_mfma_f32_16x16x32_bf16 v[64:67], v[128:131], a[96:99], v[64:67]
    ds_read_b64_tr_b16 v[144:145], v226 offset:8192
    v_mul_f32 v191, v23, v23
    v_mfma_f32_16x16x32_bf16 v[64:67], v[132:135], a[100:103], v[64:67]
    v_fma_f32 v184, v184, s89, v234
    v_fma_f32 v185, v185, s89, v234
    v_mfma_f32_16x16x32_bf16 v[80:83], v[128:131], a[104:107], v[80:83]
    ds_read_b64_tr_b16 v[146:147], v226 offset:8704
    v_fma_f32 v186, v186, s89, v234
    v_mfma_f32_16x16x32_bf16 v[80:83], v[132:135], a[108:111], v[80:83]
    v_fma_f32 v187, v187, s89, v234
    v_fma_f32 v188, v188, s89, v234
    v_mfma_f32_16x16x32_bf16 v[96:99], v[128:131], a[112:115], v[96:99]
    ds_read_b64_tr_b16 v[148:149], v226 offset:10240
    v_fma_f32 v189, v189, s89, v234
    v_mfma_f32_16x16x32_bf16 v[96:99], v[132:135], a[116:119], v[96:99]
    buffer_load_dwordx4 v222, s[32:35], s61 offen offset:2048 sc1 lds
    v_fma_f32 v190, v190, s89, v234
    v_mfma_f32_16x16x32_bf16 v[112:115], v[128:131], a[120:123], v[112:115]
    ds_read_b64_tr_b16 v[150:151], v226 offset:10752
    v_fma_f32 v191, v191, s89, v234
    v_mul_f32 v184, v184, v16
    v_mfma_f32_16x16x32_bf16 v[112:115], v[132:135], a[124:127], v[112:115]
    v_exp_f32 v184, v184
    s_waitcnt lgkmcnt(4)
    v_mfma_f32_16x16x32_bf16 v[68:71], v[136:139], a[96:99], v[68:71]
    ds_read_b64_tr_b16 v[128:129], v227 offset:8192
    v_mul_f32 v185, v185, v17
    v_mfma_f32_16x16x32_bf16 v[68:71], v[140:143], a[100:103], v[68:71]
    buffer_load_dwordx4 v223, s[32:35], s61 offen offset:3072 sc1 lds
    v_mfma_f32_16x16x32_bf16 v[84:87], v[136:139], a[104:107], v[84:87]
    ds_read_b64_tr_b16 v[130:131], v227 offset:8704
    s_add_u32 m0, s68, 131072
    v_mfma_f32_16x16x32_bf16 v[84:87], v[140:143], a[108:111], v[84:87]
    s_add_u32 s61, s61, s62
    s_cmp_eq_u32 s61, s101
    v_mfma_f32_16x16x32_bf16 v[100:103], v[136:139], a[112:115], v[100:103]
    s_cselect_b32 s61, s100, s61
    ds_read_b64_tr_b16 v[132:133], v227 offset:10240
    v_mul_f32 v186, v186, v18
    v_mfma_f32_16x16x32_bf16 v[100:103], v[140:143], a[116:119], v[100:103]
    buffer_load_dwordx4 v220, s[32:35], s61 offen offset:0 sc1 lds
    v_mfma_f32_16x16x32_bf16 v[116:119], v[136:139], a[120:123], v[116:119]
    ds_read_b64_tr_b16 v[134:135], v227 offset:10752
    v_exp_f32 v185, v185
    v_mfma_f32_16x16x32_bf16 v[116:119], v[140:143], a[124:127], v[116:119]
    v_mul_f32 v187, v187, v19
    s_waitcnt lgkmcnt(4)
    v_mfma_f32_16x16x32_bf16 v[72:75], v[144:147], a[96:99], v[72:75]
    ds_read_b64_tr_b16 v[136:137], v226 offset:16384
    v_mul_f32 v188, v188, v20
    v_mfma_f32_16x16x32_bf16 v[72:75], v[148:151], a[100:103], v[72:75]
    buffer_store_dwordx4 v[208:211], v233, s[56:59], s72 offen offset:0 sc1
    v_mfma_f32_16x16x32_bf16 v[88:91], v[144:147], a[104:107], v[88:91]
    ds_read_b64_tr_b16 v[138:139], v226 offset:16896
    v_exp_f32 v186, v186
    v_mfma_f32_16x16x32_bf16 v[88:91], v[148:151], a[108:111], v[88:91]
    v_exp_f32 v187, v187
    v_mul_f32 v189, v189, v21
    v_mfma_f32_16x16x32_bf16 v[104:107], v[144:147], a[112:115], v[104:107]
    ds_read_b64_tr_b16 v[140:141], v226 offset:18432
    v_mul_f32 v190, v190, v22
    v_mfma_f32_16x16x32_bf16 v[104:107], v[148:151], a[116:119], v[104:107]
    buffer_load_dwordx4 v221, s[32:35], s61 offen offset:1024 sc1 lds
    v_mfma_f32_16x16x32_bf16 v[120:123], v[144:147], a[120:123], v[120:123]
    ds_read_b64_tr_b16 v[142:143], v226 offset:18944
    v_exp_f32 v188, v188
    v_mfma_f32_16x16x32_bf16 v[120:123], v[148:151], a[124:127], v[120:123]
    v_mul_f32 v191, v191, v23
    s_waitcnt lgkmcnt(4)
    v_mfma_f32_16x16x32_bf16 v[76:79], v[128:131], a[96:99], v[76:79]
    ds_read_b64_tr_b16 v[144:145], v227 offset:16384
    v_mul_f32 v16, v16, v24
    v_mfma_f32_16x16x32_bf16 v[76:79], v[132:135], a[100:103], v[76:79]
    buffer_load_dwordx4 v222, s[32:35], s61 offen offset:2048 sc1 lds
    v_mul_f32 v17, v17, v25
    v_mfma_f32_16x16x32_bf16 v[92:95], v[128:131], a[104:107], v[92:95]
    ds_read_b64_tr_b16 v[146:147], v227 offset:16896
    v_exp_f32 v189, v189
    v_mfma_f32_16x16x32_bf16 v[92:95], v[132:135], a[108:111], v[92:95]
    v_exp_f32 v190, v190
    v_mfma_f32_16x16x32_bf16 v[108:111], v[128:131], a[112:115], v[108:111]
    ds_read_b64_tr_b16 v[148:149], v227 offset:18432
    v_mul_f32 v18, v18, v26
    v_mfma_f32_16x16x32_bf16 v[108:111], v[132:135], a[116:119], v[108:111]
    buffer_load_dwordx4 v223, s[32:35], s61 offen offset:3072 sc1 lds
    v_mfma_f32_16x16x32_bf16 v[124:127], v[128:131], a[120:123], v[124:127]
    ds_read_b64_tr_b16 v[150:151], v227 offset:18944
    v_exp_f32 v191, v191
    v_mfma_f32_16x16x32_bf16 v[124:127], v[132:135], a[124:127], v[124:127]
    v_mul_f32 v19, v19, v27
    s_waitcnt lgkmcnt(4)
    v_mfma_f32_16x16x32_bf16 v[64:67], v[136:139], a[128:131], v[64:67]
    ds_read_b64_tr_b16 v[128:129], v226 offset:24576
    s_mov_b32 s100, s88
    v_mfma_f32_16x16x32_bf16 v[64:67], v[140:143], a[132:135], v[64:67]
    s_lshl3_add_u32 s101, s63, s88
    v_mul_f32 v20, v20, v28
    v_mul_f32 v21, v21, v29
    v_mfma_f32_16x16x32_bf16 v[80:83], v[136:139], a[136:139], v[80:83]
    ds_read_b64_tr_b16 v[130:131], v226 offset:25088
    s_add_u32 m0, s68, 0
    v_mfma_f32_16x16x32_bf16 v[80:83], v[140:143], a[140:143], v[80:83]
    s_mov_b32 s61, s101
    v_mul_f32 v22, v22, v30
    v_mul_f32 v23, v23, v31
    v_mfma_f32_16x16x32_bf16 v[96:99], v[136:139], a[144:147], v[96:99]
    ds_read_b64_tr_b16 v[132:133], v226 offset:26624
    v_add_f32 v184, 1.0, v184
    v_mfma_f32_16x16x32_bf16 v[96:99], v[140:143], a[148:151], v[96:99]
    buffer_load_dwordx4 v220, s[32:35], s61 offen offset:0 sc1 lds
    v_mfma_f32_16x16x32_bf16 v[112:115], v[136:139], a[152:155], v[112:115]
    ds_read_b64_tr_b16 v[134:135], v226 offset:27136
    v_rcp_f32 v184, v184
    v_mfma_f32_16x16x32_bf16 v[112:115], v[140:143], a[156:159], v[112:115]
    v_add_f32 v185, 1.0, v185
    s_waitcnt lgkmcnt(4)
    v_mfma_f32_16x16x32_bf16 v[68:71], v[144:147], a[128:131], v[68:71]
    ds_read_b64_tr_b16 v[136:137], v227 offset:24576
    v_add_f32 v186, 1.0, v186
    v_mfma_f32_16x16x32_bf16 v[68:71], v[148:151], a[132:135], v[68:71]
    buffer_load_dwordx4 v221, s[32:35], s61 offen offset:1024 sc1 lds
    v_mfma_f32_16x16x32_bf16 v[84:87], v[144:147], a[136:139], v[84:87]
    ds_read_b64_tr_b16 v[138:139], v227 offset:25088
    s_bfe_u32 s76, s66, 0x80018
    v_mfma_f32_16x16x32_bf16 v[84:87], v[148:151], a[140:143], v[84:87]
    s_lshl_b32 s77, s76, 7
    s_add_u32 s88, s77, s69
    v_add_f32 v187, 1.0, v187
    v_mfma_f32_16x16x32_bf16 v[100:103], v[144:147], a[144:147], v[100:103]
    ds_read_b64_tr_b16 v[140:141], v227 offset:26624
    v_rcp_f32 v185, v185
    v_mfma_f32_16x16x32_bf16 v[100:103], v[148:151], a[148:151], v[100:103]
    buffer_load_dwordx4 v222, s[32:35], s61 offen offset:2048 sc1 lds
    v_mfma_f32_16x16x32_bf16 v[116:119], v[144:147], a[152:155], v[116:119]
    ds_read_b64_tr_b16 v[142:143], v227 offset:27136
    v_add_f32 v188, 1.0, v188
    v_mfma_f32_16x16x32_bf16 v[116:119], v[148:151], a[156:159], v[116:119]
    v_add_f32 v189, 1.0, v189
    s_waitcnt lgkmcnt(4)
    v_mfma_f32_16x16x32_bf16 v[72:75], v[128:131], a[128:131], v[72:75]
    s_waitcnt vmcnt(8)
    s_barrier
    v_mfma_f32_16x16x32_bf16 v[72:75], v[132:135], a[132:135], v[72:75]
    v_rcp_f32 v186, v186
    v_mfma_f32_16x16x32_bf16 v[88:91], v[128:131], a[136:139], v[88:91]
    ds_read_b64_tr_b16 v[144:145], v226 offset:32768
    ds_read_b64_tr_b16 v[146:147], v226 offset:33280
    v_mfma_f32_16x16x32_bf16 v[88:91], v[132:135], a[140:143], v[88:91]
    v_rcp_f32 v187, v187
    v_mfma_f32_16x16x32_bf16 v[104:107], v[128:131], a[144:147], v[104:107]
    ds_read_b64_tr_b16 v[148:149], v226 offset:34816
    v_add_f32 v190, 1.0, v190
    v_mfma_f32_16x16x32_bf16 v[104:107], v[132:135], a[148:151], v[104:107]
    buffer_load_dwordx4 v223, s[32:35], s61 offen offset:3072 sc1 lds
    v_mfma_f32_16x16x32_bf16 v[120:123], v[128:131], a[152:155], v[120:123]
    ds_read_b64_tr_b16 v[150:151], v226 offset:35328
    s_add_u32 m0, s68, 16384
    v_mfma_f32_16x16x32_bf16 v[120:123], v[132:135], a[156:159], v[120:123]
    s_mov_b32 s61, s31
    s_waitcnt lgkmcnt(4)
    v_mfma_f32_16x16x32_bf16 v[76:79], v[136:139], a[128:131], v[76:79]
    ds_read_b64_tr_b16 v[128:129], v227 offset:32768
    v_add_f32 v191, 1.0, v191
    v_mfma_f32_16x16x32_bf16 v[76:79], v[140:143], a[132:135], v[76:79]
    buffer_load_dwordx4 v220, s[32:35], s61 offen offset:0 sc1 lds
    v_mfma_f32_16x16x32_bf16 v[92:95], v[136:139], a[136:139], v[92:95]
    ds_read_b64_tr_b16 v[130:131], v227 offset:33280
    s_add_u32 s31, s88, s30
    v_mfma_f32_16x16x32_bf16 v[92:95], v[140:143], a[140:143], v[92:95]
    s_lshr_b64 s[66:67], s[66:67], 8
    v_rcp_f32 v188, v188
    v_mfma_f32_16x16x32_bf16 v[108:111], v[136:139], a[144:147], v[108:111]
    ds_read_b64_tr_b16 v[132:133], v227 offset:34816
    v_mul_f32 v16, v16, v184
    v_mfma_f32_16x16x32_bf16 v[108:111], v[140:143], a[148:151], v[108:111]
    buffer_load_dwordx4 v221, s[32:35], s61 offen offset:1024 sc1 lds
    v_mfma_f32_16x16x32_bf16 v[124:127], v[136:139], a[152:155], v[124:127]
    ds_read_b64_tr_b16 v[134:135], v227 offset:35328
    v_rcp_f32 v189, v189
    v_mfma_f32_16x16x32_bf16 v[124:127], v[140:143], a[156:159], v[124:127]
    v_mul_f32 v17, v17, v185
    s_waitcnt lgkmcnt(4)
    v_mfma_f32_16x16x32_bf16 v[64:67], v[144:147], a[160:163], v[64:67]
    ds_read_b64_tr_b16 v[136:137], v226 offset:40960
    v_mul_f32 v18, v18, v186
    v_mfma_f32_16x16x32_bf16 v[64:67], v[148:151], a[164:167], v[64:67]
    buffer_store_dwordx4 v[212:215], v233, s[56:59], s72 offen offset:1024 sc1
    v_mfma_f32_16x16x32_bf16 v[80:83], v[144:147], a[168:171], v[80:83]
    ds_read_b64_tr_b16 v[138:139], v226 offset:41472
    v_rcp_f32 v190, v190
    v_mfma_f32_16x16x32_bf16 v[80:83], v[148:151], a[172:175], v[80:83]
    v_rcp_f32 v191, v191
    v_mul_f32 v19, v19, v187
    v_mfma_f32_16x16x32_bf16 v[96:99], v[144:147], a[176:179], v[96:99]
    ds_read_b64_tr_b16 v[140:141], v226 offset:43008
    v_mul_f32 v20, v20, v188
    v_mfma_f32_16x16x32_bf16 v[96:99], v[148:151], a[180:183], v[96:99]
    buffer_load_dwordx4 v222, s[32:35], s61 offen offset:2048 sc1 lds
    v_mfma_f32_16x16x32_bf16 v[112:115], v[144:147], a[184:187], v[112:115]
    ds_read_b64_tr_b16 v[142:143], v226 offset:43520
    v_mul_f32 v21, v21, v189
    v_mul_f32 v22, v22, v190
    v_mfma_f32_16x16x32_bf16 v[112:115], v[148:151], a[188:191], v[112:115]
    v_mul_f32 v23, v23, v191
    s_waitcnt lgkmcnt(4)
    v_mfma_f32_16x16x32_bf16 v[68:71], v[128:131], a[160:163], v[68:71]
    ds_read_b64_tr_b16 v[144:145], v227 offset:40960
    v_cvt_pk_bf16_f32 v204, v16, v17
    v_mfma_f32_16x16x32_bf16 v[68:71], v[132:135], a[164:167], v[68:71]
    buffer_load_dwordx4 v223, s[32:35], s61 offen offset:3072 sc1 lds
    v_mfma_f32_16x16x32_bf16 v[84:87], v[128:131], a[168:171], v[84:87]
    ds_read_b64_tr_b16 v[146:147], v227 offset:41472
    s_add_u32 m0, s68, 32768
    v_mfma_f32_16x16x32_bf16 v[84:87], v[132:135], a[172:175], v[84:87]
    s_add_u32 s61, s61, s62
    s_cmp_eq_u32 s61, s101
    v_mfma_f32_16x16x32_bf16 v[100:103], v[128:131], a[176:179], v[100:103]
    s_cselect_b32 s61, s100, s61
    ds_read_b64_tr_b16 v[148:149], v227 offset:43008
    v_cvt_pk_bf16_f32 v206, v20, v21
    v_mfma_f32_16x16x32_bf16 v[100:103], v[132:135], a[180:183], v[100:103]
    buffer_load_dwordx4 v220, s[32:35], s61 offen offset:0 sc1 lds
    v_mfma_f32_16x16x32_bf16 v[116:119], v[128:131], a[184:187], v[116:119]
    ds_read_b64_tr_b16 v[150:151], v227 offset:43520
    v_permlane16_swap_b32 v204, v206
    v_mfma_f32_16x16x32_bf16 v[116:119], v[132:135], a[188:191], v[116:119]
    v_cvt_pk_bf16_f32 v205, v18, v19
    s_waitcnt lgkmcnt(4)
    v_mfma_f32_16x16x32_bf16 v[72:75], v[136:139], a[160:163], v[72:75]
    ds_read_b64_tr_b16 v[128:129], v228 offset:0
    v_cvt_pk_bf16_f32 v207, v22, v23
    v_mfma_f32_16x16x32_bf16 v[72:75], v[140:143], a[164:167], v[72:75]
    v_mul_f32 v184, v32, v32
    v_permlane16_swap_b32 v205, v207
    v_mfma_f32_16x16x32_bf16 v[88:91], v[136:139], a[168:171], v[88:91]
    ds_read_b64_tr_b16 v[130:131], v228 offset:512
    v_mul_f32 v185, v33, v33
    v_mfma_f32_16x16x32_bf16 v[88:91], v[140:143], a[172:175], v[88:91]
    buffer_store_dwordx4 v[204:207], v254, s[48:51], s64 offen offset:256 sc1
    v_mfma_f32_16x16x32_bf16 v[104:107], v[136:139], a[176:179], v[104:107]
    ds_read_b64_tr_b16 v[132:133], v228 offset:2048
    v_mul_f32 v186, v34, v34
    v_mfma_f32_16x16x32_bf16 v[104:107], v[140:143], a[180:183], v[104:107]
    buffer_load_dwordx4 v221, s[32:35], s61 offen offset:1024 sc1 lds
    v_mul_f32 v187, v35, v35
    v_mfma_f32_16x16x32_bf16 v[120:123], v[136:139], a[184:187], v[120:123]
    ds_read_b64_tr_b16 v[134:135], v228 offset:2560
    v_mul_f32 v188, v36, v36
    v_mul_f32 v189, v37, v37
    v_mfma_f32_16x16x32_bf16 v[120:123], v[140:143], a[188:191], v[120:123]
    v_mul_f32 v190, v38, v38
    v_mul_f32 v191, v39, v39
    s_waitcnt lgkmcnt(4)
    v_mfma_f32_16x16x32_bf16 v[76:79], v[144:147], a[160:163], v[76:79]
    ds_read_b64_tr_b16 v[136:137], v229 offset:0
    v_fma_f32 v184, v184, s89, v234
    v_mfma_f32_16x16x32_bf16 v[76:79], v[148:151], a[164:167], v[76:79]
    buffer_load_dwordx4 v222, s[32:35], s61 offen offset:2048 sc1 lds
    v_fma_f32 v185, v185, s89, v234
    v_mfma_f32_16x16x32_bf16 v[92:95], v[144:147], a[168:171], v[92:95]
    ds_read_b64_tr_b16 v[138:139], v229 offset:512
    v_fma_f32 v186, v186, s89, v234
    v_fma_f32 v187, v187, s89, v234
    v_mfma_f32_16x16x32_bf16 v[92:95], v[148:151], a[172:175], v[92:95]
    v_fma_f32 v188, v188, s89, v234
    v_fma_f32 v189, v189, s89, v234
    v_mfma_f32_16x16x32_bf16 v[108:111], v[144:147], a[176:179], v[108:111]
    ds_read_b64_tr_b16 v[140:141], v229 offset:2048
    v_fma_f32 v190, v190, s89, v234
    v_mfma_f32_16x16x32_bf16 v[108:111], v[148:151], a[180:183], v[108:111]
    buffer_load_dwordx4 v223, s[32:35], s61 offen offset:3072 sc1 lds
    v_mfma_f32_16x16x32_bf16 v[124:127], v[144:147], a[184:187], v[124:127]
    ds_read_b64_tr_b16 v[142:143], v229 offset:2560
    v_fma_f32 v191, v191, s89, v234
    v_mul_f32 v184, v184, v32
    v_mfma_f32_16x16x32_bf16 v[124:127], v[148:151], a[188:191], v[124:127]
    v_mul_f32 v185, v185, v33
    s_waitcnt lgkmcnt(4)
    v_mfma_f32_16x16x32_bf16 v[64:67], v[128:131], a[192:195], v[64:67]
    ds_read_b64_tr_b16 v[144:145], v228 offset:8192
    s_add_u32 s79, s88, s94
    v_mfma_f32_16x16x32_bf16 v[64:67], v[132:135], a[196:199], v[64:67]
    v_exp_f32 v184, v184
    v_mul_f32 v186, v186, v34
    v_mfma_f32_16x16x32_bf16 v[80:83], v[128:131], a[200:203], v[80:83]
    ds_read_b64_tr_b16 v[146:147], v228 offset:8704
    v_mul_f32 v187, v187, v35
    v_mfma_f32_16x16x32_bf16 v[80:83], v[132:135], a[204:207], v[80:83]
    buffer_load_dword v251, v230, s[32:35], s79 offen
    v_mfma_f32_16x16x32_bf16 v[96:99], v[128:131], a[208:211], v[96:99]
    ds_read_b64_tr_b16 v[148:149], v228 offset:10240
    s_add_u32 m0, s68, 147456
    v_mfma_f32_16x16x32_bf16 v[96:99], v[132:135], a[212:215], v[96:99]
    s_add_u32 s70, s70, 128
    v_mul_f32 v188, v188, v36
    v_mfma_f32_16x16x32_bf16 v[112:115], v[128:131], a[216:219], v[112:115]
    buffer_load_dwordx4 v235, s[52:55], s70 offen offset:0 nt lds
    v_mfma_f32_16x16x32_bf16 v[112:115], v[132:135], a[220:223], v[112:115]
    ds_read_b64_tr_b16 v[150:151], v228 offset:10752
    s_waitcnt lgkmcnt(4)
    v_mfma_f32_16x16x32_bf16 v[68:71], v[136:139], a[192:195], v[68:71]
    ds_read_b64_tr_b16 v[128:129], v229 offset:8192
    s_add_u32 s71, s71, 128
    v_mul_f32 v189, v189, v37
    v_mfma_f32_16x16x32_bf16 v[68:71], v[140:143], a[196:199], v[68:71]
    buffer_load_dwordx4 v235, s[52:55], s71 offen offset:1024 nt lds
    v_mul_f32 v190, v190, v38
    v_mfma_f32_16x16x32_bf16 v[84:87], v[136:139], a[200:203], v[84:87]
    ds_read_b64_tr_b16 v[130:131], v229 offset:8704
    v_exp_f32 v185, v185
    v_mfma_f32_16x16x32_bf16 v[84:87], v[140:143], a[204:207], v[84:87]
    v_exp_f32 v186, v186
    v_mul_f32 v191, v191, v39
    v_mfma_f32_16x16x32_bf16 v[100:103], v[136:139], a[208:211], v[100:103]
    ds_read_b64_tr_b16 v[132:133], v229 offset:10240
    v_exp_f32 v187, v187
    v_mfma_f32_16x16x32_bf16 v[100:103], v[140:143], a[212:215], v[100:103]
    v_exp_f32 v188, v188
    v_mfma_f32_16x16x32_bf16 v[116:119], v[136:139], a[216:219], v[116:119]
    ds_read_b64_tr_b16 v[134:135], v229 offset:10752
    v_mul_f32 v32, v32, v40
    v_mfma_f32_16x16x32_bf16 v[116:119], v[140:143], a[220:223], v[116:119]
    v_mul_f32 v33, v33, v41
    s_waitcnt lgkmcnt(4)
    v_mfma_f32_16x16x32_bf16 v[72:75], v[144:147], a[192:195], v[72:75]
    ds_read_b64_tr_b16 v[136:137], v228 offset:16384
    v_exp_f32 v189, v189
    v_mfma_f32_16x16x32_bf16 v[72:75], v[148:151], a[196:199], v[72:75]
    v_exp_f32 v190, v190
    v_mul_f32 v34, v34, v42
    v_mfma_f32_16x16x32_bf16 v[88:91], v[144:147], a[200:203], v[88:91]
    ds_read_b64_tr_b16 v[138:139], v228 offset:16896
    v_mul_f32 v35, v35, v43
    v_mfma_f32_16x16x32_bf16 v[88:91], v[148:151], a[204:207], v[88:91]
    v_exp_f32 v191, v191
    v_mul_f32 v36, v36, v44
    v_mfma_f32_16x16x32_bf16 v[104:107], v[144:147], a[208:211], v[104:107]
    ds_read_b64_tr_b16 v[140:141], v228 offset:18432
    v_mul_f32 v37, v37, v45
    v_mfma_f32_16x16x32_bf16 v[104:107], v[148:151], a[212:215], v[104:107]
    v_mul_f32 v38, v38, v46
    v_mul_f32 v39, v39, v47
    v_add_f32 v184, 1.0, v184
    v_mfma_f32_16x16x32_bf16 v[120:123], v[144:147], a[216:219], v[120:123]
    ds_read_b64_tr_b16 v[142:143], v228 offset:18944
    v_add_f32 v185, 1.0, v185
    v_mfma_f32_16x16x32_bf16 v[120:123], v[148:151], a[220:223], v[120:123]
    v_rcp_f32 v184, v184
    s_waitcnt lgkmcnt(4)
    v_mfma_f32_16x16x32_bf16 v[76:79], v[128:131], a[192:195], v[76:79]
    ds_read_b64_tr_b16 v[144:145], v229 offset:16384
    v_rcp_f32 v185, v185
    v_mfma_f32_16x16x32_bf16 v[76:79], v[132:135], a[196:199], v[76:79]
    v_add_f32 v186, 1.0, v186
    v_add_f32 v187, 1.0, v187
    v_add_f32 v188, 1.0, v188
    v_mfma_f32_16x16x32_bf16 v[92:95], v[128:131], a[200:203], v[92:95]
    ds_read_b64_tr_b16 v[146:147], v229 offset:16896
    v_rcp_f32 v186, v186
    v_mfma_f32_16x16x32_bf16 v[92:95], v[132:135], a[204:207], v[92:95]
    v_rcp_f32 v187, v187
    v_add_f32 v189, 1.0, v189
    v_mfma_f32_16x16x32_bf16 v[108:111], v[128:131], a[208:211], v[108:111]
    ds_read_b64_tr_b16 v[148:149], v229 offset:18432
    v_add_f32 v190, 1.0, v190
    v_mfma_f32_16x16x32_bf16 v[108:111], v[132:135], a[212:215], v[108:111]
    v_rcp_f32 v188, v188
    v_add_f32 v191, 1.0, v191
    v_mfma_f32_16x16x32_bf16 v[124:127], v[128:131], a[216:219], v[124:127]
    ds_read_b64_tr_b16 v[150:151], v229 offset:18944
    v_mul_f32 v32, v32, v184
    v_mfma_f32_16x16x32_bf16 v[124:127], v[132:135], a[220:223], v[124:127]
    v_rcp_f32 v189, v189
    s_waitcnt lgkmcnt(4)
    v_mfma_f32_16x16x32_bf16 v[64:67], v[136:139], a[224:227], v[64:67]
    ds_read_b64_tr_b16 v[128:129], v228 offset:24576
    v_rcp_f32 v190, v190
    v_mfma_f32_16x16x32_bf16 v[64:67], v[140:143], a[228:231], v[64:67]
    v_rcp_f32 v191, v191
    v_mul_f32 v33, v33, v185
    v_mfma_f32_16x16x32_bf16 v[80:83], v[136:139], a[232:235], v[80:83]
    ds_read_b64_tr_b16 v[130:131], v228 offset:25088
    v_mul_f32 v34, v34, v186
    v_mfma_f32_16x16x32_bf16 v[80:83], v[140:143], a[236:239], v[80:83]
    v_mul_f32 v35, v35, v187
    v_mul_f32 v36, v36, v188
    v_mul_f32 v37, v37, v189
    v_mfma_f32_16x16x32_bf16 v[96:99], v[136:139], a[240:243], v[96:99]
    ds_read_b64_tr_b16 v[132:133], v228 offset:26624
    v_mul_f32 v38, v38, v190
    v_mfma_f32_16x16x32_bf16 v[96:99], v[140:143], a[244:247], v[96:99]
    v_mul_f32 v39, v39, v191
    v_cvt_pk_bf16_f32 v200, v32, v33
    v_cvt_pk_bf16_f32 v202, v36, v37
    v_mfma_f32_16x16x32_bf16 v[112:115], v[136:139], a[248:251], v[112:115]
    ds_read_b64_tr_b16 v[134:135], v228 offset:27136
    v_cvt_pk_bf16_f32 v201, v34, v35
    v_mfma_f32_16x16x32_bf16 v[112:115], v[140:143], a[252:255], v[112:115]
    v_permlane16_swap_b32 v200, v202
    s_waitcnt lgkmcnt(4)
    v_mfma_f32_16x16x32_bf16 v[68:71], v[144:147], a[224:227], v[68:71]
    ds_read_b64_tr_b16 v[136:137], v229 offset:24576
    v_cvt_pk_bf16_f32 v203, v38, v39
    v_mul_f32 v184, v48, v48
    v_mfma_f32_16x16x32_bf16 v[68:71], v[148:151], a[228:231], v[68:71]
    v_permlane16_swap_b32 v201, v203
    v_mul_f32 v185, v49, v49
    v_mfma_f32_16x16x32_bf16 v[84:87], v[144:147], a[232:235], v[84:87]
    ds_read_b64_tr_b16 v[138:139], v229 offset:25088
    v_mul_f32 v186, v50, v50
    v_mfma_f32_16x16x32_bf16 v[84:87], v[148:151], a[236:239], v[84:87]
    buffer_store_dwordx4 v[200:203], v254, s[48:51], s64 offen offset:1024 sc1
    v_mul_f32 v187, v51, v51
    v_mfma_f32_16x16x32_bf16 v[100:103], v[144:147], a[240:243], v[100:103]
    ds_read_b64_tr_b16 v[140:141], v229 offset:26624
    v_mul_f32 v188, v52, v52
    v_mfma_f32_16x16x32_bf16 v[100:103], v[148:151], a[244:247], v[100:103]
    v_mul_f32 v189, v53, v53
    v_mul_f32 v190, v54, v54
    v_mul_f32 v191, v55, v55
    v_mfma_f32_16x16x32_bf16 v[116:119], v[144:147], a[248:251], v[116:119]
    ds_read_b64_tr_b16 v[142:143], v229 offset:27136
    v_fma_f32 v184, v184, s89, v234
    v_fma_f32 v185, v185, s89, v234
    v_mfma_f32_16x16x32_bf16 v[116:119], v[148:151], a[252:255], v[116:119]
    v_fma_f32 v186, v186, s89, v234
    v_fma_f32 v187, v187, s89, v234
    s_waitcnt lgkmcnt(4)
    v_mfma_f32_16x16x32_bf16 v[72:75], v[128:131], a[224:227], v[72:75]
    s_waitcnt vmcnt(4)
    s_barrier
    v_mfma_f32_16x16x32_bf16 v[72:75], v[132:135], a[228:231], v[72:75]
    v_fma_f32 v188, v188, s89, v234
    v_fma_f32 v189, v189, s89, v234
    v_fma_f32 v190, v190, s89, v234
    v_mfma_f32_16x16x32_bf16 v[88:91], v[128:131], a[232:235], v[88:91]
    ds_read_b64_tr_b16 v[144:145], v228 offset:32768
    v_fma_f32 v191, v191, s89, v234
    v_mfma_f32_16x16x32_bf16 v[88:91], v[132:135], a[236:239], v[88:91]
    ds_read_b64_tr_b16 v[146:147], v228 offset:33280
    v_mul_f32 v184, v184, v48
    v_mfma_f32_16x16x32_bf16 v[104:107], v[128:131], a[240:243], v[104:107]
    ds_read_b64_tr_b16 v[148:149], v228 offset:34816
    v_mul_f32 v185, v185, v49
    v_mfma_f32_16x16x32_bf16 v[104:107], v[132:135], a[244:247], v[104:107]
    v_exp_f32 v184, v184
    v_mfma_f32_16x16x32_bf16 v[120:123], v[128:131], a[248:251], v[120:123]
    ds_read_b64_tr_b16 v[150:151], v228 offset:35328
    v_mul_f32 v186, v186, v50
    v_mfma_f32_16x16x32_bf16 v[120:123], v[132:135], a[252:255], v[120:123]
    v_mul_f32 v187, v187, v51
    s_waitcnt lgkmcnt(4)
    v_mfma_f32_16x16x32_bf16 v[76:79], v[136:139], a[224:227], v[76:79]
    ds_read_b64_tr_b16 v[128:129], v229 offset:32768
    v_exp_f32 v185, v185
    v_mfma_f32_16x16x32_bf16 v[76:79], v[140:143], a[228:231], v[76:79]
    v_exp_f32 v186, v186
    v_mul_f32 v188, v188, v52
    v_mfma_f32_16x16x32_bf16 v[92:95], v[136:139], a[232:235], v[92:95]
    ds_read_b64_tr_b16 v[130:131], v229 offset:33280
    v_mul_f32 v189, v189, v53
    v_mfma_f32_16x16x32_bf16 v[92:95], v[140:143], a[236:239], v[92:95]
    v_exp_f32 v187, v187
    v_mul_f32 v190, v190, v54
    v_mfma_f32_16x16x32_bf16 v[108:111], v[136:139], a[240:243], v[108:111]
    ds_read_b64_tr_b16 v[132:133], v229 offset:34816
    v_mul_f32 v191, v191, v55
    v_mfma_f32_16x16x32_bf16 v[108:111], v[140:143], a[244:247], v[108:111]
    v_exp_f32 v188, v188
    v_mul_f32 v48, v48, v56
    v_mfma_f32_16x16x32_bf16 v[124:127], v[136:139], a[248:251], v[124:127]
    ds_read_b64_tr_b16 v[134:135], v229 offset:35328
    v_mul_f32 v49, v49, v57
    v_mfma_f32_16x16x32_bf16 v[124:127], v[140:143], a[252:255], v[124:127]
    v_exp_f32 v189, v189
    s_waitcnt lgkmcnt(4)
    v_mfma_f32_16x16x32_bf16 v[64:67], v[144:147], v[152:155], v[64:67]
    ds_read_b64_tr_b16 v[136:137], v228 offset:40960
    v_exp_f32 v190, v190
    v_mfma_f32_16x16x32_bf16 v[64:67], v[148:151], v[156:159], v[64:67]
    v_exp_f32 v191, v191
    v_mul_f32 v50, v50, v58
    v_mfma_f32_16x16x32_bf16 v[80:83], v[144:147], v[160:163], v[80:83]
    ds_read_b64_tr_b16 v[138:139], v228 offset:41472
    v_mul_f32 v51, v51, v59
    v_mul_f32 v52, v52, v60
    v_mfma_f32_16x16x32_bf16 v[80:83], v[148:151], v[164:167], v[80:83]
    v_mul_f32 v53, v53, v61
    v_mul_f32 v54, v54, v62
    v_mul_f32 v55, v55, v63
    v_mfma_f32_16x16x32_bf16 v[96:99], v[144:147], v[168:171], v[96:99]
    ds_read_b64_tr_b16 v[140:141], v228 offset:43008
    v_add_f32 v184, 1.0, v184
    v_mfma_f32_16x16x32_bf16 v[96:99], v[148:151], v[172:175], v[96:99]
    v_rcp_f32 v184, v184
    v_add_f32 v185, 1.0, v185
    v_mfma_f32_16x16x32_bf16 v[112:115], v[144:147], v[176:179], v[112:115]
    ds_read_b64_tr_b16 v[142:143], v228 offset:43520
    v_add_f32 v186, 1.0, v186
    v_mfma_f32_16x16x32_bf16 v[112:115], v[148:151], v[180:183], v[112:115]
    v_rcp_f32 v185, v185
    s_waitcnt lgkmcnt(4)
    v_mfma_f32_16x16x32_bf16 v[68:71], v[128:131], v[152:155], v[68:71]
    ds_read_b64_tr_b16 v[144:145], v229 offset:40960
    v_rcp_f32 v186, v186
    v_mfma_f32_16x16x32_bf16 v[68:71], v[132:135], v[156:159], v[68:71]
    v_add_f32 v187, 1.0, v187
    v_add_f32 v188, 1.0, v188
    v_add_f32 v189, 1.0, v189
    v_mfma_f32_16x16x32_bf16 v[84:87], v[128:131], v[160:163], v[84:87]
    ds_read_b64_tr_b16 v[146:147], v229 offset:41472
    v_add_f32 v190, 1.0, v190
    v_mfma_f32_16x16x32_bf16 v[84:87], v[132:135], v[164:167], v[84:87]
    v_rcp_f32 v187, v187
    v_add_f32 v191, 1.0, v191
    v_mfma_f32_16x16x32_bf16 v[100:103], v[128:131], v[168:171], v[100:103]
    ds_read_b64_tr_b16 v[148:149], v229 offset:43008
    v_mul_f32 v48, v48, v184
    v_mfma_f32_16x16x32_bf16 v[100:103], v[132:135], v[172:175], v[100:103]
    v_rcp_f32 v188, v188
    v_mul_f32 v49, v49, v185
    v_mfma_f32_16x16x32_bf16 v[116:119], v[128:131], v[176:179], v[116:119]
    ds_read_b64_tr_b16 v[150:151], v229 offset:43520
    v_mul_f32 v50, v50, v186
    v_mfma_f32_16x16x32_bf16 v[116:119], v[132:135], v[180:183], v[116:119]
    v_rcp_f32 v189, v189
    s_waitcnt lgkmcnt(4)
    v_mfma_f32_16x16x32_bf16 v[72:75], v[136:139], v[152:155], v[72:75]
    ds_read_b64_tr_b16 v[128:129], v224 offset:0
    v_rcp_f32 v190, v190
    v_mfma_f32_16x16x32_bf16 v[72:75], v[140:143], v[156:159], v[72:75]
    v_rcp_f32 v191, v191
    v_mul_f32 v51, v51, v187
    v_mfma_f32_16x16x32_bf16 v[88:91], v[136:139], v[160:163], v[88:91]
    ds_read_b64_tr_b16 v[130:131], v224 offset:512
    v_mul_f32 v52, v52, v188
    v_mfma_f32_16x16x32_bf16 v[88:91], v[140:143], v[164:167], v[88:91]
    v_mul_f32 v53, v53, v189
    v_mul_f32 v54, v54, v190
    v_mul_f32 v55, v55, v191
    v_mfma_f32_16x16x32_bf16 v[104:107], v[136:139], v[168:171], v[104:107]
    ds_read_b64_tr_b16 v[132:133], v224 offset:2048
    v_cvt_pk_bf16_f32 v204, v48, v49
    v_mfma_f32_16x16x32_bf16 v[104:107], v[140:143], v[172:175], v[104:107]
    v_cvt_pk_bf16_f32 v206, v52, v53
    v_cvt_pk_bf16_f32 v205, v50, v51
    v_cvt_pk_bf16_f32 v207, v54, v55
    v_mfma_f32_16x16x32_bf16 v[120:123], v[136:139], v[176:179], v[120:123]
    ds_read_b64_tr_b16 v[134:135], v224 offset:2560
    v_mfma_f32_16x16x32_bf16 v[120:123], v[140:143], v[180:183], v[120:123]
    v_permlane16_swap_b32 v204, v206
    s_waitcnt lgkmcnt(4)
    v_mfma_f32_16x16x32_bf16 v[76:79], v[144:147], v[152:155], v[76:79]
    ds_read_b64_tr_b16 v[136:137], v225 offset:0
    v_mfma_f32_16x16x32_bf16 v[76:79], v[148:151], v[156:159], v[76:79]
    v_permlane16_swap_b32 v205, v207
    v_mfma_f32_16x16x32_bf16 v[92:95], v[144:147], v[160:163], v[92:95]
    ds_read_b64_tr_b16 v[138:139], v225 offset:512
    v_mfma_f32_16x16x32_bf16 v[92:95], v[148:151], v[164:167], v[92:95]
    buffer_store_dwordx4 v[204:207], v254, s[48:51], s64 offen offset:1280 sc1
    v_mfma_f32_16x16x32_bf16 v[108:111], v[144:147], v[168:171], v[108:111]
    ds_read_b64_tr_b16 v[140:141], v225 offset:2048
    v_mfma_f32_16x16x32_bf16 v[108:111], v[148:151], v[172:175], v[108:111]
    v_mfma_f32_16x16x32_bf16 v[124:127], v[144:147], v[176:179], v[124:127]
    ds_read_b64_tr_b16 v[142:143], v225 offset:2560
    v_mfma_f32_16x16x32_bf16 v[124:127], v[148:151], v[180:183], v[124:127]
L_b2:
    s_waitcnt lgkmcnt(4)
    v_mfma_f32_16x16x32_bf16 v[0:3], v[128:131], a[0:3], 0
    ds_read_b64_tr_b16 v[144:145], v224 offset:8192
    s_and_b32 s78, s66, 0xff
    v_mfma_f32_16x16x32_bf16 v[0:3], v[132:135], a[4:7], v[0:3]
    s_lshl_b32 s78, s78, 13
    s_add_u32 s64, s65, s78
    v_mfma_f32_16x16x32_bf16 v[16:19], v[128:131], a[8:11], 0
    ds_read_b64_tr_b16 v[146:147], v224 offset:8704
    s_add_u32 m0, s68, 49152
    v_mfma_f32_16x16x32_bf16 v[16:19], v[132:135], a[12:15], v[16:19]
    s_add_u32 s61, s61, s62
    s_cmp_eq_u32 s61, s101
    v_mfma_f32_16x16x32_bf16 v[32:35], v[128:131], a[16:19], 0
    s_cselect_b32 s61, s100, s61
    ds_read_b64_tr_b16 v[148:149], v224 offset:10240
    v_mfma_f32_16x16x32_bf16 v[32:35], v[132:135], a[20:23], v[32:35]
    buffer_load_dwordx4 v220, s[32:35], s61 offen offset:0 sc1 lds
    v_mfma_f32_16x16x32_bf16 v[48:51], v[128:131], a[24:27], 0
    ds_read_b64_tr_b16 v[150:151], v224 offset:10752
    v_mfma_f32_16x16x32_bf16 v[48:51], v[132:135], a[28:31], v[48:51]
    s_waitcnt lgkmcnt(4)
    v_mfma_f32_16x16x32_bf16 v[4:7], v[136:139], a[0:3], 0
    ds_read_b64_tr_b16 v[128:129], v225 offset:8192
    v_mul_f32 v184, v64, v64
    v_mfma_f32_16x16x32_bf16 v[4:7], v[140:143], a[4:7], v[4:7]
    buffer_load_dwordx4 v221, s[32:35], s61 offen offset:1024 sc1 lds
    v_mfma_f32_16x16x32_bf16 v[20:23], v[136:139], a[8:11], 0
    ds_read_b64_tr_b16 v[130:131], v225 offset:8704
    v_mul_f32 v185, v65, v65
    v_mfma_f32_16x16x32_bf16 v[20:23], v[140:143], a[12:15], v[20:23]
    v_mul_f32 v186, v66, v66
    v_mul_f32 v187, v67, v67
    v_mfma_f32_16x16x32_bf16 v[36:39], v[136:139], a[16:19], 0
    ds_read_b64_tr_b16 v[132:133], v225 offset:10240
    v_mul_f32 v188, v68, v68
    v_mfma_f32_16x16x32_bf16 v[36:39], v[140:143], a[20:23], v[36:39]
    buffer_load_dwordx4 v222, s[32:35], s61 offen offset:2048 sc1 lds
    v_mfma_f32_16x16x32_bf16 v[52:55], v[136:139], a[24:27], 0
    ds_read_b64_tr_b16 v[134:135], v225 offset:10752
    v_mul_f32 v189, v69, v69
    v_mul_f32 v190, v70, v70
    v_mfma_f32_16x16x32_bf16 v[52:55], v[140:143], a[28:31], v[52:55]
    v_mul_f32 v191, v71, v71
    s_waitcnt lgkmcnt(4)
    v_mfma_f32_16x16x32_bf16 v[8:11], v[144:147], a[0:3], 0
    ds_read_b64_tr_b16 v[136:137], v224 offset:16384
    v_fma_f32 v184, v184, s89, v234
    v_mfma_f32_16x16x32_bf16 v[8:11], v[148:151], a[4:7], v[8:11]
    v_fma_f32 v185, v185, s89, v234
    v_fma_f32 v186, v186, s89, v234
    v_mfma_f32_16x16x32_bf16 v[24:27], v[144:147], a[8:11], 0
    ds_read_b64_tr_b16 v[138:139], v224 offset:16896
    v_fma_f32 v187, v187, s89, v234
    v_mfma_f32_16x16x32_bf16 v[24:27], v[148:151], a[12:15], v[24:27]
    v_fma_f32 v188, v188, s89, v234
    v_fma_f32 v189, v189, s89, v234
    v_mfma_f32_16x16x32_bf16 v[40:43], v[144:147], a[16:19], 0
    ds_read_b64_tr_b16 v[140:141], v224 offset:18432
    buffer_load_dwordx4 v223, s[32:35], s61 offen offset:3072 sc1 lds
    v_mfma_f32_16x16x32_bf16 v[40:43], v[148:151], a[20:23], v[40:43]
    v_fma_f32 v190, v190, s89, v234
    v_fma_f32 v191, v191, s89, v234
    v_mfma_f32_16x16x32_bf16 v[56:59], v[144:147], a[24:27], 0
    ds_read_b64_tr_b16 v[142:143], v224 offset:18944
    s_add_u32 m0, s68, 65536
    s_add_u32 s61, s61, s62
    v_mfma_f32_16x16x32_bf16 v[56:59], v[148:151], a[28:31], v[56:59]
    s_cmp_eq_u32 s61, s101
    s_cselect_b32 s61, s100, s61
    s_waitcnt lgkmcnt(4)
    v_mfma_f32_16x16x32_bf16 v[12:15], v[128:131], a[0:3], 0
    ds_read_b64_tr_b16 v[144:145], v225 offset:16384
    v_mul_f32 v184, v184, v64
    v_mfma_f32_16x16x32_bf16 v[12:15], v[132:135], a[4:7], v[12:15]
    buffer_load_dwordx4 v220, s[32:35], s61 offen offset:0 sc1 lds
    v_mfma_f32_16x16x32_bf16 v[28:31], v[128:131], a[8:11], 0
    ds_read_b64_tr_b16 v[146:147], v225 offset:16896
    v_exp_f32 v184, v184
    v_mfma_f32_16x16x32_bf16 v[28:31], v[132:135], a[12:15], v[28:31]
    v_mul_f32 v185, v185, v65
    v_mul_f32 v186, v186, v66
    v_mul_f32 v187, v187, v67
    v_mfma_f32_16x16x32_bf16 v[44:47], v[128:131], a[16:19], 0
    ds_read_b64_tr_b16 v[148:149], v225 offset:18432
    v_mul_f32 v188, v188, v68
    v_mfma_f32_16x16x32_bf16 v[44:47], v[132:135], a[20:23], v[44:47]
    buffer_load_dwordx4 v221, s[32:35], s61 offen offset:1024 sc1 lds
    v_mfma_f32_16x16x32_bf16 v[60:63], v[128:131], a[24:27], 0
    ds_read_b64_tr_b16 v[150:151], v225 offset:18944
    v_exp_f32 v185, v185
    v_mfma_f32_16x16x32_bf16 v[60:63], v[132:135], a[28:31], v[60:63]
    v_mul_f32 v189, v189, v69
    s_waitcnt lgkmcnt(4)
    v_mfma_f32_16x16x32_bf16 v[0:3], v[136:139], a[32:35], v[0:3]
    ds_read_b64_tr_b16 v[128:129], v224 offset:24576
    v_exp_f32 v186, v186
    v_mfma_f32_16x16x32_bf16 v[0:3], v[140:143], a[36:39], v[0:3]
    v_exp_f32 v187, v187
    v_mfma_f32_16x16x32_bf16 v[16:19], v[136:139], a[40:43], v[16:19]
    ds_read_b64_tr_b16 v[130:131], v224 offset:25088
    v_mul_f32 v190, v190, v70
    v_mfma_f32_16x16x32_bf16 v[16:19], v[140:143], a[44:47], v[16:19]
    v_exp_f32 v188, v188
    v_mul_f32 v191, v191, v71
    v_mfma_f32_16x16x32_bf16 v[32:35], v[136:139], a[48:51], v[32:35]
    ds_read_b64_tr_b16 v[132:133], v224 offset:26624
    v_mul_f32 v64, v64, v72
    v_mfma_f32_16x16x32_bf16 v[32:35], v[140:143], a[52:55], v[32:35]
    buffer_load_dwordx4 v222, s[32:35], s61 offen offset:2048 sc1 lds
    v_mfma_f32_16x16x32_bf16 v[48:51], v[136:139], a[56:59], v[48:51]
    ds_read_b64_tr_b16 v[134:135], v224 offset:27136
    v_exp_f32 v189, v189
    v_mfma_f32_16x16x32_bf16 v[48:51], v[140:143], a[60:63], v[48:51]
    v_exp_f32 v190, v190
    s_waitcnt lgkmcnt(4)
    v_mfma_f32_16x16x32_bf16 v[4:7], v[144:147], a[32:35], v[4:7]
    ds_read_b64_tr_b16 v[136:137], v225 offset:24576
    v_mul_f32 v65, v65, v73
    v_mfma_f32_16x16x32_bf16 v[4:7], v[148:151], a[36:39], v[4:7]
    buffer_load_dwordx4 v223, s[32:35], s61 offen offset:3072 sc1 lds
    v_mfma_f32_16x16x32_bf16 v[20:23], v[144:147], a[40:43], v[20:23]
    ds_read_b64_tr_b16 v[138:139], v225 offset:25088
    s_add_u32 m0, s68, 81920
    v_mfma_f32_16x16x32_bf16 v[20:23], v[148:151], a[44:47], v[20:23]
    s_add_u32 s61, s61, s62
    s_cmp_eq_u32 s61, s101
    v_mul_f32 v66, v66, v74
    v_mfma_f32_16x16x32_bf16 v[36:39], v[144:147], a[48:51], v[36:39]
    s_cselect_b32 s61, s100, s61
    ds_read_b64_tr_b16 v[140:141], v225 offset:26624
    v_mfma_f32_16x16x32_bf16 v[36:39], v[148:151], a[52:55], v[36:39]
    buffer_load_dwordx4 v220, s[32:35], s61 offen offset:0 sc1 lds
    v_mul_f32 v67, v67, v75
    v_mfma_f32_16x16x32_bf16 v[52:55], v[144:147], a[56:59], v[52:55]
    ds_read_b64_tr_b16 v[142:143], v225 offset:27136
    v_mul_f32 v68, v68, v76
    v_mfma_f32_16x16x32_bf16 v[52:55], v[148:151], a[60:63], v[52:55]
    v_mul_f32 v69, v69, v77
    s_waitcnt lgkmcnt(4)
    v_mfma_f32_16x16x32_bf16 v[8:11], v[128:131], a[32:35], v[8:11]
    ds_read_b64_tr_b16 v[144:145], v224 offset:32768
    v_exp_f32 v191, v191
    v_mfma_f32_16x16x32_bf16 v[8:11], v[132:135], a[36:39], v[8:11]
    v_mul_f32 v70, v70, v78
    v_mul_f32 v71, v71, v79
    v_mfma_f32_16x16x32_bf16 v[24:27], v[128:131], a[40:43], v[24:27]
    ds_read_b64_tr_b16 v[146:147], v224 offset:33280
    v_add_f32 v184, 1.0, v184
    v_mfma_f32_16x16x32_bf16 v[24:27], v[132:135], a[44:47], v[24:27]
    v_rcp_f32 v184, v184
    v_add_f32 v185, 1.0, v185
    v_mfma_f32_16x16x32_bf16 v[40:43], v[128:131], a[48:51], v[40:43]
    ds_read_b64_tr_b16 v[148:149], v224 offset:34816
    v_add_f32 v186, 1.0, v186
    v_mfma_f32_16x16x32_bf16 v[40:43], v[132:135], a[52:55], v[40:43]
    buffer_load_dwordx4 v221, s[32:35], s61 offen offset:1024 sc1 lds
    v_mfma_f32_16x16x32_bf16 v[56:59], v[128:131], a[56:59], v[56:59]
    ds_read_b64_tr_b16 v[150:151], v224 offset:35328
    v_rcp_f32 v185, v185
    v_mfma_f32_16x16x32_bf16 v[56:59], v[132:135], a[60:63], v[56:59]
    v_rcp_f32 v186, v186
    s_waitcnt lgkmcnt(4)
    v_mfma_f32_16x16x32_bf16 v[12:15], v[136:139], a[32:35], v[12:15]
    ds_read_b64_tr_b16 v[128:129], v225 offset:32768
    v_add_f32 v187, 1.0, v187
    v_add_f32 v188, 1.0, v188
    v_mfma_f32_16x16x32_bf16 v[12:15], v[140:143], a[36:39], v[12:15]
    buffer_load_dwordx4 v222, s[32:35], s61 offen offset:2048 sc1 lds
    v_mfma_f32_16x16x32_bf16 v[28:31], v[136:139], a[40:43], v[28:31]
    ds_read_b64_tr_b16 v[130:131], v225 offset:33280
    v_rcp_f32 v187, v187
    v_mfma_f32_16x16x32_bf16 v[28:31], v[140:143], a[44:47], v[28:31]
    v_rcp_f32 v188, v188
    v_add_f32 v189, 1.0, v189
    v_mfma_f32_16x16x32_bf16 v[44:47], v[136:139], a[48:51], v[44:47]
    ds_read_b64_tr_b16 v[132:133], v225 offset:34816
    v_add_f32 v190, 1.0, v190
    v_mfma_f32_16x16x32_bf16 v[44:47], v[140:143], a[52:55], v[44:47]
    buffer_load_dwordx4 v223, s[32:35], s61 offen offset:3072 sc1 lds
    v_mfma_f32_16x16x32_bf16 v[60:63], v[136:139], a[56:59], v[60:63]
    ds_read_b64_tr_b16 v[134:135], v225 offset:35328
    v_rcp_f32 v189, v189
    v_mfma_f32_16x16x32_bf16 v[60:63], v[140:143], a[60:63], v[60:63]
    v_add_f32 v191, 1.0, v191
    s_waitcnt lgkmcnt(4)
    v_mfma_f32_16x16x32_bf16 v[0:3], v[144:147], a[64:67], v[0:3]
    ds_read_b64_tr_b16 v[136:137], v224 offset:40960
    v_mul_f32 v64, v64, v184
    v_mfma_f32_16x16x32_bf16 v[0:3], v[148:151], a[68:71], v[0:3]
    v_rcp_f32 v190, v190
    v_mfma_f32_16x16x32_bf16 v[16:19], v[144:147], a[72:75], v[16:19]
    ds_read_b64_tr_b16 v[138:139], v224 offset:41472
    s_add_u32 m0, s68, 98304
    v_mfma_f32_16x16x32_bf16 v[16:19], v[148:151], a[76:79], v[16:19]
    s_add_u32 s61, s61, s62
    s_cmp_eq_u32 s61, s101
    v_mfma_f32_16x16x32_bf16 v[32:35], v[144:147], a[80:83], v[32:35]
    s_cselect_b32 s61, s100, s61
    ds_read_b64_tr_b16 v[140:141], v224 offset:43008
    v_mul_f32 v65, v65, v185
    v_mfma_f32_16x16x32_bf16 v[32:35], v[148:151], a[84:87], v[32:35]
    buffer_load_dwordx4 v220, s[32:35], s61 offen offset:0 sc1 lds
    v_mul_f32 v66, v66, v186
    v_mfma_f32_16x16x32_bf16 v[48:51], v[144:147], a[88:91], v[48:51]
    ds_read_b64_tr_b16 v[142:143], v224 offset:43520
    v_rcp_f32 v191, v191
    v_mfma_f32_16x16x32_bf16 v[48:51], v[148:151], a[92:95], v[48:51]
    v_mul_f32 v67, v67, v187
    s_waitcnt lgkmcnt(4)
    v_mfma_f32_16x16x32_bf16 v[4:7], v[128:131], a[64:67], v[4:7]
    ds_read_b64_tr_b16 v[144:145], v225 offset:40960
    v_mul_f32 v68, v68, v188
    v_mfma_f32_16x16x32_bf16 v[4:7], v[132:135], a[68:71], v[4:7]
    buffer_load_dwordx4 v221, s[32:35], s61 offen offset:1024 sc1 lds
    v_mfma_f32_16x16x32_bf16 v[20:23], v[128:131], a[72:75], v[20:23]
    ds_read_b64_tr_b16 v[146:147], v225 offset:41472
    v_mul_f32 v69, v69, v189
    v_mul_f32 v70, v70, v190
    v_mfma_f32_16x16x32_bf16 v[20:23], v[132:135], a[76:79], v[20:23]
    v_mul_f32 v71, v71, v191
    v_cvt_pk_bf16_f32 v200, v64, v65
    v_cvt_pk_bf16_f32 v202, v68, v69
    v_mfma_f32_16x16x32_bf16 v[36:39], v[128:131], a[80:83], v[36:39]
    ds_read_b64_tr_b16 v[148:149], v225 offset:43008
    v_cvt_pk_bf16_f32 v201, v66, v67
    v_mfma_f32_16x16x32_bf16 v[36:39], v[132:135], a[84:87], v[36:39]
    buffer_load_dwordx4 v222, s[32:35], s61 offen offset:2048 sc1 lds
    v_mfma_f32_16x16x32_bf16 v[52:55], v[128:131], a[88:91], v[52:55]
    ds_read_b64_tr_b16 v[150:151], v225 offset:43520
    v_permlane16_swap_b32 v200, v202
    v_mfma_f32_16x16x32_bf16 v[52:55], v[132:135], a[92:95], v[52:55]
    v_cvt_pk_bf16_f32 v203, v70, v71
    s_waitcnt lgkmcnt(4)
    v_mfma_f32_16x16x32_bf16 v[8:11], v[136:139], a[64:67], v[8:11]
    s_waitcnt vmcnt(7)
    s_barrier
    v_mfma_f32_16x16x32_bf16 v[8:11], v[140:143], a[68:71], v[8:11]
    v_permlane16_swap_b32 v201, v203
    v_mfma_f32_16x16x32_bf16 v[24:27], v[136:139], a[72:75], v[24:27]
    ds_read_b64_tr_b16 v[128:129], v226 offset:0
    ds_read_b64_tr_b16 v[130:131], v226 offset:512
    ds_read_b64_tr_b16 v[208:209], v236 offset:16384
    v_mfma_f32_16x16x32_bf16 v[24:27], v[140:143], a[76:79], v[24:27]
    buffer_store_dwordx4 v[200:203], v254, s[48:51], s64 offen offset:0 sc1
    v_mfma_f32_16x16x32_bf16 v[40:43], v[136:139], a[80:83], v[40:43]
    ds_read_b64_tr_b16 v[132:133], v226 offset:2048
    buffer_load_dwordx4 v223, s[32:35], s61 offen offset:3072 sc1 lds
    v_mfma_f32_16x16x32_bf16 v[40:43], v[140:143], a[84:87], v[40:43]
    ds_read_b64_tr_b16 v[210:211], v236 offset:16896
    v_mul_f32 v184, v80, v80
    v_mfma_f32_16x16x32_bf16 v[56:59], v[136:139], a[88:91], v[56:59]
    ds_read_b64_tr_b16 v[134:135], v226 offset:2560
    s_add_u32 m0, s68, 114688
    s_add_u32 s61, s61, s62
    v_mfma_f32_16x16x32_bf16 v[56:59], v[140:143], a[92:95], v[56:59]
    s_cmp_eq_u32 s61, s101
    s_cselect_b32 s61, s100, s61
    s_waitcnt lgkmcnt(6)
    v_mfma_f32_16x16x32_bf16 v[12:15], v[144:147], a[64:67], v[12:15]
    ds_read_b64_tr_b16 v[136:137], v227 offset:0
    v_mul_f32 v185, v81, v81
    v_mfma_f32_16x16x32_bf16 v[12:15], v[148:151], a[68:71], v[12:15]
    buffer_load_dwordx4 v220, s[32:35], s61 offen offset:0 sc1 lds
    v_mfma_f32_16x16x32_bf16 v[28:31], v[144:147], a[72:75], v[28:31]
    ds_read_b64_tr_b16 v[138:139], v227 offset:512
    ds_read_b64_tr_b16 v[212:213], v236 offset:16448
    v_mfma_f32_16x16x32_bf16 v[28:31], v[148:151], a[76:79], v[28:31]
    ds_read_b64_tr_b16 v[214:215], v236 offset:16960
    v_mul_f32 v186, v82, v82
    v_mfma_f32_16x16x32_bf16 v[44:47], v[144:147], a[80:83], v[44:47]
    ds_read_b64_tr_b16 v[140:141], v227 offset:2048
    v_mul_f32 v187, v83, v83
    v_mfma_f32_16x16x32_bf16 v[44:47], v[148:151], a[84:87], v[44:47]
    buffer_load_dwordx4 v221, s[32:35], s61 offen offset:1024 sc1 lds
    v_mfma_f32_16x16x32_bf16 v[60:63], v[144:147], a[88:91], v[60:63]
    ds_read_b64_tr_b16 v[142:143], v227 offset:2560
    v_mul_f32 v188, v84, v84
    v_mfma_f32_16x16x32_bf16 v[60:63], v[148:151], a[92:95], v[60:63]
    v_mul_f32 v189, v85, v85
    s_waitcnt lgkmcnt(6)
    v_mfma_f32_16x16x32_bf16 v[0:3], v[128:131], a[96:99], v[0:3]
    ds_read_b64_tr_b16 v[144:145], v226 offset:8192
    v_mul_f32 v190, v86, v86
    v_mfma_f32_16x16x32_bf16 v[0:3], v[132:135], a[100:103], v[0:3]
    v_mul_f32 v191, v87, v87
    v_fma_f32 v184, v184, s89, v234
    v_mfma_f32_16x16x32_bf16 v[16:19], v[128:131], a[104:107], v[16:19]
    ds_read_b64_tr_b16 v[146:147], v226 offset:8704
    v_fma_f32 v185, v185, s89, v234
    v_mfma_f32_16x16x32_bf16 v[16:19], v[132:135], a[108:111], v[16:19]
    v_fma_f32 v186, v186, s89, v234
    v_fma_f32 v187, v187, s89, v234
    v_mfma_f32_16x16x32_bf16 v[32:35], v[128:131], a[112:115], v[32:35]
    ds_read_b64_tr_b16 v[148:149], v226 offset:10240
    v_fma_f32 v188, v188, s89, v234
    v_mfma_f32_16x16x32_bf16 v[32:35], v[132:135], a[116:119], v[32:35]
    buffer_load_dwordx4 v222, s[32:35], s61 offen offset:2048 sc1 lds
    v_mfma_f32_16x16x32_bf16 v[48:51], v[128:131], a[120:123], v[48:51]
    ds_read_b64_tr_b16 v[150:151], v226 offset:10752
    v_fma_f32 v189, v189, s89, v234
    v_fma_f32 v190, v190, s89, v234
    v_mfma_f32_16x16x32_bf16 v[48:51], v[132:135], a[124:127], v[48:51]
    v_fma_f32 v191, v191, s89, v234
    v_mul_f32 v184, v184, v80
    s_waitcnt lgkmcnt(4)
    v_mfma_f32_16x16x32_bf16 v[4:7], v[136:139], a[96:99], v[4:7]
    ds_read_b64_tr_b16 v[128:129], v227 offset:8192
    v_mul_f32 v185, v185, v81
    v_mfma_f32_16x16x32_bf16 v[4:7], v[140:143], a[100:103], v[4:7]
    buffer_load_dwordx4 v223, s[32:35], s61 offen offset:3072 sc1 lds
    v_mfma_f32_16x16x32_bf16 v[20:23], v[136:139], a[104:107], v[20:23]
    ds_read_b64_tr_b16 v[130:131], v227 offset:8704
    s_add_u32 m0, s68, 131072
    v_mfma_f32_16x16x32_bf16 v[20:23], v[140:143], a[108:111], v[20:23]
    s_add_u32 s61, s61, s62
    s_cmp_eq_u32 s61, s101
    v_mfma_f32_16x16x32_bf16 v[36:39], v[136:139], a[112:115], v[36:39]
    s_cselect_b32 s61, s100, s61
    ds_read_b64_tr_b16 v[132:133], v227 offset:10240
    v_mul_f32 v186, v186, v82
    v_mfma_f32_16x16x32_bf16 v[36:39], v[140:143], a[116:119], v[36:39]
    buffer_load_dwordx4 v220, s[32:35], s61 offen offset:0 sc1 lds
    v_mfma_f32_16x16x32_bf16 v[52:55], v[136:139], a[120:123], v[52:55]
    ds_read_b64_tr_b16 v[134:135], v227 offset:10752
    v_exp_f32 v184, v184
    v_mfma_f32_16x16x32_bf16 v[52:55], v[140:143], a[124:127], v[52:55]
    v_mul_f32 v187, v187, v83
    s_waitcnt lgkmcnt(4)
    v_mfma_f32_16x16x32_bf16 v[8:11], v[144:147], a[96:99], v[8:11]
    ds_read_b64_tr_b16 v[136:137], v226 offset:16384
    v_mul_f32 v188, v188, v84
    v_mfma_f32_16x16x32_bf16 v[8:11], v[148:151], a[100:103], v[8:11]
    buffer_store_dwordx4 v[208:211], v233, s[56:59], s72 offen offset:2048 sc1
    v_mfma_f32_16x16x32_bf16 v[24:27], v[144:147], a[104:107], v[24:27]
    ds_read_b64_tr_b16 v[138:139], v226 offset:16896
    v_exp_f32 v185, v185
    v_mfma_f32_16x16x32_bf16 v[24:27], v[148:151], a[108:111], v[24:27]
    v_exp_f32 v186, v186
    v_mul_f32 v189, v189, v85
    v_mfma_f32_16x16x32_bf16 v[40:43], v[144:147], a[112:115], v[40:43]
    ds_read_b64_tr_b16 v[140:141], v226 offset:18432
    v_mul_f32 v190, v190, v86
    v_mfma_f32_16x16x32_bf16 v[40:43], v[148:151], a[116:119], v[40:43]
    buffer_load_dwordx4 v221, s[32:35], s61 offen offset:1024 sc1 lds
    v_mfma_f32_16x16x32_bf16 v[56:59], v[144:147], a[120:123], v[56:59]
    ds_read_b64_tr_b16 v[142:143], v226 offset:18944
    v_exp_f32 v187, v187
    v_mfma_f32_16x16x32_bf16 v[56:59], v[148:151], a[124:127], v[56:59]
    v_mul_f32 v191, v191, v87
    s_waitcnt lgkmcnt(4)
    v_mfma_f32_16x16x32_bf16 v[12:15], v[128:131], a[96:99], v[12:15]
    ds_read_b64_tr_b16 v[144:145], v227 offset:16384
    v_mul_f32 v80, v80, v88
    v_mfma_f32_16x16x32_bf16 v[12:15], v[132:135], a[100:103], v[12:15]
    buffer_load_dwordx4 v222, s[32:35], s61 offen offset:2048 sc1 lds
    v_mul_f32 v81, v81, v89
    v_mfma_f32_16x16x32_bf16 v[28:31], v[128:131], a[104:107], v[28:31]
    ds_read_b64_tr_b16 v[146:147], v227 offset:16896
    v_exp_f32 v188, v188
    v_mfma_f32_16x16x32_bf16 v[28:31], v[132:135], a[108:111], v[28:31]
    v_exp_f32 v189, v189
    v_mfma_f32_16x16x32_bf16 v[44:47], v[128:131], a[112:115], v[44:47]
    ds_read_b64_tr_b16 v[148:149], v227 offset:18432
    v_mul_f32 v82, v82, v90
    v_mfma_f32_16x16x32_bf16 v[44:47], v[132:135], a[116:119], v[44:47]
    buffer_load_dwordx4 v223, s[32:35], s61 offen offset:3072 sc1 lds
    v_mfma_f32_16x16x32_bf16 v[60:63], v[128:131], a[120:123], v[60:63]
    ds_read_b64_tr_b16 v[150:151], v227 offset:18944
    v_exp_f32 v190, v190
    v_mfma_f32_16x16x32_bf16 v[60:63], v[132:135], a[124:127], v[60:63]
    v_mul_f32 v83, v83, v91
    s_waitcnt lgkmcnt(4)
    v_mfma_f32_16x16x32_bf16 v[0:3], v[136:139], a[128:131], v[0:3]
    ds_read_b64_tr_b16 v[128:129], v226 offset:24576
    s_mov_b32 s100, s88
    v_mfma_f32_16x16x32_bf16 v[0:3], v[140:143], a[132:135], v[0:3]
    s_lshl3_add_u32 s101, s63, s88
    v_exp_f32 v191, v191
    v_mfma_f32_16x16x32_bf16 v[16:19], v[136:139], a[136:139], v[16:19]
    ds_read_b64_tr_b16 v[130:131], v226 offset:25088
    s_add_u32 m0, s68, 0
    v_mfma_f32_16x16x32_bf16 v[16:19], v[140:143], a[140:143], v[16:19]
    s_mov_b32 s61, s101
    v_mul_f32 v84, v84, v92
    v_mul_f32 v85, v85, v93
    v_mfma_f32_16x16x32_bf16 v[32:35], v[136:139], a[144:147], v[32:35]
    ds_read_b64_tr_b16 v[132:133], v226 offset:26624
    v_mul_f32 v86, v86, v94
    v_mfma_f32_16x16x32_bf16 v[32:35], v[140:143], a[148:151], v[32:35]
    buffer_load_dwordx4 v220, s[32:35], s61 offen offset:0 sc1 lds
    v_mfma_f32_16x16x32_bf16 v[48:51], v[136:139], a[152:155], v[48:51]
    ds_read_b64_tr_b16 v[134:135], v226 offset:27136
    v_mul_f32 v87, v87, v95
    v_add_f32 v184, 1.0, v184
    v_mfma_f32_16x16x32_bf16 v[48:51], v[140:143], a[156:159], v[48:51]
    v_add_f32 v185, 1.0, v185
    s_waitcnt lgkmcnt(4)
    v_mfma_f32_16x16x32_bf16 v[4:7], v[144:147], a[128:131], v[4:7]
    ds_read_b64_tr_b16 v[136:137], v227 offset:24576
    v_add_f32 v186, 1.0, v186
    v_mfma_f32_16x16x32_bf16 v[4:7], v[148:151], a[132:135], v[4:7]
    buffer_load_dwordx4 v221, s[32:35], s61 offen offset:1024 sc1 lds
    v_mfma_f32_16x16x32_bf16 v[20:23], v[144:147], a[136:139], v[20:23]
    ds_read_b64_tr_b16 v[138:139], v227 offset:25088
    s_bfe_u32 s76, s66, 0x80018
    v_mfma_f32_16x16x32_bf16 v[20:23], v[148:151], a[140:143], v[20:23]
    s_lshl_b32 s77, s76, 7
    s_add_u32 s88, s77, s69
    v_add_f32 v187, 1.0, v187
    v_mfma_f32_16x16x32_bf16 v[36:39], v[144:147], a[144:147], v[36:39]
    ds_read_b64_tr_b16 v[140:141], v227 offset:26624
    v_rcp_f32 v184, v184
    v_mfma_f32_16x16x32_bf16 v[36:39], v[148:151], a[148:151], v[36:39]
    buffer_load_dwordx4 v222, s[32:35], s61 offen offset:2048 sc1 lds
    v_mfma_f32_16x16x32_bf16 v[52:55], v[144:147], a[152:155], v[52:55]
    ds_read_b64_tr_b16 v[142:143], v227 offset:27136
    v_add_f32 v188, 1.0, v188
    v_mfma_f32_16x16x32_bf16 v[52:55], v[148:151], a[156:159], v[52:55]
    v_add_f32 v189, 1.0, v189
    s_waitcnt lgkmcnt(4)
    v_mfma_f32_16x16x32_bf16 v[8:11], v[128:131], a[128:131], v[8:11]
    s_waitcnt vmcnt(8)
    s_barrier
    v_mfma_f32_16x16x32_bf16 v[8:11], v[132:135], a[132:135], v[8:11]
    v_rcp_f32 v185, v185
    v_mfma_f32_16x16x32_bf16 v[24:27], v[128:131], a[136:139], v[24:27]
    ds_read_b64_tr_b16 v[144:145], v226 offset:32768
    ds_read_b64_tr_b16 v[146:147], v226 offset:33280
    v_mfma_f32_16x16x32_bf16 v[24:27], v[132:135], a[140:143], v[24:27]
    v_rcp_f32 v186, v186
    v_mfma_f32_16x16x32_bf16 v[40:43], v[128:131], a[144:147], v[40:43]
    ds_read_b64_tr_b16 v[148:149], v226 offset:34816
    v_add_f32 v190, 1.0, v190
    v_mfma_f32_16x16x32_bf16 v[40:43], v[132:135], a[148:151], v[40:43]
    buffer_load_dwordx4 v223, s[32:35], s61 offen offset:3072 sc1 lds
    v_mfma_f32_16x16x32_bf16 v[56:59], v[128:131], a[152:155], v[56:59]
    ds_read_b64_tr_b16 v[150:151], v226 offset:35328
    s_add_u32 m0, s68, 16384
    v_mfma_f32_16x16x32_bf16 v[56:59], v[132:135], a[156:159], v[56:59]
    s_mov_b32 s61, s31
    s_waitcnt lgkmcnt(4)
    v_mfma_f32_16x16x32_bf16 v[12:15], v[136:139], a[128:131], v[12:15]
    ds_read_b64_tr_b16 v[128:129], v227 offset:32768
    v_add_f32 v191, 1.0, v191
    v_mfma_f32_16x16x32_bf16 v[12:15], v[140:143], a[132:135], v[12:15]
    buffer_load_dwordx4 v220, s[32:35], s61 offen offset:0 sc1 lds
    v_mfma_f32_16x16x32_bf16 v[28:31], v[136:139], a[136:139], v[28:31]
    ds_read_b64_tr_b16 v[130:131], v227 offset:33280
    s_add_u32 s31, s88, s30
    v_mfma_f32_16x16x32_bf16 v[28:31], v[140:143], a[140:143], v[28:31]
    s_lshr_b64 s[66:67], s[66:67], 8
    v_rcp_f32 v187, v187
    v_mfma_f32_16x16x32_bf16 v[44:47], v[136:139], a[144:147], v[44:47]
    ds_read_b64_tr_b16 v[132:133], v227 offset:34816
    v_mul_f32 v80, v80, v184
    v_mfma_f32_16x16x32_bf16 v[44:47], v[140:143], a[148:151], v[44:47]
    buffer_load_dwordx4 v221, s[32:35], s61 offen offset:1024 sc1 lds
    v_mfma_f32_16x16x32_bf16 v[60:63], v[136:139], a[152:155], v[60:63]
    ds_read_b64_tr_b16 v[134:135], v227 offset:35328
    v_rcp_f32 v188, v188
    v_mfma_f32_16x16x32_bf16 v[60:63], v[140:143], a[156:159], v[60:63]
    v_mul_f32 v81, v81, v185
    s_waitcnt lgkmcnt(4)
    v_mfma_f32_16x16x32_bf16 v[0:3], v[144:147], a[160:163], v[0:3]
    ds_read_b64_tr_b16 v[136:137], v226 offset:40960
    v_mul_f32 v82, v82, v186
    v_mfma_f32_16x16x32_bf16 v[0:3], v[148:151], a[164:167], v[0:3]
    buffer_store_dwordx4 v[212:215], v233, s[56:59], s73 offen offset:0 sc1
    v_mul_f32 v83, v83, v187
    v_mfma_f32_16x16x32_bf16 v[16:19], v[144:147], a[168:171], v[16:19]
    ds_read_b64_tr_b16 v[138:139], v226 offset:41472
    v_rcp_f32 v189, v189
    v_mfma_f32_16x16x32_bf16 v[16:19], v[148:151], a[172:175], v[16:19]
    v_rcp_f32 v190, v190
    v_mfma_f32_16x16x32_bf16 v[32:35], v[144:147], a[176:179], v[32:35]
    ds_read_b64_tr_b16 v[140:141], v226 offset:43008
    v_mul_f32 v84, v84, v188
    v_mfma_f32_16x16x32_bf16 v[32:35], v[148:151], a[180:183], v[32:35]
    buffer_load_dwordx4 v222, s[32:35], s61 offen offset:2048 sc1 lds
    v_mfma_f32_16x16x32_bf16 v[48:51], v[144:147], a[184:187], v[48:51]
    ds_read_b64_tr_b16 v[142:143], v226 offset:43520
    v_rcp_f32 v191, v191
    v_mfma_f32_16x16x32_bf16 v[48:51], v[148:151], a[188:191], v[48:51]
    v_mul_f32 v85, v85, v189
    s_waitcnt lgkmcnt(4)
    v_mfma_f32_16x16x32_bf16 v[4:7], v[128:131], a[160:163], v[4:7]
    ds_read_b64_tr_b16 v[144:145], v227 offset:40960
    v_mul_f32 v86, v86, v190
    v_mfma_f32_16x16x32_bf16 v[4:7], v[132:135], a[164:167], v[4:7]
    buffer_load_dwordx4 v223, s[32:35], s61 offen offset:3072 sc1 lds
    v_mfma_f32_16x16x32_bf16 v[20:23], v[128:131], a[168:171], v[20:23]
    ds_read_b64_tr_b16 v[146:147], v227 offset:41472
    s_add_u32 m0, s68, 32768
    v_mfma_f32_16x16x32_bf16 v[20:23], v[132:135], a[172:175], v[20:23]
    s_add_u32 s61, s61, s62
    s_cmp_eq_u32 s61, s101
    v_mul_f32 v87, v87, v191
    v_mfma_f32_16x16x32_bf16 v[36:39], v[128:131], a[176:179], v[36:39]
    s_cselect_b32 s61, s100, s61
    ds_read_b64_tr_b16 v[148:149], v227 offset:43008
    v_mfma_f32_16x16x32_bf16 v[36:39], v[132:135], a[180:183], v[36:39]
    buffer_load_dwordx4 v220, s[32:35], s61 offen offset:0 sc1 lds
    v_cvt_pk_bf16_f32 v204, v80, v81
    v_mfma_f32_16x16x32_bf16 v[52:55], v[128:131], a[184:187], v[52:55]
    ds_read_b64_tr_b16 v[150:151], v227 offset:43520
    v_cvt_pk_bf16_f32 v206, v84, v85
    v_mfma_f32_16x16x32_bf16 v[52:55], v[132:135], a[188:191], v[52:55]
    v_cvt_pk_bf16_f32 v205, v82, v83
    s_waitcnt lgkmcnt(4)
    v_mfma_f32_16x16x32_bf16 v[8:11], v[136:139], a[160:163], v[8:11]
    ds_read_b64_tr_b16 v[128:129], v228 offset:0
    v_permlane16_swap_b32 v204, v206
    v_mfma_f32_16x16x32_bf16 v[8:11], v[140:143], a[164:167], v[8:11]
    v_cvt_pk_bf16_f32 v207, v86, v87
    v_mul_f32 v184, v96, v96
    v_mfma_f32_16x16x32_bf16 v[24:27], v[136:139], a[168:171], v[24:27]
    ds_read_b64_tr_b16 v[130:131], v228 offset:512
    v_mul_f32 v185, v97, v97
    v_mfma_f32_16x16x32_bf16 v[24:27], v[140:143], a[172:175], v[24:27]
    v_permlane16_swap_b32 v205, v207
    v_mul_f32 v186, v98, v98
    v_mfma_f32_16x16x32_bf16 v[40:43], v[136:139], a[176:179], v[40:43]
    ds_read_b64_tr_b16 v[132:133], v228 offset:2048
    v_mul_f32 v187, v99, v99
    v_mfma_f32_16x16x32_bf16 v[40:43], v[140:143], a[180:183], v[40:43]
    buffer_load_dwordx4 v221, s[32:35], s61 offen offset:1024 sc1 lds
    v_mfma_f32_16x16x32_bf16 v[56:59], v[136:139], a[184:187], v[56:59]
    ds_read_b64_tr_b16 v[134:135], v228 offset:2560
    buffer_store_dwordx4 v[204:207], v254, s[48:51], s64 offen offset:256 sc1
    v_mfma_f32_16x16x32_bf16 v[56:59], v[140:143], a[188:191], v[56:59]
    v_mul_f32 v188, v100, v100
    v_mul_f32 v189, v101, v101
    s_waitcnt lgkmcnt(4)
    v_mfma_f32_16x16x32_bf16 v[12:15], v[144:147], a[160:163], v[12:15]
    ds_read_b64_tr_b16 v[136:137], v229 offset:0
    v_mul_f32 v190, v102, v102
    v_mul_f32 v191, v103, v103
    v_mfma_f32_16x16x32_bf16 v[12:15], v[148:151], a[164:167], v[12:15]
    buffer_load_dwordx4 v222, s[32:35], s61 offen offset:2048 sc1 lds
    v_mfma_f32_16x16x32_bf16 v[28:31], v[144:147], a[168:171], v[28:31]
    ds_read_b64_tr_b16 v[138:139], v229 offset:512
    v_fma_f32 v184, v184, s89, v234
    v_fma_f32 v185, v185, s89, v234
    v_mfma_f32_16x16x32_bf16 v[28:31], v[148:151], a[172:175], v[28:31]
    v_fma_f32 v186, v186, s89, v234
    v_fma_f32 v187, v187, s89, v234
    v_fma_f32 v188, v188, s89, v234
    v_mfma_f32_16x16x32_bf16 v[44:47], v[144:147], a[176:179], v[44:47]
    ds_read_b64_tr_b16 v[140:141], v229 offset:2048
    v_fma_f32 v189, v189, s89, v234
    v_mfma_f32_16x16x32_bf16 v[44:47], v[148:151], a[180:183], v[44:47]
    buffer_load_dwordx4 v223, s[32:35], s61 offen offset:3072 sc1 lds
    v_mfma_f32_16x16x32_bf16 v[60:63], v[144:147], a[184:187], v[60:63]
    ds_read_b64_tr_b16 v[142:143], v229 offset:2560
    v_fma_f32 v190, v190, s89, v234
    v_fma_f32 v191, v191, s89, v234
    v_mfma_f32_16x16x32_bf16 v[60:63], v[148:151], a[188:191], v[60:63]
    v_mul_f32 v184, v184, v96
    s_waitcnt lgkmcnt(4)
    v_mfma_f32_16x16x32_bf16 v[0:3], v[128:131], a[192:195], v[0:3]
    ds_read_b64_tr_b16 v[144:145], v228 offset:8192
    s_add_u32 s79, s88, s94
    v_mfma_f32_16x16x32_bf16 v[0:3], v[132:135], a[196:199], v[0:3]
    v_exp_f32 v184, v184
    v_mfma_f32_16x16x32_bf16 v[16:19], v[128:131], a[200:203], v[16:19]
    ds_read_b64_tr_b16 v[146:147], v228 offset:8704
    v_mul_f32 v185, v185, v97
    v_mfma_f32_16x16x32_bf16 v[16:19], v[132:135], a[204:207], v[16:19]
    buffer_load_dword v251, v230, s[32:35], s79 offen
    v_mfma_f32_16x16x32_bf16 v[32:35], v[128:131], a[208:211], v[32:35]
    ds_read_b64_tr_b16 v[148:149], v228 offset:10240
    s_add_u32 m0, s68, 147456
    v_mfma_f32_16x16x32_bf16 v[32:35], v[132:135], a[212:215], v[32:35]
    s_add_u32 s70, s70, 128
    v_mul_f32 v186, v186, v98
    v_mfma_f32_16x16x32_bf16 v[48:51], v[128:131], a[216:219], v[48:51]
    buffer_load_dwordx4 v235, s[52:55], s70 offen offset:0 nt lds
    v_mfma_f32_16x16x32_bf16 v[48:51], v[132:135], a[220:223], v[48:51]
    ds_read_b64_tr_b16 v[150:151], v228 offset:10752
    v_mul_f32 v187, v187, v99
    s_waitcnt lgkmcnt(4)
    v_mfma_f32_16x16x32_bf16 v[4:7], v[136:139], a[192:195], v[4:7]
    ds_read_b64_tr_b16 v[128:129], v229 offset:8192
    s_add_u32 s71, s71, 128
    v_mul_f32 v188, v188, v100
    v_mfma_f32_16x16x32_bf16 v[4:7], v[140:143], a[196:199], v[4:7]
    buffer_load_dwordx4 v235, s[52:55], s71 offen offset:1024 nt lds
    v_mul_f32 v189, v189, v101
    v_mfma_f32_16x16x32_bf16 v[20:23], v[136:139], a[200:203], v[20:23]
    ds_read_b64_tr_b16 v[130:131], v229 offset:8704
    v_exp_f32 v185, v185
    v_mfma_f32_16x16x32_bf16 v[20:23], v[140:143], a[204:207], v[20:23]
    v_exp_f32 v186, v186
    v_mul_f32 v190, v190, v102
    v_mfma_f32_16x16x32_bf16 v[36:39], v[136:139], a[208:211], v[36:39]
    ds_read_b64_tr_b16 v[132:133], v229 offset:10240
    v_mul_f32 v191, v191, v103
    v_mfma_f32_16x16x32_bf16 v[36:39], v[140:143], a[212:215], v[36:39]
    v_exp_f32 v187, v187
    v_mul_f32 v96, v96, v104
    v_mfma_f32_16x16x32_bf16 v[52:55], v[136:139], a[216:219], v[52:55]
    ds_read_b64_tr_b16 v[134:135], v229 offset:10752
    v_mul_f32 v97, v97, v105
    v_mfma_f32_16x16x32_bf16 v[52:55], v[140:143], a[220:223], v[52:55]
    v_mul_f32 v98, v98, v106
    s_waitcnt lgkmcnt(4)
    v_mfma_f32_16x16x32_bf16 v[8:11], v[144:147], a[192:195], v[8:11]
    ds_read_b64_tr_b16 v[136:137], v228 offset:16384
    v_exp_f32 v188, v188
    v_mfma_f32_16x16x32_bf16 v[8:11], v[148:151], a[196:199], v[8:11]
    v_exp_f32 v189, v189
    v_mul_f32 v99, v99, v107
    v_mfma_f32_16x16x32_bf16 v[24:27], v[144:147], a[200:203], v[24:27]
    ds_read_b64_tr_b16 v[138:139], v228 offset:16896
    v_mul_f32 v100, v100, v108
    v_mfma_f32_16x16x32_bf16 v[24:27], v[148:151], a[204:207], v[24:27]
    v_exp_f32 v190, v190
    v_mul_f32 v101, v101, v109
    v_mfma_f32_16x16x32_bf16 v[40:43], v[144:147], a[208:211], v[40:43]
    ds_read_b64_tr_b16 v[140:141], v228 offset:18432
    v_mul_f32 v102, v102, v110
    v_mfma_f32_16x16x32_bf16 v[40:43], v[148:151], a[212:215], v[40:43]
    v_exp_f32 v191, v191
    v_mul_f32 v103, v103, v111
    v_mfma_f32_16x16x32_bf16 v[56:59], v[144:147], a[216:219], v[56:59]
    ds_read_b64_tr_b16 v[142:143], v228 offset:18944
    v_add_f32 v184, 1.0, v184
    v_mfma_f32_16x16x32_bf16 v[56:59], v[148:151], a[220:223], v[56:59]
    v_rcp_f32 v184, v184
    s_waitcnt lgkmcnt(4)
    v_mfma_f32_16x16x32_bf16 v[12:15], v[128:131], a[192:195], v[12:15]
    ds_read_b64_tr_b16 v[144:145], v229 offset:16384
    v_add_f32 v185, 1.0, v185
    v_add_f32 v186, 1.0, v186
    v_mfma_f32_16x16x32_bf16 v[12:15], v[132:135], a[196:199], v[12:15]
    v_rcp_f32 v185, v185
    v_add_f32 v187, 1.0, v187
    v_mfma_f32_16x16x32_bf16 v[28:31], v[128:131], a[200:203], v[28:31]
    ds_read_b64_tr_b16 v[146:147], v229 offset:16896
    v_rcp_f32 v186, v186
    v_mfma_f32_16x16x32_bf16 v[28:31], v[132:135], a[204:207], v[28:31]
    v_rcp_f32 v187, v187
    v_add_f32 v188, 1.0, v188
    v_mfma_f32_16x16x32_bf16 v[44:47], v[128:131], a[208:211], v[44:47]
    ds_read_b64_tr_b16 v[148:149], v229 offset:18432
    v_add_f32 v189, 1.0, v189
    v_mfma_f32_16x16x32_bf16 v[44:47], v[132:135], a[212:215], v[44:47]
    v_rcp_f32 v188, v188
    v_add_f32 v190, 1.0, v190
    v_mfma_f32_16x16x32_bf16 v[60:63], v[128:131], a[216:219], v[60:63]
    ds_read_b64_tr_b16 v[150:151], v229 offset:18944
    v_add_f32 v191, 1.0, v191
    v_mfma_f32_16x16x32_bf16 v[60:63], v[132:135], a[220:223], v[60:63]
    v_rcp_f32 v189, v189
    s_waitcnt lgkmcnt(4)
    v_mfma_f32_16x16x32_bf16 v[0:3], v[136:139], a[224:227], v[0:3]
    ds_read_b64_tr_b16 v[128:129], v228 offset:24576
    v_rcp_f32 v190, v190
    v_mfma_f32_16x16x32_bf16 v[0:3], v[140:143], a[228:231], v[0:3]
    v_rcp_f32 v191, v191
    v_mul_f32 v96, v96, v184
    v_mfma_f32_16x16x32_bf16 v[16:19], v[136:139], a[232:235], v[16:19]
    ds_read_b64_tr_b16 v[130:131], v228 offset:25088
    v_mul_f32 v97, v97, v185
    v_mfma_f32_16x16x32_bf16 v[16:19], v[140:143], a[236:239], v[16:19]
    v_mul_f32 v98, v98, v186
    v_mul_f32 v99, v99, v187
    v_mul_f32 v100, v100, v188
    v_mfma_f32_16x16x32_bf16 v[32:35], v[136:139], a[240:243], v[32:35]
    ds_read_b64_tr_b16 v[132:133], v228 offset:26624
    v_mul_f32 v101, v101, v189
    v_mfma_f32_16x16x32_bf16 v[32:35], v[140:143], a[244:247], v[32:35]
    v_mul_f32 v102, v102, v190
    v_mul_f32 v103, v103, v191
    v_cvt_pk_bf16_f32 v200, v96, v97
    v_mfma_f32_16x16x32_bf16 v[48:51], v[136:139], a[248:251], v[48:51]
    ds_read_b64_tr_b16 v[134:135], v228 offset:27136
    v_cvt_pk_bf16_f32 v202, v100, v101
    v_mfma_f32_16x16x32_bf16 v[48:51], v[140:143], a[252:255], v[48:51]
    v_cvt_pk_bf16_f32 v201, v98, v99
    v_cvt_pk_bf16_f32 v203, v102, v103
    s_waitcnt lgkmcnt(4)
    v_mfma_f32_16x16x32_bf16 v[4:7], v[144:147], a[224:227], v[4:7]
    ds_read_b64_tr_b16 v[136:137], v229 offset:24576
    v_permlane16_swap_b32 v200, v202
    v_mfma_f32_16x16x32_bf16 v[4:7], v[148:151], a[228:231], v[4:7]
    v_permlane16_swap_b32 v201, v203
    v_mul_f32 v184, v112, v112
    v_mfma_f32_16x16x32_bf16 v[20:23], v[144:147], a[232:235], v[20:23]
    ds_read_b64_tr_b16 v[138:139], v229 offset:25088
    buffer_store_dwordx4 v[200:203], v254, s[48:51], s64 offen offset:1024 sc1
    v_mfma_f32_16x16x32_bf16 v[20:23], v[148:151], a[236:239], v[20:23]
    v_mul_f32 v185, v113, v113
    v_mul_f32 v186, v114, v114
    v_mul_f32 v187, v115, v115
    v_mfma_f32_16x16x32_bf16 v[36:39], v[144:147], a[240:243], v[36:39]
    ds_read_b64_tr_b16 v[140:141], v229 offset:26624
    v_mul_f32 v188, v116, v116
    v_mfma_f32_16x16x32_bf16 v[36:39], v[148:151], a[244:247], v[36:39]
    v_mul_f32 v189, v117, v117
    v_mul_f32 v190, v118, v118
    v_mul_f32 v191, v119, v119
    v_mfma_f32_16x16x32_bf16 v[52:55], v[144:147], a[248:251], v[52:55]
    ds_read_b64_tr_b16 v[142:143], v229 offset:27136
    v_fma_f32 v184, v184, s89, v234
    v_mfma_f32_16x16x32_bf16 v[52:55], v[148:151], a[252:255], v[52:55]
    v_fma_f32 v185, v185, s89, v234
    v_fma_f32 v186, v186, s89, v234
    s_waitcnt lgkmcnt(4)
    v_mfma_f32_16x16x32_bf16 v[8:11], v[128:131], a[224:227], v[8:11]
    s_waitcnt vmcnt(4)
    s_barrier
    v_mfma_f32_16x16x32_bf16 v[8:11], v[132:135], a[228:231], v[8:11]
    v_fma_f32 v187, v187, s89, v234
    v_fma_f32 v188, v188, s89, v234
    v_fma_f32 v189, v189, s89, v234
    v_mfma_f32_16x16x32_bf16 v[24:27], v[128:131], a[232:235], v[24:27]
    ds_read_b64_tr_b16 v[144:145], v228 offset:32768
    v_fma_f32 v190, v190, s89, v234
    v_mfma_f32_16x16x32_bf16 v[24:27], v[132:135], a[236:239], v[24:27]
    ds_read_b64_tr_b16 v[146:147], v228 offset:33280
    v_fma_f32 v191, v191, s89, v234
    v_mfma_f32_16x16x32_bf16 v[40:43], v[128:131], a[240:243], v[40:43]
    ds_read_b64_tr_b16 v[148:149], v228 offset:34816
    v_mul_f32 v184, v184, v112
    v_mul_f32 v185, v185, v113
    v_mfma_f32_16x16x32_bf16 v[40:43], v[132:135], a[244:247], v[40:43]
    v_exp_f32 v184, v184
    v_mfma_f32_16x16x32_bf16 v[56:59], v[128:131], a[248:251], v[56:59]
    ds_read_b64_tr_b16 v[150:151], v228 offset:35328
    v_mul_f32 v186, v186, v114
    v_mfma_f32_16x16x32_bf16 v[56:59], v[132:135], a[252:255], v[56:59]
    v_mul_f32 v187, v187, v115
    s_waitcnt lgkmcnt(4)
    v_mfma_f32_16x16x32_bf16 v[12:15], v[136:139], a[224:227], v[12:15]
    ds_read_b64_tr_b16 v[128:129], v229 offset:32768
    v_exp_f32 v185, v185
    v_mfma_f32_16x16x32_bf16 v[12:15], v[140:143], a[228:231], v[12:15]
    v_exp_f32 v186, v186
    v_mul_f32 v188, v188, v116
    v_mfma_f32_16x16x32_bf16 v[28:31], v[136:139], a[232:235], v[28:31]
    ds_read_b64_tr_b16 v[130:131], v229 offset:33280
    v_mul_f32 v189, v189, v117
    v_mfma_f32_16x16x32_bf16 v[28:31], v[140:143], a[236:239], v[28:31]
    v_exp_f32 v187, v187
    v_mul_f32 v190, v190, v118
    v_mfma_f32_16x16x32_bf16 v[44:47], v[136:139], a[240:243], v[44:47]
    ds_read_b64_tr_b16 v[132:133], v229 offset:34816
    v_mul_f32 v191, v191, v119
    v_mfma_f32_16x16x32_bf16 v[44:47], v[140:143], a[244:247], v[44:47]
    v_exp_f32 v188, v188
    v_mul_f32 v112, v112, v120
    v_mfma_f32_16x16x32_bf16 v[60:63], v[136:139], a[248:251], v[60:63]
    ds_read_b64_tr_b16 v[134:135], v229 offset:35328
    v_mul_f32 v113, v113, v121
    v_mfma_f32_16x16x32_bf16 v[60:63], v[140:143], a[252:255], v[60:63]
    v_exp_f32 v189, v189
    s_waitcnt lgkmcnt(4)
    v_mfma_f32_16x16x32_bf16 v[0:3], v[144:147], v[152:155], v[0:3]
    ds_read_b64_tr_b16 v[136:137], v228 offset:40960
    v_exp_f32 v190, v190
    v_mfma_f32_16x16x32_bf16 v[0:3], v[148:151], v[156:159], v[0:3]
    v_exp_f32 v191, v191
    v_mul_f32 v114, v114, v122
    v_mfma_f32_16x16x32_bf16 v[16:19], v[144:147], v[160:163], v[16:19]
    ds_read_b64_tr_b16 v[138:139], v228 offset:41472
    v_mul_f32 v115, v115, v123
    v_mfma_f32_16x16x32_bf16 v[16:19], v[148:151], v[164:167], v[16:19]
    v_mul_f32 v116, v116, v124
    v_mul_f32 v117, v117, v125
    v_mul_f32 v118, v118, v126
    v_mfma_f32_16x16x32_bf16 v[32:35], v[144:147], v[168:171], v[32:35]
    ds_read_b64_tr_b16 v[140:141], v228 offset:43008
    v_mul_f32 v119, v119, v127
    v_mfma_f32_16x16x32_bf16 v[32:35], v[148:151], v[172:175], v[32:35]
    v_add_f32 v184, 1.0, v184
    v_add_f32 v185, 1.0, v185
    v_add_f32 v186, 1.0, v186
    v_mfma_f32_16x16x32_bf16 v[48:51], v[144:147], v[176:179], v[48:51]
    ds_read_b64_tr_b16 v[142:143], v228 offset:43520
    v_add_f32 v187, 1.0, v187
    v_mfma_f32_16x16x32_bf16 v[48:51], v[148:151], v[180:183], v[48:51]
    v_rcp_f32 v184, v184
    s_waitcnt lgkmcnt(4)
    v_mfma_f32_16x16x32_bf16 v[4:7], v[128:131], v[152:155], v[4:7]
    ds_read_b64_tr_b16 v[144:145], v229 offset:40960
    v_rcp_f32 v185, v185
    v_mfma_f32_16x16x32_bf16 v[4:7], v[132:135], v[156:159], v[4:7]
    v_rcp_f32 v186, v186
    v_add_f32 v188, 1.0, v188
    v_mfma_f32_16x16x32_bf16 v[20:23], v[128:131], v[160:163], v[20:23]
    ds_read_b64_tr_b16 v[146:147], v229 offset:41472
    v_rcp_f32 v187, v187
    v_mfma_f32_16x16x32_bf16 v[20:23], v[132:135], v[164:167], v[20:23]
    v_rcp_f32 v188, v188
    v_add_f32 v189, 1.0, v189
    v_mfma_f32_16x16x32_bf16 v[36:39], v[128:131], v[168:171], v[36:39]
    ds_read_b64_tr_b16 v[148:149], v229 offset:43008
    v_add_f32 v190, 1.0, v190
    v_mfma_f32_16x16x32_bf16 v[36:39], v[132:135], v[172:175], v[36:39]
    v_rcp_f32 v189, v189
    v_add_f32 v191, 1.0, v191
    v_mfma_f32_16x16x32_bf16 v[52:55], v[128:131], v[176:179], v[52:55]
    ds_read_b64_tr_b16 v[150:151], v229 offset:43520
    v_mul_f32 v112, v112, v184
    v_mfma_f32_16x16x32_bf16 v[52:55], v[132:135], v[180:183], v[52:55]
    v_rcp_f32 v190, v190
    s_waitcnt lgkmcnt(4)
    v_mfma_f32_16x16x32_bf16 v[8:11], v[136:139], v[152:155], v[8:11]
    ds_read_b64_tr_b16 v[128:129], v224 offset:0
    v_rcp_f32 v191, v191
    v_mfma_f32_16x16x32_bf16 v[8:11], v[140:143], v[156:159], v[8:11]
    v_mul_f32 v113, v113, v185
    v_mul_f32 v114, v114, v186
    v_mul_f32 v115, v115, v187
    v_mfma_f32_16x16x32_bf16 v[24:27], v[136:139], v[160:163], v[24:27]
    ds_read_b64_tr_b16 v[130:131], v224 offset:512
    v_mul_f32 v116, v116, v188
    v_mfma_f32_16x16x32_bf16 v[24:27], v[140:143], v[164:167], v[24:27]
    v_mul_f32 v117, v117, v189
    v_mul_f32 v118, v118, v190
    v_mul_f32 v119, v119, v191
    v_mfma_f32_16x16x32_bf16 v[40:43], v[136:139], v[168:171], v[40:43]
    ds_read_b64_tr_b16 v[132:133], v224 offset:2048
    v_cvt_pk_bf16_f32 v204, v112, v113
    v_mfma_f32_16x16x32_bf16 v[40:43], v[140:143], v[172:175], v[40:43]
    v_cvt_pk_bf16_f32 v206, v116, v117
    v_cvt_pk_bf16_f32 v205, v114, v115
    v_cvt_pk_bf16_f32 v207, v118, v119
    v_mfma_f32_16x16x32_bf16 v[56:59], v[136:139], v[176:179], v[56:59]
    ds_read_b64_tr_b16 v[134:135], v224 offset:2560
    v_mfma_f32_16x16x32_bf16 v[56:59], v[140:143], v[180:183], v[56:59]
    v_permlane16_swap_b32 v204, v206
    s_waitcnt lgkmcnt(4)
    v_mfma_f32_16x16x32_bf16 v[12:15], v[144:147], v[152:155], v[12:15]
    ds_read_b64_tr_b16 v[136:137], v225 offset:0
    v_mfma_f32_16x16x32_bf16 v[12:15], v[148:151], v[156:159], v[12:15]
    v_permlane16_swap_b32 v205, v207
    v_mfma_f32_16x16x32_bf16 v[28:31], v[144:147], v[160:163], v[28:31]
    ds_read_b64_tr_b16 v[138:139], v225 offset:512
    v_mfma_f32_16x16x32_bf16 v[28:31], v[148:151], v[164:167], v[28:31]
    buffer_store_dwordx4 v[204:207], v254, s[48:51], s64 offen offset:1280 sc1
    v_mfma_f32_16x16x32_bf16 v[44:47], v[144:147], v[168:171], v[44:47]
    ds_read_b64_tr_b16 v[140:141], v225 offset:2048
    v_mfma_f32_16x16x32_bf16 v[44:47], v[148:151], v[172:175], v[44:47]
    v_mfma_f32_16x16x32_bf16 v[60:63], v[144:147], v[176:179], v[60:63]
    ds_read_b64_tr_b16 v[142:143], v225 offset:2560
    v_mfma_f32_16x16x32_bf16 v[60:63], v[148:151], v[180:183], v[60:63]
L_b3:
    s_waitcnt lgkmcnt(4)
    v_mfma_f32_16x16x32_bf16 v[64:67], v[128:131], a[0:3], 0
    ds_read_b64_tr_b16 v[144:145], v224 offset:8192
    s_and_b32 s78, s66, 0xff
    v_mfma_f32_16x16x32_bf16 v[64:67], v[132:135], a[4:7], v[64:67]
    s_lshl_b32 s78, s78, 13
    s_add_u32 s64, s65, s78
    v_mfma_f32_16x16x32_bf16 v[80:83], v[128:131], a[8:11], 0
    ds_read_b64_tr_b16 v[146:147], v224 offset:8704
    s_add_u32 m0, s68, 49152
    v_mfma_f32_16x16x32_bf16 v[80:83], v[132:135], a[12:15], v[80:83]
    s_add_u32 s61, s61, s62
    s_cmp_eq_u32 s61, s101
    v_mfma_f32_16x16x32_bf16 v[96:99], v[128:131], a[16:19], 0
    s_cselect_b32 s61, s100, s61
    ds_read_b64_tr_b16 v[148:149], v224 offset:10240
    v_mfma_f32_16x16x32_bf16 v[96:99], v[132:135], a[20:23], v[96:99]
    buffer_load_dwordx4 v220, s[32:35], s61 offen offset:0 sc1 lds
    v_mfma_f32_16x16x32_bf16 v[112:115], v[128:131], a[24:27], 0
    ds_read_b64_tr_b16 v[150:151], v224 offset:10752
    v_mfma_f32_16x16x32_bf16 v[112:115], v[132:135], a[28:31], v[112:115]
    s_waitcnt lgkmcnt(4)
    v_mfma_f32_16x16x32_bf16 v[68:71], v[136:139], a[0:3], 0
    ds_read_b64_tr_b16 v[128:129], v225 offset:8192
    v_mul_f32 v184, v0, v0
    v_mfma_f32_16x16x32_bf16 v[68:71], v[140:143], a[4:7], v[68:71]
    buffer_load_dwordx4 v221, s[32:35], s61 offen offset:1024 sc1 lds
    v_mfma_f32_16x16x32_bf16 v[84:87], v[136:139], a[8:11], 0
    ds_read_b64_tr_b16 v[130:131], v225 offset:8704
    v_mul_f32 v185, v1, v1
    v_mfma_f32_16x16x32_bf16 v[84:87], v[140:143], a[12:15], v[84:87]
    v_mul_f32 v186, v2, v2
    v_mul_f32 v187, v3, v3
    v_mfma_f32_16x16x32_bf16 v[100:103], v[136:139], a[16:19], 0
    ds_read_b64_tr_b16 v[132:133], v225 offset:10240
    v_mul_f32 v188, v4, v4
    v_mfma_f32_16x16x32_bf16 v[100:103], v[140:143], a[20:23], v[100:103]
    buffer_load_dwordx4 v222, s[32:35], s61 offen offset:2048 sc1 lds
    v_mfma_f32_16x16x32_bf16 v[116:119], v[136:139], a[24:27], 0
    ds_read_b64_tr_b16 v[134:135], v225 offset:10752
    v_mul_f32 v189, v5, v5
    v_mfma_f32_16x16x32_bf16 v[116:119], v[140:143], a[28:31], v[116:119]
    v_mul_f32 v190, v6, v6
    v_mul_f32 v191, v7, v7
    s_waitcnt lgkmcnt(4)
    v_mfma_f32_16x16x32_bf16 v[72:75], v[144:147], a[0:3], 0
    ds_read_b64_tr_b16 v[136:137], v224 offset:16384
    v_fma_f32 v184, v184, s89, v234
    v_mfma_f32_16x16x32_bf16 v[72:75], v[148:151], a[4:7], v[72:75]
    v_fma_f32 v185, v185, s89, v234
    v_fma_f32 v186, v186, s89, v234
    v_mfma_f32_16x16x32_bf16 v[88:91], v[144:147], a[8:11], 0
    ds_read_b64_tr_b16 v[138:139], v224 offset:16896
    v_fma_f32 v187, v187, s89, v234
    v_mfma_f32_16x16x32_bf16 v[88:91], v[148:151], a[12:15], v[88:91]
    v_fma_f32 v188, v188, s89, v234
    v_fma_f32 v189, v189, s89, v234
    v_mfma_f32_16x16x32_bf16 v[104:107], v[144:147], a[16:19], 0
    ds_read_b64_tr_b16 v[140:141], v224 offset:18432
    buffer_load_dwordx4 v223, s[32:35], s61 offen offset:3072 sc1 lds
    v_mfma_f32_16x16x32_bf16 v[104:107], v[148:151], a[20:23], v[104:107]
    v_fma_f32 v190, v190, s89, v234
    v_fma_f32 v191, v191, s89, v234
    v_mfma_f32_16x16x32_bf16 v[120:123], v[144:147], a[24:27], 0
    ds_read_b64_tr_b16 v[142:143], v224 offset:18944
    s_add_u32 m0, s68, 65536
    s_add_u32 s61, s61, s62
    v_mfma_f32_16x16x32_bf16 v[120:123], v[148:151], a[28:31], v[120:123]
    s_cmp_eq_u32 s61, s101
    s_cselect_b32 s61, s100, s61
    s_waitcnt lgkmcnt(4)
    v_mfma_f32_16x16x32_bf16 v[76:79], v[128:131], a[0:3], 0
    ds_read_b64_tr_b16 v[144:145], v225 offset:16384
    v_mul_f32 v184, v184, v0
    v_mfma_f32_16x16x32_bf16 v[76:79], v[132:135], a[4:7], v[76:79]
    buffer_load_dwordx4 v220, s[32:35], s61 offen offset:0 sc1 lds
    v_mfma_f32_16x16x32_bf16 v[92:95], v[128:131], a[8:11], 0
    ds_read_b64_tr_b16 v[146:147], v225 offset:16896
    v_exp_f32 v184, v184
    v_mfma_f32_16x16x32_bf16 v[92:95], v[132:135], a[12:15], v[92:95]
    v_mul_f32 v185, v185, v1
    v_mul_f32 v186, v186, v2
    v_mfma_f32_16x16x32_bf16 v[108:111], v[128:131], a[16:19], 0
    ds_read_b64_tr_b16 v[148:149], v225 offset:18432
    v_mul_f32 v187, v187, v3
    v_mfma_f32_16x16x32_bf16 v[108:111], v[132:135], a[20:23], v[108:111]
    buffer_load_dwordx4 v221, s[32:35], s61 offen offset:1024 sc1 lds
    v_mfma_f32_16x16x32_bf16 v[124:127], v[128:131], a[24:27], 0
    ds_read_b64_tr_b16 v[150:151], v225 offset:18944
    v_exp_f32 v185, v185
    v_mfma_f32_16x16x32_bf16 v[124:127], v[132:135], a[28:31], v[124:127]
    v_mul_f32 v188, v188, v4
    s_waitcnt lgkmcnt(4)
    v_mfma_f32_16x16x32_bf16 v[64:67], v[136:139], a[32:35], v[64:67]
    ds_read_b64_tr_b16 v[128:129], v224 offset:24576
    v_exp_f32 v186, v186
    v_mfma_f32_16x16x32_bf16 v[64:67], v[140:143], a[36:39], v[64:67]
    v_exp_f32 v187, v187
    v_mfma_f32_16x16x32_bf16 v[80:83], v[136:139], a[40:43], v[80:83]
    ds_read_b64_tr_b16 v[130:131], v224 offset:25088
    v_mul_f32 v189, v189, v5
    v_mfma_f32_16x16x32_bf16 v[80:83], v[140:143], a[44:47], v[80:83]
    v_exp_f32 v188, v188
    v_mfma_f32_16x16x32_bf16 v[96:99], v[136:139], a[48:51], v[96:99]
    ds_read_b64_tr_b16 v[132:133], v224 offset:26624
    v_mul_f32 v190, v190, v6
    v_mfma_f32_16x16x32_bf16 v[96:99], v[140:143], a[52:55], v[96:99]
    buffer_load_dwordx4 v222, s[32:35], s61 offen offset:2048 sc1 lds
    v_mul_f32 v191, v191, v7
    v_mfma_f32_16x16x32_bf16 v[112:115], v[136:139], a[56:59], v[112:115]
    ds_read_b64_tr_b16 v[134:135], v224 offset:27136
    v_exp_f32 v189, v189
    v_mfma_f32_16x16x32_bf16 v[112:115], v[140:143], a[60:63], v[112:115]
    v_exp_f32 v190, v190
    s_waitcnt lgkmcnt(4)
    v_mfma_f32_16x16x32_bf16 v[68:71], v[144:147], a[32:35], v[68:71]
    ds_read_b64_tr_b16 v[136:137], v225 offset:24576
    v_mul_f32 v0, v0, v8
    v_mfma_f32_16x16x32_bf16 v[68:71], v[148:151], a[36:39], v[68:71]
    buffer_load_dwordx4 v223, s[32:35], s61 offen offset:3072 sc1 lds
    v_mfma_f32_16x16x32_bf16 v[84:87], v[144:147], a[40:43], v[84:87]
    ds_read_b64_tr_b16 v[138:139], v225 offset:25088
    s_add_u32 m0, s68, 81920
    v_mfma_f32_16x16x32_bf16 v[84:87], v[148:151], a[44:47], v[84:87]
    s_add_u32 s61, s61, s62
    s_cmp_eq_u32 s61, s101
    v_mfma_f32_16x16x32_bf16 v[100:103], v[144:147], a[48:51], v[100:103]
    s_cselect_b32 s61, s100, s61
    ds_read_b64_tr_b16 v[140:141], v225 offset:26624
    v_mul_f32 v1, v1, v9
    v_mfma_f32_16x16x32_bf16 v[100:103], v[148:151], a[52:55], v[100:103]
    buffer_load_dwordx4 v220, s[32:35], s61 offen offset:0 sc1 lds
    v_mfma_f32_16x16x32_bf16 v[116:119], v[144:147], a[56:59], v[116:119]
    ds_read_b64_tr_b16 v[142:143], v225 offset:27136
    v_exp_f32 v191, v191
    v_mfma_f32_16x16x32_bf16 v[116:119], v[148:151], a[60:63], v[116:119]
    v_mul_f32 v2, v2, v10
    s_waitcnt lgkmcnt(4)
    v_mfma_f32_16x16x32_bf16 v[72:75], v[128:131], a[32:35], v[72:75]
    ds_read_b64_tr_b16 v[144:145], v224 offset:32768
    v_mul_f32 v3, v3, v11
    v_mfma_f32_16x16x32_bf16 v[72:75], v[132:135], a[36:39], v[72:75]
    v_mul_f32 v4, v4, v12
    v_mul_f32 v5, v5, v13
    v_mul_f32 v6, v6, v14
    v_mfma_f32_16x16x32_bf16 v[88:91], v[128:131], a[40:43], v[88:91]
    ds_read_b64_tr_b16 v[146:147], v224 offset:33280
    v_mul_f32 v7, v7, v15
    v_mfma_f32_16x16x32_bf16 v[88:91], v[132:135], a[44:47], v[88:91]
    v_add_f32 v184, 1.0, v184
    v_add_f32 v185, 1.0, v185
    v_mfma_f32_16x16x32_bf16 v[104:107], v[128:131], a[48:51], v[104:107]
    ds_read_b64_tr_b16 v[148:149], v224 offset:34816
    v_add_f32 v186, 1.0, v186
    v_mfma_f32_16x16x32_bf16 v[104:107], v[132:135], a[52:55], v[104:107]
    buffer_load_dwordx4 v221, s[32:35], s61 offen offset:1024 sc1 lds
    v_mfma_f32_16x16x32_bf16 v[120:123], v[128:131], a[56:59], v[120:123]
    ds_read_b64_tr_b16 v[150:151], v224 offset:35328
    v_rcp_f32 v184, v184
    v_mfma_f32_16x16x32_bf16 v[120:123], v[132:135], a[60:63], v[120:123]
    v_rcp_f32 v185, v185
    s_waitcnt lgkmcnt(4)
    v_mfma_f32_16x16x32_bf16 v[76:79], v[136:139], a[32:35], v[76:79]
    ds_read_b64_tr_b16 v[128:129], v225 offset:32768
    v_rcp_f32 v186, v186
    v_mfma_f32_16x16x32_bf16 v[76:79], v[140:143], a[36:39], v[76:79]
    buffer_load_dwordx4 v222, s[32:35], s61 offen offset:2048 sc1 lds
    v_mfma_f32_16x16x32_bf16 v[92:95], v[136:139], a[40:43], v[92:95]
    ds_read_b64_tr_b16 v[130:131], v225 offset:33280
    v_add_f32 v187, 1.0, v187
    v_add_f32 v188, 1.0, v188
    v_mfma_f32_16x16x32_bf16 v[92:95], v[140:143], a[44:47], v[92:95]
    v_rcp_f32 v187, v187
    v_mfma_f32_16x16x32_bf16 v[108:111], v[136:139], a[48:51], v[108:111]
    ds_read_b64_tr_b16 v[132:133], v225 offset:34816
    v_add_f32 v189, 1.0, v189
    v_mfma_f32_16x16x32_bf16 v[108:111], v[140:143], a[52:55], v[108:111]
    buffer_load_dwordx4 v223, s[32:35], s61 offen offset:3072 sc1 lds
    v_mfma_f32_16x16x32_bf16 v[124:127], v[136:139], a[56:59], v[124:127]
    ds_read_b64_tr_b16 v[134:135], v225 offset:35328
    v_rcp_f32 v188, v188
    v_mfma_f32_16x16x32_bf16 v[124:127], v[140:143], a[60:63], v[124:127]
    v_add_f32 v190, 1.0, v190
    s_waitcnt lgkmcnt(4)
    v_mfma_f32_16x16x32_bf16 v[64:67], v[144:147], a[64:67], v[64:67]
    ds_read_b64_tr_b16 v[136:137], v224 offset:40960
    v_add_f32 v191, 1.0, v191
    v_mfma_f32_16x16x32_bf16 v[64:67], v[148:151], a[68:71], v[64:67]
    v_rcp_f32 v189, v189
    v_mfma_f32_16x16x32_bf16 v[80:83], v[144:147], a[72:75], v[80:83]
    ds_read_b64_tr_b16 v[138:139], v224 offset:41472
    s_add_u32 m0, s68, 98304
    v_mfma_f32_16x16x32_bf16 v[80:83], v[148:151], a[76:79], v[80:83]
    s_add_u32 s61, s61, s62
    s_cmp_eq_u32 s61, s101
    v_mfma_f32_16x16x32_bf16 v[96:99], v[144:147], a[80:83], v[96:99]
    s_cselect_b32 s61, s100, s61
    ds_read_b64_tr_b16 v[140:141], v224 offset:43008
    v_mul_f32 v0, v0, v184
    v_mfma_f32_16x16x32_bf16 v[96:99], v[148:151], a[84:87], v[96:99]
    buffer_load_dwordx4 v220, s[32:35], s61 offen offset:0 sc1 lds
    v_mul_f32 v1, v1, v185
    v_mfma_f32_16x16x32_bf16 v[112:115], v[144:147], a[88:91], v[112:115]
    ds_read_b64_tr_b16 v[142:143], v224 offset:43520
    v_rcp_f32 v190, v190
    v_mfma_f32_16x16x32_bf16 v[112:115], v[148:151], a[92:95], v[112:115]
    v_mul_f32 v2, v2, v186
    s_waitcnt lgkmcnt(4)
    v_mfma_f32_16x16x32_bf16 v[68:71], v[128:131], a[64:67], v[68:71]
    ds_read_b64_tr_b16 v[144:145], v225 offset:40960
    v_mul_f32 v3, v3, v187
    v_mfma_f32_16x16x32_bf16 v[68:71], v[132:135], a[68:71], v[68:71]
    buffer_load_dwordx4 v221, s[32:35], s61 offen offset:1024 sc1 lds
    v_mfma_f32_16x16x32_bf16 v[84:87], v[128:131], a[72:75], v[84:87]
    ds_read_b64_tr_b16 v[146:147], v225 offset:41472
    v_rcp_f32 v191, v191
    v_mfma_f32_16x16x32_bf16 v[84:87], v[132:135], a[76:79], v[84:87]
    v_mul_f32 v4, v4, v188
    v_mul_f32 v5, v5, v189
    v_mul_f32 v6, v6, v190
    v_mfma_f32_16x16x32_bf16 v[100:103], v[128:131], a[80:83], v[100:103]
    ds_read_b64_tr_b16 v[148:149], v225 offset:43008
    v_mul_f32 v7, v7, v191
    v_mfma_f32_16x16x32_bf16 v[100:103], v[132:135], a[84:87], v[100:103]
    buffer_load_dwordx4 v222, s[32:35], s61 offen offset:2048 sc1 lds
    v_mfma_f32_16x16x32_bf16 v[116:119], v[128:131], a[88:91], v[116:119]
    ds_read_b64_tr_b16 v[150:151], v225 offset:43520
    v_cvt_pk_bf16_f32 v200, v0, v1
    v_cvt_pk_bf16_f32 v202, v4, v5
    v_mfma_f32_16x16x32_bf16 v[116:119], v[132:135], a[92:95], v[116:119]
    v_cvt_pk_bf16_f32 v201, v2, v3
    s_waitcnt lgkmcnt(4)
    v_mfma_f32_16x16x32_bf16 v[72:75], v[136:139], a[64:67], v[72:75]
    s_waitcnt vmcnt(7)
    s_barrier
    v_mfma_f32_16x16x32_bf16 v[72:75], v[140:143], a[68:71], v[72:75]
    v_permlane16_swap_b32 v200, v202
    v_mfma_f32_16x16x32_bf16 v[88:91], v[136:139], a[72:75], v[88:91]
    ds_read_b64_tr_b16 v[128:129], v226 offset:0
    ds_read_b64_tr_b16 v[130:131], v226 offset:512
    ds_read_b64_tr_b16 v[208:209], v236 offset:16384
    v_mfma_f32_16x16x32_bf16 v[88:91], v[140:143], a[76:79], v[88:91]
    v_cvt_pk_bf16_f32 v203, v6, v7
    v_mul_f32 v184, v16, v16
    v_mfma_f32_16x16x32_bf16 v[104:107], v[136:139], a[80:83], v[104:107]
    ds_read_b64_tr_b16 v[132:133], v226 offset:2048
    buffer_load_dwordx4 v223, s[32:35], s61 offen offset:3072 sc1 lds
    v_mfma_f32_16x16x32_bf16 v[104:107], v[140:143], a[84:87], v[104:107]
    ds_read_b64_tr_b16 v[210:211], v236 offset:16896
    v_mul_f32 v185, v17, v17
    v_mfma_f32_16x16x32_bf16 v[120:123], v[136:139], a[88:91], v[120:123]
    ds_read_b64_tr_b16 v[134:135], v226 offset:2560
    s_add_u32 m0, s68, 114688
    s_add_u32 s61, s61, s62
    v_mfma_f32_16x16x32_bf16 v[120:123], v[140:143], a[92:95], v[120:123]
    s_cmp_eq_u32 s61, s101
    s_cselect_b32 s61, s100, s61
    s_waitcnt lgkmcnt(6)
    v_mfma_f32_16x16x32_bf16 v[76:79], v[144:147], a[64:67], v[76:79]
    ds_read_b64_tr_b16 v[136:137], v227 offset:0
    v_mul_f32 v186, v18, v18
    v_mfma_f32_16x16x32_bf16 v[76:79], v[148:151], a[68:71], v[76:79]
    buffer_load_dwordx4 v220, s[32:35], s61 offen offset:0 sc1 lds
    v_mfma_f32_16x16x32_bf16 v[92:95], v[144:147], a[72:75], v[92:95]
    ds_read_b64_tr_b16 v[138:139], v227 offset:512
    ds_read_b64_tr_b16 v[212:213], v236 offset:16448
    v_mfma_f32_16x16x32_bf16 v[92:95], v[148:151], a[76:79], v[92:95]
    ds_read_b64_tr_b16 v[214:215], v236 offset:16960
    v_mul_f32 v187, v19, v19
    v_mfma_f32_16x16x32_bf16 v[108:111], v[144:147], a[80:83], v[108:111]
    ds_read_b64_tr_b16 v[140:141], v227 offset:2048
    v_mul_f32 v188, v20, v20
    v_mfma_f32_16x16x32_bf16 v[108:111], v[148:151], a[84:87], v[108:111]
    buffer_load_dwordx4 v221, s[32:35], s61 offen offset:1024 sc1 lds
    v_mfma_f32_16x16x32_bf16 v[124:127], v[144:147], a[88:91], v[124:127]
    ds_read_b64_tr_b16 v[142:143], v227 offset:2560
    v_mul_f32 v189, v21, v21
    v_mfma_f32_16x16x32_bf16 v[124:127], v[148:151], a[92:95], v[124:127]
    v_mul_f32 v190, v22, v22
    s_waitcnt lgkmcnt(6)
    v_mfma_f32_16x16x32_bf16 v[64:67], v[128:131], a[96:99], v[64:67]
    ds_read_b64_tr_b16 v[144:145], v226 offset:8192
    v_mul_f32 v191, v23, v23
    v_mfma_f32_16x16x32_bf16 v[64:67], v[132:135], a[100:103], v[64:67]
    v_permlane16_swap_b32 v201, v203
    v_mfma_f32_16x16x32_bf16 v[80:83], v[128:131], a[104:107], v[80:83]
    ds_read_b64_tr_b16 v[146:147], v226 offset:8704
    s_waitcnt lgkmcnt(4)
    v_mfma_f32_16x16x32_bf16 v[80:83], v[132:135], a[108:111], v[80:83]
    buffer_store_dwordx4 v[208:211], v233, s[56:59], s73 offen offset:1024 sc1
    v_mfma_f32_16x16x32_bf16 v[96:99], v[128:131], a[112:115], v[96:99]
    ds_read_b64_tr_b16 v[148:149], v226 offset:10240
    v_fma_f32 v184, v184, s89, v234
    v_mfma_f32_16x16x32_bf16 v[96:99], v[132:135], a[116:119], v[96:99]
    buffer_load_dwordx4 v222, s[32:35], s61 offen offset:2048 sc1 lds
    v_mfma_f32_16x16x32_bf16 v[112:115], v[128:131], a[120:123], v[112:115]
    ds_read_b64_tr_b16 v[150:151], v226 offset:10752
    v_fma_f32 v185, v185, s89, v234
    v_mfma_f32_16x16x32_bf16 v[112:115], v[132:135], a[124:127], v[112:115]
    buffer_store_dwordx4 v[212:215], v233, s[56:59], s73 offen offset:2048 sc1
    s_waitcnt lgkmcnt(4)
    v_mfma_f32_16x16x32_bf16 v[68:71], v[136:139], a[96:99], v[68:71]
    ds_read_b64_tr_b16 v[128:129], v227 offset:8192
    v_fma_f32 v186, v186, s89, v234
    v_mfma_f32_16x16x32_bf16 v[68:71], v[140:143], a[100:103], v[68:71]
    buffer_load_dwordx4 v223, s[32:35], s61 offen offset:3072 sc1 lds
    v_mfma_f32_16x16x32_bf16 v[84:87], v[136:139], a[104:107], v[84:87]
    ds_read_b64_tr_b16 v[130:131], v227 offset:8704
    s_add_u32 m0, s68, 131072
    v_mfma_f32_16x16x32_bf16 v[84:87], v[140:143], a[108:111], v[84:87]
    s_add_u32 s61, s61, s62
    s_cmp_eq_u32 s61, s101
    v_mfma_f32_16x16x32_bf16 v[100:103], v[136:139], a[112:115], v[100:103]
    s_cselect_b32 s61, s100, s61
    ds_read_b64_tr_b16 v[132:133], v227 offset:10240
    v_mfma_f32_16x16x32_bf16 v[100:103], v[140:143], a[116:119], v[100:103]
    buffer_load_dwordx4 v220, s[32:35], s61 offen offset:0 sc1 lds
    v_mfma_f32_16x16x32_bf16 v[116:119], v[136:139], a[120:123], v[116:119]
    ds_read_b64_tr_b16 v[134:135], v227 offset:10752
    v_fma_f32 v187, v187, s89, v234
    v_mfma_f32_16x16x32_bf16 v[116:119], v[140:143], a[124:127], v[116:119]
    v_fma_f32 v188, v188, s89, v234
    s_waitcnt lgkmcnt(4)
    v_mfma_f32_16x16x32_bf16 v[72:75], v[144:147], a[96:99], v[72:75]
    ds_read_b64_tr_b16 v[136:137], v226 offset:16384
    v_fma_f32 v189, v189, s89, v234
    v_mfma_f32_16x16x32_bf16 v[72:75], v[148:151], a[100:103], v[72:75]
    buffer_store_dwordx4 v[200:203], v254, s[48:51], s64 offen offset:0 sc1
    v_mfma_f32_16x16x32_bf16 v[88:91], v[144:147], a[104:107], v[88:91]
    ds_read_b64_tr_b16 v[138:139], v226 offset:16896
    v_fma_f32 v190, v190, s89, v234
    v_mfma_f32_16x16x32_bf16 v[88:91], v[148:151], a[108:111], v[88:91]
    v_fma_f32 v191, v191, s89, v234
    v_mul_f32 v184, v184, v16
    v_mul_f32 v185, v185, v17
    v_mfma_f32_16x16x32_bf16 v[104:107], v[144:147], a[112:115], v[104:107]
    ds_read_b64_tr_b16 v[140:141], v226 offset:18432
    v_mul_f32 v186, v186, v18
    v_mfma_f32_16x16x32_bf16 v[104:107], v[148:151], a[116:119], v[104:107]
    buffer_load_dwordx4 v221, s[32:35], s61 offen offset:1024 sc1 lds
    v_mfma_f32_16x16x32_bf16 v[120:123], v[144:147], a[120:123], v[120:123]
    ds_read_b64_tr_b16 v[142:143], v226 offset:18944
    v_exp_f32 v184, v184
    v_mfma_f32_16x16x32_bf16 v[120:123], v[148:151], a[124:127], v[120:123]
    v_exp_f32 v185, v185
    s_waitcnt lgkmcnt(4)
    v_mfma_f32_16x16x32_bf16 v[76:79], v[128:131], a[96:99], v[76:79]
    ds_read_b64_tr_b16 v[144:145], v227 offset:16384
    v_mul_f32 v187, v187, v19
    v_mfma_f32_16x16x32_bf16 v[76:79], v[132:135], a[100:103], v[76:79]
    buffer_load_dwordx4 v222, s[32:35], s61 offen offset:2048 sc1 lds
    v_mul_f32 v188, v188, v20
    v_mfma_f32_16x16x32_bf16 v[92:95], v[128:131], a[104:107], v[92:95]
    ds_read_b64_tr_b16 v[146:147], v227 offset:16896
    v_exp_f32 v186, v186
    v_mfma_f32_16x16x32_bf16 v[92:95], v[132:135], a[108:111], v[92:95]
    v_exp_f32 v187, v187
    v_mfma_f32_16x16x32_bf16 v[108:111], v[128:131], a[112:115], v[108:111]
    ds_read_b64_tr_b16 v[148:149], v227 offset:18432
    v_mul_f32 v189, v189, v21
    v_mfma_f32_16x16x32_bf16 v[108:111], v[132:135], a[116:119], v[108:111]
    buffer_load_dwordx4 v223, s[32:35], s61 offen offset:3072 sc1 lds
    v_mfma_f32_16x16x32_bf16 v[124:127], v[128:131], a[120:123], v[124:127]
    ds_read_b64_tr_b16 v[150:151], v227 offset:18944
    v_exp_f32 v188, v188
    v_mfma_f32_16x16x32_bf16 v[124:127], v[132:135], a[124:127], v[124:127]
    v_mul_f32 v190, v190, v22
    s_waitcnt lgkmcnt(4)
    v_mfma_f32_16x16x32_bf16 v[64:67], v[136:139], a[128:131], v[64:67]
    ds_read_b64_tr_b16 v[128:129], v226 offset:24576
    s_mov_b32 s100, s88
    v_mfma_f32_16x16x32_bf16 v[64:67], v[140:143], a[132:135], v[64:67]
    s_lshl3_add_u32 s101, s63, s88
    v_exp_f32 v189, v189
    v_mfma_f32_16x16x32_bf16 v[80:83], v[136:139], a[136:139], v[80:83]
    ds_read_b64_tr_b16 v[130:131], v226 offset:25088
    s_add_u32 m0, s68, 0
    v_mfma_f32_16x16x32_bf16 v[80:83], v[140:143], a[140:143], v[80:83]
    s_mov_b32 s61, s101
    v_exp_f32 v190, v190
    v_mfma_f32_16x16x32_bf16 v[96:99], v[136:139], a[144:147], v[96:99]
    ds_read_b64_tr_b16 v[132:133], v226 offset:26624
    v_mul_f32 v191, v191, v23
    v_mfma_f32_16x16x32_bf16 v[96:99], v[140:143], a[148:151], v[96:99]
    buffer_load_dwordx4 v220, s[32:35], s61 offen offset:0 sc1 lds
    v_mfma_f32_16x16x32_bf16 v[112:115], v[136:139], a[152:155], v[112:115]
    ds_read_b64_tr_b16 v[134:135], v226 offset:27136
    v_exp_f32 v191, v191
    v_mfma_f32_16x16x32_bf16 v[112:115], v[140:143], a[156:159], v[112:115]
    v_mul_f32 v16, v16, v24
    s_waitcnt lgkmcnt(4)
    v_mfma_f32_16x16x32_bf16 v[68:71], v[144:147], a[128:131], v[68:71]
    ds_read_b64_tr_b16 v[136:137], v227 offset:24576
    v_mul_f32 v17, v17, v25
    v_mfma_f32_16x16x32_bf16 v[68:71], v[148:151], a[132:135], v[68:71]
    buffer_load_dwordx4 v221, s[32:35], s61 offen offset:1024 sc1 lds
    v_mfma_f32_16x16x32_bf16 v[84:87], v[144:147], a[136:139], v[84:87]
    ds_read_b64_tr_b16 v[138:139], v227 offset:25088
    s_lshl_b32 s92, s2, 2
    v_mfma_f32_16x16x32_bf16 v[84:87], v[148:151], a[140:143], v[84:87]
    s_add_u32 s92, s92, 31785984
    v_mul_f32 v18, v18, v26
    v_mul_f32 v19, v19, v27
    v_mfma_f32_16x16x32_bf16 v[100:103], v[144:147], a[144:147], v[100:103]
    ds_read_b64_tr_b16 v[140:141], v227 offset:26624
    v_mul_f32 v20, v20, v28
    v_mfma_f32_16x16x32_bf16 v[100:103], v[148:151], a[148:151], v[100:103]
    buffer_load_dwordx4 v222, s[32:35], s61 offen offset:2048 sc1 lds
    v_mfma_f32_16x16x32_bf16 v[116:119], v[144:147], a[152:155], v[116:119]
    ds_read_b64_tr_b16 v[142:143], v227 offset:27136
    v_mul_f32 v21, v21, v29
    v_mul_f32 v22, v22, v30
    v_mfma_f32_16x16x32_bf16 v[116:119], v[148:151], a[156:159], v[116:119]
    v_mul_f32 v23, v23, v31
    s_waitcnt lgkmcnt(4)
    v_mfma_f32_16x16x32_bf16 v[72:75], v[128:131], a[128:131], v[72:75]
    s_waitcnt vmcnt(8)
    s_barrier
    v_mfma_f32_16x16x32_bf16 v[72:75], v[132:135], a[132:135], v[72:75]
    v_add_f32 v184, 1.0, v184
    v_add_f32 v185, 1.0, v185
    v_mfma_f32_16x16x32_bf16 v[88:91], v[128:131], a[136:139], v[88:91]
    ds_read_b64_tr_b16 v[144:145], v226 offset:32768
    ds_read_b64_tr_b16 v[146:147], v226 offset:33280
    v_mfma_f32_16x16x32_bf16 v[88:91], v[132:135], a[140:143], v[88:91]
    buffer_store_dword v240, v239, s[44:47], s92 offen sc1
    v_mfma_f32_16x16x32_bf16 v[104:107], v[128:131], a[144:147], v[104:107]
    ds_read_b64_tr_b16 v[148:149], v226 offset:34816
    v_add_f32 v186, 1.0, v186
    v_mfma_f32_16x16x32_bf16 v[104:107], v[132:135], a[148:151], v[104:107]
    buffer_load_dwordx4 v223, s[32:35], s61 offen offset:3072 sc1 lds
    v_mfma_f32_16x16x32_bf16 v[120:123], v[128:131], a[152:155], v[120:123]
    ds_read_b64_tr_b16 v[150:151], v226 offset:35328
    s_add_u32 m0, s68, 16384
    v_mfma_f32_16x16x32_bf16 v[120:123], v[132:135], a[156:159], v[120:123]
    s_mov_b32 s61, s31
    s_waitcnt lgkmcnt(4)
    v_mfma_f32_16x16x32_bf16 v[76:79], v[136:139], a[128:131], v[76:79]
    ds_read_b64_tr_b16 v[128:129], v227 offset:32768
    v_add_f32 v187, 1.0, v187
    v_mfma_f32_16x16x32_bf16 v[76:79], v[140:143], a[132:135], v[76:79]
    buffer_load_dwordx4 v220, s[32:35], s61 offen offset:0 sc1 lds
    v_mfma_f32_16x16x32_bf16 v[92:95], v[136:139], a[136:139], v[92:95]
    ds_read_b64_tr_b16 v[130:131], v227 offset:33280
    s_lshr_b64 s[66:67], s[66:67], 8
    v_mfma_f32_16x16x32_bf16 v[92:95], v[140:143], a[140:143], v[92:95]
    v_rcp_f32 v184, v184
    v_add_f32 v188, 1.0, v188
    v_mfma_f32_16x16x32_bf16 v[108:111], v[136:139], a[144:147], v[108:111]
    ds_read_b64_tr_b16 v[132:133], v227 offset:34816
    v_add_f32 v189, 1.0, v189
    v_mfma_f32_16x16x32_bf16 v[108:111], v[140:143], a[148:151], v[108:111]
    buffer_load_dwordx4 v221, s[32:35], s61 offen offset:1024 sc1 lds
    v_mfma_f32_16x16x32_bf16 v[124:127], v[136:139], a[152:155], v[124:127]
    ds_read_b64_tr_b16 v[134:135], v227 offset:35328
    v_add_f32 v190, 1.0, v190
    v_mfma_f32_16x16x32_bf16 v[124:127], v[140:143], a[156:159], v[124:127]
    v_add_f32 v191, 1.0, v191
    s_waitcnt lgkmcnt(4)
    v_mfma_f32_16x16x32_bf16 v[64:67], v[144:147], a[160:163], v[64:67]
    ds_read_b64_tr_b16 v[136:137], v226 offset:40960
    v_mul_f32 v16, v16, v184
    v_mfma_f32_16x16x32_bf16 v[64:67], v[148:151], a[164:167], v[64:67]
    v_rcp_f32 v185, v185
    v_mul_f32 v184, v32, v32
    v_mfma_f32_16x16x32_bf16 v[80:83], v[144:147], a[168:171], v[80:83]
    ds_read_b64_tr_b16 v[138:139], v226 offset:41472
    v_mul_f32 v17, v17, v185
    v_mfma_f32_16x16x32_bf16 v[80:83], v[148:151], a[172:175], v[80:83]
    v_rcp_f32 v186, v186
    v_mfma_f32_16x16x32_bf16 v[96:99], v[144:147], a[176:179], v[96:99]
    ds_read_b64_tr_b16 v[140:141], v226 offset:43008
    v_mul_f32 v18, v18, v186
    v_mfma_f32_16x16x32_bf16 v[96:99], v[148:151], a[180:183], v[96:99]
    buffer_load_dwordx4 v222, s[32:35], s61 offen offset:2048 sc1 lds
    v_cvt_pk_bf16_f32 v204, v16, v17
    v_mfma_f32_16x16x32_bf16 v[112:115], v[144:147], a[184:187], v[112:115]
    ds_read_b64_tr_b16 v[142:143], v226 offset:43520
    v_rcp_f32 v187, v187
    v_mfma_f32_16x16x32_bf16 v[112:115], v[148:151], a[188:191], v[112:115]
    v_rcp_f32 v188, v188
    s_waitcnt lgkmcnt(4)
    v_mfma_f32_16x16x32_bf16 v[68:71], v[128:131], a[160:163], v[68:71]
    ds_read_b64_tr_b16 v[144:145], v227 offset:40960
    v_mul_f32 v19, v19, v187
    v_mfma_f32_16x16x32_bf16 v[68:71], v[132:135], a[164:167], v[68:71]
    buffer_load_dwordx4 v223, s[32:35], s61 offen offset:3072 sc1 lds
    v_mfma_f32_16x16x32_bf16 v[84:87], v[128:131], a[168:171], v[84:87]
    ds_read_b64_tr_b16 v[146:147], v227 offset:41472
    s_add_u32 m0, s68, 32768
    v_mfma_f32_16x16x32_bf16 v[84:87], v[132:135], a[172:175], v[84:87]
    s_add_u32 s61, s61, s62
    s_cmp_eq_u32 s61, s101
    v_mfma_f32_16x16x32_bf16 v[100:103], v[128:131], a[176:179], v[100:103]
    s_cselect_b32 s61, s100, s61
    ds_read_b64_tr_b16 v[148:149], v227 offset:43008
    v_mul_f32 v20, v20, v188
    v_mfma_f32_16x16x32_bf16 v[100:103], v[132:135], a[180:183], v[100:103]
    buffer_load_dwordx4 v220, s[32:35], s61 offen offset:0 sc1 lds
    v_mfma_f32_16x16x32_bf16 v[116:119], v[128:131], a[184:187], v[116:119]
    ds_read_b64_tr_b16 v[150:151], v227 offset:43520
    v_rcp_f32 v189, v189
    v_mfma_f32_16x16x32_bf16 v[116:119], v[132:135], a[188:191], v[116:119]
    v_mul_f32 v21, v21, v189
    s_waitcnt lgkmcnt(4)
    v_mfma_f32_16x16x32_bf16 v[72:75], v[136:139], a[160:163], v[72:75]
    ds_read_b64_tr_b16 v[128:129], v228 offset:0
    v_cvt_pk_bf16_f32 v206, v20, v21
    v_mfma_f32_16x16x32_bf16 v[72:75], v[140:143], a[164:167], v[72:75]
    v_rcp_f32 v190, v190
    v_mfma_f32_16x16x32_bf16 v[88:91], v[136:139], a[168:171], v[88:91]
    ds_read_b64_tr_b16 v[130:131], v228 offset:512
    v_mul_f32 v22, v22, v190
    v_mfma_f32_16x16x32_bf16 v[88:91], v[140:143], a[172:175], v[88:91]
    v_rcp_f32 v191, v191
    v_cvt_pk_bf16_f32 v205, v18, v19
    v_mfma_f32_16x16x32_bf16 v[104:107], v[136:139], a[176:179], v[104:107]
    ds_read_b64_tr_b16 v[132:133], v228 offset:2048
    v_mul_f32 v23, v23, v191
    v_mfma_f32_16x16x32_bf16 v[104:107], v[140:143], a[180:183], v[104:107]
    buffer_load_dwordx4 v221, s[32:35], s61 offen offset:1024 sc1 lds
    v_mfma_f32_16x16x32_bf16 v[120:123], v[136:139], a[184:187], v[120:123]
    ds_read_b64_tr_b16 v[134:135], v228 offset:2560
    v_permlane16_swap_b32 v204, v206
    v_mfma_f32_16x16x32_bf16 v[120:123], v[140:143], a[188:191], v[120:123]
    v_cvt_pk_bf16_f32 v207, v22, v23
    v_mul_f32 v185, v33, v33
    s_waitcnt lgkmcnt(4)
    v_mfma_f32_16x16x32_bf16 v[76:79], v[144:147], a[160:163], v[76:79]
    ds_read_b64_tr_b16 v[136:137], v229 offset:0
    v_mul_f32 v186, v34, v34
    v_mfma_f32_16x16x32_bf16 v[76:79], v[148:151], a[164:167], v[76:79]
    buffer_load_dwordx4 v222, s[32:35], s61 offen offset:2048 sc1 lds
    v_mul_f32 v187, v35, v35
    v_mfma_f32_16x16x32_bf16 v[92:95], v[144:147], a[168:171], v[92:95]
    ds_read_b64_tr_b16 v[138:139], v229 offset:512
    v_permlane16_swap_b32 v205, v207
    v_mfma_f32_16x16x32_bf16 v[92:95], v[148:151], a[172:175], v[92:95]
    buffer_store_dwordx4 v[204:207], v254, s[48:51], s64 offen offset:256 sc1
    v_mfma_f32_16x16x32_bf16 v[108:111], v[144:147], a[176:179], v[108:111]
    ds_read_b64_tr_b16 v[140:141], v229 offset:2048
    v_mul_f32 v188, v36, v36
    v_mfma_f32_16x16x32_bf16 v[108:111], v[148:151], a[180:183], v[108:111]
    buffer_load_dwordx4 v223, s[32:35], s61 offen offset:3072 sc1 lds
    v_mfma_f32_16x16x32_bf16 v[124:127], v[144:147], a[184:187], v[124:127]
    ds_read_b64_tr_b16 v[142:143], v229 offset:2560
    v_mul_f32 v189, v37, v37
    v_mul_f32 v190, v38, v38
    v_mfma_f32_16x16x32_bf16 v[124:127], v[148:151], a[188:191], v[124:127]
    v_mul_f32 v191, v39, v39
    s_waitcnt lgkmcnt(4)
    v_mfma_f32_16x16x32_bf16 v[64:67], v[128:131], a[192:195], v[64:67]
    ds_read_b64_tr_b16 v[144:145], v228 offset:8192
    v_fma_f32 v184, v184, s89, v234
    v_fma_f32 v185, v185, s89, v234
    v_mfma_f32_16x16x32_bf16 v[64:67], v[132:135], a[196:199], v[64:67]
    v_fma_f32 v186, v186, s89, v234
    v_fma_f32 v187, v187, s89, v234
    v_fma_f32 v188, v188, s89, v234
    v_mfma_f32_16x16x32_bf16 v[80:83], v[128:131], a[200:203], v[80:83]
    ds_read_b64_tr_b16 v[146:147], v228 offset:8704
    v_fma_f32 v189, v189, s89, v234
    v_mfma_f32_16x16x32_bf16 v[80:83], v[132:135], a[204:207], v[80:83]
    v_fma_f32 v190, v190, s89, v234
    v_fma_f32 v191, v191, s89, v234
    v_mul_f32 v184, v184, v32
    v_mfma_f32_16x16x32_bf16 v[96:99], v[128:131], a[208:211], v[96:99]
    ds_read_b64_tr_b16 v[148:149], v228 offset:10240
    v_mul_f32 v185, v185, v33
    v_mfma_f32_16x16x32_bf16 v[96:99], v[132:135], a[212:215], v[96:99]
    v_exp_f32 v184, v184
    v_mul_f32 v186, v186, v34
    v_mfma_f32_16x16x32_bf16 v[112:115], v[128:131], a[216:219], v[112:115]
    ds_read_b64_tr_b16 v[150:151], v228 offset:10752
    v_mul_f32 v187, v187, v35
    v_mfma_f32_16x16x32_bf16 v[112:115], v[132:135], a[220:223], v[112:115]
    v_exp_f32 v185, v185
    s_waitcnt lgkmcnt(4)
    v_mfma_f32_16x16x32_bf16 v[68:71], v[136:139], a[192:195], v[68:71]
    ds_read_b64_tr_b16 v[128:129], v229 offset:8192
    v_exp_f32 v186, v186
    v_mfma_f32_16x16x32_bf16 v[68:71], v[140:143], a[196:199], v[68:71]
    v_exp_f32 v187, v187
    v_mul_f32 v188, v188, v36
    v_mfma_f32_16x16x32_bf16 v[84:87], v[136:139], a[200:203], v[84:87]
    ds_read_b64_tr_b16 v[130:131], v229 offset:8704
    v_mul_f32 v189, v189, v37
    v_mfma_f32_16x16x32_bf16 v[84:87], v[140:143], a[204:207], v[84:87]
    v_exp_f32 v188, v188
    v_mul_f32 v190, v190, v38
    v_mfma_f32_16x16x32_bf16 v[100:103], v[136:139], a[208:211], v[100:103]
    ds_read_b64_tr_b16 v[132:133], v229 offset:10240
    v_mul_f32 v191, v191, v39
    v_mfma_f32_16x16x32_bf16 v[100:103], v[140:143], a[212:215], v[100:103]
    v_exp_f32 v189, v189
    v_mul_f32 v32, v32, v40
    v_mfma_f32_16x16x32_bf16 v[116:119], v[136:139], a[216:219], v[116:119]
    ds_read_b64_tr_b16 v[134:135], v229 offset:10752
    v_mul_f32 v33, v33, v41
    v_mfma_f32_16x16x32_bf16 v[116:119], v[140:143], a[220:223], v[116:119]
    v_exp_f32 v190, v190
    s_waitcnt lgkmcnt(4)
    v_mfma_f32_16x16x32_bf16 v[72:75], v[144:147], a[192:195], v[72:75]
    ds_read_b64_tr_b16 v[136:137], v228 offset:16384
    v_exp_f32 v191, v191
    v_mfma_f32_16x16x32_bf16 v[72:75], v[148:151], a[196:199], v[72:75]
    v_mul_f32 v34, v34, v42
    v_mul_f32 v35, v35, v43
    v_mul_f32 v36, v36, v44
    v_mfma_f32_16x16x32_bf16 v[88:91], v[144:147], a[200:203], v[88:91]
    ds_read_b64_tr_b16 v[138:139], v228 offset:16896
    v_mul_f32 v37, v37, v45
    v_mfma_f32_16x16x32_bf16 v[88:91], v[148:151], a[204:207], v[88:91]
    v_mul_f32 v38, v38, v46
    v_mul_f32 v39, v39, v47
    v_add_f32 v184, 1.0, v184
    v_mfma_f32_16x16x32_bf16 v[104:107], v[144:147], a[208:211], v[104:107]
    ds_read_b64_tr_b16 v[140:141], v228 offset:18432
    v_add_f32 v185, 1.0, v185
    v_mfma_f32_16x16x32_bf16 v[104:107], v[148:151], a[212:215], v[104:107]
    v_rcp_f32 v184, v184
    v_add_f32 v186, 1.0, v186
    v_mfma_f32_16x16x32_bf16 v[120:123], v[144:147], a[216:219], v[120:123]
    ds_read_b64_tr_b16 v[142:143], v228 offset:18944
    v_add_f32 v187, 1.0, v187
    v_mfma_f32_16x16x32_bf16 v[120:123], v[148:151], a[220:223], v[120:123]
    v_rcp_f32 v185, v185
    s_waitcnt lgkmcnt(4)
    v_mfma_f32_16x16x32_bf16 v[76:79], v[128:131], a[192:195], v[76:79]
    ds_read_b64_tr_b16 v[144:145], v229 offset:16384
    v_rcp_f32 v186, v186
    v_mfma_f32_16x16x32_bf16 v[76:79], v[132:135], a[196:199], v[76:79]
    v_rcp_f32 v187, v187
    v_add_f32 v188, 1.0, v188
    v_mfma_f32_16x16x32_bf16 v[92:95], v[128:131], a[200:203], v[92:95]
    ds_read_b64_tr_b16 v[146:147], v229 offset:16896
    v_add_f32 v189, 1.0, v189
    v_mfma_f32_16x16x32_bf16 v[92:95], v[132:135], a[204:207], v[92:95]
    v_rcp_f32 v188, v188
    v_add_f32 v190, 1.0, v190
    v_mfma_f32_16x16x32_bf16 v[108:111], v[128:131], a[208:211], v[108:111]
    ds_read_b64_tr_b16 v[148:149], v229 offset:18432
    v_add_f32 v191, 1.0, v191
    v_mfma_f32_16x16x32_bf16 v[108:111], v[132:135], a[212:215], v[108:111]
    v_rcp_f32 v189, v189
    v_mul_f32 v32, v32, v184
    v_mfma_f32_16x16x32_bf16 v[124:127], v[128:131], a[216:219], v[124:127]
    ds_read_b64_tr_b16 v[150:151], v229 offset:18944
    v_mul_f32 v33, v33, v185
    v_mfma_f32_16x16x32_bf16 v[124:127], v[132:135], a[220:223], v[124:127]
    v_rcp_f32 v190, v190
    s_waitcnt lgkmcnt(4)
    v_mfma_f32_16x16x32_bf16 v[64:67], v[136:139], a[224:227], v[64:67]
    ds_read_b64_tr_b16 v[128:129], v228 offset:24576
    v_rcp_f32 v191, v191
    v_mfma_f32_16x16x32_bf16 v[64:67], v[140:143], a[228:231], v[64:67]
    v_mul_f32 v34, v34, v186
    v_mul_f32 v35, v35, v187
    v_mul_f32 v36, v36, v188
    v_mfma_f32_16x16x32_bf16 v[80:83], v[136:139], a[232:235], v[80:83]
    ds_read_b64_tr_b16 v[130:131], v228 offset:25088
    v_mul_f32 v37, v37, v189
    v_mfma_f32_16x16x32_bf16 v[80:83], v[140:143], a[236:239], v[80:83]
    v_mul_f32 v38, v38, v190
    v_mul_f32 v39, v39, v191
    v_cvt_pk_bf16_f32 v200, v32, v33
    v_mfma_f32_16x16x32_bf16 v[96:99], v[136:139], a[240:243], v[96:99]
    ds_read_b64_tr_b16 v[132:133], v228 offset:26624
    v_cvt_pk_bf16_f32 v202, v36, v37
    v_mfma_f32_16x16x32_bf16 v[96:99], v[140:143], a[244:247], v[96:99]
    v_cvt_pk_bf16_f32 v201, v34, v35
    v_permlane16_swap_b32 v200, v202
    v_mfma_f32_16x16x32_bf16 v[112:115], v[136:139], a[248:251], v[112:115]
    ds_read_b64_tr_b16 v[134:135], v228 offset:27136
    v_cvt_pk_bf16_f32 v203, v38, v39
    v_mfma_f32_16x16x32_bf16 v[112:115], v[140:143], a[252:255], v[112:115]
    v_mul_f32 v184, v48, v48
    v_mul_f32 v185, v49, v49
    s_waitcnt lgkmcnt(4)
    v_mfma_f32_16x16x32_bf16 v[68:71], v[144:147], a[224:227], v[68:71]
    ds_read_b64_tr_b16 v[136:137], v229 offset:24576
    v_permlane16_swap_b32 v201, v203
    v_mfma_f32_16x16x32_bf16 v[68:71], v[148:151], a[228:231], v[68:71]
    buffer_store_dwordx4 v[200:203], v254, s[48:51], s64 offen offset:1024 sc1
    v_mul_f32 v186, v50, v50
    v_mfma_f32_16x16x32_bf16 v[84:87], v[144:147], a[232:235], v[84:87]
    ds_read_b64_tr_b16 v[138:139], v229 offset:25088
    v_mul_f32 v187, v51, v51
    v_mfma_f32_16x16x32_bf16 v[84:87], v[148:151], a[236:239], v[84:87]
    v_mul_f32 v188, v52, v52
    v_mul_f32 v189, v53, v53
    v_mul_f32 v190, v54, v54
    v_mfma_f32_16x16x32_bf16 v[100:103], v[144:147], a[240:243], v[100:103]
    ds_read_b64_tr_b16 v[140:141], v229 offset:26624
    v_mul_f32 v191, v55, v55
    v_mfma_f32_16x16x32_bf16 v[100:103], v[148:151], a[244:247], v[100:103]
    v_fma_f32 v184, v184, s89, v234
    v_fma_f32 v185, v185, s89, v234
    v_fma_f32 v186, v186, s89, v234
    v_mfma_f32_16x16x32_bf16 v[116:119], v[144:147], a[248:251], v[116:119]
    ds_read_b64_tr_b16 v[142:143], v229 offset:27136
    v_fma_f32 v187, v187, s89, v234
    v_mfma_f32_16x16x32_bf16 v[116:119], v[148:151], a[252:255], v[116:119]
    v_fma_f32 v188, v188, s89, v234
    v_fma_f32 v189, v189, s89, v234
    s_waitcnt lgkmcnt(4)
    v_mfma_f32_16x16x32_bf16 v[72:75], v[128:131], a[224:227], v[72:75]
    s_waitcnt vmcnt(1)
    s_barrier
    v_mfma_f32_16x16x32_bf16 v[72:75], v[132:135], a[228:231], v[72:75]
    v_fma_f32 v190, v190, s89, v234
    v_fma_f32 v191, v191, s89, v234
    v_mul_f32 v184, v184, v48
    v_mfma_f32_16x16x32_bf16 v[88:91], v[128:131], a[232:235], v[88:91]
    ds_read_b64_tr_b16 v[144:145], v228 offset:32768
    v_mul_f32 v185, v185, v49
    v_mfma_f32_16x16x32_bf16 v[88:91], v[132:135], a[236:239], v[88:91]
    ds_read_b64_tr_b16 v[146:147], v228 offset:33280
    v_mul_f32 v186, v186, v50
    v_mfma_f32_16x16x32_bf16 v[104:107], v[128:131], a[240:243], v[104:107]
    ds_read_b64_tr_b16 v[148:149], v228 offset:34816
    v_mul_f32 v187, v187, v51
    v_mfma_f32_16x16x32_bf16 v[104:107], v[132:135], a[244:247], v[104:107]
    v_exp_f32 v184, v184
    v_mfma_f32_16x16x32_bf16 v[120:123], v[128:131], a[248:251], v[120:123]
    ds_read_b64_tr_b16 v[150:151], v228 offset:35328
    v_mul_f32 v188, v188, v52
    v_mfma_f32_16x16x32_bf16 v[120:123], v[132:135], a[252:255], v[120:123]
    v_mul_f32 v189, v189, v53
    s_waitcnt lgkmcnt(4)
    v_mfma_f32_16x16x32_bf16 v[76:79], v[136:139], a[224:227], v[76:79]
    ds_read_b64_tr_b16 v[128:129], v229 offset:32768
    v_exp_f32 v185, v185
    v_mfma_f32_16x16x32_bf16 v[76:79], v[140:143], a[228:231], v[76:79]
    v_exp_f32 v186, v186
    v_mul_f32 v190, v190, v54
    v_mfma_f32_16x16x32_bf16 v[92:95], v[136:139], a[232:235], v[92:95]
    ds_read_b64_tr_b16 v[130:131], v229 offset:33280
    v_mul_f32 v191, v191, v55
    v_mfma_f32_16x16x32_bf16 v[92:95], v[140:143], a[236:239], v[92:95]
    v_exp_f32 v187, v187
    v_mul_f32 v48, v48, v56
    v_mfma_f32_16x16x32_bf16 v[108:111], v[136:139], a[240:243], v[108:111]
    ds_read_b64_tr_b16 v[132:133], v229 offset:34816
    v_mul_f32 v49, v49, v57
    v_mfma_f32_16x16x32_bf16 v[108:111], v[140:143], a[244:247], v[108:111]
    v_exp_f32 v188, v188
    v_mul_f32 v50, v50, v58
    v_mfma_f32_16x16x32_bf16 v[124:127], v[136:139], a[248:251], v[124:127]
    ds_read_b64_tr_b16 v[134:135], v229 offset:35328
    v_mul_f32 v51, v51, v59
    v_mfma_f32_16x16x32_bf16 v[124:127], v[140:143], a[252:255], v[124:127]
    v_exp_f32 v189, v189
    s_waitcnt lgkmcnt(4)
    v_mfma_f32_16x16x32_bf16 v[64:67], v[144:147], v[152:155], v[64:67]
    ds_read_b64_tr_b16 v[136:137], v228 offset:40960
    v_exp_f32 v190, v190
    v_mfma_f32_16x16x32_bf16 v[64:67], v[148:151], v[156:159], v[64:67]
    v_exp_f32 v191, v191
    v_mul_f32 v52, v52, v60
    v_mfma_f32_16x16x32_bf16 v[80:83], v[144:147], v[160:163], v[80:83]
    ds_read_b64_tr_b16 v[138:139], v228 offset:41472
    v_mul_f32 v53, v53, v61
    v_mfma_f32_16x16x32_bf16 v[80:83], v[148:151], v[164:167], v[80:83]
    v_mul_f32 v54, v54, v62
    v_mul_f32 v55, v55, v63
    v_add_f32 v184, 1.0, v184
    v_mfma_f32_16x16x32_bf16 v[96:99], v[144:147], v[168:171], v[96:99]
    ds_read_b64_tr_b16 v[140:141], v228 offset:43008
    v_add_f32 v185, 1.0, v185
    v_mfma_f32_16x16x32_bf16 v[96:99], v[148:151], v[172:175], v[96:99]
    v_rcp_f32 v184, v184
    v_add_f32 v186, 1.0, v186
    v_mfma_f32_16x16x32_bf16 v[112:115], v[144:147], v[176:179], v[112:115]
    ds_read_b64_tr_b16 v[142:143], v228 offset:43520
    v_add_f32 v187, 1.0, v187
    v_mfma_f32_16x16x32_bf16 v[112:115], v[148:151], v[180:183], v[112:115]
    v_rcp_f32 v185, v185
    s_waitcnt lgkmcnt(4)
    v_mfma_f32_16x16x32_bf16 v[68:71], v[128:131], v[152:155], v[68:71]
    ds_read_b64_tr_b16 v[144:145], v229 offset:40960
    v_rcp_f32 v186, v186
    v_mfma_f32_16x16x32_bf16 v[68:71], v[132:135], v[156:159], v[68:71]
    v_rcp_f32 v187, v187
    v_add_f32 v188, 1.0, v188
    v_mfma_f32_16x16x32_bf16 v[84:87], v[128:131], v[160:163], v[84:87]
    ds_read_b64_tr_b16 v[146:147], v229 offset:41472
    v_add_f32 v189, 1.0, v189
    v_mfma_f32_16x16x32_bf16 v[84:87], v[132:135], v[164:167], v[84:87]
    v_rcp_f32 v188, v188
    v_add_f32 v190, 1.0, v190
    v_mfma_f32_16x16x32_bf16 v[100:103], v[128:131], v[168:171], v[100:103]
    ds_read_b64_tr_b16 v[148:149], v229 offset:43008
    v_add_f32 v191, 1.0, v191
    v_mfma_f32_16x16x32_bf16 v[100:103], v[132:135], v[172:175], v[100:103]
    v_rcp_f32 v189, v189
    v_mul_f32 v48, v48, v184
    v_mfma_f32_16x16x32_bf16 v[116:119], v[128:131], v[176:179], v[116:119]
    ds_read_b64_tr_b16 v[150:151], v229 offset:43520
    v_mul_f32 v49, v49, v185
    v_mfma_f32_16x16x32_bf16 v[116:119], v[132:135], v[180:183], v[116:119]
    v_rcp_f32 v190, v190
    s_waitcnt lgkmcnt(4)
    v_mfma_f32_16x16x32_bf16 v[72:75], v[136:139], v[152:155], v[72:75]
    ds_read_b64_tr_b16 v[128:129], v224 offset:0
    v_rcp_f32 v191, v191
    v_mfma_f32_16x16x32_bf16 v[72:75], v[140:143], v[156:159], v[72:75]
    v_mul_f32 v50, v50, v186
    v_mul_f32 v51, v51, v187
    v_mul_f32 v52, v52, v188
    v_mfma_f32_16x16x32_bf16 v[88:91], v[136:139], v[160:163], v[88:91]
    ds_read_b64_tr_b16 v[130:131], v224 offset:512
    v_mul_f32 v53, v53, v189
    v_mfma_f32_16x16x32_bf16 v[88:91], v[140:143], v[164:167], v[88:91]
    v_mul_f32 v54, v54, v190
    v_mul_f32 v55, v55, v191
    v_cvt_pk_bf16_f32 v204, v48, v49
    v_mfma_f32_16x16x32_bf16 v[104:107], v[136:139], v[168:171], v[104:107]
    ds_read_b64_tr_b16 v[132:133], v224 offset:2048
    v_cvt_pk_bf16_f32 v206, v52, v53
    v_mfma_f32_16x16x32_bf16 v[104:107], v[140:143], v[172:175], v[104:107]
    v_cvt_pk_bf16_f32 v205, v50, v51
    v_permlane16_swap_b32 v204, v206
    v_mfma_f32_16x16x32_bf16 v[120:123], v[136:139], v[176:179], v[120:123]
    ds_read_b64_tr_b16 v[134:135], v224 offset:2560
    v_cvt_pk_bf16_f32 v207, v54, v55
    v_mfma_f32_16x16x32_bf16 v[120:123], v[140:143], v[180:183], v[120:123]
    s_waitcnt lgkmcnt(4)
    v_mfma_f32_16x16x32_bf16 v[76:79], v[144:147], v[152:155], v[76:79]
    ds_read_b64_tr_b16 v[136:137], v225 offset:0
    v_mfma_f32_16x16x32_bf16 v[76:79], v[148:151], v[156:159], v[76:79]
    v_permlane16_swap_b32 v205, v207
    v_mfma_f32_16x16x32_bf16 v[92:95], v[144:147], v[160:163], v[92:95]
    ds_read_b64_tr_b16 v[138:139], v225 offset:512
    v_mfma_f32_16x16x32_bf16 v[92:95], v[148:151], v[164:167], v[92:95]
    buffer_store_dwordx4 v[204:207], v254, s[48:51], s64 offen offset:1280 sc1
    v_mfma_f32_16x16x32_bf16 v[108:111], v[144:147], v[168:171], v[108:111]
    ds_read_b64_tr_b16 v[140:141], v225 offset:2048
    v_mfma_f32_16x16x32_bf16 v[108:111], v[148:151], v[172:175], v[108:111]
    v_mfma_f32_16x16x32_bf16 v[124:127], v[144:147], v[176:179], v[124:127]
    ds_read_b64_tr_b16 v[142:143], v225 offset:2560
    v_mfma_f32_16x16x32_bf16 v[124:127], v[148:151], v[180:183], v[124:127]
L_last:
    s_waitcnt lgkmcnt(4)
    v_mfma_f32_16x16x32_bf16 v[0:3], v[128:131], a[0:3], 0
    ds_read_b64_tr_b16 v[144:145], v224 offset:8192
    s_and_b32 s78, s66, 0xff
    v_mfma_f32_16x16x32_bf16 v[0:3], v[132:135], a[4:7], v[0:3]
    s_lshl_b32 s78, s78, 13
    s_add_u32 s64, s65, s78
    v_mfma_f32_16x16x32_bf16 v[16:19], v[128:131], a[8:11], 0
    ds_read_b64_tr_b16 v[146:147], v224 offset:8704
    s_add_u32 m0, s68, 49152
    v_mfma_f32_16x16x32_bf16 v[16:19], v[132:135], a[12:15], v[16:19]
    s_add_u32 s61, s61, s62
    s_cmp_eq_u32 s61, s101
    v_mfma_f32_16x16x32_bf16 v[32:35], v[128:131], a[16:19], 0
    s_cselect_b32 s61, s100, s61
    ds_read_b64_tr_b16 v[148:149], v224 offset:10240
    v_mfma_f32_16x16x32_bf16 v[32:35], v[132:135], a[20:23], v[32:35]
    buffer_load_dwordx4 v220, s[32:35], s61 offen offset:0 sc1 lds
    v_mfma_f32_16x16x32_bf16 v[48:51], v[128:131], a[24:27], 0
    ds_read_b64_tr_b16 v[150:151], v224 offset:10752
    v_mfma_f32_16x16x32_bf16 v[48:51], v[132:135], a[28:31], v[48:51]
    s_waitcnt lgkmcnt(4)
    v_mfma_f32_16x16x32_bf16 v[4:7], v[136:139], a[0:3], 0
    ds_read_b64_tr_b16 v[128:129], v225 offset:8192
    v_mul_f32 v184, v64, v64
    v_mfma_f32_16x16x32_bf16 v[4:7], v[140:143], a[4:7], v[4:7]
    buffer_load_dwordx4 v221, s[32:35], s61 offen offset:1024 sc1 lds
    v_mfma_f32_16x16x32_bf16 v[20:23], v[136:139], a[8:11], 0
    ds_read_b64_tr_b16 v[130:131], v225 offset:8704
    v_mul_f32 v185, v65, v65
    v_mfma_f32_16x16x32_bf16 v[20:23], v[140:143], a[12:15], v[20:23]
    v_mul_f32 v186, v66, v66
    v_mul_f32 v187, v67, v67
    v_mul_f32 v188, v68, v68
    v_mfma_f32_16x16x32_bf16 v[36:39], v[136:139], a[16:19], 0
    ds_read_b64_tr_b16 v[132:133], v225 offset:10240
    v_mul_f32 v189, v69, v69
    v_mfma_f32_16x16x32_bf16 v[36:39], v[140:143], a[20:23], v[36:39]
    buffer_load_dwordx4 v222, s[32:35], s61 offen offset:2048 sc1 lds
    v_mfma_f32_16x16x32_bf16 v[52:55], v[136:139], a[24:27], 0
    ds_read_b64_tr_b16 v[134:135], v225 offset:10752
    v_mul_f32 v190, v70, v70
    v_mul_f32 v191, v71, v71
    v_mfma_f32_16x16x32_bf16 v[52:55], v[140:143], a[28:31], v[52:55]
    v_fma_f32 v184, v184, s89, v234
    v_fma_f32 v185, v185, s89, v234
    s_waitcnt lgkmcnt(4)
    v_mfma_f32_16x16x32_bf16 v[8:11], v[144:147], a[0:3], 0
    ds_read_b64_tr_b16 v[136:137], v224 offset:16384
    s_mov_b32 s74, 31784960
    v_mfma_f32_16x16x32_bf16 v[8:11], v[148:151], a[4:7], v[8:11]
    buffer_load_dwordx4 v[244:247], v233, s[44:47], s74 offen sc1
    v_mfma_f32_16x16x32_bf16 v[24:27], v[144:147], a[8:11], 0
    ds_read_b64_tr_b16 v[138:139], v224 offset:16896
    v_fma_f32 v186, v186, s89, v234
    v_fma_f32 v187, v187, s89, v234
    v_mfma_f32_16x16x32_bf16 v[24:27], v[148:151], a[12:15], v[24:27]
    v_fma_f32 v188, v188, s89, v234
    v_fma_f32 v189, v189, s89, v234
    v_mfma_f32_16x16x32_bf16 v[40:43], v[144:147], a[16:19], 0
    ds_read_b64_tr_b16 v[140:141], v224 offset:18432
    buffer_load_dwordx4 v223, s[32:35], s61 offen offset:3072 sc1 lds
    v_mfma_f32_16x16x32_bf16 v[40:43], v[148:151], a[20:23], v[40:43]
    v_fma_f32 v190, v190, s89, v234
    v_fma_f32 v191, v191, s89, v234
    v_mfma_f32_16x16x32_bf16 v[56:59], v[144:147], a[24:27], 0
    ds_read_b64_tr_b16 v[142:143], v224 offset:18944
    s_add_u32 m0, s68, 65536
    s_add_u32 s61, s61, s62
    v_mfma_f32_16x16x32_bf16 v[56:59], v[148:151], a[28:31], v[56:59]
    s_cmp_eq_u32 s61, s101
    s_cselect_b32 s61, s100, s61
    s_waitcnt lgkmcnt(4)
    v_mfma_f32_16x16x32_bf16 v[12:15], v[128:131], a[0:3], 0
    ds_read_b64_tr_b16 v[144:145], v225 offset:16384
    v_mul_f32 v184, v184, v64
    v_mfma_f32_16x16x32_bf16 v[12:15], v[132:135], a[4:7], v[12:15]
    buffer_load_dwordx4 v220, s[32:35], s61 offen offset:0 sc1 lds
    v_mfma_f32_16x16x32_bf16 v[28:31], v[128:131], a[8:11], 0
    ds_read_b64_tr_b16 v[146:147], v225 offset:16896
    v_exp_f32 v184, v184
    v_mfma_f32_16x16x32_bf16 v[28:31], v[132:135], a[12:15], v[28:31]
    v_mul_f32 v185, v185, v65
    v_mul_f32 v186, v186, v66
    v_mfma_f32_16x16x32_bf16 v[44:47], v[128:131], a[16:19], 0
    ds_read_b64_tr_b16 v[148:149], v225 offset:18432
    v_mul_f32 v187, v187, v67
    v_mfma_f32_16x16x32_bf16 v[44:47], v[132:135], a[20:23], v[44:47]
    buffer_load_dwordx4 v221, s[32:35], s61 offen offset:1024 sc1 lds
    v_mul_f32 v188, v188, v68
    v_mfma_f32_16x16x32_bf16 v[60:63], v[128:131], a[24:27], 0
    ds_read_b64_tr_b16 v[150:151], v225 offset:18944
    v_exp_f32 v185, v185
    v_mfma_f32_16x16x32_bf16 v[60:63], v[132:135], a[28:31], v[60:63]
    v_exp_f32 v186, v186
    s_waitcnt lgkmcnt(4)
    v_mfma_f32_16x16x32_bf16 v[0:3], v[136:139], a[32:35], v[0:3]
    ds_read_b64_tr_b16 v[128:129], v224 offset:24576
    v_exp_f32 v187, v187
    v_mfma_f32_16x16x32_bf16 v[0:3], v[140:143], a[36:39], v[0:3]
    v_exp_f32 v188, v188
    v_mul_f32 v189, v189, v69
    v_mfma_f32_16x16x32_bf16 v[16:19], v[136:139], a[40:43], v[16:19]
    ds_read_b64_tr_b16 v[130:131], v224 offset:25088
    v_mul_f32 v190, v190, v70
    v_mfma_f32_16x16x32_bf16 v[16:19], v[140:143], a[44:47], v[16:19]
    v_exp_f32 v189, v189
    v_mul_f32 v191, v191, v71
    v_mfma_f32_16x16x32_bf16 v[32:35], v[136:139], a[48:51], v[32:35]
    ds_read_b64_tr_b16 v[132:133], v224 offset:26624
    v_mul_f32 v64, v64, v72
    v_mfma_f32_16x16x32_bf16 v[32:35], v[140:143], a[52:55], v[32:35]
    buffer_load_dwordx4 v222, s[32:35], s61 offen offset:2048 sc1 lds
    v_mul_f32 v65, v65, v73
    v_mfma_f32_16x16x32_bf16 v[48:51], v[136:139], a[56:59], v[48:51]
    ds_read_b64_tr_b16 v[134:135], v224 offset:27136
    v_exp_f32 v190, v190
    v_mfma_f32_16x16x32_bf16 v[48:51], v[140:143], a[60:63], v[48:51]
    v_exp_f32 v191, v191
    s_waitcnt lgkmcnt(4)
    v_mfma_f32_16x16x32_bf16 v[4:7], v[144:147], a[32:35], v[4:7]
    ds_read_b64_tr_b16 v[136:137], v225 offset:24576
    v_mul_f32 v66, v66, v74
    v_mul_f32 v67, v67, v75
    v_mfma_f32_16x16x32_bf16 v[4:7], v[148:151], a[36:39], v[4:7]
    buffer_load_dwordx4 v223, s[32:35], s61 offen offset:3072 sc1 lds
    v_mfma_f32_16x16x32_bf16 v[20:23], v[144:147], a[40:43], v[20:23]
    ds_read_b64_tr_b16 v[138:139], v225 offset:25088
    s_add_u32 m0, s68, 81920
    v_mfma_f32_16x16x32_bf16 v[20:23], v[148:151], a[44:47], v[20:23]
    s_add_u32 s61, s61, s62
    s_cmp_eq_u32 s61, s101
    v_mul_f32 v68, v68, v76
    v_mfma_f32_16x16x32_bf16 v[36:39], v[144:147], a[48:51], v[36:39]
    s_cselect_b32 s61, s100, s61
    ds_read_b64_tr_b16 v[140:141], v225 offset:26624
    v_mul_f32 v69, v69, v77
    v_mfma_f32_16x16x32_bf16 v[36:39], v[148:151], a[52:55], v[36:39]
    buffer_load_dwordx4 v220, s[32:35], s61 offen offset:0 sc1 lds
    v_mfma_f32_16x16x32_bf16 v[52:55], v[144:147], a[56:59], v[52:55]
    ds_read_b64_tr_b16 v[142:143], v225 offset:27136
    v_mul_f32 v70, v70, v78
    v_mul_f32 v71, v71, v79
    v_mfma_f32_16x16x32_bf16 v[52:55], v[148:151], a[60:63], v[52:55]
    v_add_f32 v184, 1.0, v184
    s_waitcnt lgkmcnt(4)
    v_mfma_f32_16x16x32_bf16 v[8:11], v[128:131], a[32:35], v[8:11]
    ds_read_b64_tr_b16 v[144:145], v224 offset:32768
    v_rcp_f32 v184, v184
    v_mfma_f32_16x16x32_bf16 v[8:11], v[132:135], a[36:39], v[8:11]
    v_add_f32 v185, 1.0, v185
    v_add_f32 v186, 1.0, v186
    v_add_f32 v187, 1.0, v187
    v_mfma_f32_16x16x32_bf16 v[24:27], v[128:131], a[40:43], v[24:27]
    ds_read_b64_tr_b16 v[146:147], v224 offset:33280
    v_add_f32 v188, 1.0, v188
    v_mfma_f32_16x16x32_bf16 v[24:27], v[132:135], a[44:47], v[24:27]
    v_rcp_f32 v185, v185
    v_add_f32 v189, 1.0, v189
    v_mfma_f32_16x16x32_bf16 v[40:43], v[128:131], a[48:51], v[40:43]
    ds_read_b64_tr_b16 v[148:149], v224 offset:34816
    v_add_f32 v190, 1.0, v190
    v_mfma_f32_16x16x32_bf16 v[40:43], v[132:135], a[52:55], v[40:43]
    buffer_load_dwordx4 v221, s[32:35], s61 offen offset:1024 sc1 lds
    v_add_f32 v191, 1.0, v191
    v_mfma_f32_16x16x32_bf16 v[56:59], v[128:131], a[56:59], v[56:59]
    ds_read_b64_tr_b16 v[150:151], v224 offset:35328
    v_rcp_f32 v186, v186
    v_mfma_f32_16x16x32_bf16 v[56:59], v[132:135], a[60:63], v[56:59]
    v_rcp_f32 v187, v187
    s_waitcnt lgkmcnt(4)
    v_mfma_f32_16x16x32_bf16 v[12:15], v[136:139], a[32:35], v[12:15]
    ds_read_b64_tr_b16 v[128:129], v225 offset:32768
    v_rcp_f32 v188, v188
    v_mfma_f32_16x16x32_bf16 v[12:15], v[140:143], a[36:39], v[12:15]
    buffer_load_dwordx4 v222, s[32:35], s61 offen offset:2048 sc1 lds
    v_mul_f32 v64, v64, v184
    v_mfma_f32_16x16x32_bf16 v[28:31], v[136:139], a[40:43], v[28:31]
    ds_read_b64_tr_b16 v[130:131], v225 offset:33280
    v_rcp_f32 v189, v189
    v_mfma_f32_16x16x32_bf16 v[28:31], v[140:143], a[44:47], v[28:31]
    v_rcp_f32 v190, v190
    v_mul_f32 v65, v65, v185
    v_mfma_f32_16x16x32_bf16 v[44:47], v[136:139], a[48:51], v[44:47]
    ds_read_b64_tr_b16 v[132:133], v225 offset:34816
    v_mul_f32 v66, v66, v186
    v_mfma_f32_16x16x32_bf16 v[44:47], v[140:143], a[52:55], v[44:47]
    buffer_load_dwordx4 v223, s[32:35], s61 offen offset:3072 sc1 lds
    v_mul_f32 v67, v67, v187
    v_mfma_f32_16x16x32_bf16 v[60:63], v[136:139], a[56:59], v[60:63]
    ds_read_b64_tr_b16 v[134:135], v225 offset:35328
    v_rcp_f32 v191, v191
    v_mfma_f32_16x16x32_bf16 v[60:63], v[140:143], a[60:63], v[60:63]
    v_mul_f32 v68, v68, v188
    v_mul_f32 v69, v69, v189
    s_waitcnt lgkmcnt(4)
    v_mfma_f32_16x16x32_bf16 v[0:3], v[144:147], a[64:67], v[0:3]
    ds_read_b64_tr_b16 v[136:137], v224 offset:40960
    v_mul_f32 v70, v70, v190
    v_mfma_f32_16x16x32_bf16 v[0:3], v[148:151], a[68:71], v[0:3]
    v_mul_f32 v71, v71, v191
    v_cvt_pk_bf16_f32 v200, v64, v65
    v_mfma_f32_16x16x32_bf16 v[16:19], v[144:147], a[72:75], v[16:19]
    ds_read_b64_tr_b16 v[138:139], v224 offset:41472
    s_add_u32 m0, s68, 98304
    v_mfma_f32_16x16x32_bf16 v[16:19], v[148:151], a[76:79], v[16:19]
    s_add_u32 s61, s61, s62
    s_cmp_eq_u32 s61, s101
    v_mfma_f32_16x16x32_bf16 v[32:35], v[144:147], a[80:83], v[32:35]
    s_cselect_b32 s61, s100, s61
    ds_read_b64_tr_b16 v[140:141], v224 offset:43008
    v_cvt_pk_bf16_f32 v202, v68, v69
    v_mfma_f32_16x16x32_bf16 v[32:35], v[148:151], a[84:87], v[32:35]
    buffer_load_dwordx4 v220, s[32:35], s61 offen offset:0 sc1 lds
    v_cvt_pk_bf16_f32 v201, v66, v67
    v_mfma_f32_16x16x32_bf16 v[48:51], v[144:147], a[88:91], v[48:51]
    ds_read_b64_tr_b16 v[142:143], v224 offset:43520
    v_permlane16_swap_b32 v200, v202
    v_mfma_f32_16x16x32_bf16 v[48:51], v[148:151], a[92:95], v[48:51]
    v_cvt_pk_bf16_f32 v203, v70, v71
    v_mul_f32 v184, v80, v80
    s_waitcnt lgkmcnt(4)
    v_mfma_f32_16x16x32_bf16 v[4:7], v[128:131], a[64:67], v[4:7]
    ds_read_b64_tr_b16 v[144:145], v225 offset:40960
    v_permlane16_swap_b32 v201, v203
    v_mfma_f32_16x16x32_bf16 v[4:7], v[132:135], a[68:71], v[4:7]
    buffer_load_dwordx4 v221, s[32:35], s61 offen offset:1024 sc1 lds
    v_mfma_f32_16x16x32_bf16 v[20:23], v[128:131], a[72:75], v[20:23]
    ds_read_b64_tr_b16 v[146:147], v225 offset:41472
    buffer_store_dwordx4 v[200:203], v254, s[48:51], s64 offen offset:0 sc1
    v_mfma_f32_16x16x32_bf16 v[20:23], v[132:135], a[76:79], v[20:23]
    v_mul_f32 v185, v81, v81
    v_mul_f32 v186, v82, v82
    v_mul_f32 v187, v83, v83
    v_mfma_f32_16x16x32_bf16 v[36:39], v[128:131], a[80:83], v[36:39]
    ds_read_b64_tr_b16 v[148:149], v225 offset:43008
    v_mul_f32 v188, v84, v84
    v_mfma_f32_16x16x32_bf16 v[36:39], v[132:135], a[84:87], v[36:39]
    buffer_load_dwordx4 v222, s[32:35], s61 offen offset:2048 sc1 lds
    v_mul_f32 v189, v85, v85
    v_mfma_f32_16x16x32_bf16 v[52:55], v[128:131], a[88:91], v[52:55]
    ds_read_b64_tr_b16 v[150:151], v225 offset:43520
    v_mul_f32 v190, v86, v86
    v_mul_f32 v191, v87, v87
    v_mfma_f32_16x16x32_bf16 v[52:55], v[132:135], a[92:95], v[52:55]
    v_fma_f32 v184, v184, s89, v234
    v_fma_f32 v185, v185, s89, v234
    s_waitcnt lgkmcnt(4)
    v_mfma_f32_16x16x32_bf16 v[8:11], v[136:139], a[64:67], v[8:11]
    s_waitcnt vmcnt(8)
    s_barrier
    v_mfma_f32_16x16x32_bf16 v[8:11], v[140:143], a[68:71], v[8:11]
    v_fma_f32 v186, v186, s89, v234
    v_fma_f32 v187, v187, s89, v234
    v_mfma_f32_16x16x32_bf16 v[24:27], v[136:139], a[72:75], v[24:27]
    ds_read_b64_tr_b16 v[128:129], v226 offset:0
    ds_read_b64_tr_b16 v[130:131], v226 offset:512
    v_mfma_f32_16x16x32_bf16 v[24:27], v[140:143], a[76:79], v[24:27]
    v_fma_f32 v188, v188, s89, v234
    v_fma_f32 v189, v189, s89, v234
    v_mfma_f32_16x16x32_bf16 v[40:43], v[136:139], a[80:83], v[40:43]
    ds_read_b64_tr_b16 v[132:133], v226 offset:2048
    buffer_load_dwordx4 v223, s[32:35], s61 offen offset:3072 sc1 lds
    v_mfma_f32_16x16x32_bf16 v[40:43], v[140:143], a[84:87], v[40:43]
    v_fma_f32 v190, v190, s89, v234
    v_fma_f32 v191, v191, s89, v234
    v_mfma_f32_16x16x32_bf16 v[56:59], v[136:139], a[88:91], v[56:59]
    ds_read_b64_tr_b16 v[134:135], v226 offset:2560
    s_add_u32 m0, s68, 114688
    s_add_u32 s61, s61, s62
    v_mfma_f32_16x16x32_bf16 v[56:59], v[140:143], a[92:95], v[56:59]
    s_cmp_eq_u32 s61, s101
    s_cselect_b32 s61, s100, s61
    s_waitcnt lgkmcnt(4)
    v_mfma_f32_16x16x32_bf16 v[12:15], v[144:147], a[64:67], v[12:15]
    ds_read_b64_tr_b16 v[136:137], v227 offset:0
    v_mul_f32 v184, v184, v80
    v_mfma_f32_16x16x32_bf16 v[12:15], v[148:151], a[68:71], v[12:15]
    buffer_load_dwordx4 v220, s[32:35], s61 offen offset:0 sc1 lds
    v_mfma_f32_16x16x32_bf16 v[28:31], v[144:147], a[72:75], v[28:31]
    ds_read_b64_tr_b16 v[138:139], v227 offset:512
    v_mul_f32 v185, v185, v81
    v_mfma_f32_16x16x32_bf16 v[28:31], v[148:151], a[76:79], v[28:31]
    v_exp_f32 v184, v184
    v_mfma_f32_16x16x32_bf16 v[44:47], v[144:147], a[80:83], v[44:47]
    ds_read_b64_tr_b16 v[140:141], v227 offset:2048
    v_mul_f32 v186, v186, v82
    v_mfma_f32_16x16x32_bf16 v[44:47], v[148:151], a[84:87], v[44:47]
    buffer_load_dwordx4 v221, s[32:35], s61 offen offset:1024 sc1 lds
    v_mfma_f32_16x16x32_bf16 v[60:63], v[144:147], a[88:91], v[60:63]
    ds_read_b64_tr_b16 v[142:143], v227 offset:2560
    v_exp_f32 v185, v185
    v_mfma_f32_16x16x32_bf16 v[60:63], v[148:151], a[92:95], v[60:63]
    v_mul_f32 v187, v187, v83
    s_waitcnt lgkmcnt(4)
    v_mfma_f32_16x16x32_bf16 v[0:3], v[128:131], a[96:99], v[0:3]
    ds_read_b64_tr_b16 v[144:145], v226 offset:8192
    s_mov_b64 s[40:41], s[28:29]
    v_mul_f32 v188, v188, v84
    v_mfma_f32_16x16x32_bf16 v[0:3], v[132:135], a[100:103], v[0:3]
    s_mov_b32 s42, 31610880
    v_exp_f32 v186, v186
    v_mfma_f32_16x16x32_bf16 v[16:19], v[128:131], a[104:107], v[16:19]
    ds_read_b64_tr_b16 v[146:147], v226 offset:8704
    v_exp_f32 v187, v187
    v_mfma_f32_16x16x32_bf16 v[16:19], v[132:135], a[108:111], v[16:19]
    v_exp_f32 v188, v188
    v_mul_f32 v189, v189, v85
    v_mfma_f32_16x16x32_bf16 v[32:35], v[128:131], a[112:115], v[32:35]
    ds_read_b64_tr_b16 v[148:149], v226 offset:10240
    v_mul_f32 v190, v190, v86
    v_mfma_f32_16x16x32_bf16 v[32:35], v[132:135], a[116:119], v[32:35]
    buffer_load_dwordx4 v222, s[32:35], s61 offen offset:2048 sc1 lds
    v_mfma_f32_16x16x32_bf16 v[48:51], v[128:131], a[120:123], v[48:51]
    ds_read_b64_tr_b16 v[150:151], v226 offset:10752
    v_exp_f32 v189, v189
    v_mfma_f32_16x16x32_bf16 v[48:51], v[132:135], a[124:127], v[48:51]
    v_exp_f32 v190, v190
    s_waitcnt lgkmcnt(4)
    v_mfma_f32_16x16x32_bf16 v[4:7], v[136:139], a[96:99], v[4:7]
    ds_read_b64_tr_b16 v[128:129], v227 offset:8192
    v_mul_f32 v191, v191, v87
    v_mfma_f32_16x16x32_bf16 v[4:7], v[140:143], a[100:103], v[4:7]
    buffer_load_dwordx4 v223, s[32:35], s61 offen offset:3072 sc1 lds
    v_mfma_f32_16x16x32_bf16 v[20:23], v[136:139], a[104:107], v[20:23]
    ds_read_b64_tr_b16 v[130:131], v227 offset:8704
    s_add_u32 m0, s68, 131072
    v_mfma_f32_16x16x32_bf16 v[20:23], v[140:143], a[108:111], v[20:23]
    s_add_u32 s61, s61, s62
    s_cmp_eq_u32 s61, s101
    v_mul_f32 v80, v80, v88
    v_mfma_f32_16x16x32_bf16 v[36:39], v[136:139], a[112:115], v[36:39]
    s_cselect_b32 s61, s100, s61
    ds_read_b64_tr_b16 v[132:133], v227 offset:10240
    v_mul_f32 v81, v81, v89
    v_mfma_f32_16x16x32_bf16 v[36:39], v[140:143], a[116:119], v[36:39]
    buffer_load_dwordx4 v220, s[32:35], s61 offen offset:0 sc1 lds
    v_mfma_f32_16x16x32_bf16 v[52:55], v[136:139], a[120:123], v[52:55]
    ds_read_b64_tr_b16 v[134:135], v227 offset:10752
    v_exp_f32 v191, v191
    v_mfma_f32_16x16x32_bf16 v[52:55], v[140:143], a[124:127], v[52:55]
    v_mul_f32 v82, v82, v90
    s_waitcnt lgkmcnt(4)
    v_mfma_f32_16x16x32_bf16 v[8:11], v[144:147], a[96:99], v[8:11]
    ds_read_b64_tr_b16 v[136:137], v226 offset:16384
    v_min3_u32 v244, v244, v245, v246
    v_mfma_f32_16x16x32_bf16 v[8:11], v[148:151], a[100:103], v[8:11]
    v_min_u32 v244, v244, v247
    v_cmp_eq_u32 vcc, 0, v244
    v_mul_f32 v83, v83, v91
    v_mfma_f32_16x16x32_bf16 v[24:27], v[144:147], a[104:107], v[24:27]
    ds_read_b64_tr_b16 v[138:139], v226 offset:16896
    s_cbranch_vccnz L_kvspin
L_kvok:
    v_mul_f32 v84, v84, v92
    v_mfma_f32_16x16x32_bf16 v[24:27], v[148:151], a[108:111], v[24:27]
    v_mul_f32 v85, v85, v93
    v_mul_f32 v86, v86, v94
    v_mul_f32 v87, v87, v95
    v_mfma_f32_16x16x32_bf16 v[40:43], v[144:147], a[112:115], v[40:43]
    ds_read_b64_tr_b16 v[140:141], v226 offset:18432
    v_add_f32 v184, 1.0, v184
    v_mfma_f32_16x16x32_bf16 v[40:43], v[148:151], a[116:119], v[40:43]
    buffer_load_dwordx4 v221, s[32:35], s61 offen offset:1024 sc1 lds
    v_mfma_f32_16x16x32_bf16 v[56:59], v[144:147], a[120:123], v[56:59]
    ds_read_b64_tr_b16 v[142:143], v226 offset:18944
    v_rcp_f32 v184, v184
    v_mfma_f32_16x16x32_bf16 v[56:59], v[148:151], a[124:127], v[56:59]
    v_add_f32 v185, 1.0, v185
    s_waitcnt lgkmcnt(4)
    v_mfma_f32_16x16x32_bf16 v[12:15], v[128:131], a[96:99], v[12:15]
    ds_read_b64_tr_b16 v[144:145], v227 offset:16384
    v_add_f32 v186, 1.0, v186
    v_mfma_f32_16x16x32_bf16 v[12:15], v[132:135], a[100:103], v[12:15]
    buffer_load_dwordx4 v222, s[32:35], s61 offen offset:2048 sc1 lds
    v_add_f32 v187, 1.0, v187
    v_mfma_f32_16x16x32_bf16 v[28:31], v[128:131], a[104:107], v[28:31]
    ds_read_b64_tr_b16 v[146:147], v227 offset:16896
    v_rcp_f32 v185, v185
    v_mfma_f32_16x16x32_bf16 v[28:31], v[132:135], a[108:111], v[28:31]
    v_rcp_f32 v186, v186
    v_add_f32 v188, 1.0, v188
    v_mfma_f32_16x16x32_bf16 v[44:47], v[128:131], a[112:115], v[44:47]
    ds_read_b64_tr_b16 v[148:149], v227 offset:18432
    v_add_f32 v189, 1.0, v189
    v_mfma_f32_16x16x32_bf16 v[44:47], v[132:135], a[116:119], v[44:47]
    buffer_load_dwordx4 v223, s[32:35], s61 offen offset:3072 sc1 lds
    v_mfma_f32_16x16x32_bf16 v[60:63], v[128:131], a[120:123], v[60:63]
    ds_read_b64_tr_b16 v[150:151], v227 offset:18944
    v_rcp_f32 v187, v187
    v_mfma_f32_16x16x32_bf16 v[60:63], v[132:135], a[124:127], v[60:63]
    v_rcp_f32 v188, v188
    s_waitcnt lgkmcnt(4)
    v_mfma_f32_16x16x32_bf16 v[0:3], v[136:139], a[128:131], v[0:3]
    ds_read_b64_tr_b16 v[128:129], v226 offset:24576
    s_lshl_b32 s76, s87, 7
    v_add_f32 v190, 1.0, v190
    v_mfma_f32_16x16x32_bf16 v[0:3], v[140:143], a[132:135], v[0:3]
    s_add_u32 s76, s76, 31789056
    v_rcp_f32 v189, v189
    v_mfma_f32_16x16x32_bf16 v[16:19], v[136:139], a[136:139], v[16:19]
    ds_read_b64_tr_b16 v[130:131], v226 offset:25088
    s_add_u32 m0, s68, 0
    v_mfma_f32_16x16x32_bf16 v[16:19], v[140:143], a[140:143], v[16:19]
    s_add_u32 s101, s68, 31457280
    v_rcp_f32 v190, v190
    v_mfma_f32_16x16x32_bf16 v[32:35], v[136:139], a[144:147], v[32:35]
    ds_read_b64_tr_b16 v[132:133], v226 offset:26624
    v_add_f32 v191, 1.0, v191
    v_mfma_f32_16x16x32_bf16 v[32:35], v[140:143], a[148:151], v[32:35]
    buffer_load_dwordx4 v233, s[40:43], s101 offen offset:0 sc1 lds
    v_mul_f32 v80, v80, v184
    v_mfma_f32_16x16x32_bf16 v[48:51], v[136:139], a[152:155], v[48:51]
    ds_read_b64_tr_b16 v[134:135], v226 offset:27136
    v_rcp_f32 v191, v191
    v_mfma_f32_16x16x32_bf16 v[48:51], v[140:143], a[156:159], v[48:51]
    v_mul_f32 v81, v81, v185
    s_waitcnt lgkmcnt(4)
    v_mfma_f32_16x16x32_bf16 v[4:7], v[144:147], a[128:131], v[4:7]
    ds_read_b64_tr_b16 v[136:137], v227 offset:24576
    v_mul_f32 v82, v82, v186
    v_mfma_f32_16x16x32_bf16 v[4:7], v[148:151], a[132:135], v[4:7]
    buffer_load_dwordx4 v233, s[40:43], s101 offen offset:1024 sc1 lds
    v_mul_f32 v83, v83, v187
    v_mfma_f32_16x16x32_bf16 v[20:23], v[144:147], a[136:139], v[20:23]
    ds_read_b64_tr_b16 v[138:139], v227 offset:25088
    v_mul_f32 v84, v84, v188
    v_mul_f32 v85, v85, v189
    v_mfma_f32_16x16x32_bf16 v[20:23], v[148:151], a[140:143], v[20:23]
    v_mul_f32 v86, v86, v190
    v_mul_f32 v87, v87, v191
    v_cvt_pk_bf16_f32 v204, v80, v81
    v_mfma_f32_16x16x32_bf16 v[36:39], v[144:147], a[144:147], v[36:39]
    ds_read_b64_tr_b16 v[140:141], v227 offset:26624
    v_cvt_pk_bf16_f32 v206, v84, v85
    v_mfma_f32_16x16x32_bf16 v[36:39], v[148:151], a[148:151], v[36:39]
    buffer_load_dwordx4 v233, s[40:43], s101 offen offset:2048 sc1 lds
    v_mfma_f32_16x16x32_bf16 v[52:55], v[144:147], a[152:155], v[52:55]
    ds_read_b64_tr_b16 v[142:143], v227 offset:27136
    v_permlane16_swap_b32 v204, v206
    v_mfma_f32_16x16x32_bf16 v[52:55], v[148:151], a[156:159], v[52:55]
    v_cvt_pk_bf16_f32 v205, v82, v83
    v_cvt_pk_bf16_f32 v207, v86, v87
    s_waitcnt lgkmcnt(4)
    v_mfma_f32_16x16x32_bf16 v[8:11], v[128:131], a[128:131], v[8:11]
    s_waitcnt vmcnt(7)
    s_barrier
    v_mfma_f32_16x16x32_bf16 v[8:11], v[132:135], a[132:135], v[8:11]
    v_permlane16_swap_b32 v205, v207
    v_mul_f32 v184, v96, v96
    v_mfma_f32_16x16x32_bf16 v[24:27], v[128:131], a[136:139], v[24:27]
    ds_read_b64_tr_b16 v[144:145], v226 offset:32768
    ds_read_b64_tr_b16 v[146:147], v226 offset:33280
    v_mfma_f32_16x16x32_bf16 v[24:27], v[132:135], a[140:143], v[24:27]
    buffer_store_dwordx4 v[204:207], v254, s[48:51], s64 offen offset:256 sc1
    v_mfma_f32_16x16x32_bf16 v[40:43], v[128:131], a[144:147], v[40:43]
    ds_read_b64_tr_b16 v[148:149], v226 offset:34816
    v_mul_f32 v185, v97, v97
    v_mfma_f32_16x16x32_bf16 v[40:43], v[132:135], a[148:151], v[40:43]
    buffer_load_dwordx4 v233, s[40:43], s101 offen offset:3072 sc1 lds
    v_mfma_f32_16x16x32_bf16 v[56:59], v[128:131], a[152:155], v[56:59]
    ds_read_b64_tr_b16 v[150:151], v226 offset:35328
    s_add_u32 m0, s68, 16384
    v_mfma_f32_16x16x32_bf16 v[56:59], v[132:135], a[156:159], v[56:59]
    s_add_u32 s101, s68, 31473664
    s_waitcnt lgkmcnt(4)
    v_mfma_f32_16x16x32_bf16 v[12:15], v[136:139], a[128:131], v[12:15]
    ds_read_b64_tr_b16 v[128:129], v227 offset:32768
    v_mul_f32 v186, v98, v98
    v_mul_f32 v187, v99, v99
    v_mfma_f32_16x16x32_bf16 v[12:15], v[140:143], a[132:135], v[12:15]
    buffer_load_dwordx4 v233, s[40:43], s101 offen offset:0 sc1 lds
    v_mfma_f32_16x16x32_bf16 v[28:31], v[136:139], a[136:139], v[28:31]
    ds_read_b64_tr_b16 v[130:131], v227 offset:33280
    v_mul_f32 v188, v100, v100
    v_mul_f32 v189, v101, v101
    v_mfma_f32_16x16x32_bf16 v[28:31], v[140:143], a[140:143], v[28:31]
    v_mul_f32 v190, v102, v102
    v_mul_f32 v191, v103, v103
    v_fma_f32 v184, v184, s89, v234
    v_mfma_f32_16x16x32_bf16 v[44:47], v[136:139], a[144:147], v[44:47]
    ds_read_b64_tr_b16 v[132:133], v227 offset:34816
    v_fma_f32 v185, v185, s89, v234
    v_mfma_f32_16x16x32_bf16 v[44:47], v[140:143], a[148:151], v[44:47]
    buffer_load_dwordx4 v233, s[40:43], s101 offen offset:1024 sc1 lds
    v_fma_f32 v186, v186, s89, v234
    v_mfma_f32_16x16x32_bf16 v[60:63], v[136:139], a[152:155], v[60:63]
    ds_read_b64_tr_b16 v[134:135], v227 offset:35328
    v_fma_f32 v187, v187, s89, v234
    v_fma_f32 v188, v188, s89, v234
    v_mfma_f32_16x16x32_bf16 v[60:63], v[140:143], a[156:159], v[60:63]
    v_fma_f32 v189, v189, s89, v234
    v_fma_f32 v190, v190, s89, v234
    s_waitcnt lgkmcnt(4)
    v_mfma_f32_16x16x32_bf16 v[0:3], v[144:147], a[160:163], v[0:3]
    ds_read_b64_tr_b16 v[136:137], v226 offset:40960
    v_fma_f32 v191, v191, s89, v234
    v_mul_f32 v184, v184, v96
    v_mfma_f32_16x16x32_bf16 v[0:3], v[148:151], a[164:167], v[0:3]
    v_exp_f32 v184, v184
    v_mul_f32 v185, v185, v97
    v_mfma_f32_16x16x32_bf16 v[16:19], v[144:147], a[168:171], v[16:19]
    ds_read_b64_tr_b16 v[138:139], v226 offset:41472
    v_mul_f32 v186, v186, v98
    v_mfma_f32_16x16x32_bf16 v[16:19], v[148:151], a[172:175], v[16:19]
    v_exp_f32 v185, v185
    v_mul_f32 v187, v187, v99
    v_mfma_f32_16x16x32_bf16 v[32:35], v[144:147], a[176:179], v[32:35]
    ds_read_b64_tr_b16 v[140:141], v226 offset:43008
    v_mul_f32 v188, v188, v100
    v_mfma_f32_16x16x32_bf16 v[32:35], v[148:151], a[180:183], v[32:35]
    buffer_load_dwordx4 v233, s[40:43], s101 offen offset:2048 sc1 lds
    v_mul_f32 v189, v189, v101
    v_mfma_f32_16x16x32_bf16 v[48:51], v[144:147], a[184:187], v[48:51]
    ds_read_b64_tr_b16 v[142:143], v226 offset:43520
    v_exp_f32 v186, v186
    v_mfma_f32_16x16x32_bf16 v[48:51], v[148:151], a[188:191], v[48:51]
    v_exp_f32 v187, v187
    s_waitcnt lgkmcnt(4)
    v_mfma_f32_16x16x32_bf16 v[4:7], v[128:131], a[160:163], v[4:7]
    ds_read_b64_tr_b16 v[144:145], v227 offset:40960
    v_exp_f32 v188, v188
    v_mfma_f32_16x16x32_bf16 v[4:7], v[132:135], a[164:167], v[4:7]
    buffer_load_dwordx4 v233, s[40:43], s101 offen offset:3072 sc1 lds
    v_mul_f32 v190, v190, v102
    v_mfma_f32_16x16x32_bf16 v[20:23], v[128:131], a[168:171], v[20:23]
    ds_read_b64_tr_b16 v[146:147], v227 offset:41472
    s_add_u32 m0, s68, 32768
    v_mul_f32 v191, v191, v103
    v_mfma_f32_16x16x32_bf16 v[20:23], v[132:135], a[172:175], v[20:23]
    s_add_u32 s101, s68, 31490048
    v_exp_f32 v189, v189
    v_mfma_f32_16x16x32_bf16 v[36:39], v[128:131], a[176:179], v[36:39]
    ds_read_b64_tr_b16 v[148:149], v227 offset:43008
    v_mul_f32 v96, v96, v104
    v_mfma_f32_16x16x32_bf16 v[36:39], v[132:135], a[180:183], v[36:39]
    buffer_load_dwordx4 v233, s[40:43], s101 offen offset:0 sc1 lds
    v_mfma_f32_16x16x32_bf16 v[52:55], v[128:131], a[184:187], v[52:55]
    ds_read_b64_tr_b16 v[150:151], v227 offset:43520
    v_exp_f32 v190, v190
    v_mfma_f32_16x16x32_bf16 v[52:55], v[132:135], a[188:191], v[52:55]
    v_mul_f32 v97, v97, v105
    s_waitcnt lgkmcnt(4)
    v_mfma_f32_16x16x32_bf16 v[8:11], v[136:139], a[160:163], v[8:11]
    ds_read_b64_tr_b16 v[128:129], v228 offset:0
    v_exp_f32 v191, v191
    v_mfma_f32_16x16x32_bf16 v[8:11], v[140:143], a[164:167], v[8:11]
    buffer_load_dwordx2 v[244:245], off, s[44:47], s76 sc1
    v_mfma_f32_16x16x32_bf16 v[24:27], v[136:139], a[168:171], v[24:27]
    ds_read_b64_tr_b16 v[130:131], v228 offset:512
    v_lshl_add_u32 v249, s60, 2, v233
    v_mul_f32 v98, v98, v106
    v_mfma_f32_16x16x32_bf16 v[24:27], v[140:143], a[172:175], v[24:27]
    s_add_u32 s77, s22, 36864
    v_mul_f32 v99, v99, v107
    v_mul_f32 v100, v100, v108
    v_mfma_f32_16x16x32_bf16 v[40:43], v[136:139], a[176:179], v[40:43]
    ds_read_b64_tr_b16 v[132:133], v228 offset:2048
    v_mul_f32 v101, v101, v109
    v_mfma_f32_16x16x32_bf16 v[40:43], v[140:143], a[180:183], v[40:43]
    buffer_load_dwordx4 v233, s[40:43], s101 offen offset:1024 sc1 lds
    v_mfma_f32_16x16x32_bf16 v[56:59], v[136:139], a[184:187], v[56:59]
    ds_read_b64_tr_b16 v[134:135], v228 offset:2560
    v_mul_f32 v102, v102, v110
    v_mul_f32 v103, v103, v111
    v_mfma_f32_16x16x32_bf16 v[56:59], v[140:143], a[188:191], v[56:59]
    v_add_f32 v184, 1.0, v184
    v_add_f32 v185, 1.0, v185
    s_waitcnt lgkmcnt(4)
    v_mfma_f32_16x16x32_bf16 v[12:15], v[144:147], a[160:163], v[12:15]
    ds_read_b64_tr_b16 v[136:137], v229 offset:0
    v_add_f32 v186, 1.0, v186
    v_mfma_f32_16x16x32_bf16 v[12:15], v[148:151], a[164:167], v[12:15]
    buffer_load_dwordx4 v233, s[40:43], s101 offen offset:2048 sc1 lds
    v_add_f32 v187, 1.0, v187
    v_mfma_f32_16x16x32_bf16 v[28:31], v[144:147], a[168:171], v[28:31]
    ds_read_b64_tr_b16 v[138:139], v229 offset:512
    v_rcp_f32 v184, v184
    v_mfma_f32_16x16x32_bf16 v[28:31], v[148:151], a[172:175], v[28:31]
    v_rcp_f32 v185, v185
    v_add_f32 v188, 1.0, v188
    v_mfma_f32_16x16x32_bf16 v[44:47], v[144:147], a[176:179], v[44:47]
    ds_read_b64_tr_b16 v[140:141], v229 offset:2048
    v_add_f32 v189, 1.0, v189
    v_mfma_f32_16x16x32_bf16 v[44:47], v[148:151], a[180:183], v[44:47]
    buffer_load_dwordx4 v233, s[40:43], s101 offen offset:3072 sc1 lds
    v_mfma_f32_16x16x32_bf16 v[60:63], v[144:147], a[184:187], v[60:63]
    ds_read_b64_tr_b16 v[142:143], v229 offset:2560
    v_rcp_f32 v186, v186
    v_mfma_f32_16x16x32_bf16 v[60:63], v[148:151], a[188:191], v[60:63]
    v_rcp_f32 v187, v187
    s_waitcnt lgkmcnt(4)
    v_mfma_f32_16x16x32_bf16 v[0:3], v[128:131], a[192:195], v[0:3]
    ds_read_b64_tr_b16 v[144:145], v228 offset:8192
    v_rcp_f32 v188, v188
    v_mfma_f32_16x16x32_bf16 v[0:3], v[132:135], a[196:199], v[0:3]
    v_rcp_f32 v189, v189
    v_add_f32 v190, 1.0, v190
    v_mfma_f32_16x16x32_bf16 v[16:19], v[128:131], a[200:203], v[16:19]
    ds_read_b64_tr_b16 v[146:147], v228 offset:8704
    s_add_u32 m0, s68, 49152
    v_mfma_f32_16x16x32_bf16 v[16:19], v[132:135], a[204:207], v[16:19]
    s_add_u32 s101, s68, 31506432
    v_rcp_f32 v190, v190
    v_mfma_f32_16x16x32_bf16 v[32:35], v[128:131], a[208:211], v[32:35]
    ds_read_b64_tr_b16 v[148:149], v228 offset:10240
    v_add_f32 v191, 1.0, v191
    v_mfma_f32_16x16x32_bf16 v[32:35], v[132:135], a[212:215], v[32:35]
    buffer_load_dwordx4 v233, s[40:43], s101 offen offset:0 sc1 lds
    v_mul_f32 v96, v96, v184
    v_mfma_f32_16x16x32_bf16 v[48:51], v[128:131], a[216:219], v[48:51]
    ds_read_b64_tr_b16 v[150:151], v228 offset:10752
    v_rcp_f32 v191, v191
    v_mfma_f32_16x16x32_bf16 v[48:51], v[132:135], a[220:223], v[48:51]
    v_mul_f32 v97, v97, v185
    v_mul_f32 v98, v98, v186
    s_waitcnt lgkmcnt(4)
    v_mfma_f32_16x16x32_bf16 v[4:7], v[136:139], a[192:195], v[4:7]
    ds_read_b64_tr_b16 v[128:129], v229 offset:8192
    v_mul_f32 v99, v99, v187
    v_mul_f32 v100, v100, v188
    v_mfma_f32_16x16x32_bf16 v[4:7], v[140:143], a[196:199], v[4:7]
    buffer_load_dwordx4 v233, s[40:43], s101 offen offset:1024 sc1 lds
    v_mfma_f32_16x16x32_bf16 v[20:23], v[136:139], a[200:203], v[20:23]
    ds_read_b64_tr_b16 v[130:131], v229 offset:8704
    v_mul_f32 v101, v101, v189
    v_mul_f32 v102, v102, v190
    v_mfma_f32_16x16x32_bf16 v[20:23], v[140:143], a[204:207], v[20:23]
    v_mul_f32 v103, v103, v191
    v_cvt_pk_bf16_f32 v200, v96, v97
    v_cvt_pk_bf16_f32 v202, v100, v101
    v_mfma_f32_16x16x32_bf16 v[36:39], v[136:139], a[208:211], v[36:39]
    ds_read_b64_tr_b16 v[132:133], v229 offset:10240
    v_cvt_pk_bf16_f32 v201, v98, v99
    v_mfma_f32_16x16x32_bf16 v[36:39], v[140:143], a[212:215], v[36:39]
    buffer_load_dwordx4 v233, s[40:43], s101 offen offset:2048 sc1 lds
    v_cvt_pk_bf16_f32 v203, v102, v103
    v_mfma_f32_16x16x32_bf16 v[52:55], v[136:139], a[216:219], v[52:55]
    ds_read_b64_tr_b16 v[134:135], v229 offset:10752
    v_permlane16_swap_b32 v200, v202
    v_mfma_f32_16x16x32_bf16 v[52:55], v[140:143], a[220:223], v[52:55]
    v_permlane16_swap_b32 v201, v203
    s_waitcnt lgkmcnt(4)
    v_mfma_f32_16x16x32_bf16 v[8:11], v[144:147], a[192:195], v[8:11]
    s_waitcnt vmcnt(17)
    s_barrier
    v_mfma_f32_16x16x32_bf16 v[8:11], v[148:151], a[196:199], v[8:11]
    buffer_store_dwordx4 v[200:203], v254, s[48:51], s64 offen offset:1024 sc1
    v_mfma_f32_16x16x32_bf16 v[24:27], v[144:147], a[200:203], v[24:27]
    ds_read_b64_tr_b16 v[136:137], v228 offset:16384
    ds_read_b64_tr_b16 v[138:139], v228 offset:16896
    v_mfma_f32_16x16x32_bf16 v[24:27], v[148:151], a[204:207], v[24:27]
    v_mul_f32 v184, v112, v112
    v_mul_f32 v185, v113, v113
    v_mfma_f32_16x16x32_bf16 v[40:43], v[144:147], a[208:211], v[40:43]
    ds_read_b64_tr_b16 v[140:141], v228 offset:18432
    v_mul_f32 v186, v114, v114
    v_mfma_f32_16x16x32_bf16 v[40:43], v[148:151], a[212:215], v[40:43]
    buffer_load_dwordx4 v233, s[40:43], s101 offen offset:3072 sc1 lds
    v_mfma_f32_16x16x32_bf16 v[56:59], v[144:147], a[216:219], v[56:59]
    ds_read_b64_tr_b16 v[142:143], v228 offset:18944
    s_add_u32 m0, s68, 65536
    v_mfma_f32_16x16x32_bf16 v[56:59], v[148:151], a[220:223], v[56:59]
    s_add_u32 s101, s68, 31522816
    s_waitcnt lgkmcnt(4)
    v_mfma_f32_16x16x32_bf16 v[12:15], v[128:131], a[192:195], v[12:15]
    ds_read_b64_tr_b16 v[144:145], v229 offset:16384
    v_mul_f32 v187, v115, v115
    v_mul_f32 v188, v116, v116
    v_mfma_f32_16x16x32_bf16 v[12:15], v[132:135], a[196:199], v[12:15]
    buffer_load_dwordx4 v233, s[40:43], s101 offen offset:0 sc1 lds
    v_mul_f32 v189, v117, v117
    v_mfma_f32_16x16x32_bf16 v[28:31], v[128:131], a[200:203], v[28:31]
    ds_read_b64_tr_b16 v[146:147], v229 offset:16896
    v_mul_f32 v190, v118, v118
    v_mul_f32 v191, v119, v119
    v_mfma_f32_16x16x32_bf16 v[28:31], v[132:135], a[204:207], v[28:31]
    v_fma_f32 v184, v184, s89, v234
    v_fma_f32 v185, v185, s89, v234
    v_fma_f32 v186, v186, s89, v234
    v_mfma_f32_16x16x32_bf16 v[44:47], v[128:131], a[208:211], v[44:47]
    ds_read_b64_tr_b16 v[148:149], v229 offset:18432
    v_fma_f32 v187, v187, s89, v234
    v_mfma_f32_16x16x32_bf16 v[44:47], v[132:135], a[212:215], v[44:47]
    buffer_load_dwordx4 v233, s[40:43], s101 offen offset:1024 sc1 lds
    v_mfma_f32_16x16x32_bf16 v[60:63], v[128:131], a[216:219], v[60:63]
    ds_read_b64_tr_b16 v[150:151], v229 offset:18944
    v_fma_f32 v188, v188, s89, v234
    v_fma_f32 v189, v189, s89, v234
    v_mfma_f32_16x16x32_bf16 v[60:63], v[132:135], a[220:223], v[60:63]
    v_fma_f32 v190, v190, s89, v234
    v_fma_f32 v191, v191, s89, v234
    s_waitcnt lgkmcnt(4)
    v_mfma_f32_16x16x32_bf16 v[0:3], v[136:139], a[224:227], v[0:3]
    ds_read_b64_tr_b16 v[128:129], v228 offset:24576
    s_waitcnt vmcnt(10)
    v_mfma_f32_16x16x32_bf16 v[0:3], v[140:143], a[228:231], v[0:3]
    v_min_u32 v244, v244, v245
    v_cmp_eq_u32 vcc, 0, v244
    v_mul_f32 v184, v184, v112
    v_mfma_f32_16x16x32_bf16 v[16:19], v[136:139], a[232:235], v[16:19]
    ds_read_b64_tr_b16 v[130:131], v228 offset:25088
    s_cbranch_vccnz L_fqspin
L_fqok:
    v_mfma_f32_16x16x32_bf16 v[16:19], v[140:143], a[236:239], v[16:19]
    v_exp_f32 v184, v184
    v_mul_f32 v185, v185, v113
    v_mfma_f32_16x16x32_bf16 v[32:35], v[136:139], a[240:243], v[32:35]
    ds_read_b64_tr_b16 v[132:133], v228 offset:26624
    v_mul_f32 v186, v186, v114
    v_mfma_f32_16x16x32_bf16 v[32:35], v[140:143], a[244:247], v[32:35]
    buffer_load_dwordx4 v233, s[40:43], s101 offen offset:2048 sc1 lds
    v_mfma_f32_16x16x32_bf16 v[48:51], v[136:139], a[248:251], v[48:51]
    ds_read_b64_tr_b16 v[134:135], v228 offset:27136
    v_mul_f32 v187, v187, v115
    v_mfma_f32_16x16x32_bf16 v[48:51], v[140:143], a[252:255], v[48:51]
    buffer_load_dwordx4 v[208:211], v233, s[44:47], s22 offen sc1
    s_waitcnt lgkmcnt(4)
    v_mfma_f32_16x16x32_bf16 v[4:7], v[144:147], a[224:227], v[4:7]
    ds_read_b64_tr_b16 v[136:137], v229 offset:24576
    v_mul_f32 v188, v188, v116
    v_mfma_f32_16x16x32_bf16 v[4:7], v[148:151], a[228:231], v[4:7]
    buffer_load_dwordx4 v233, s[40:43], s101 offen offset:3072 sc1 lds
    v_mfma_f32_16x16x32_bf16 v[20:23], v[144:147], a[232:235], v[20:23]
    ds_read_b64_tr_b16 v[138:139], v229 offset:25088
    s_add_u32 m0, s68, 81920
    v_mul_f32 v189, v189, v117
    v_mfma_f32_16x16x32_bf16 v[20:23], v[148:151], a[236:239], v[20:23]
    s_add_u32 s101, s68, 31539200
    v_exp_f32 v185, v185
    v_mfma_f32_16x16x32_bf16 v[36:39], v[144:147], a[240:243], v[36:39]
    ds_read_b64_tr_b16 v[140:141], v229 offset:26624
    v_mul_f32 v190, v190, v118
    v_mfma_f32_16x16x32_bf16 v[36:39], v[148:151], a[244:247], v[36:39]
    buffer_load_dwordx4 v233, s[40:43], s101 offen offset:0 sc1 lds
    v_mul_f32 v191, v191, v119
    v_mfma_f32_16x16x32_bf16 v[52:55], v[144:147], a[248:251], v[52:55]
    ds_read_b64_tr_b16 v[142:143], v229 offset:27136
    v_exp_f32 v186, v186
    v_mfma_f32_16x16x32_bf16 v[52:55], v[148:151], a[252:255], v[52:55]
    v_mul_f32 v112, v112, v120
    s_waitcnt lgkmcnt(4)
    v_mfma_f32_16x16x32_bf16 v[8:11], v[128:131], a[224:227], v[8:11]
    ds_read_b64_tr_b16 v[144:145], v228 offset:32768
    v_mul_f32 v113, v113, v121
    v_mfma_f32_16x16x32_bf16 v[8:11], v[132:135], a[228:231], v[8:11]
    buffer_load_dwordx4 v[212:215], v233, s[44:47], s22 offen offset:512 sc1
    v_mfma_f32_16x16x32_bf16 v[24:27], v[128:131], a[232:235], v[24:27]
    ds_read_b64_tr_b16 v[146:147], v228 offset:33280
    v_exp_f32 v187, v187
    v_mfma_f32_16x16x32_bf16 v[24:27], v[132:135], a[236:239], v[24:27]
    v_exp_f32 v188, v188
    v_mfma_f32_16x16x32_bf16 v[40:43], v[128:131], a[240:243], v[40:43]
    ds_read_b64_tr_b16 v[148:149], v228 offset:34816
    v_mul_f32 v114, v114, v122
    v_mfma_f32_16x16x32_bf16 v[40:43], v[132:135], a[244:247], v[40:43]
    buffer_load_dwordx4 v233, s[40:43], s101 offen offset:1024 sc1 lds
    v_mfma_f32_16x16x32_bf16 v[56:59], v[128:131], a[248:251], v[56:59]
    ds_read_b64_tr_b16 v[150:151], v228 offset:35328
    v_exp_f32 v189, v189
    v_mfma_f32_16x16x32_bf16 v[56:59], v[132:135], a[252:255], v[56:59]
    buffer_load_dword v236, v249, s[44:47], s22 offen offset:1024 sc1
    s_waitcnt lgkmcnt(4)
    v_mfma_f32_16x16x32_bf16 v[12:15], v[136:139], a[224:227], v[12:15]
    ds_read_b64_tr_b16 v[128:129], v229 offset:32768
    v_exp_f32 v190, v190
    v_mfma_f32_16x16x32_bf16 v[12:15], v[140:143], a[228:231], v[12:15]
    buffer_load_dwordx4 v233, s[40:43], s101 offen offset:2048 sc1 lds
    v_mul_f32 v115, v115, v123
    v_mfma_f32_16x16x32_bf16 v[28:31], v[136:139], a[232:235], v[28:31]
    ds_read_b64_tr_b16 v[130:131], v229 offset:33280
    v_exp_f32 v191, v191
    v_mfma_f32_16x16x32_bf16 v[28:31], v[140:143], a[236:239], v[28:31]
    v_mul_f32 v116, v116, v124
    v_mul_f32 v117, v117, v125
    v_mul_f32 v118, v118, v126
    v_mfma_f32_16x16x32_bf16 v[44:47], v[136:139], a[240:243], v[44:47]
    ds_read_b64_tr_b16 v[132:133], v229 offset:34816
    v_mul_f32 v119, v119, v127
    v_mfma_f32_16x16x32_bf16 v[44:47], v[140:143], a[244:247], v[44:47]
    buffer_load_dwordx4 v233, s[40:43], s101 offen offset:3072 sc1 lds
    v_add_f32 v184, 1.0, v184
    v_mfma_f32_16x16x32_bf16 v[60:63], v[136:139], a[248:251], v[60:63]
    ds_read_b64_tr_b16 v[134:135], v229 offset:35328
    v_rcp_f32 v184, v184
    v_mfma_f32_16x16x32_bf16 v[60:63], v[140:143], a[252:255], v[60:63]
    v_add_f32 v185, 1.0, v185
    v_add_f32 v186, 1.0, v186
    s_waitcnt lgkmcnt(4)
    v_mfma_f32_16x16x32_bf16 v[0:3], v[144:147], v[152:155], v[0:3]
    s_waitcnt vmcnt(21)
    s_barrier
    v_mfma_f32_16x16x32_bf16 v[0:3], v[148:151], v[156:159], v[0:3]
    v_rcp_f32 v185, v185
    v_mfma_f32_16x16x32_bf16 v[16:19], v[144:147], v[160:163], v[16:19]
    ds_read_b64_tr_b16 v[136:137], v228 offset:40960
    ds_read_b64_tr_b16 v[138:139], v228 offset:41472
    v_mfma_f32_16x16x32_bf16 v[16:19], v[148:151], v[164:167], v[16:19]
    s_add_u32 m0, s68, 98304
    s_add_u32 s101, s68, 31555584
    v_mfma_f32_16x16x32_bf16 v[32:35], v[144:147], v[168:171], v[32:35]
    ds_read_b64_tr_b16 v[140:141], v228 offset:43008
    v_add_f32 v187, 1.0, v187
    v_mfma_f32_16x16x32_bf16 v[32:35], v[148:151], v[172:175], v[32:35]
    buffer_load_dwordx4 v233, s[40:43], s101 offen offset:0 sc1 lds
    v_mfma_f32_16x16x32_bf16 v[48:51], v[144:147], v[176:179], v[48:51]
    ds_read_b64_tr_b16 v[142:143], v228 offset:43520
    v_add_f32 v188, 1.0, v188
    v_mfma_f32_16x16x32_bf16 v[48:51], v[148:151], v[180:183], v[48:51]
    buffer_load_dwordx4 v[192:195], v233, s[44:47], s77 offen sc1
    s_waitcnt lgkmcnt(4)
    v_mfma_f32_16x16x32_bf16 v[4:7], v[128:131], v[152:155], v[4:7]
    ds_read_b64_tr_b16 v[144:145], v229 offset:40960
    v_add_f32 v189, 1.0, v189
    v_mfma_f32_16x16x32_bf16 v[4:7], v[132:135], v[156:159], v[4:7]
    buffer_load_dwordx4 v[196:199], v233, s[44:47], s77 offen offset:512 sc1
    v_mfma_f32_16x16x32_bf16 v[20:23], v[128:131], v[160:163], v[20:23]
    ds_read_b64_tr_b16 v[146:147], v229 offset:41472
    v_add_f32 v190, 1.0, v190
    v_mfma_f32_16x16x32_bf16 v[20:23], v[132:135], v[164:167], v[20:23]
    v_rcp_f32 v186, v186
    v_add_f32 v191, 1.0, v191
    v_mfma_f32_16x16x32_bf16 v[36:39], v[128:131], v[168:171], v[36:39]
    ds_read_b64_tr_b16 v[148:149], v229 offset:43008
    v_mul_f32 v112, v112, v184
    v_mfma_f32_16x16x32_bf16 v[36:39], v[132:135], v[172:175], v[36:39]
    buffer_load_dwordx4 v233, s[40:43], s101 offen offset:1024 sc1 lds
    v_mfma_f32_16x16x32_bf16 v[52:55], v[128:131], v[176:179], v[52:55]
    ds_read_b64_tr_b16 v[150:151], v229 offset:43520
    v_rcp_f32 v187, v187
    v_mfma_f32_16x16x32_bf16 v[52:55], v[132:135], v[180:183], v[52:55]
    v_rcp_f32 v188, v188
    s_waitcnt lgkmcnt(4)
    v_mfma_f32_16x16x32_bf16 v[8:11], v[136:139], v[152:155], v[8:11]
    buffer_load_dword v237, v249, s[44:47], s77 offen offset:1024 sc1
    v_mul_f32 v113, v113, v185
    v_mfma_f32_16x16x32_bf16 v[8:11], v[140:143], v[156:159], v[8:11]
    v_rcp_f32 v189, v189
    v_mul_f32 v114, v114, v186
    v_mfma_f32_16x16x32_bf16 v[24:27], v[136:139], v[160:163], v[24:27]
    v_rcp_f32 v190, v190
    v_mul_f32 v115, v115, v187
    v_mfma_f32_16x16x32_bf16 v[24:27], v[140:143], v[164:167], v[24:27]
    v_rcp_f32 v191, v191
    v_mul_f32 v116, v116, v188
    v_mfma_f32_16x16x32_bf16 v[40:43], v[136:139], v[168:171], v[40:43]
    buffer_load_dwordx4 v233, s[40:43], s101 offen offset:2048 sc1 lds
    v_mul_f32 v117, v117, v189
    v_mfma_f32_16x16x32_bf16 v[40:43], v[140:143], v[172:175], v[40:43]
    v_mul_f32 v118, v118, v190
    v_mul_f32 v119, v119, v191
    v_cvt_pk_bf16_f32 v204, v112, v113
    v_mfma_f32_16x16x32_bf16 v[56:59], v[136:139], v[176:179], v[56:59]
    v_cvt_pk_bf16_f32 v206, v116, v117
    v_cvt_pk_bf16_f32 v205, v114, v115
    v_cvt_pk_bf16_f32 v207, v118, v119
    v_mfma_f32_16x16x32_bf16 v[56:59], v[140:143], v[180:183], v[56:59]
    v_permlane16_swap_b32 v204, v206
    s_waitcnt lgkmcnt(0)
    v_mfma_f32_16x16x32_bf16 v[12:15], v[144:147], v[152:155], v[12:15]
    v_permlane16_swap_b32 v205, v207
    v_mfma_f32_16x16x32_bf16 v[12:15], v[148:151], v[156:159], v[12:15]
    buffer_store_dwordx4 v[204:207], v254, s[48:51], s64 offen offset:1280 sc1
    v_mfma_f32_16x16x32_bf16 v[28:31], v[144:147], v[160:163], v[28:31]
    v_mfma_f32_16x16x32_bf16 v[28:31], v[148:151], v[164:167], v[28:31]
    v_mfma_f32_16x16x32_bf16 v[44:47], v[144:147], v[168:171], v[44:47]
    buffer_load_dwordx4 v233, s[40:43], s101 offen offset:3072 sc1 lds
    v_mfma_f32_16x16x32_bf16 v[44:47], v[148:151], v[172:175], v[44:47]
    v_mfma_f32_16x16x32_bf16 v[60:63], v[144:147], v[176:179], v[60:63]
    v_mfma_f32_16x16x32_bf16 v[60:63], v[148:151], v[180:183], v[60:63]
L_trans:
    s_bfe_u32 s78, s66, 0x80008
    s_mov_b32 s50, 41943040
    s_lshl_b32 s78, s78, 13
    s_add_u32 s64, s65, s78
    s_mov_b32 s88, s89
    s_mov_b32 s36, 0
    v_min_u32 v225, 512, v233
    v_mov_b32 v94, 0
    v_mov_b32 v95, 0
    v_cmp_gt_u32 vcc, 32, v241
    s_mov_b32 s74, 31785984
    ds_read_b128 v[216:219], v225 offset:4096
    ds_read_b128 v[200:203], v243 offset:4624
    ds_read_b128 v[204:207], v243 offset:5232
    v_pk_mul_f32 v[64:65], v[0:1], v[0:1]
    v_pk_mul_f32 v[66:67], v[2:3], v[2:3]
    v_pk_mul_f32 v[68:69], v[4:5], v[4:5]
    v_pk_mul_f32 v[70:71], v[6:7], v[6:7]
    v_pk_fma_f32 v[64:65], v[64:65], s[88:89], v[234:235] op_sel_hi:[1,1,0]
    v_pk_fma_f32 v[66:67], v[66:67], s[88:89], v[234:235] op_sel_hi:[1,1,0]
    v_pk_fma_f32 v[68:69], v[68:69], s[88:89], v[234:235] op_sel_hi:[1,1,0]
    v_pk_fma_f32 v[70:71], v[70:71], s[88:89], v[234:235] op_sel_hi:[1,1,0]
    v_pk_mul_f32 v[64:65], v[64:65], v[0:1]
    v_pk_mul_f32 v[66:67], v[66:67], v[2:3]
    v_pk_mul_f32 v[68:69], v[68:69], v[4:5]
    v_pk_mul_f32 v[70:71], v[70:71], v[6:7]
    v_pk_mul_f32 v[0:1], v[0:1], v[8:9]
    v_pk_mul_f32 v[2:3], v[2:3], v[10:11]
    v_pk_mul_f32 v[4:5], v[4:5], v[12:13]
    v_pk_mul_f32 v[6:7], v[6:7], v[14:15]
    v_mfma_f32_32x32x8_bf16 v[160:175], v[94:95], v[94:95], 0
    v_exp_f32 v64, v64
    v_exp_f32 v65, v65
    v_exp_f32 v66, v66
    v_mfma_f32_32x32x8_bf16 v[176:191], v[94:95], v[94:95], 0
    v_exp_f32 v67, v67
    v_exp_f32 v68, v68
    v_exp_f32 v69, v69
    v_exp_f32 v70, v70
    v_exp_f32 v71, v71
    v_pk_add_f32 v[64:65], v[64:65], 1.0 op_sel_hi:[1,0]
    v_pk_add_f32 v[66:67], v[66:67], 1.0 op_sel_hi:[1,0]
    v_pk_add_f32 v[68:69], v[68:69], 1.0 op_sel_hi:[1,0]
    v_pk_add_f32 v[70:71], v[70:71], 1.0 op_sel_hi:[1,0]
    v_rcp_f32 v64, v64
    v_rcp_f32 v65, v65
    v_rcp_f32 v66, v66
    v_rcp_f32 v67, v67
    v_rcp_f32 v68, v68
    v_rcp_f32 v69, v69
    v_rcp_f32 v70, v70
    v_rcp_f32 v71, v71
    v_pk_mul_f32 v[0:1], v[0:1], v[64:65]
    v_pk_mul_f32 v[2:3], v[2:3], v[66:67]
    v_pk_mul_f32 v[4:5], v[4:5], v[68:69]
    v_pk_mul_f32 v[6:7], v[6:7], v[70:71]
    v_cvt_pk_bf16_f32 v80, v0, v1
    v_cvt_pk_bf16_f32 v82, v4, v5
    v_cvt_pk_bf16_f32 v81, v2, v3
    v_cvt_pk_bf16_f32 v83, v6, v7
    s_nop 0
    v_permlane16_swap_b32 v80, v82
    v_permlane16_swap_b32 v81, v83
    buffer_store_dwordx4 v[80:83], v254, s[48:51], s64 offen offset:0 sc1
    s_waitcnt vmcnt(4)
    s_set_gpr_idx_on s60, gpr_idx(SRC0)
    s_nop 0
    v_mov_b32 v96, v208
    v_mov_b32 v97, v209
    v_mov_b32 v98, v210
    v_mov_b32 v99, v211
    v_mov_b32 v100, v192
    v_mov_b32 v101, v193
    v_mov_b32 v102, v194
    v_mov_b32 v103, v195
    s_set_gpr_idx_off
    ds_read_b128 v[192:195], v233 offset:0
    ds_read_b128 v[196:199], v233 offset:1024
    v_cndmask_b32 v104, 0, v236, vcc
    v_mov_b32 v105, 0
    v_cndmask_b32 v108, 0, v237, vcc
    v_mov_b32 v109, 0
    v_pk_mul_f32 v[64:65], v[16:17], v[16:17]
    v_pk_mul_f32 v[66:67], v[18:19], v[18:19]
    v_pk_mul_f32 v[68:69], v[20:21], v[20:21]
    v_pk_mul_f32 v[70:71], v[22:23], v[22:23]
    v_pk_fma_f32 v[64:65], v[64:65], s[88:89], v[234:235] op_sel_hi:[1,1,0]
    v_pk_fma_f32 v[66:67], v[66:67], s[88:89], v[234:235] op_sel_hi:[1,1,0]
    v_pk_fma_f32 v[68:69], v[68:69], s[88:89], v[234:235] op_sel_hi:[1,1,0]
    v_pk_fma_f32 v[70:71], v[70:71], s[88:89], v[234:235] op_sel_hi:[1,1,0]
    v_pk_mul_f32 v[64:65], v[64:65], v[16:17]
    v_pk_mul_f32 v[66:67], v[66:67], v[18:19]
    v_pk_mul_f32 v[68:69], v[68:69], v[20:21]
    v_pk_mul_f32 v[70:71], v[70:71], v[22:23]
    v_pk_mul_f32 v[16:17], v[16:17], v[24:25]
    v_pk_mul_f32 v[18:19], v[18:19], v[26:27]
    v_pk_mul_f32 v[20:21], v[20:21], v[28:29]
    v_pk_mul_f32 v[22:23], v[22:23], v[30:31]
    s_waitcnt lgkmcnt(0)
    v_mfma_f32_32x32x8_bf16 v[112:127], v[216:217], v[104:105], 0
    v_exp_f32 v64, v64
    v_exp_f32 v65, v65
    v_exp_f32 v66, v66
    v_mfma_f32_32x32x8_bf16 v[128:143], v[216:217], v[108:109], 0
    v_exp_f32 v67, v67
    v_exp_f32 v68, v68
    v_exp_f32 v69, v69
    v_exp_f32 v70, v70
    v_exp_f32 v71, v71
    v_pk_add_f32 v[64:65], v[64:65], 1.0 op_sel_hi:[1,0]
    v_pk_add_f32 v[66:67], v[66:67], 1.0 op_sel_hi:[1,0]
    v_pk_add_f32 v[68:69], v[68:69], 1.0 op_sel_hi:[1,0]
    v_pk_add_f32 v[70:71], v[70:71], 1.0 op_sel_hi:[1,0]
    v_mfma_f32_32x32x16_bf16 v[112:127], v[192:195], v[96:99], v[112:127]
    buffer_load_dwordx4 v[244:247], v233, s[44:47], s74 offen sc1
    v_rcp_f32 v64, v64
    v_rcp_f32 v65, v65
    v_rcp_f32 v66, v66
    v_mfma_f32_32x32x16_bf16 v[128:143], v[192:195], v[100:103], v[128:143]
    v_rcp_f32 v67, v67
    v_rcp_f32 v68, v68
    v_rcp_f32 v69, v69
    v_rcp_f32 v70, v70
    v_rcp_f32 v71, v71
    v_pk_mul_f32 v[16:17], v[16:17], v[64:65]
    v_pk_mul_f32 v[18:19], v[18:19], v[66:67]
    v_pk_mul_f32 v[20:21], v[20:21], v[68:69]
    v_pk_mul_f32 v[22:23], v[22:23], v[70:71]
    v_mfma_f32_32x32x8_bf16 v[0:15], v[94:95], v[94:95], 0
    v_cvt_pk_bf16_f32 v84, v16, v17
    v_cvt_pk_bf16_f32 v86, v20, v21
    v_cvt_pk_bf16_f32 v85, v18, v19
    v_cvt_pk_bf16_f32 v87, v22, v23
    s_nop 0
    v_permlane16_swap_b32 v84, v86
    v_permlane16_swap_b32 v85, v87
    buffer_store_dwordx4 v[84:87], v254, s[48:51], s64 offen offset:256 sc1
    v_mov_b32 v224, v233
    v_add_u32 v226, 4096, v233
    v_add_u32 v227, 12288, v233
    v_add_u32 v228, 20480, v233
    v_add_u32 v229, 28672, v233
    v_mov_b32 v156, 0
    v_mov_b32 v157, 0
    v_mov_b32 v158, 0
    v_mov_b32 v212, 0
    v_mov_b32 v213, 0
    v_mov_b32 v214, 0
    v_mov_b32 v215, 0
    v_max3_f32 v112, v112, v113, v114
    v_max3_f32 v128, v128, v129, v130
    v_max3_f32 v112, v112, v115, v116
    v_max3_f32 v128, v128, v131, v132
    v_max3_f32 v112, v112, v117, v118
    v_max3_f32 v128, v128, v133, v134
    v_max3_f32 v112, v112, v119, v120
    v_max3_f32 v128, v128, v135, v136
    v_max3_f32 v112, v112, v121, v122
    v_max3_f32 v128, v128, v137, v138
    v_max3_f32 v112, v112, v123, v124
    v_max3_f32 v128, v128, v139, v140
    v_max3_f32 v112, v112, v125, v126
    v_max3_f32 v128, v128, v141, v142
    v_max_f32 v112, v112, v127
    v_max_f32 v128, v128, v143
    v_mov_b32 v113, v112
    v_mov_b32 v129, v128
    s_nop 0
    v_permlane32_swap_b32 v112, v113
    v_permlane32_swap_b32 v128, v129
    v_max_f32 v112, v112, v113
    v_max_f32 v128, v128, v129
    v_and_b32 v88, 0xffff0000, v112
    v_sub_f32 v89, v112, v88
    v_and_b32 v90, 0xffff0000, v89
    v_sub_f32 v89, v89, v90
    v_lshrrev_b32 v88, 16, v88
    v_or_b32 v88, v88, v90
    v_xor_b32 v88, 0x80008000, v88
    v_lshrrev_b32 v89, 16, v89
    v_xor_b32 v89, 0x8000, v89
    v_cndmask_b32 v104, v88, v236, vcc
    v_cndmask_b32 v105, v89, 0, vcc
    v_cndmask_b32 v106, v88, 0, vcc
    v_cndmask_b32 v107, v89, v236, vcc
    v_and_b32 v88, 0xffff0000, v128
    v_sub_f32 v89, v128, v88
    v_and_b32 v90, 0xffff0000, v89
    v_sub_f32 v89, v89, v90
    v_lshrrev_b32 v88, 16, v88
    v_or_b32 v88, v88, v90
    v_xor_b32 v88, 0x80008000, v88
    v_lshrrev_b32 v89, 16, v89
    v_xor_b32 v89, 0x8000, v89
    v_cndmask_b32 v108, v88, v237, vcc
    v_cndmask_b32 v109, v89, 0, vcc
    v_cndmask_b32 v110, v88, 0, vcc
    v_cndmask_b32 v111, v89, v237, vcc
    v_pk_mul_f32 v[64:65], v[32:33], v[32:33]
    v_pk_mul_f32 v[66:67], v[34:35], v[34:35]
    v_pk_mul_f32 v[68:69], v[36:37], v[36:37]
    v_pk_mul_f32 v[70:71], v[38:39], v[38:39]
    v_pk_fma_f32 v[64:65], v[64:65], s[88:89], v[234:235] op_sel_hi:[1,1,0]
    v_pk_fma_f32 v[66:67], v[66:67], s[88:89], v[234:235] op_sel_hi:[1,1,0]
    v_pk_fma_f32 v[68:69], v[68:69], s[88:89], v[234:235] op_sel_hi:[1,1,0]
    v_pk_fma_f32 v[70:71], v[70:71], s[88:89], v[234:235] op_sel_hi:[1,1,0]
    v_pk_mul_f32 v[64:65], v[64:65], v[32:33]
    v_pk_mul_f32 v[66:67], v[66:67], v[34:35]
    v_pk_mul_f32 v[68:69], v[68:69], v[36:37]
    v_pk_mul_f32 v[70:71], v[70:71], v[38:39]
    v_pk_mul_f32 v[32:33], v[32:33], v[40:41]
    v_pk_mul_f32 v[34:35], v[34:35], v[42:43]
    v_pk_mul_f32 v[36:37], v[36:37], v[44:45]
    v_pk_mul_f32 v[38:39], v[38:39], v[46:47]
    v_mfma_f32_32x32x8_bf16 v[112:127], v[216:217], v[104:105], 0
    v_exp_f32 v64, v64
    v_exp_f32 v65, v65
    v_exp_f32 v66, v66
    v_mfma_f32_32x32x8_bf16 v[16:31], v[94:95], v[94:95], 0
    v_exp_f32 v67, v67
    v_exp_f32 v68, v68
    v_exp_f32 v69, v69
    v_exp_f32 v70, v70
    v_exp_f32 v71, v71
    v_pk_add_f32 v[64:65], v[64:65], 1.0 op_sel_hi:[1,0]
    v_pk_add_f32 v[66:67], v[66:67], 1.0 op_sel_hi:[1,0]
    v_pk_add_f32 v[68:69], v[68:69], 1.0 op_sel_hi:[1,0]
    v_pk_add_f32 v[70:71], v[70:71], 1.0 op_sel_hi:[1,0]
    v_mfma_f32_32x32x16_bf16 v[112:127], v[192:195], v[96:99], v[112:127]
    v_rcp_f32 v64, v64
    v_rcp_f32 v65, v65
    v_rcp_f32 v66, v66
    v_rcp_f32 v67, v67
    v_rcp_f32 v68, v68
    v_rcp_f32 v69, v69
    v_rcp_f32 v70, v70
    v_rcp_f32 v71, v71
    v_pk_mul_f32 v[32:33], v[32:33], v[64:65]
    v_pk_mul_f32 v[34:35], v[34:35], v[66:67]
    v_pk_mul_f32 v[36:37], v[36:37], v[68:69]
    v_pk_mul_f32 v[38:39], v[38:39], v[70:71]
    v_cvt_pk_bf16_f32 v80, v32, v33
    v_cvt_pk_bf16_f32 v82, v36, v37
    v_cvt_pk_bf16_f32 v81, v34, v35
    v_cvt_pk_bf16_f32 v83, v38, v39
    s_nop 0
    v_permlane16_swap_b32 v80, v82
    v_permlane16_swap_b32 v81, v83
    buffer_store_dwordx4 v[80:83], v254, s[48:51], s64 offen offset:1024 sc1
    v_pk_mul_f32 v[64:65], v[48:49], v[48:49]
    v_pk_mul_f32 v[66:67], v[50:51], v[50:51]
    v_pk_mul_f32 v[68:69], v[52:53], v[52:53]
    v_pk_mul_f32 v[70:71], v[54:55], v[54:55]
    v_pk_fma_f32 v[64:65], v[64:65], s[88:89], v[234:235] op_sel_hi:[1,1,0]
    v_pk_fma_f32 v[66:67], v[66:67], s[88:89], v[234:235] op_sel_hi:[1,1,0]
    v_pk_fma_f32 v[68:69], v[68:69], s[88:89], v[234:235] op_sel_hi:[1,1,0]
    v_pk_fma_f32 v[70:71], v[70:71], s[88:89], v[234:235] op_sel_hi:[1,1,0]
    v_pk_mul_f32 v[64:65], v[64:65], v[48:49]
    v_pk_mul_f32 v[66:67], v[66:67], v[50:51]
    v_pk_mul_f32 v[68:69], v[68:69], v[52:53]
    v_pk_mul_f32 v[70:71], v[70:71], v[54:55]
    v_pk_mul_f32 v[48:49], v[48:49], v[56:57]
    v_pk_mul_f32 v[50:51], v[50:51], v[58:59]
    v_pk_mul_f32 v[52:53], v[52:53], v[60:61]
    v_pk_mul_f32 v[54:55], v[54:55], v[62:63]
    v_mfma_f32_32x32x8_bf16 v[32:47], v[94:95], v[94:95], 0
    v_exp_f32 v64, v64
    v_exp_f32 v65, v65
    v_exp_f32 v66, v66
    v_exp_f32 v67, v67
    v_exp_f32 v68, v68
    v_exp_f32 v69, v69
    v_exp_f32 v70, v70
    v_exp_f32 v71, v71
    v_pk_add_f32 v[64:65], v[64:65], 1.0 op_sel_hi:[1,0]
    v_pk_add_f32 v[66:67], v[66:67], 1.0 op_sel_hi:[1,0]
    v_pk_add_f32 v[68:69], v[68:69], 1.0 op_sel_hi:[1,0]
    v_pk_add_f32 v[70:71], v[70:71], 1.0 op_sel_hi:[1,0]
    v_rcp_f32 v64, v64
    v_rcp_f32 v65, v65
    v_rcp_f32 v66, v66
    v_rcp_f32 v67, v67
    v_rcp_f32 v68, v68
    v_rcp_f32 v69, v69
    v_rcp_f32 v70, v70
    v_rcp_f32 v71, v71
    v_pk_mul_f32 v[48:49], v[48:49], v[64:65]
    v_pk_mul_f32 v[50:51], v[50:51], v[66:67]
    v_pk_mul_f32 v[52:53], v[52:53], v[68:69]
    v_pk_mul_f32 v[54:55], v[54:55], v[70:71]
    v_cvt_pk_bf16_f32 v84, v48, v49
    v_cvt_pk_bf16_f32 v86, v52, v53
    v_cvt_pk_bf16_f32 v85, v50, v51
    v_cvt_pk_bf16_f32 v87, v54, v55
    s_nop 0
    v_permlane16_swap_b32 v84, v86
    v_permlane16_swap_b32 v85, v87
    buffer_store_dwordx4 v[84:87], v254, s[48:51], s64 offen offset:1280 sc1
    s_waitcnt vmcnt(3)
    s_barrier
    v_mfma_f32_32x32x8_bf16 v[48:63], v[94:95], v[94:95], 0
    v_min3_u32 v244, v244, v245, v246
    v_min_u32 v244, v244, v247
    v_cmp_eq_u32 vcc, 0, v244
    s_mov_b32 s37, 1
    v_mfma_f32_32x32x8_bf16 v[64:79], v[94:95], v[94:95], 0
    s_cbranch_vccnz L_qspin
L_qok:
    v_and_b32 v248, 0x7c, v250
    v_mov_b32 v244, -1
    v_mov_b32 v245, -1
    v_mov_b32 v246, -1
    v_mov_b32 v247, -1
    v_mfma_f32_32x32x8_bf16 v[80:95], v[94:95], v[94:95], 0
    v_exp_f32 v112, v112
    v_exp_f32 v113, v113
    v_cvt_pk_bf16_f32 v159, v142, v143
    v_mfma_f32_32x32x8_bf16 v[128:143], v[216:217], v[108:109], 0
    ds_read_b128 v[208:211], v243 offset:5840
    v_exp_f32 v114, v114
    v_exp_f32 v115, v115
    v_exp_f32 v116, v116
    v_cvt_pk_bf16_f32 v144, v112, v113
    v_mfma_f32_32x32x16_bf16 v[176:191], v[212:215], v[156:159], v[176:191]
    ds_read_b128 v[212:215], v243 offset:6448
    v_exp_f32 v117, v117
    v_exp_f32 v118, v118
    v_cvt_pk_bf16_f32 v145, v114, v115
    v_mfma_f32_32x32x16_bf16 v[128:143], v[192:195], v[100:103], v[128:143]
    ds_read_b128 v[192:195], v224 offset:2048
    buffer_store_dwordx4 v[244:247], v233, s[44:47], s20 offen sc1
    v_exp_f32 v119, v119
    v_exp_f32 v120, v120
    v_cvt_pk_bf16_f32 v146, v116, v117
    v_cvt_pk_bf16_f32 v147, v118, v119
    v_exp_f32 v121, v121
    v_exp_f32 v122, v122
    v_exp_f32 v123, v123
    v_mfma_f32_32x32x16_bf16 v[160:175], v[200:203], v[144:147], v[160:175]
    buffer_store_dwordx4 v[244:247], v233, s[44:47], s20 offen offset:1024 sc1
    v_exp_f32 v124, v124
    v_exp_f32 v125, v125
    v_cvt_pk_bf16_f32 v148, v120, v121
    v_exp_f32 v126, v126
    v_exp_f32 v127, v127
    v_cvt_pk_bf16_f32 v149, v122, v123
    v_cvt_pk_bf16_f32 v150, v124, v125
    v_exp_f32 v128, v128
    v_exp_f32 v129, v129
    v_cvt_pk_bf16_f32 v151, v126, v127
    v_mfma_f32_32x32x8_bf16 v[112:127], v[216:217], v[106:107], 0
    v_exp_f32 v130, v130
    v_exp_f32 v131, v131
    v_exp_f32 v132, v132
    v_cvt_pk_bf16_f32 v152, v128, v129
    v_mfma_f32_32x32x16_bf16 v[160:175], v[204:207], v[148:151], v[160:175]
    buffer_store_dword v244, v250, s[44:47], s21 offen sc1
    v_exp_f32 v133, v133
    v_exp_f32 v134, v134
    v_cvt_pk_bf16_f32 v153, v130, v131
    v_mfma_f32_32x32x16_bf16 v[112:127], v[196:199], v[96:99], v[112:127]
    s_add_u32 m0, s68, 114688
    s_add_u32 s101, s68, 31571968
    buffer_load_dwordx4 v233, s[40:43], s101 offen offset:0 sc1 lds
    v_exp_f32 v135, v135
    v_exp_f32 v136, v136
    v_cvt_pk_bf16_f32 v154, v132, v133
    v_cvt_pk_bf16_f32 v155, v134, v135
    v_exp_f32 v137, v137
    v_exp_f32 v138, v138
    v_exp_f32 v139, v139
    v_mfma_f32_32x32x16_bf16 v[176:191], v[200:203], v[152:155], v[176:191]
    buffer_load_dwordx4 v233, s[40:43], s101 offen offset:1024 sc1 lds
    s_waitcnt lgkmcnt(0)
    v_exp_f32 v140, v140
    v_exp_f32 v141, v141
    v_cvt_pk_bf16_f32 v156, v136, v137
    v_exp_f32 v142, v142
    v_exp_f32 v143, v143
    v_cvt_pk_bf16_f32 v157, v138, v139
    v_cvt_pk_bf16_f32 v158, v140, v141
    v_exp_f32 v112, v112
    v_exp_f32 v113, v113
    v_cvt_pk_bf16_f32 v159, v142, v143
    v_mfma_f32_32x32x8_bf16 v[128:143], v[216:217], v[110:111], 0
    ds_read_b128 v[200:203], v243 offset:7056
    v_exp_f32 v114, v114
    v_exp_f32 v115, v115
    v_exp_f32 v116, v116
    v_cvt_pk_bf16_f32 v144, v112, v113
    v_mfma_f32_32x32x16_bf16 v[176:191], v[204:207], v[156:159], v[176:191]
    ds_read_b128 v[204:207], v243 offset:7664
    v_exp_f32 v117, v117
    v_exp_f32 v118, v118
    v_cvt_pk_bf16_f32 v145, v114, v115
    v_mfma_f32_32x32x16_bf16 v[128:143], v[196:199], v[100:103], v[128:143]
    ds_read_b128 v[196:199], v224 offset:3072
    buffer_load_dwordx4 v233, s[40:43], s101 offen offset:2048 sc1 lds
    v_exp_f32 v119, v119
    v_exp_f32 v120, v120
    v_cvt_pk_bf16_f32 v146, v116, v117
    v_cvt_pk_bf16_f32 v147, v118, v119
    v_exp_f32 v121, v121
    v_exp_f32 v122, v122
    v_exp_f32 v123, v123
    v_mfma_f32_32x32x16_bf16 v[160:175], v[208:211], v[144:147], v[160:175]
    ds_read_b128 v[220:223], v225 offset:13696
    buffer_load_dwordx4 v233, s[40:43], s101 offen offset:3072 sc1 lds
    v_exp_f32 v124, v124
    v_exp_f32 v125, v125
    v_cvt_pk_bf16_f32 v148, v120, v121
    v_exp_f32 v126, v126
    v_exp_f32 v127, v127
    v_cvt_pk_bf16_f32 v149, v122, v123
    v_cvt_pk_bf16_f32 v150, v124, v125
    v_exp_f32 v128, v128
    v_exp_f32 v129, v129
    v_cvt_pk_bf16_f32 v151, v126, v127
    v_mfma_f32_32x32x8_bf16 v[112:127], v[218:219], v[104:105], 0
    v_exp_f32 v130, v130
    v_exp_f32 v131, v131
    v_exp_f32 v132, v132
    v_cvt_pk_bf16_f32 v152, v128, v129
    v_mfma_f32_32x32x16_bf16 v[160:175], v[212:215], v[148:151], v[160:175]
    s_add_u32 m0, s68, 131072
    s_add_u32 s101, s68, 31588352
    buffer_load_dwordx4 v233, s[40:43], s101 offen offset:0 sc1 lds
    v_exp_f32 v133, v133
    v_exp_f32 v134, v134
    v_cvt_pk_bf16_f32 v153, v130, v131
    v_mfma_f32_32x32x16_bf16 v[112:127], v[192:195], v[96:99], v[112:127]
    buffer_load_dwordx4 v233, s[40:43], s101 offen offset:1024 sc1 lds
    v_exp_f32 v135, v135
    v_exp_f32 v136, v136
    v_cvt_pk_bf16_f32 v154, v132, v133
    v_cvt_pk_bf16_f32 v155, v134, v135
    v_exp_f32 v137, v137
    v_exp_f32 v138, v138
    v_exp_f32 v139, v139
    v_mfma_f32_32x32x16_bf16 v[176:191], v[208:211], v[152:155], v[176:191]
    buffer_load_dwordx4 v233, s[40:43], s101 offen offset:2048 sc1 lds
    s_waitcnt lgkmcnt(0)
    v_exp_f32 v140, v140
    v_exp_f32 v141, v141
    v_cvt_pk_bf16_f32 v156, v136, v137
    v_exp_f32 v142, v142
    v_exp_f32 v143, v143
    v_cvt_pk_bf16_f32 v157, v138, v139
    v_cvt_pk_bf16_f32 v158, v140, v141
    v_exp_f32 v112, v112
    v_exp_f32 v113, v113
    v_cvt_pk_bf16_f32 v159, v142, v143
    v_mfma_f32_32x32x8_bf16 v[128:143], v[218:219], v[108:109], 0
    ds_read_b128 v[208:211], v243 offset:8272
    v_exp_f32 v114, v114
    v_exp_f32 v115, v115
    v_exp_f32 v116, v116
    v_cvt_pk_bf16_f32 v144, v112, v113
    v_mfma_f32_32x32x16_bf16 v[176:191], v[212:215], v[156:159], v[176:191]
    ds_read_b128 v[212:215], v243 offset:8880
    v_exp_f32 v117, v117
    v_exp_f32 v118, v118
    v_cvt_pk_bf16_f32 v145, v114, v115
    v_mfma_f32_32x32x16_bf16 v[128:143], v[192:195], v[100:103], v[128:143]
    ds_read_b128 v[192:195], v224 offset:9600
    buffer_load_dwordx4 v233, s[40:43], s101 offen offset:3072 sc1 lds
    v_exp_f32 v119, v119
    v_exp_f32 v120, v120
    v_cvt_pk_bf16_f32 v146, v116, v117
    v_cvt_pk_bf16_f32 v147, v118, v119
    v_exp_f32 v121, v121
    v_exp_f32 v122, v122
    v_exp_f32 v123, v123
    v_mfma_f32_32x32x16_bf16 v[160:175], v[200:203], v[144:147], v[160:175]
    s_add_u32 m0, s68, 147456
    s_add_u32 s101, s68, 31604736
    buffer_load_dwordx4 v233, s[40:43], s101 offen offset:0 sc1 lds
    v_exp_f32 v124, v124
    v_exp_f32 v125, v125
    v_cvt_pk_bf16_f32 v148, v120, v121
    v_exp_f32 v126, v126
    v_exp_f32 v127, v127
    v_cvt_pk_bf16_f32 v149, v122, v123
    v_cvt_pk_bf16_f32 v150, v124, v125
    v_exp_f32 v128, v128
    v_exp_f32 v129, v129
    v_cvt_pk_bf16_f32 v151, v126, v127
    v_mfma_f32_32x32x8_bf16 v[112:127], v[218:219], v[106:107], 0
    v_exp_f32 v130, v130
    v_exp_f32 v131, v131
    v_exp_f32 v132, v132
    v_cvt_pk_bf16_f32 v152, v128, v129
    v_mfma_f32_32x32x16_bf16 v[160:175], v[204:207], v[148:151], v[160:175]
    buffer_load_dwordx4 v233, s[40:43], s101 offen offset:1024 sc1 lds
    v_exp_f32 v133, v133
    v_exp_f32 v134, v134
    v_cvt_pk_bf16_f32 v153, v130, v131
    v_mfma_f32_32x32x16_bf16 v[112:127], v[196:199], v[96:99], v[112:127]
    buffer_load_dwordx4 v233, s[40:43], s101 offen offset:2048 sc1 lds
    v_exp_f32 v135, v135
    v_exp_f32 v136, v136
    v_cvt_pk_bf16_f32 v154, v132, v133
    v_cvt_pk_bf16_f32 v155, v134, v135
    v_exp_f32 v137, v137
    v_exp_f32 v138, v138
    v_exp_f32 v139, v139
    v_mfma_f32_32x32x16_bf16 v[176:191], v[200:203], v[152:155], v[176:191]
    buffer_load_dwordx4 v233, s[40:43], s101 offen offset:3072 sc1 lds
    s_waitcnt lgkmcnt(0)
    v_exp_f32 v140, v140
    v_exp_f32 v141, v141
    v_cvt_pk_bf16_f32 v156, v136, v137
    v_exp_f32 v142, v142
    v_exp_f32 v143, v143
    v_cvt_pk_bf16_f32 v157, v138, v139
    v_cvt_pk_bf16_f32 v158, v140, v141
    v_exp_f32 v112, v112
    v_exp_f32 v113, v113
    v_cvt_pk_bf16_f32 v159, v142, v143
    v_mfma_f32_32x32x8_bf16 v[128:143], v[218:219], v[110:111], 0
    ds_read_b128 v[200:203], v243 offset:14224
    v_exp_f32 v114, v114
    v_exp_f32 v115, v115
    v_exp_f32 v116, v116
    v_cvt_pk_bf16_f32 v144, v112, v113
    v_mfma_f32_32x32x16_bf16 v[176:191], v[204:207], v[156:159], v[176:191]
    ds_read_b128 v[204:207], v243 offset:14832
    v_exp_f32 v117, v117
    v_exp_f32 v118, v118
    v_cvt_pk_bf16_f32 v145, v114, v115
    v_mfma_f32_32x32x16_bf16 v[128:143], v[196:199], v[100:103], v[128:143]
    ds_read_b128 v[196:199], v224 offset:10624
    buffer_load_dword v231, v248, s[44:47], s23 offen offset:0 sc1
    v_exp_f32 v119, v119
    v_exp_f32 v120, v120
    v_cvt_pk_bf16_f32 v146, v116, v117
    v_cvt_pk_bf16_f32 v147, v118, v119
    v_exp_f32 v121, v121
    v_exp_f32 v122, v122
    v_exp_f32 v123, v123
    v_mfma_f32_32x32x16_bf16 v[160:175], v[208:211], v[144:147], v[160:175]
    buffer_load_dword v232, v248, s[44:47], s23 offen offset:128 sc1
    v_exp_f32 v124, v124
    v_exp_f32 v125, v125
    v_cvt_pk_bf16_f32 v148, v120, v121
    v_exp_f32 v126, v126
    v_exp_f32 v127, v127
    v_cvt_pk_bf16_f32 v149, v122, v123
    v_cvt_pk_bf16_f32 v150, v124, v125
    v_exp_f32 v128, v128
    v_exp_f32 v129, v129
    v_cvt_pk_bf16_f32 v151, v126, v127
    v_mfma_f32_32x32x8_bf16 v[112:127], v[220:221], v[104:105], 0
    v_exp_f32 v130, v130
    v_exp_f32 v131, v131
    v_exp_f32 v132, v132
    v_cvt_pk_bf16_f32 v152, v128, v129
    v_mfma_f32_32x32x16_bf16 v[160:175], v[212:215], v[148:151], v[160:175]
    global_load_dwordx4 a[80:83], v226, s[12:13] offset:-4096 sc1
    v_exp_f32 v133, v133
    v_exp_f32 v134, v134
    v_cvt_pk_bf16_f32 v153, v130, v131
    v_mfma_f32_32x32x16_bf16 v[112:127], v[192:195], v[96:99], v[112:127]
    global_load_dwordx4 a[84:87], v226, s[12:13] offset:-3072 sc1
    v_exp_f32 v135, v135
    v_exp_f32 v136, v136
    v_cvt_pk_bf16_f32 v154, v132, v133
    v_cvt_pk_bf16_f32 v155, v134, v135
    v_exp_f32 v137, v137
    v_exp_f32 v138, v138
    v_exp_f32 v139, v139
    v_mfma_f32_32x32x16_bf16 v[176:191], v[208:211], v[152:155], v[176:191]
    global_load_dwordx4 a[88:91], v226, s[14:15] offset:-4096 sc1
    s_waitcnt lgkmcnt(0)
    v_exp_f32 v140, v140
    v_exp_f32 v141, v141
    v_cvt_pk_bf16_f32 v156, v136, v137
    v_exp_f32 v142, v142
    v_exp_f32 v143, v143
    v_cvt_pk_bf16_f32 v157, v138, v139
    v_cvt_pk_bf16_f32 v158, v140, v141
    v_exp_f32 v112, v112
    v_exp_f32 v113, v113
    v_cvt_pk_bf16_f32 v159, v142, v143
    v_mfma_f32_32x32x8_bf16 v[128:143], v[220:221], v[108:109], 0
    ds_read_b128 v[208:211], v243 offset:15440
    v_exp_f32 v114, v114
    v_exp_f32 v115, v115
    v_exp_f32 v116, v116
    v_cvt_pk_bf16_f32 v144, v112, v113
    v_mfma_f32_32x32x16_bf16 v[176:191], v[212:215], v[156:159], v[176:191]
    ds_read_b128 v[212:215], v243 offset:16048
    v_exp_f32 v117, v117
    v_exp_f32 v118, v118
    v_cvt_pk_bf16_f32 v145, v114, v115
    v_mfma_f32_32x32x16_bf16 v[128:143], v[192:195], v[100:103], v[128:143]
    ds_read_b128 v[192:195], v224 offset:11648
    global_load_dwordx4 a[92:95], v226, s[14:15] offset:-3072 sc1
    v_exp_f32 v119, v119
    v_exp_f32 v120, v120
    v_cvt_pk_bf16_f32 v146, v116, v117
    v_cvt_pk_bf16_f32 v147, v118, v119
    v_exp_f32 v121, v121
    v_exp_f32 v122, v122
    v_exp_f32 v123, v123
    v_mfma_f32_32x32x16_bf16 v[160:175], v[200:203], v[144:147], v[160:175]
    global_load_dwordx4 a[96:99], v226, s[14:15] offset:-2048 sc1
    v_exp_f32 v124, v124
    v_exp_f32 v125, v125
    v_cvt_pk_bf16_f32 v148, v120, v121
    v_exp_f32 v126, v126
    v_exp_f32 v127, v127
    v_cvt_pk_bf16_f32 v149, v122, v123
    v_cvt_pk_bf16_f32 v150, v124, v125
    v_exp_f32 v128, v128
    v_exp_f32 v129, v129
    v_cvt_pk_bf16_f32 v151, v126, v127
    v_mfma_f32_32x32x8_bf16 v[112:127], v[220:221], v[106:107], 0
    v_exp_f32 v130, v130
    v_exp_f32 v131, v131
    v_exp_f32 v132, v132
    v_cvt_pk_bf16_f32 v152, v128, v129
    v_mfma_f32_32x32x16_bf16 v[160:175], v[204:207], v[148:151], v[160:175]
    global_load_dwordx4 a[100:103], v226, s[12:13] offset:-2048 sc1
    v_exp_f32 v133, v133
    v_exp_f32 v134, v134
    v_cvt_pk_bf16_f32 v153, v130, v131
    v_mfma_f32_32x32x16_bf16 v[112:127], v[196:199], v[96:99], v[112:127]
    global_load_dwordx4 a[104:107], v226, s[12:13] offset:-1024 sc1
    v_exp_f32 v135, v135
    v_exp_f32 v136, v136
    v_cvt_pk_bf16_f32 v154, v132, v133
    v_cvt_pk_bf16_f32 v155, v134, v135
    v_exp_f32 v137, v137
    v_exp_f32 v138, v138
    v_exp_f32 v139, v139
    v_mfma_f32_32x32x16_bf16 v[176:191], v[200:203], v[152:155], v[176:191]
    global_load_dwordx4 a[108:111], v226, s[14:15] offset:-1024 sc1
    s_waitcnt lgkmcnt(0)
    v_exp_f32 v140, v140
    v_exp_f32 v141, v141
    v_cvt_pk_bf16_f32 v156, v136, v137
    v_exp_f32 v142, v142
    v_exp_f32 v143, v143
    v_cvt_pk_bf16_f32 v157, v138, v139
    v_cvt_pk_bf16_f32 v158, v140, v141
    v_exp_f32 v112, v112
    v_exp_f32 v113, v113
    v_cvt_pk_bf16_f32 v159, v142, v143
    v_mfma_f32_32x32x8_bf16 v[128:143], v[220:221], v[110:111], 0
    ds_read_b128 v[200:203], v243 offset:16656
    v_exp_f32 v114, v114
    v_exp_f32 v115, v115
    v_exp_f32 v116, v116
    v_cvt_pk_bf16_f32 v144, v112, v113
    v_mfma_f32_32x32x16_bf16 v[176:191], v[204:207], v[156:159], v[176:191]
    ds_read_b128 v[204:207], v243 offset:17264
    v_exp_f32 v117, v117
    v_exp_f32 v118, v118
    v_cvt_pk_bf16_f32 v145, v114, v115
    v_mfma_f32_32x32x16_bf16 v[128:143], v[196:199], v[100:103], v[128:143]
    ds_read_b128 v[196:199], v224 offset:12672
    global_load_dwordx4 a[112:115], v226, s[14:15] offset:0 sc1
    v_exp_f32 v119, v119
    v_exp_f32 v120, v120
    v_cvt_pk_bf16_f32 v146, v116, v117
    v_cvt_pk_bf16_f32 v147, v118, v119
    v_exp_f32 v121, v121
    v_exp_f32 v122, v122
    v_exp_f32 v123, v123
    v_mfma_f32_32x32x16_bf16 v[160:175], v[208:211], v[144:147], v[160:175]
    ds_read_b128 v[216:219], v225 offset:23296
    global_load_dwordx4 a[116:119], v226, s[14:15] offset:1024 sc1
    v_exp_f32 v124, v124
    v_exp_f32 v125, v125
    v_cvt_pk_bf16_f32 v148, v120, v121
    v_exp_f32 v126, v126
    v_exp_f32 v127, v127
    v_cvt_pk_bf16_f32 v149, v122, v123
    v_cvt_pk_bf16_f32 v150, v124, v125
    v_exp_f32 v128, v128
    v_exp_f32 v129, v129
    v_cvt_pk_bf16_f32 v151, v126, v127
    v_mfma_f32_32x32x8_bf16 v[112:127], v[222:223], v[104:105], 0
    v_exp_f32 v130, v130
    v_exp_f32 v131, v131
    v_exp_f32 v132, v132
    v_cvt_pk_bf16_f32 v152, v128, v129
    v_mfma_f32_32x32x16_bf16 v[160:175], v[212:215], v[148:151], v[160:175]
    global_load_dwordx4 a[120:123], v226, s[12:13] offset:0 sc1
    v_exp_f32 v133, v133
    v_exp_f32 v134, v134
    v_cvt_pk_bf16_f32 v153, v130, v131
    v_mfma_f32_32x32x16_bf16 v[112:127], v[192:195], v[96:99], v[112:127]
    global_load_dwordx4 a[124:127], v226, s[12:13] offset:1024 sc1
    v_exp_f32 v135, v135
    v_exp_f32 v136, v136
    v_cvt_pk_bf16_f32 v154, v132, v133
    v_cvt_pk_bf16_f32 v155, v134, v135
    v_exp_f32 v137, v137
    v_exp_f32 v138, v138
    v_exp_f32 v139, v139
    v_mfma_f32_32x32x16_bf16 v[176:191], v[208:211], v[152:155], v[176:191]
    global_load_dwordx4 a[128:131], v226, s[14:15] offset:2048 sc1
    s_waitcnt lgkmcnt(0)
    v_exp_f32 v140, v140
    v_exp_f32 v141, v141
    v_cvt_pk_bf16_f32 v156, v136, v137
    v_exp_f32 v142, v142
    v_exp_f32 v143, v143
    v_cvt_pk_bf16_f32 v157, v138, v139
    v_cvt_pk_bf16_f32 v158, v140, v141
    v_exp_f32 v112, v112
    v_exp_f32 v113, v113
    v_cvt_pk_bf16_f32 v159, v142, v143
    v_mfma_f32_32x32x8_bf16 v[128:143], v[222:223], v[108:109], 0
    ds_read_b128 v[208:211], v243 offset:17872
    v_exp_f32 v114, v114
    v_exp_f32 v115, v115
    v_exp_f32 v116, v116
    v_cvt_pk_bf16_f32 v144, v112, v113
    v_mfma_f32_32x32x16_bf16 v[176:191], v[212:215], v[156:159], v[176:191]
    ds_read_b128 v[212:215], v243 offset:18480
    v_exp_f32 v117, v117
    v_exp_f32 v118, v118
    v_cvt_pk_bf16_f32 v145, v114, v115
    v_mfma_f32_32x32x16_bf16 v[128:143], v[192:195], v[100:103], v[128:143]
    ds_read_b128 v[192:195], v224 offset:19200
    global_load_dwordx4 a[132:135], v226, s[14:15] offset:3072 sc1
    v_exp_f32 v119, v119
    v_exp_f32 v120, v120
    v_cvt_pk_bf16_f32 v146, v116, v117
    v_cvt_pk_bf16_f32 v147, v118, v119
    v_exp_f32 v121, v121
    v_exp_f32 v122, v122
    v_exp_f32 v123, v123
    v_mfma_f32_32x32x16_bf16 v[160:175], v[200:203], v[144:147], v[160:175]
    global_load_dwordx4 a[136:139], v227, s[14:15] offset:-4096 sc1
    v_exp_f32 v124, v124
    v_exp_f32 v125, v125
    v_cvt_pk_bf16_f32 v148, v120, v121
    v_exp_f32 v126, v126
    v_exp_f32 v127, v127
    v_cvt_pk_bf16_f32 v149, v122, v123
    v_cvt_pk_bf16_f32 v150, v124, v125
    v_exp_f32 v128, v128
    v_exp_f32 v129, v129
    v_cvt_pk_bf16_f32 v151, v126, v127
    v_mfma_f32_32x32x8_bf16 v[112:127], v[222:223], v[106:107], 0
    v_exp_f32 v130, v130
    v_exp_f32 v131, v131
    v_exp_f32 v132, v132
    v_cvt_pk_bf16_f32 v152, v128, v129
    v_mfma_f32_32x32x16_bf16 v[160:175], v[204:207], v[148:151], v[160:175]
    global_load_dwordx4 a[140:143], v226, s[18:19] offset:-4096 sc1
    v_exp_f32 v133, v133
    v_exp_f32 v134, v134
    v_cvt_pk_bf16_f32 v153, v130, v131
    v_mfma_f32_32x32x16_bf16 v[112:127], v[196:199], v[96:99], v[112:127]
    global_load_dwordx4 a[144:147], v226, s[18:19] offset:-3072 sc1
    v_exp_f32 v135, v135
    v_exp_f32 v136, v136
    v_cvt_pk_bf16_f32 v154, v132, v133
    v_cvt_pk_bf16_f32 v155, v134, v135
    v_exp_f32 v137, v137
    v_exp_f32 v138, v138
    v_exp_f32 v139, v139
    v_mfma_f32_32x32x16_bf16 v[176:191], v[200:203], v[152:155], v[176:191]
    global_load_dwordx4 a[148:151], v226, s[18:19] offset:-2048 sc1
    s_waitcnt lgkmcnt(0)
    v_exp_f32 v140, v140
    v_exp_f32 v141, v141
    v_cvt_pk_bf16_f32 v156, v136, v137
    v_exp_f32 v142, v142
    v_exp_f32 v143, v143
    v_cvt_pk_bf16_f32 v157, v138, v139
    v_cvt_pk_bf16_f32 v158, v140, v141
    v_exp_f32 v112, v112
    v_exp_f32 v113, v113
    v_cvt_pk_bf16_f32 v159, v142, v143
    v_mfma_f32_32x32x8_bf16 v[128:143], v[222:223], v[110:111], 0
    ds_read_b128 v[200:203], v243 offset:23824
    v_exp_f32 v114, v114
    v_exp_f32 v115, v115
    v_exp_f32 v116, v116
    v_cvt_pk_bf16_f32 v144, v112, v113
    v_mfma_f32_32x32x16_bf16 v[176:191], v[204:207], v[156:159], v[176:191]
    ds_read_b128 v[204:207], v243 offset:24432
    v_exp_f32 v117, v117
    v_exp_f32 v118, v118
    v_cvt_pk_bf16_f32 v145, v114, v115
    v_mfma_f32_32x32x16_bf16 v[128:143], v[196:199], v[100:103], v[128:143]
    ds_read_b128 v[196:199], v224 offset:20224
    global_load_dwordx4 a[152:155], v226, s[18:19] offset:-1024 sc1
    v_exp_f32 v119, v119
    v_exp_f32 v120, v120
    v_cvt_pk_bf16_f32 v146, v116, v117
    v_cvt_pk_bf16_f32 v147, v118, v119
    v_exp_f32 v121, v121
    v_exp_f32 v122, v122
    v_exp_f32 v123, v123
    v_mfma_f32_32x32x16_bf16 v[160:175], v[208:211], v[144:147], v[160:175]
    global_load_dwordx4 a[156:159], v226, s[18:19] offset:0 sc1
    v_exp_f32 v124, v124
    v_exp_f32 v125, v125
    v_cvt_pk_bf16_f32 v148, v120, v121
    v_exp_f32 v126, v126
    v_exp_f32 v127, v127
    v_cvt_pk_bf16_f32 v149, v122, v123
    v_cvt_pk_bf16_f32 v150, v124, v125
    v_exp_f32 v128, v128
    v_exp_f32 v129, v129
    v_cvt_pk_bf16_f32 v151, v126, v127
    v_mfma_f32_32x32x8_bf16 v[112:127], v[216:217], v[104:105], 0
    v_exp_f32 v130, v130
    v_exp_f32 v131, v131
    v_exp_f32 v132, v132
    v_cvt_pk_bf16_f32 v152, v128, v129
    v_mfma_f32_32x32x16_bf16 v[160:175], v[212:215], v[148:151], v[160:175]
    global_load_dwordx4 a[160:163], v226, s[18:19] offset:1024 sc1
    v_exp_f32 v133, v133
    v_exp_f32 v134, v134
    v_cvt_pk_bf16_f32 v153, v130, v131
    v_mfma_f32_32x32x16_bf16 v[112:127], v[192:195], v[96:99], v[112:127]
    global_load_dwordx4 a[164:167], v226, s[18:19] offset:2048 sc1
    v_exp_f32 v135, v135
    v_exp_f32 v136, v136
    v_cvt_pk_bf16_f32 v154, v132, v133
    v_cvt_pk_bf16_f32 v155, v134, v135
    v_add_u32 v224, 19200, v224
    v_add_u32 v243, 19200, v243
    v_add_u32 v225, 19200, v225
    v_exp_f32 v137, v137
    v_exp_f32 v138, v138
    v_exp_f32 v139, v139
    v_mfma_f32_32x32x16_bf16 v[176:191], v[208:211], v[152:155], v[176:191]
    s_waitcnt lgkmcnt(0)
    v_exp_f32 v140, v140
    v_exp_f32 v141, v141
    v_cvt_pk_bf16_f32 v156, v136, v137
    v_exp_f32 v142, v142
    v_exp_f32 v143, v143
    v_cvt_pk_bf16_f32 v157, v138, v139
    v_cvt_pk_bf16_f32 v158, v140, v141
    s_lshl_b32 s74, s87, 7
    s_add_u32 s74, s74, 31787008
    s_and_b32 s76, s2, 3
    s_lshr_b32 s77, s2, 6
    s_lshl2_add_u32 s76, s76, s77
    s_lshl2_add_u32 s92, s76, s74
    v_and_b32 v248, 0x3c, v250
    s_waitcnt vmcnt(22)
    s_barrier
    buffer_store_dword v240, v239, s[44:47], s92 offen sc1
    v_sub_f32 v235, 1.0, v231
    v_max_f32 v235, 0x2b800000, v235
    v_rcp_f32 v244, v235
    v_sub_f32 v238, 1.0, v232
    v_max_f32 v238, 0x2b800000, v238
    v_rcp_f32 v245, v238
    s_nop 0
    v_mul_f32 v231, v231, v244
    v_mul_f32 v232, v232, v245
    s_lshr_b32 s76, s2, 6
    s_andn2_b32 s76, s76, s60
    s_and_b32 s76, s76, 1
    s_mul_i32 s76, s76, 44
    s_sub_u32 s76, 240, s76
    s_cmp_eq_u32 s95, 3
    s_cselect_b32 s76, s76, -1
    s_lshl_b32 s77, s76, 11
    s_mul_i32 s76, s76, 3072
    s_ashr_i32 s78, s76, 31
    s_add_u32 s12, s12, s77
    s_addc_u32 s13, s13, s78
    s_add_u32 s14, s14, s76
    s_addc_u32 s15, s15, s78
    s_cmp_eq_u32 s95, 0
    s_cbranch_scc1 L_itL
    v_exp_f32 v112, v112
    v_exp_f32 v113, v113
    v_cvt_pk_bf16_f32 v159, v142, v143
    v_mfma_f32_32x32x8_bf16 v[128:143], v[216:217], v[108:109], 0
    ds_read_b128 v[208:211], v243 offset:5840
    v_exp_f32 v114, v114
    v_exp_f32 v115, v115
    v_exp_f32 v116, v116
    v_cvt_pk_bf16_f32 v144, v112, v113
    v_mfma_f32_32x32x16_bf16 v[176:191], v[212:215], v[156:159], v[176:191]
    ds_read_b128 v[212:215], v243 offset:6448
    v_exp_f32 v117, v117
    v_exp_f32 v118, v118
    v_cvt_pk_bf16_f32 v145, v114, v115
    v_mfma_f32_32x32x16_bf16 v[128:143], v[192:195], v[100:103], v[128:143]
    ds_read_b128 v[192:195], v224 offset:2048
    v_exp_f32 v119, v119
    v_exp_f32 v120, v120
    v_cvt_pk_bf16_f32 v146, v116, v117
    v_cvt_pk_bf16_f32 v147, v118, v119
    v_exp_f32 v121, v121
    v_exp_f32 v122, v122
    v_exp_f32 v123, v123
    v_mfma_f32_32x32x16_bf16 v[160:175], v[200:203], v[144:147], v[160:175]
    v_exp_f32 v124, v124
    v_exp_f32 v125, v125
    v_cvt_pk_bf16_f32 v148, v120, v121
    v_exp_f32 v126, v126
    v_exp_f32 v127, v127
    v_cvt_pk_bf16_f32 v149, v122, v123
    v_cvt_pk_bf16_f32 v150, v124, v125
    v_exp_f32 v128, v128
    v_exp_f32 v129, v129
    v_cvt_pk_bf16_f32 v151, v126, v127
    v_mfma_f32_32x32x8_bf16 v[112:127], v[216:217], v[106:107], 0
    v_exp_f32 v130, v130
    v_exp_f32 v131, v131
    v_exp_f32 v132, v132
    v_cvt_pk_bf16_f32 v152, v128, v129
    v_mfma_f32_32x32x16_bf16 v[160:175], v[204:207], v[148:151], v[160:175]
    v_exp_f32 v133, v133
    v_exp_f32 v134, v134
    v_cvt_pk_bf16_f32 v153, v130, v131
    v_mfma_f32_32x32x16_bf16 v[112:127], v[196:199], v[96:99], v[112:127]
    v_exp_f32 v135, v135
    v_exp_f32 v136, v136
    v_cvt_pk_bf16_f32 v154, v132, v133
    v_cvt_pk_bf16_f32 v155, v134, v135
    v_exp_f32 v137, v137
    v_exp_f32 v138, v138
    v_exp_f32 v139, v139
    v_mfma_f32_32x32x16_bf16 v[176:191], v[200:203], v[152:155], v[176:191]
    s_waitcnt lgkmcnt(0)
    v_exp_f32 v140, v140
    v_exp_f32 v141, v141
    v_cvt_pk_bf16_f32 v156, v136, v137
    v_exp_f32 v142, v142
    v_exp_f32 v143, v143
    v_cvt_pk_bf16_f32 v157, v138, v139
    v_cvt_pk_bf16_f32 v158, v140, v141
    v_exp_f32 v112, v112
    v_exp_f32 v113, v113
    v_cvt_pk_bf16_f32 v159, v142, v143
    v_mfma_f32_32x32x8_bf16 v[128:143], v[216:217], v[110:111], 0
    ds_read_b128 v[200:203], v243 offset:7056
    v_exp_f32 v114, v114
    v_exp_f32 v115, v115
    v_exp_f32 v116, v116
    v_cvt_pk_bf16_f32 v144, v112, v113
    v_mfma_f32_32x32x16_bf16 v[176:191], v[204:207], v[156:159], v[176:191]
    ds_read_b128 v[204:207], v243 offset:7664
    v_exp_f32 v117, v117
    v_exp_f32 v118, v118
    v_cvt_pk_bf16_f32 v145, v114, v115
    v_mfma_f32_32x32x16_bf16 v[128:143], v[196:199], v[100:103], v[128:143]
    ds_read_b128 v[196:199], v224 offset:3072
    v_exp_f32 v119, v119
    v_exp_f32 v120, v120
    v_cvt_pk_bf16_f32 v146, v116, v117
    v_cvt_pk_bf16_f32 v147, v118, v119
    v_exp_f32 v121, v121
    v_exp_f32 v122, v122
    v_exp_f32 v123, v123
    v_mfma_f32_32x32x16_bf16 v[160:175], v[208:211], v[144:147], v[160:175]
    ds_read_b128 v[220:223], v225 offset:13696
    v_exp_f32 v124, v124
    v_exp_f32 v125, v125
    v_cvt_pk_bf16_f32 v148, v120, v121
    v_exp_f32 v126, v126
    v_exp_f32 v127, v127
    v_cvt_pk_bf16_f32 v149, v122, v123
    v_cvt_pk_bf16_f32 v150, v124, v125
    v_exp_f32 v128, v128
    v_exp_f32 v129, v129
    v_cvt_pk_bf16_f32 v151, v126, v127
    v_mfma_f32_32x32x8_bf16 v[112:127], v[218:219], v[104:105], 0
    v_exp_f32 v130, v130
    v_exp_f32 v131, v131
    v_exp_f32 v132, v132
    v_cvt_pk_bf16_f32 v152, v128, v129
    v_mfma_f32_32x32x16_bf16 v[160:175], v[212:215], v[148:151], v[160:175]
    v_exp_f32 v133, v133
    v_exp_f32 v134, v134
    v_cvt_pk_bf16_f32 v153, v130, v131
    v_mfma_f32_32x32x16_bf16 v[112:127], v[192:195], v[96:99], v[112:127]
    v_exp_f32 v135, v135
    v_exp_f32 v136, v136
    v_cvt_pk_bf16_f32 v154, v132, v133
    v_cvt_pk_bf16_f32 v155, v134, v135
    v_exp_f32 v137, v137
    v_exp_f32 v138, v138
    v_exp_f32 v139, v139
    v_mfma_f32_32x32x16_bf16 v[176:191], v[208:211], v[152:155], v[176:191]
    s_waitcnt lgkmcnt(0)
    v_exp_f32 v140, v140
    v_exp_f32 v141, v141
    v_cvt_pk_bf16_f32 v156, v136, v137
    v_exp_f32 v142, v142
    v_exp_f32 v143, v143
    v_cvt_pk_bf16_f32 v157, v138, v139
    v_cvt_pk_bf16_f32 v158, v140, v141
    v_exp_f32 v112, v112
    v_exp_f32 v113, v113
    v_cvt_pk_bf16_f32 v159, v142, v143
    v_mfma_f32_32x32x8_bf16 v[128:143], v[218:219], v[108:109], 0
    ds_read_b128 v[208:211], v243 offset:8272
    v_exp_f32 v114, v114
    v_exp_f32 v115, v115
    v_exp_f32 v116, v116
    v_cvt_pk_bf16_f32 v144, v112, v113
    v_mfma_f32_32x32x16_bf16 v[176:191], v[212:215], v[156:159], v[176:191]
    ds_read_b128 v[212:215], v243 offset:8880
    v_exp_f32 v117, v117
    v_exp_f32 v118, v118
    v_cvt_pk_bf16_f32 v145, v114, v115
    v_mfma_f32_32x32x16_bf16 v[128:143], v[192:195], v[100:103], v[128:143]
    ds_read_b128 v[192:195], v224 offset:9600
    v_exp_f32 v119, v119
    v_exp_f32 v120, v120
    v_cvt_pk_bf16_f32 v146, v116, v117
    v_cvt_pk_bf16_f32 v147, v118, v119
    v_exp_f32 v121, v121
    v_exp_f32 v122, v122
    v_exp_f32 v123, v123
    v_mfma_f32_32x32x16_bf16 v[160:175], v[200:203], v[144:147], v[160:175]
    v_exp_f32 v124, v124
    v_exp_f32 v125, v125
    v_cvt_pk_bf16_f32 v148, v120, v121
    v_exp_f32 v126, v126
    v_exp_f32 v127, v127
    v_cvt_pk_bf16_f32 v149, v122, v123
    v_cvt_pk_bf16_f32 v150, v124, v125
    v_exp_f32 v128, v128
    v_exp_f32 v129, v129
    v_cvt_pk_bf16_f32 v151, v126, v127
    v_mfma_f32_32x32x8_bf16 v[112:127], v[218:219], v[106:107], 0
    v_exp_f32 v130, v130
    v_exp_f32 v131, v131
    v_exp_f32 v132, v132
    v_cvt_pk_bf16_f32 v152, v128, v129
    v_mfma_f32_32x32x16_bf16 v[160:175], v[204:207], v[148:151], v[160:175]
    v_exp_f32 v133, v133
    v_exp_f32 v134, v134
    v_cvt_pk_bf16_f32 v153, v130, v131
    v_mfma_f32_32x32x16_bf16 v[112:127], v[196:199], v[96:99], v[112:127]
    v_exp_f32 v135, v135
    v_exp_f32 v136, v136
    v_cvt_pk_bf16_f32 v154, v132, v133
    v_cvt_pk_bf16_f32 v155, v134, v135
    v_exp_f32 v137, v137
    v_exp_f32 v138, v138
    v_exp_f32 v139, v139
    v_mfma_f32_32x32x16_bf16 v[176:191], v[200:203], v[152:155], v[176:191]
    s_waitcnt lgkmcnt(0)
    v_exp_f32 v140, v140
    v_exp_f32 v141, v141
    v_cvt_pk_bf16_f32 v156, v136, v137
    v_exp_f32 v142, v142
    v_exp_f32 v143, v143
    v_cvt_pk_bf16_f32 v157, v138, v139
    v_cvt_pk_bf16_f32 v158, v140, v141
    v_exp_f32 v112, v112
    v_exp_f32 v113, v113
    v_cvt_pk_bf16_f32 v159, v142, v143
    v_mfma_f32_32x32x8_bf16 v[128:143], v[218:219], v[110:111], 0
    ds_read_b128 v[200:203], v243 offset:14224
    v_exp_f32 v114, v114
    v_exp_f32 v115, v115
    v_exp_f32 v116, v116
    v_cvt_pk_bf16_f32 v144, v112, v113
    v_mfma_f32_32x32x16_bf16 v[176:191], v[204:207], v[156:159], v[176:191]
    ds_read_b128 v[204:207], v243 offset:14832
    v_exp_f32 v117, v117
    v_exp_f32 v118, v118
    v_cvt_pk_bf16_f32 v145, v114, v115
    v_mfma_f32_32x32x16_bf16 v[128:143], v[196:199], v[100:103], v[128:143]
    ds_read_b128 v[196:199], v224 offset:10624
    v_exp_f32 v119, v119
    v_exp_f32 v120, v120
    v_cvt_pk_bf16_f32 v146, v116, v117
    v_cvt_pk_bf16_f32 v147, v118, v119
    v_exp_f32 v121, v121
    v_exp_f32 v122, v122
    v_exp_f32 v123, v123
    v_mfma_f32_32x32x16_bf16 v[160:175], v[208:211], v[144:147], v[160:175]
    v_exp_f32 v124, v124
    v_exp_f32 v125, v125
    v_cvt_pk_bf16_f32 v148, v120, v121
    v_exp_f32 v126, v126
    v_exp_f32 v127, v127
    v_cvt_pk_bf16_f32 v149, v122, v123
    v_cvt_pk_bf16_f32 v150, v124, v125
    v_exp_f32 v128, v128
    v_exp_f32 v129, v129
    v_cvt_pk_bf16_f32 v151, v126, v127
    v_mfma_f32_32x32x8_bf16 v[112:127], v[220:221], v[104:105], 0
    v_exp_f32 v130, v130
    v_exp_f32 v131, v131
    v_exp_f32 v132, v132
    v_cvt_pk_bf16_f32 v152, v128, v129
    v_mfma_f32_32x32x16_bf16 v[160:175], v[212:215], v[148:151], v[160:175]
    v_exp_f32 v133, v133
    v_exp_f32 v134, v134
    v_cvt_pk_bf16_f32 v153, v130, v131
    v_mfma_f32_32x32x16_bf16 v[112:127], v[192:195], v[96:99], v[112:127]
    v_exp_f32 v135, v135
    v_exp_f32 v136, v136
    v_cvt_pk_bf16_f32 v154, v132, v133
    v_cvt_pk_bf16_f32 v155, v134, v135
    v_exp_f32 v137, v137
    v_exp_f32 v138, v138
    v_exp_f32 v139, v139
    v_mfma_f32_32x32x16_bf16 v[176:191], v[208:211], v[152:155], v[176:191]
    s_waitcnt lgkmcnt(0)
    v_exp_f32 v140, v140
    v_exp_f32 v141, v141
    v_cvt_pk_bf16_f32 v156, v136, v137
    v_exp_f32 v142, v142
    v_exp_f32 v143, v143
    v_cvt_pk_bf16_f32 v157, v138, v139
    v_cvt_pk_bf16_f32 v158, v140, v141
    v_exp_f32 v112, v112
    v_exp_f32 v113, v113
    v_cvt_pk_bf16_f32 v159, v142, v143
    v_mfma_f32_32x32x8_bf16 v[128:143], v[220:221], v[108:109], 0
    ds_read_b128 v[208:211], v243 offset:15440
    v_exp_f32 v114, v114
    v_exp_f32 v115, v115
    v_exp_f32 v116, v116
    v_cvt_pk_bf16_f32 v144, v112, v113
    v_mfma_f32_32x32x16_bf16 v[176:191], v[212:215], v[156:159], v[176:191]
    ds_read_b128 v[212:215], v243 offset:16048
    v_exp_f32 v117, v117
    v_exp_f32 v118, v118
    v_cvt_pk_bf16_f32 v145, v114, v115
    v_mfma_f32_32x32x16_bf16 v[128:143], v[192:195], v[100:103], v[128:143]
    ds_read_b128 v[192:195], v224 offset:11648
    v_exp_f32 v119, v119
    v_exp_f32 v120, v120
    v_cvt_pk_bf16_f32 v146, v116, v117
    v_cvt_pk_bf16_f32 v147, v118, v119
    v_exp_f32 v121, v121
    v_exp_f32 v122, v122
    v_exp_f32 v123, v123
    v_mfma_f32_32x32x16_bf16 v[160:175], v[200:203], v[144:147], v[160:175]
    v_exp_f32 v124, v124
    v_exp_f32 v125, v125
    v_cvt_pk_bf16_f32 v148, v120, v121
    v_exp_f32 v126, v126
    v_exp_f32 v127, v127
    v_cvt_pk_bf16_f32 v149, v122, v123
    v_cvt_pk_bf16_f32 v150, v124, v125
    v_exp_f32 v128, v128
    v_exp_f32 v129, v129
    v_cvt_pk_bf16_f32 v151, v126, v127
    v_mfma_f32_32x32x8_bf16 v[112:127], v[220:221], v[106:107], 0
    v_exp_f32 v130, v130
    v_exp_f32 v131, v131
    v_exp_f32 v132, v132
    v_cvt_pk_bf16_f32 v152, v128, v129
    v_mfma_f32_32x32x16_bf16 v[160:175], v[204:207], v[148:151], v[160:175]
    v_exp_f32 v133, v133
    v_exp_f32 v134, v134
    v_cvt_pk_bf16_f32 v153, v130, v131
    v_mfma_f32_32x32x16_bf16 v[112:127], v[196:199], v[96:99], v[112:127]
    v_exp_f32 v135, v135
    v_exp_f32 v136, v136
    v_cvt_pk_bf16_f32 v154, v132, v133
    v_cvt_pk_bf16_f32 v155, v134, v135
    v_exp_f32 v137, v137
    v_exp_f32 v138, v138
    v_exp_f32 v139, v139
    v_mfma_f32_32x32x16_bf16 v[176:191], v[200:203], v[152:155], v[176:191]
    s_waitcnt lgkmcnt(0)
    v_exp_f32 v140, v140
    v_exp_f32 v141, v141
    v_cvt_pk_bf16_f32 v156, v136, v137
    v_exp_f32 v142, v142
    v_exp_f32 v143, v143
    v_cvt_pk_bf16_f32 v157, v138, v139
    v_cvt_pk_bf16_f32 v158, v140, v141
    v_exp_f32 v112, v112
    v_exp_f32 v113, v113
    v_cvt_pk_bf16_f32 v159, v142, v143
    v_mfma_f32_32x32x8_bf16 v[128:143], v[220:221], v[110:111], 0
    ds_read_b128 v[200:203], v243 offset:16656
    v_exp_f32 v114, v114
    v_exp_f32 v115, v115
    v_exp_f32 v116, v116
    v_cvt_pk_bf16_f32 v144, v112, v113
    v_mfma_f32_32x32x16_bf16 v[176:191], v[204:207], v[156:159], v[176:191]
    ds_read_b128 v[204:207], v243 offset:17264
    v_exp_f32 v117, v117
    v_exp_f32 v118, v118
    v_cvt_pk_bf16_f32 v145, v114, v115
    v_mfma_f32_32x32x16_bf16 v[128:143], v[196:199], v[100:103], v[128:143]
    ds_read_b128 v[196:199], v224 offset:12672
    v_exp_f32 v119, v119
    v_exp_f32 v120, v120
    v_cvt_pk_bf16_f32 v146, v116, v117
    v_cvt_pk_bf16_f32 v147, v118, v119
    v_exp_f32 v121, v121
    v_exp_f32 v122, v122
    v_exp_f32 v123, v123
    v_mfma_f32_32x32x16_bf16 v[160:175], v[208:211], v[144:147], v[160:175]
    ds_read_b128 v[216:219], v225 offset:23296
    v_exp_f32 v124, v124
    v_exp_f32 v125, v125
    v_cvt_pk_bf16_f32 v148, v120, v121
    v_exp_f32 v126, v126
    v_exp_f32 v127, v127
    v_cvt_pk_bf16_f32 v149, v122, v123
    v_cvt_pk_bf16_f32 v150, v124, v125
    v_exp_f32 v128, v128
    v_exp_f32 v129, v129
    v_cvt_pk_bf16_f32 v151, v126, v127
    v_mfma_f32_32x32x8_bf16 v[112:127], v[222:223], v[104:105], 0
    v_exp_f32 v130, v130
    v_exp_f32 v131, v131
    v_exp_f32 v132, v132
    v_cvt_pk_bf16_f32 v152, v128, v129
    v_mfma_f32_32x32x16_bf16 v[160:175], v[212:215], v[148:151], v[160:175]
    buffer_load_dword v244, v248, s[44:47], s74 offen sc1
    v_exp_f32 v133, v133
    v_exp_f32 v134, v134
    v_cvt_pk_bf16_f32 v153, v130, v131
    v_mfma_f32_32x32x16_bf16 v[112:127], v[192:195], v[96:99], v[112:127]
    v_exp_f32 v135, v135
    v_exp_f32 v136, v136
    v_cvt_pk_bf16_f32 v154, v132, v133
    v_cvt_pk_bf16_f32 v155, v134, v135
    v_exp_f32 v137, v137
    v_exp_f32 v138, v138
    v_exp_f32 v139, v139
    v_mfma_f32_32x32x16_bf16 v[176:191], v[208:211], v[152:155], v[176:191]
    s_waitcnt lgkmcnt(0)
    v_exp_f32 v140, v140
    v_exp_f32 v141, v141
    v_cvt_pk_bf16_f32 v156, v136, v137
    v_exp_f32 v142, v142
    v_exp_f32 v143, v143
    v_cvt_pk_bf16_f32 v157, v138, v139
    v_cvt_pk_bf16_f32 v158, v140, v141
    v_exp_f32 v112, v112
    v_exp_f32 v113, v113
    v_cvt_pk_bf16_f32 v159, v142, v143
    v_mfma_f32_32x32x8_bf16 v[128:143], v[222:223], v[108:109], 0
    ds_read_b128 v[208:211], v243 offset:17872
    v_exp_f32 v114, v114
    v_exp_f32 v115, v115
    v_exp_f32 v116, v116
    v_cvt_pk_bf16_f32 v144, v112, v113
    v_mfma_f32_32x32x16_bf16 v[176:191], v[212:215], v[156:159], v[176:191]
    ds_read_b128 v[212:215], v243 offset:18480
    v_exp_f32 v117, v117
    v_exp_f32 v118, v118
    v_cvt_pk_bf16_f32 v145, v114, v115
    v_mfma_f32_32x32x16_bf16 v[128:143], v[192:195], v[100:103], v[128:143]
    ds_read_b128 v[192:195], v224 offset:19200
    v_exp_f32 v119, v119
    v_exp_f32 v120, v120
    v_cvt_pk_bf16_f32 v146, v116, v117
    v_cvt_pk_bf16_f32 v147, v118, v119
    v_exp_f32 v121, v121
    v_exp_f32 v122, v122
    v_exp_f32 v123, v123
    v_mfma_f32_32x32x16_bf16 v[160:175], v[200:203], v[144:147], v[160:175]
    v_exp_f32 v124, v124
    v_exp_f32 v125, v125
    v_cvt_pk_bf16_f32 v148, v120, v121
    v_exp_f32 v126, v126
    v_exp_f32 v127, v127
    v_cvt_pk_bf16_f32 v149, v122, v123
    v_cvt_pk_bf16_f32 v150, v124, v125
    v_exp_f32 v128, v128
    v_exp_f32 v129, v129
    v_cvt_pk_bf16_f32 v151, v126, v127
    v_mfma_f32_32x32x8_bf16 v[112:127], v[222:223], v[106:107], 0
    v_exp_f32 v130, v130
    v_exp_f32 v131, v131
    v_exp_f32 v132, v132
    v_cvt_pk_bf16_f32 v152, v128, v129
    v_mfma_f32_32x32x16_bf16 v[160:175], v[204:207], v[148:151], v[160:175]
    v_exp_f32 v133, v133
    v_exp_f32 v134, v134
    v_cvt_pk_bf16_f32 v153, v130, v131
    v_mfma_f32_32x32x16_bf16 v[112:127], v[196:199], v[96:99], v[112:127]
    v_exp_f32 v135, v135
    v_exp_f32 v136, v136
    v_cvt_pk_bf16_f32 v154, v132, v133
    v_cvt_pk_bf16_f32 v155, v134, v135
    v_exp_f32 v137, v137
    v_exp_f32 v138, v138
    v_exp_f32 v139, v139
    v_mfma_f32_32x32x16_bf16 v[176:191], v[200:203], v[152:155], v[176:191]
    s_waitcnt lgkmcnt(0)
    v_exp_f32 v140, v140
    v_exp_f32 v141, v141
    v_cvt_pk_bf16_f32 v156, v136, v137
    v_exp_f32 v142, v142
    v_exp_f32 v143, v143
    v_cvt_pk_bf16_f32 v157, v138, v139
    v_cvt_pk_bf16_f32 v158, v140, v141
    v_exp_f32 v112, v112
    v_exp_f32 v113, v113
    v_cvt_pk_bf16_f32 v159, v142, v143
    v_mfma_f32_32x32x8_bf16 v[128:143], v[222:223], v[110:111], 0
    ds_read_b128 v[200:203], v243 offset:23824
    v_exp_f32 v114, v114
    v_exp_f32 v115, v115
    v_exp_f32 v116, v116
    v_cvt_pk_bf16_f32 v144, v112, v113
    v_mfma_f32_32x32x16_bf16 v[176:191], v[204:207], v[156:159], v[176:191]
    ds_read_b128 v[204:207], v243 offset:24432
    v_exp_f32 v117, v117
    v_exp_f32 v118, v118
    v_cvt_pk_bf16_f32 v145, v114, v115
    v_mfma_f32_32x32x16_bf16 v[128:143], v[196:199], v[100:103], v[128:143]
    ds_read_b128 v[196:199], v224 offset:20224
    v_exp_f32 v119, v119
    v_exp_f32 v120, v120
    v_cvt_pk_bf16_f32 v146, v116, v117
    v_cvt_pk_bf16_f32 v147, v118, v119
    v_exp_f32 v121, v121
    v_exp_f32 v122, v122
    v_exp_f32 v123, v123
    v_mfma_f32_32x32x16_bf16 v[160:175], v[208:211], v[144:147], v[160:175]
    v_exp_f32 v124, v124
    v_exp_f32 v125, v125
    v_cvt_pk_bf16_f32 v148, v120, v121
    v_exp_f32 v126, v126
    v_exp_f32 v127, v127
    v_cvt_pk_bf16_f32 v149, v122, v123
    v_cvt_pk_bf16_f32 v150, v124, v125
    v_exp_f32 v128, v128
    v_exp_f32 v129, v129
    v_cvt_pk_bf16_f32 v151, v126, v127
    v_mfma_f32_32x32x8_bf16 v[112:127], v[216:217], v[104:105], 0
    v_exp_f32 v130, v130
    v_exp_f32 v131, v131
    v_exp_f32 v132, v132
    v_cvt_pk_bf16_f32 v152, v128, v129
    v_mfma_f32_32x32x16_bf16 v[160:175], v[212:215], v[148:151], v[160:175]
    v_exp_f32 v133, v133
    v_exp_f32 v134, v134
    v_cvt_pk_bf16_f32 v153, v130, v131
    v_mfma_f32_32x32x16_bf16 v[112:127], v[192:195], v[96:99], v[112:127]
    v_exp_f32 v135, v135
    v_exp_f32 v136, v136
    v_cvt_pk_bf16_f32 v154, v132, v133
    v_cvt_pk_bf16_f32 v155, v134, v135
    v_add_u32 v224, 19200, v224
    v_add_u32 v243, 19200, v243
    v_add_u32 v225, 19200, v225
    v_exp_f32 v137, v137
    v_exp_f32 v138, v138
    v_exp_f32 v139, v139
    v_mfma_f32_32x32x16_bf16 v[176:191], v[208:211], v[152:155], v[176:191]
    s_waitcnt lgkmcnt(0)
    v_exp_f32 v140, v140
    v_exp_f32 v141, v141
    v_cvt_pk_bf16_f32 v156, v136, v137
    v_exp_f32 v142, v142
    v_exp_f32 v143, v143
    v_cvt_pk_bf16_f32 v157, v138, v139
    v_cvt_pk_bf16_f32 v158, v140, v141
    s_waitcnt vmcnt(0)
    v_cmp_eq_u32 vcc, 0, v244
    s_mov_b32 s37, 0
    s_mov_b32 s36, 4
    s_getpc_b64 s[40:41]
L_pc3:
    s_add_u32 s40, s40, L_done-L_pc3
    s_addc_u32 s41, s41, 0
    s_mov_b32 s42, L_fallback-L_done
    v_lshlrev_b32 v249, 7, v241
    buffer_load_dword v251, v249, s[40:43], 0 offen
    s_cbranch_vccnz L_pfspin
L_itL:
    v_exp_f32 v112, v112
    v_exp_f32 v113, v113
    v_cvt_pk_bf16_f32 v159, v142, v143
    v_mfma_f32_32x32x8_bf16 v[128:143], v[216:217], v[108:109], 0
    ds_read_b128 v[208:211], v243 offset:5840
    v_exp_f32 v114, v114
    v_exp_f32 v115, v115
    v_exp_f32 v116, v116
    v_cvt_pk_bf16_f32 v144, v112, v113
    v_mfma_f32_32x32x16_bf16 v[176:191], v[212:215], v[156:159], v[176:191]
    ds_read_b128 v[212:215], v243 offset:6448
    v_exp_f32 v117, v117
    v_exp_f32 v118, v118
    v_cvt_pk_bf16_f32 v145, v114, v115
    v_mfma_f32_32x32x16_bf16 v[128:143], v[192:195], v[100:103], v[128:143]
    ds_read_b128 v[192:195], v224 offset:2048
    global_load_dwordx4 a[168:171], v226, s[18:19] offset:3072 sc1
    v_exp_f32 v119, v119
    v_exp_f32 v120, v120
    v_cvt_pk_bf16_f32 v146, v116, v117
    v_cvt_pk_bf16_f32 v147, v118, v119
    v_exp_f32 v121, v121
    v_exp_f32 v122, v122
    v_exp_f32 v123, v123
    v_mfma_f32_32x32x16_bf16 v[160:175], v[200:203], v[144:147], v[160:175]
    global_load_dwordx4 a[172:175], v227, s[18:19] offset:-4096 sc1
    v_exp_f32 v124, v124
    v_exp_f32 v125, v125
    v_cvt_pk_bf16_f32 v148, v120, v121
    v_exp_f32 v126, v126
    v_exp_f32 v127, v127
    v_cvt_pk_bf16_f32 v149, v122, v123
    v_cvt_pk_bf16_f32 v150, v124, v125
    v_exp_f32 v128, v128
    v_exp_f32 v129, v129
    v_cvt_pk_bf16_f32 v151, v126, v127
    v_mfma_f32_32x32x8_bf16 v[112:127], v[216:217], v[106:107], 0
    v_exp_f32 v130, v130
    v_exp_f32 v131, v131
    v_exp_f32 v132, v132
    v_cvt_pk_bf16_f32 v152, v128, v129
    v_mfma_f32_32x32x16_bf16 v[160:175], v[204:207], v[148:151], v[160:175]
    global_load_dwordx4 a[176:179], v227, s[18:19] offset:-3072 sc1
    v_exp_f32 v133, v133
    v_exp_f32 v134, v134
    v_cvt_pk_bf16_f32 v153, v130, v131
    v_mfma_f32_32x32x16_bf16 v[112:127], v[196:199], v[96:99], v[112:127]
    global_load_dwordx4 a[180:183], v227, s[18:19] offset:-2048 sc1
    v_exp_f32 v135, v135
    v_exp_f32 v136, v136
    v_cvt_pk_bf16_f32 v154, v132, v133
    v_cvt_pk_bf16_f32 v155, v134, v135
    v_exp_f32 v137, v137
    v_exp_f32 v138, v138
    v_exp_f32 v139, v139
    v_mfma_f32_32x32x16_bf16 v[176:191], v[200:203], v[152:155], v[176:191]
    global_load_dwordx4 a[184:187], v227, s[18:19] offset:-1024 sc1
    s_waitcnt lgkmcnt(0)
    v_exp_f32 v140, v140
    v_exp_f32 v141, v141
    v_cvt_pk_bf16_f32 v156, v136, v137
    v_exp_f32 v142, v142
    v_exp_f32 v143, v143
    v_cvt_pk_bf16_f32 v157, v138, v139
    v_cvt_pk_bf16_f32 v158, v140, v141
    v_exp_f32 v112, v112
    v_exp_f32 v113, v113
    v_cvt_pk_bf16_f32 v159, v142, v143
    v_mfma_f32_32x32x8_bf16 v[128:143], v[216:217], v[110:111], 0
    ds_read_b128 v[200:203], v243 offset:7056
    v_exp_f32 v114, v114
    v_exp_f32 v115, v115
    v_exp_f32 v116, v116
    v_cvt_pk_bf16_f32 v144, v112, v113
    v_mfma_f32_32x32x16_bf16 v[176:191], v[204:207], v[156:159], v[176:191]
    ds_read_b128 v[204:207], v243 offset:7664
    v_exp_f32 v117, v117
    v_exp_f32 v118, v118
    v_cvt_pk_bf16_f32 v145, v114, v115
    v_mfma_f32_32x32x16_bf16 v[128:143], v[196:199], v[100:103], v[128:143]
    ds_read_b128 v[196:199], v224 offset:3072
    global_load_dwordx4 a[188:191], v227, s[18:19] offset:0 sc1
    v_exp_f32 v119, v119
    v_exp_f32 v120, v120
    v_cvt_pk_bf16_f32 v146, v116, v117
    v_cvt_pk_bf16_f32 v147, v118, v119
    v_exp_f32 v121, v121
    v_exp_f32 v122, v122
    v_exp_f32 v123, v123
    v_mfma_f32_32x32x16_bf16 v[160:175], v[208:211], v[144:147], v[160:175]
    ds_read_b128 v[220:223], v225 offset:13696
    global_load_dwordx4 a[192:195], v227, s[18:19] offset:1024 sc1
    v_exp_f32 v124, v124
    v_exp_f32 v125, v125
    v_cvt_pk_bf16_f32 v148, v120, v121
    v_exp_f32 v126, v126
    v_exp_f32 v127, v127
    v_cvt_pk_bf16_f32 v149, v122, v123
    v_cvt_pk_bf16_f32 v150, v124, v125
    v_exp_f32 v128, v128
    v_exp_f32 v129, v129
    v_cvt_pk_bf16_f32 v151, v126, v127
    v_mfma_f32_32x32x8_bf16 v[112:127], v[218:219], v[104:105], 0
    v_exp_f32 v130, v130
    v_exp_f32 v131, v131
    v_exp_f32 v132, v132
    v_cvt_pk_bf16_f32 v152, v128, v129
    v_mfma_f32_32x32x16_bf16 v[160:175], v[212:215], v[148:151], v[160:175]
    global_load_dwordx4 a[196:199], v227, s[18:19] offset:2048 sc1
    v_exp_f32 v133, v133
    v_exp_f32 v134, v134
    v_cvt_pk_bf16_f32 v153, v130, v131
    v_mfma_f32_32x32x16_bf16 v[112:127], v[192:195], v[96:99], v[112:127]
    global_load_dwordx4 a[200:203], v227, s[18:19] offset:3072 sc1
    v_exp_f32 v135, v135
    v_exp_f32 v136, v136
    v_cvt_pk_bf16_f32 v154, v132, v133
    v_cvt_pk_bf16_f32 v155, v134, v135
    v_exp_f32 v137, v137
    v_exp_f32 v138, v138
    v_exp_f32 v139, v139
    v_mfma_f32_32x32x16_bf16 v[176:191], v[208:211], v[152:155], v[176:191]
    global_load_dwordx4 a[204:207], v228, s[18:19] offset:-4096 sc1
    s_waitcnt lgkmcnt(0)
    v_exp_f32 v140, v140
    v_exp_f32 v141, v141
    v_cvt_pk_bf16_f32 v156, v136, v137
    v_exp_f32 v142, v142
    v_exp_f32 v143, v143
    v_cvt_pk_bf16_f32 v157, v138, v139
    v_cvt_pk_bf16_f32 v158, v140, v141
    v_exp_f32 v112, v112
    v_exp_f32 v113, v113
    v_cvt_pk_bf16_f32 v159, v142, v143
    v_mfma_f32_32x32x8_bf16 v[128:143], v[218:219], v[108:109], 0
    ds_read_b128 v[208:211], v243 offset:8272
    v_exp_f32 v114, v114
    v_exp_f32 v115, v115
    v_exp_f32 v116, v116
    v_cvt_pk_bf16_f32 v144, v112, v113
    v_mfma_f32_32x32x16_bf16 v[176:191], v[212:215], v[156:159], v[176:191]
    ds_read_b128 v[212:215], v243 offset:8880
    v_exp_f32 v117, v117
    v_exp_f32 v118, v118
    v_cvt_pk_bf16_f32 v145, v114, v115
    v_mfma_f32_32x32x16_bf16 v[128:143], v[192:195], v[100:103], v[128:143]
    ds_read_b128 v[192:195], v224 offset:9600
    global_load_dwordx4 a[208:211], v228, s[18:19] offset:-3072 sc1
    v_exp_f32 v119, v119
    v_exp_f32 v120, v120
    v_cvt_pk_bf16_f32 v146, v116, v117
    v_cvt_pk_bf16_f32 v147, v118, v119
    v_exp_f32 v121, v121
    v_exp_f32 v122, v122
    v_exp_f32 v123, v123
    v_mfma_f32_32x32x16_bf16 v[160:175], v[200:203], v[144:147], v[160:175]
    global_load_dwordx4 a[212:215], v228, s[18:19] offset:-2048 sc1
    v_exp_f32 v124, v124
    v_exp_f32 v125, v125
    v_cvt_pk_bf16_f32 v148, v120, v121
    v_exp_f32 v126, v126
    v_exp_f32 v127, v127
    v_cvt_pk_bf16_f32 v149, v122, v123
    v_cvt_pk_bf16_f32 v150, v124, v125
    v_exp_f32 v128, v128
    v_exp_f32 v129, v129
    v_cvt_pk_bf16_f32 v151, v126, v127
    v_mfma_f32_32x32x8_bf16 v[112:127], v[218:219], v[106:107], 0
    v_exp_f32 v130, v130
    v_exp_f32 v131, v131
    v_exp_f32 v132, v132
    v_cvt_pk_bf16_f32 v152, v128, v129
    v_mfma_f32_32x32x16_bf16 v[160:175], v[204:207], v[148:151], v[160:175]
    global_load_dwordx4 a[216:219], v228, s[18:19] offset:-1024 sc1
    v_exp_f32 v133, v133
    v_exp_f32 v134, v134
    v_cvt_pk_bf16_f32 v153, v130, v131
    v_mfma_f32_32x32x16_bf16 v[112:127], v[196:199], v[96:99], v[112:127]
    global_load_dwordx4 a[220:223], v228, s[18:19] offset:0 sc1
    v_exp_f32 v135, v135
    v_exp_f32 v136, v136
    v_cvt_pk_bf16_f32 v154, v132, v133
    v_cvt_pk_bf16_f32 v155, v134, v135
    v_exp_f32 v137, v137
    v_exp_f32 v138, v138
    v_exp_f32 v139, v139
    v_mfma_f32_32x32x16_bf16 v[176:191], v[200:203], v[152:155], v[176:191]
    global_load_dwordx4 a[224:227], v228, s[18:19] offset:1024 sc1
    s_waitcnt lgkmcnt(0)
    v_exp_f32 v140, v140
    v_exp_f32 v141, v141
    v_cvt_pk_bf16_f32 v156, v136, v137
    v_exp_f32 v142, v142
    v_exp_f32 v143, v143
    v_cvt_pk_bf16_f32 v157, v138, v139
    v_cvt_pk_bf16_f32 v158, v140, v141
    v_exp_f32 v112, v112
    v_exp_f32 v113, v113
    v_cvt_pk_bf16_f32 v159, v142, v143
    v_mfma_f32_32x32x8_bf16 v[128:143], v[218:219], v[110:111], 0
    ds_read_b128 v[200:203], v243 offset:14224
    v_exp_f32 v114, v114
    v_exp_f32 v115, v115
    v_exp_f32 v116, v116
    v_cvt_pk_bf16_f32 v144, v112, v113
    v_mfma_f32_32x32x16_bf16 v[176:191], v[204:207], v[156:159], v[176:191]
    ds_read_b128 v[204:207], v243 offset:14832
    v_exp_f32 v117, v117
    v_exp_f32 v118, v118
    v_cvt_pk_bf16_f32 v145, v114, v115
    v_mfma_f32_32x32x16_bf16 v[128:143], v[196:199], v[100:103], v[128:143]
    ds_read_b128 v[196:199], v224 offset:10624
    global_load_dwordx4 a[228:231], v228, s[18:19] offset:2048 sc1
    v_exp_f32 v119, v119
    v_exp_f32 v120, v120
    v_cvt_pk_bf16_f32 v146, v116, v117
    v_cvt_pk_bf16_f32 v147, v118, v119
    v_exp_f32 v121, v121
    v_exp_f32 v122, v122
    v_exp_f32 v123, v123
    v_mfma_f32_32x32x16_bf16 v[160:175], v[208:211], v[144:147], v[160:175]
    global_load_dwordx4 a[232:235], v228, s[18:19] offset:3072 sc1
    v_exp_f32 v124, v124
    v_exp_f32 v125, v125
    v_cvt_pk_bf16_f32 v148, v120, v121
    v_exp_f32 v126, v126
    v_exp_f32 v127, v127
    v_cvt_pk_bf16_f32 v149, v122, v123
    v_cvt_pk_bf16_f32 v150, v124, v125
    v_exp_f32 v128, v128
    v_exp_f32 v129, v129
    v_cvt_pk_bf16_f32 v151, v126, v127
    v_mfma_f32_32x32x8_bf16 v[112:127], v[220:221], v[104:105], 0
    v_exp_f32 v130, v130
    v_exp_f32 v131, v131
    v_exp_f32 v132, v132
    v_cvt_pk_bf16_f32 v152, v128, v129
    v_mfma_f32_32x32x16_bf16 v[160:175], v[212:215], v[148:151], v[160:175]
    global_load_dwordx4 a[236:239], v229, s[18:19] offset:-4096 sc1
    v_exp_f32 v133, v133
    v_exp_f32 v134, v134
    v_cvt_pk_bf16_f32 v153, v130, v131
    v_mfma_f32_32x32x16_bf16 v[112:127], v[192:195], v[96:99], v[112:127]
    global_load_dwordx4 a[240:243], v229, s[18:19] offset:-3072 sc1
    v_exp_f32 v135, v135
    v_exp_f32 v136, v136
    v_cvt_pk_bf16_f32 v154, v132, v133
    v_cvt_pk_bf16_f32 v155, v134, v135
    v_exp_f32 v137, v137
    v_exp_f32 v138, v138
    v_exp_f32 v139, v139
    v_mfma_f32_32x32x16_bf16 v[176:191], v[208:211], v[152:155], v[176:191]
    global_load_dwordx4 a[244:247], v229, s[18:19] offset:-2048 sc1
    s_waitcnt lgkmcnt(0)
    v_exp_f32 v140, v140
    v_exp_f32 v141, v141
    v_cvt_pk_bf16_f32 v156, v136, v137
    v_exp_f32 v142, v142
    v_exp_f32 v143, v143
    v_cvt_pk_bf16_f32 v157, v138, v139
    v_cvt_pk_bf16_f32 v158, v140, v141
    v_exp_f32 v112, v112
    v_exp_f32 v113, v113
    v_cvt_pk_bf16_f32 v159, v142, v143
    v_mfma_f32_32x32x8_bf16 v[128:143], v[220:221], v[108:109], 0
    ds_read_b128 v[208:211], v243 offset:15440
    v_exp_f32 v114, v114
    v_exp_f32 v115, v115
    v_exp_f32 v116, v116
    v_cvt_pk_bf16_f32 v144, v112, v113
    v_mfma_f32_32x32x16_bf16 v[176:191], v[212:215], v[156:159], v[176:191]
    ds_read_b128 v[212:215], v243 offset:16048
    v_exp_f32 v117, v117
    v_exp_f32 v118, v118
    v_cvt_pk_bf16_f32 v145, v114, v115
    v_mfma_f32_32x32x16_bf16 v[128:143], v[192:195], v[100:103], v[128:143]
    ds_read_b128 v[192:195], v224 offset:11648
    v_exp_f32 v119, v119
    v_exp_f32 v120, v120
    v_cvt_pk_bf16_f32 v146, v116, v117
    v_cvt_pk_bf16_f32 v147, v118, v119
    v_exp_f32 v121, v121
    v_exp_f32 v122, v122
    v_exp_f32 v123, v123
    v_mfma_f32_32x32x16_bf16 v[160:175], v[200:203], v[144:147], v[160:175]
    global_load_dwordx4 a[0:3], v227, s[12:13] offset:-4096 sc1
    v_exp_f32 v124, v124
    v_exp_f32 v125, v125
    v_cvt_pk_bf16_f32 v148, v120, v121
    v_exp_f32 v126, v126
    v_exp_f32 v127, v127
    v_cvt_pk_bf16_f32 v149, v122, v123
    v_cvt_pk_bf16_f32 v150, v124, v125
    v_exp_f32 v128, v128
    v_exp_f32 v129, v129
    v_cvt_pk_bf16_f32 v151, v126, v127
    v_mfma_f32_32x32x8_bf16 v[112:127], v[220:221], v[106:107], 0
    global_load_dwordx4 a[8:11], v227, s[14:15] offset:0 sc1
    v_exp_f32 v130, v130
    v_exp_f32 v131, v131
    v_exp_f32 v132, v132
    v_cvt_pk_bf16_f32 v152, v128, v129
    v_mfma_f32_32x32x16_bf16 v[160:175], v[204:207], v[148:151], v[160:175]
    global_load_dwordx4 a[12:15], v227, s[14:15] offset:1024 sc1
    v_exp_f32 v133, v133
    v_exp_f32 v134, v134
    v_cvt_pk_bf16_f32 v153, v130, v131
    v_mfma_f32_32x32x16_bf16 v[112:127], v[196:199], v[96:99], v[112:127]
    global_load_dwordx4 a[16:19], v227, s[14:15] offset:2048 sc1
    v_exp_f32 v135, v135
    v_exp_f32 v136, v136
    v_cvt_pk_bf16_f32 v154, v132, v133
    v_cvt_pk_bf16_f32 v155, v134, v135
    v_exp_f32 v137, v137
    v_exp_f32 v138, v138
    v_exp_f32 v139, v139
    v_mfma_f32_32x32x16_bf16 v[176:191], v[200:203], v[152:155], v[176:191]
    global_load_dwordx4 a[4:7], v227, s[12:13] offset:-3072 sc1
    s_waitcnt lgkmcnt(0)
    v_exp_f32 v140, v140
    v_exp_f32 v141, v141
    v_cvt_pk_bf16_f32 v156, v136, v137
    v_exp_f32 v142, v142
    v_exp_f32 v143, v143
    v_cvt_pk_bf16_f32 v157, v138, v139
    v_cvt_pk_bf16_f32 v158, v140, v141
    v_exp_f32 v112, v112
    v_exp_f32 v113, v113
    v_cvt_pk_bf16_f32 v159, v142, v143
    v_mfma_f32_32x32x8_bf16 v[128:143], v[220:221], v[110:111], 0
    ds_read_b128 v[200:203], v243 offset:16656
    v_exp_f32 v114, v114
    v_exp_f32 v115, v115
    v_exp_f32 v116, v116
    v_cvt_pk_bf16_f32 v144, v112, v113
    v_mfma_f32_32x32x16_bf16 v[176:191], v[204:207], v[156:159], v[176:191]
    ds_read_b128 v[204:207], v243 offset:17264
    v_exp_f32 v117, v117
    v_exp_f32 v118, v118
    v_cvt_pk_bf16_f32 v145, v114, v115
    v_mfma_f32_32x32x16_bf16 v[128:143], v[196:199], v[100:103], v[128:143]
    ds_read_b128 v[196:199], v224 offset:12672
    v_exp_f32 v119, v119
    v_exp_f32 v120, v120
    v_cvt_pk_bf16_f32 v146, v116, v117
    v_cvt_pk_bf16_f32 v147, v118, v119
    v_exp_f32 v121, v121
    v_exp_f32 v122, v122
    v_exp_f32 v123, v123
    v_mfma_f32_32x32x16_bf16 v[160:175], v[208:211], v[144:147], v[160:175]
    ds_read_b128 v[216:219], v225 offset:23296
    global_load_dwordx4 a[20:23], v227, s[12:13] offset:-2048 sc1
    v_exp_f32 v124, v124
    v_exp_f32 v125, v125
    v_cvt_pk_bf16_f32 v148, v120, v121
    v_exp_f32 v126, v126
    v_exp_f32 v127, v127
    v_cvt_pk_bf16_f32 v149, v122, v123
    v_cvt_pk_bf16_f32 v150, v124, v125
    v_exp_f32 v128, v128
    v_exp_f32 v129, v129
    v_cvt_pk_bf16_f32 v151, v126, v127
    v_mfma_f32_32x32x8_bf16 v[112:127], v[222:223], v[104:105], 0
    global_load_dwordx4 a[28:31], v227, s[14:15] offset:3072 sc1
    v_exp_f32 v130, v130
    v_exp_f32 v131, v131
    v_exp_f32 v132, v132
    v_cvt_pk_bf16_f32 v152, v128, v129
    v_mfma_f32_32x32x16_bf16 v[160:175], v[212:215], v[148:151], v[160:175]
    global_load_dwordx4 a[32:35], v228, s[14:15] offset:-4096 sc1
    v_exp_f32 v133, v133
    v_exp_f32 v134, v134
    v_cvt_pk_bf16_f32 v153, v130, v131
    v_mfma_f32_32x32x16_bf16 v[112:127], v[192:195], v[96:99], v[112:127]
    global_load_dwordx4 a[36:39], v228, s[14:15] offset:-3072 sc1
    v_exp_f32 v135, v135
    v_exp_f32 v136, v136
    v_cvt_pk_bf16_f32 v154, v132, v133
    v_cvt_pk_bf16_f32 v155, v134, v135
    v_exp_f32 v137, v137
    v_exp_f32 v138, v138
    v_exp_f32 v139, v139
    v_mfma_f32_32x32x16_bf16 v[176:191], v[208:211], v[152:155], v[176:191]
    global_load_dwordx4 a[24:27], v227, s[12:13] offset:-1024 sc1
    s_waitcnt lgkmcnt(0)
    v_exp_f32 v140, v140
    v_exp_f32 v141, v141
    v_cvt_pk_bf16_f32 v156, v136, v137
    v_exp_f32 v142, v142
    v_exp_f32 v143, v143
    v_cvt_pk_bf16_f32 v157, v138, v139
    v_cvt_pk_bf16_f32 v158, v140, v141
    v_exp_f32 v112, v112
    v_exp_f32 v113, v113
    v_cvt_pk_bf16_f32 v159, v142, v143
    v_mfma_f32_32x32x8_bf16 v[128:143], v[222:223], v[108:109], 0
    ds_read_b128 v[208:211], v243 offset:17872
    v_exp_f32 v114, v114
    v_exp_f32 v115, v115
    v_exp_f32 v116, v116
    v_cvt_pk_bf16_f32 v144, v112, v113
    v_mfma_f32_32x32x16_bf16 v[176:191], v[212:215], v[156:159], v[176:191]
    ds_read_b128 v[212:215], v243 offset:18480
    v_exp_f32 v117, v117
    v_exp_f32 v118, v118
    v_cvt_pk_bf16_f32 v145, v114, v115
    v_mfma_f32_32x32x16_bf16 v[128:143], v[192:195], v[100:103], v[128:143]
    ds_read_b128 v[192:195], v224 offset:19200
    v_exp_f32 v119, v119
    v_exp_f32 v120, v120
    v_cvt_pk_bf16_f32 v146, v116, v117
    v_cvt_pk_bf16_f32 v147, v118, v119
    v_exp_f32 v121, v121
    v_exp_f32 v122, v122
    v_exp_f32 v123, v123
    v_mfma_f32_32x32x16_bf16 v[160:175], v[200:203], v[144:147], v[160:175]
    global_load_dwordx4 a[40:43], v227, s[12:13] offset:0 sc1
    v_exp_f32 v124, v124
    v_exp_f32 v125, v125
    v_cvt_pk_bf16_f32 v148, v120, v121
    v_exp_f32 v126, v126
    v_exp_f32 v127, v127
    v_cvt_pk_bf16_f32 v149, v122, v123
    v_cvt_pk_bf16_f32 v150, v124, v125
    v_exp_f32 v128, v128
    v_exp_f32 v129, v129
    v_cvt_pk_bf16_f32 v151, v126, v127
    v_mfma_f32_32x32x8_bf16 v[112:127], v[222:223], v[106:107], 0
    global_load_dwordx4 a[48:51], v228, s[14:15] offset:-2048 sc1
    v_exp_f32 v130, v130
    v_exp_f32 v131, v131
    v_exp_f32 v132, v132
    v_cvt_pk_bf16_f32 v152, v128, v129
    v_mfma_f32_32x32x16_bf16 v[160:175], v[204:207], v[148:151], v[160:175]
    global_load_dwordx4 a[52:55], v228, s[14:15] offset:-1024 sc1
    v_exp_f32 v133, v133
    v_exp_f32 v134, v134
    v_cvt_pk_bf16_f32 v153, v130, v131
    v_mfma_f32_32x32x16_bf16 v[112:127], v[196:199], v[96:99], v[112:127]
    global_load_dwordx4 a[56:59], v228, s[14:15] offset:0 sc1
    v_exp_f32 v135, v135
    v_exp_f32 v136, v136
    v_cvt_pk_bf16_f32 v154, v132, v133
    v_cvt_pk_bf16_f32 v155, v134, v135
    v_exp_f32 v137, v137
    v_exp_f32 v138, v138
    v_exp_f32 v139, v139
    v_mfma_f32_32x32x16_bf16 v[176:191], v[200:203], v[152:155], v[176:191]
    global_load_dwordx4 a[44:47], v227, s[12:13] offset:1024 sc1
    s_waitcnt lgkmcnt(0)
    v_exp_f32 v140, v140
    v_exp_f32 v141, v141
    v_cvt_pk_bf16_f32 v156, v136, v137
    v_exp_f32 v142, v142
    v_exp_f32 v143, v143
    v_cvt_pk_bf16_f32 v157, v138, v139
    v_cvt_pk_bf16_f32 v158, v140, v141
    v_exp_f32 v112, v112
    v_exp_f32 v113, v113
    v_cvt_pk_bf16_f32 v159, v142, v143
    v_mfma_f32_32x32x8_bf16 v[128:143], v[222:223], v[110:111], 0
    ds_read_b128 v[200:203], v243 offset:23824
    v_exp_f32 v114, v114
    v_exp_f32 v115, v115
    v_exp_f32 v116, v116
    v_cvt_pk_bf16_f32 v144, v112, v113
    v_mfma_f32_32x32x16_bf16 v[176:191], v[204:207], v[156:159], v[176:191]
    ds_read_b128 v[204:207], v243 offset:24432
    v_exp_f32 v117, v117
    v_exp_f32 v118, v118
    v_cvt_pk_bf16_f32 v145, v114, v115
    v_mfma_f32_32x32x16_bf16 v[128:143], v[196:199], v[100:103], v[128:143]
    ds_read_b128 v[196:199], v224 offset:20224
    v_exp_f32 v119, v119
    v_exp_f32 v120, v120
    v_cvt_pk_bf16_f32 v146, v116, v117
    v_cvt_pk_bf16_f32 v147, v118, v119
    v_exp_f32 v121, v121
    v_exp_f32 v122, v122
    v_exp_f32 v123, v123
    v_mfma_f32_32x32x16_bf16 v[160:175], v[208:211], v[144:147], v[160:175]
    global_load_dwordx4 a[60:63], v227, s[12:13] offset:2048 sc1
    v_exp_f32 v124, v124
    v_exp_f32 v125, v125
    v_cvt_pk_bf16_f32 v148, v120, v121
    v_exp_f32 v126, v126
    v_exp_f32 v127, v127
    v_cvt_pk_bf16_f32 v149, v122, v123
    v_cvt_pk_bf16_f32 v150, v124, v125
    v_exp_f32 v128, v128
    v_exp_f32 v129, v129
    v_cvt_pk_bf16_f32 v151, v126, v127
    v_mfma_f32_32x32x8_bf16 v[112:127], v[216:217], v[104:105], 0
    global_load_dwordx4 a[68:71], v228, s[14:15] offset:1024 sc1
    v_exp_f32 v130, v130
    v_exp_f32 v131, v131
    v_exp_f32 v132, v132
    v_cvt_pk_bf16_f32 v152, v128, v129
    v_mfma_f32_32x32x16_bf16 v[160:175], v[212:215], v[148:151], v[160:175]
    global_load_dwordx4 a[72:75], v228, s[14:15] offset:2048 sc1
    v_exp_f32 v133, v133
    v_exp_f32 v134, v134
    v_cvt_pk_bf16_f32 v153, v130, v131
    v_mfma_f32_32x32x16_bf16 v[112:127], v[192:195], v[96:99], v[112:127]
    global_load_dwordx4 a[76:79], v228, s[14:15] offset:3072 sc1
    v_exp_f32 v135, v135
    v_exp_f32 v136, v136
    v_cvt_pk_bf16_f32 v154, v132, v133
    v_cvt_pk_bf16_f32 v155, v134, v135
    v_add_u32 v224, 19200, v224
    v_add_u32 v243, 19200, v243
    v_add_u32 v225, 19200, v225
    v_exp_f32 v137, v137
    v_exp_f32 v138, v138
    v_exp_f32 v139, v139
    v_mfma_f32_32x32x16_bf16 v[176:191], v[208:211], v[152:155], v[176:191]
    global_load_dwordx4 a[64:67], v227, s[12:13] offset:3072 sc1
    s_waitcnt vmcnt(15) lgkmcnt(0)
    buffer_load_dword v244, v248, s[44:47], s74 offen sc1
    v_exp_f32 v140, v140
    v_exp_f32 v141, v141
    v_cvt_pk_bf16_f32 v156, v136, v137
    v_exp_f32 v142, v142
    v_exp_f32 v143, v143
    v_cvt_pk_bf16_f32 v157, v138, v139
    v_cvt_pk_bf16_f32 v158, v140, v141
    s_add_u32 s12, s12, 16384
    s_addc_u32 s13, s13, 0
    s_add_u32 s14, s14, 24576
    s_addc_u32 s15, s15, 0
.p2align 6
L_itM:
    v_mfma_f32_32x32x16_bf16 v[0:15], a[8:11], a[0:3], v[0:15]
    ds_read_b128 v[208:211], v243 offset:5840
    v_exp_f32 v112, v112
    v_exp_f32 v113, v113
    v_cvt_pk_bf16_f32 v159, v142, v143
    v_mfma_f32_32x32x8_bf16 v[128:143], v[216:217], v[108:109], 0
    v_exp_f32 v114, v114
    v_exp_f32 v115, v115
    v_exp_f32 v116, v116
    v_cvt_pk_bf16_f32 v144, v112, v113
    v_mfma_f32_32x32x16_bf16 v[176:191], v[212:215], v[156:159], v[176:191]
    ds_read_b128 v[212:215], v243 offset:6448
    v_exp_f32 v117, v117
    v_exp_f32 v118, v118
    v_cvt_pk_bf16_f32 v145, v114, v115
    v_mfma_f32_32x32x16_bf16 v[128:143], v[192:195], v[100:103], v[128:143]
    v_exp_f32 v119, v119
    v_exp_f32 v120, v120
    v_cvt_pk_bf16_f32 v146, v116, v117
    v_cvt_pk_bf16_f32 v147, v118, v119
    v_mfma_f32_32x32x16_bf16 v[16:31], a[12:15], a[0:3], v[16:31]
    v_exp_f32 v121, v121
    v_exp_f32 v122, v122
    v_exp_f32 v123, v123
    v_mfma_f32_32x32x16_bf16 v[160:175], v[200:203], v[144:147], v[160:175]
    ds_read_b128 v[192:195], v224 offset:2048
    v_exp_f32 v124, v124
    v_exp_f32 v125, v125
    v_cvt_pk_bf16_f32 v148, v120, v121
    v_mfma_f32_32x32x16_bf16 v[32:47], a[16:19], a[0:3], v[32:47]
    v_exp_f32 v126, v126
    v_exp_f32 v127, v127
    v_cvt_pk_bf16_f32 v149, v122, v123
    v_cvt_pk_bf16_f32 v150, v124, v125
    v_mfma_f32_32x32x16_bf16 v[48:63], a[8:11], a[4:7], v[48:63]
    global_load_dwordx4 a[0:3], v226, s[12:13] offset:-4096 sc1
    v_exp_f32 v128, v128
    v_exp_f32 v129, v129
    v_cvt_pk_bf16_f32 v151, v126, v127
    v_mfma_f32_32x32x8_bf16 v[112:127], v[216:217], v[106:107], 0
    v_exp_f32 v130, v130
    v_exp_f32 v131, v131
    v_exp_f32 v132, v132
    v_cvt_pk_bf16_f32 v152, v128, v129
    v_mfma_f32_32x32x16_bf16 v[160:175], v[204:207], v[148:151], v[160:175]
    global_load_dwordx4 a[8:11], v226, s[14:15] offset:-4096 sc1
    v_exp_f32 v133, v133
    v_exp_f32 v134, v134
    v_cvt_pk_bf16_f32 v153, v130, v131
    v_mfma_f32_32x32x16_bf16 v[112:127], v[196:199], v[96:99], v[112:127]
    v_exp_f32 v135, v135
    v_exp_f32 v136, v136
    v_cvt_pk_bf16_f32 v154, v132, v133
    v_cvt_pk_bf16_f32 v155, v134, v135
    v_mfma_f32_32x32x16_bf16 v[64:79], a[12:15], a[4:7], v[64:79]
    v_exp_f32 v137, v137
    v_exp_f32 v138, v138
    v_exp_f32 v139, v139
    v_mfma_f32_32x32x16_bf16 v[176:191], v[200:203], v[152:155], v[176:191]
    global_load_dwordx4 a[12:15], v226, s[14:15] offset:-3072 sc1
    v_exp_f32 v140, v140
    v_exp_f32 v141, v141
    v_cvt_pk_bf16_f32 v156, v136, v137
    v_mfma_f32_32x32x16_bf16 v[80:95], a[16:19], a[4:7], v[80:95]
    global_load_dwordx4 a[16:19], v226, s[14:15] offset:-2048 sc1
    global_load_dwordx4 a[4:7], v226, s[12:13] offset:-3072 sc1
    s_waitcnt vmcnt(15) lgkmcnt(0)
    v_exp_f32 v142, v142
    v_exp_f32 v143, v143
    v_cvt_pk_bf16_f32 v157, v138, v139
    v_cvt_pk_bf16_f32 v158, v140, v141
    v_mfma_f32_32x32x16_bf16 v[0:15], a[28:31], a[20:23], v[0:15]
    ds_read_b128 v[200:203], v243 offset:7056
    v_exp_f32 v112, v112
    v_exp_f32 v113, v113
    v_cvt_pk_bf16_f32 v159, v142, v143
    v_mfma_f32_32x32x8_bf16 v[128:143], v[216:217], v[110:111], 0
    v_exp_f32 v114, v114
    v_exp_f32 v115, v115
    v_exp_f32 v116, v116
    v_cvt_pk_bf16_f32 v144, v112, v113
    v_mfma_f32_32x32x16_bf16 v[176:191], v[204:207], v[156:159], v[176:191]
    ds_read_b128 v[204:207], v243 offset:7664
    v_exp_f32 v117, v117
    v_exp_f32 v118, v118
    v_cvt_pk_bf16_f32 v145, v114, v115
    v_mfma_f32_32x32x16_bf16 v[128:143], v[196:199], v[100:103], v[128:143]
    v_exp_f32 v119, v119
    v_exp_f32 v120, v120
    v_cvt_pk_bf16_f32 v146, v116, v117
    v_cvt_pk_bf16_f32 v147, v118, v119
    v_mfma_f32_32x32x16_bf16 v[16:31], a[32:35], a[20:23], v[16:31]
    ds_read_b128 v[220:223], v225 offset:13696
    v_exp_f32 v121, v121
    v_exp_f32 v122, v122
    v_exp_f32 v123, v123
    v_mfma_f32_32x32x16_bf16 v[160:175], v[208:211], v[144:147], v[160:175]
    ds_read_b128 v[196:199], v224 offset:3072
    v_exp_f32 v124, v124
    v_exp_f32 v125, v125
    v_cvt_pk_bf16_f32 v148, v120, v121
    v_mfma_f32_32x32x16_bf16 v[32:47], a[36:39], a[20:23], v[32:47]
    v_exp_f32 v126, v126
    v_exp_f32 v127, v127
    v_cvt_pk_bf16_f32 v149, v122, v123
    v_cvt_pk_bf16_f32 v150, v124, v125
    v_mfma_f32_32x32x16_bf16 v[48:63], a[28:31], a[24:27], v[48:63]
    global_load_dwordx4 a[20:23], v226, s[12:13] offset:-2048 sc1
    v_exp_f32 v128, v128
    v_exp_f32 v129, v129
    v_cvt_pk_bf16_f32 v151, v126, v127
    v_mfma_f32_32x32x8_bf16 v[112:127], v[218:219], v[104:105], 0
    v_exp_f32 v130, v130
    v_exp_f32 v131, v131
    v_exp_f32 v132, v132
    v_cvt_pk_bf16_f32 v152, v128, v129
    v_mfma_f32_32x32x16_bf16 v[160:175], v[212:215], v[148:151], v[160:175]
    global_load_dwordx4 a[28:31], v226, s[14:15] offset:-1024 sc1
    v_exp_f32 v133, v133
    v_exp_f32 v134, v134
    v_cvt_pk_bf16_f32 v153, v130, v131
    v_mfma_f32_32x32x16_bf16 v[112:127], v[192:195], v[96:99], v[112:127]
    v_exp_f32 v135, v135
    v_exp_f32 v136, v136
    v_cvt_pk_bf16_f32 v154, v132, v133
    v_cvt_pk_bf16_f32 v155, v134, v135
    v_mfma_f32_32x32x16_bf16 v[64:79], a[32:35], a[24:27], v[64:79]
    v_exp_f32 v137, v137
    v_exp_f32 v138, v138
    v_exp_f32 v139, v139
    v_mfma_f32_32x32x16_bf16 v[176:191], v[208:211], v[152:155], v[176:191]
    global_load_dwordx4 a[32:35], v226, s[14:15] offset:0 sc1
    v_exp_f32 v140, v140
    v_exp_f32 v141, v141
    v_cvt_pk_bf16_f32 v156, v136, v137
    v_mfma_f32_32x32x16_bf16 v[80:95], a[36:39], a[24:27], v[80:95]
    global_load_dwordx4 a[36:39], v226, s[14:15] offset:1024 sc1
    global_load_dwordx4 a[24:27], v226, s[12:13] offset:-1024 sc1
    s_waitcnt vmcnt(15) lgkmcnt(0)
    v_exp_f32 v142, v142
    v_exp_f32 v143, v143
    v_cvt_pk_bf16_f32 v157, v138, v139
    v_cvt_pk_bf16_f32 v158, v140, v141
    v_mfma_f32_32x32x16_bf16 v[0:15], a[48:51], a[40:43], v[0:15]
    ds_read_b128 v[208:211], v243 offset:8272
    v_exp_f32 v112, v112
    v_exp_f32 v113, v113
    v_cvt_pk_bf16_f32 v159, v142, v143
    v_mfma_f32_32x32x8_bf16 v[128:143], v[218:219], v[108:109], 0
    v_exp_f32 v114, v114
    v_exp_f32 v115, v115
    v_exp_f32 v116, v116
    v_cvt_pk_bf16_f32 v144, v112, v113
    v_mfma_f32_32x32x16_bf16 v[176:191], v[212:215], v[156:159], v[176:191]
    ds_read_b128 v[212:215], v243 offset:8880
    v_exp_f32 v117, v117
    v_exp_f32 v118, v118
    v_cvt_pk_bf16_f32 v145, v114, v115
    v_mfma_f32_32x32x16_bf16 v[128:143], v[192:195], v[100:103], v[128:143]
    v_exp_f32 v119, v119
    v_exp_f32 v120, v120
    v_cvt_pk_bf16_f32 v146, v116, v117
    v_cvt_pk_bf16_f32 v147, v118, v119
    v_mfma_f32_32x32x16_bf16 v[16:31], a[52:55], a[40:43], v[16:31]
    v_exp_f32 v121, v121
    v_exp_f32 v122, v122
    v_exp_f32 v123, v123
    v_mfma_f32_32x32x16_bf16 v[160:175], v[200:203], v[144:147], v[160:175]
    ds_read_b128 v[192:195], v224 offset:9600
    v_exp_f32 v124, v124
    v_exp_f32 v125, v125
    v_cvt_pk_bf16_f32 v148, v120, v121
    v_mfma_f32_32x32x16_bf16 v[32:47], a[56:59], a[40:43], v[32:47]
    v_exp_f32 v126, v126
    v_exp_f32 v127, v127
    v_cvt_pk_bf16_f32 v149, v122, v123
    v_cvt_pk_bf16_f32 v150, v124, v125
    v_mfma_f32_32x32x16_bf16 v[48:63], a[48:51], a[44:47], v[48:63]
    global_load_dwordx4 a[40:43], v226, s[12:13] offset:0 sc1
    v_exp_f32 v128, v128
    v_exp_f32 v129, v129
    v_cvt_pk_bf16_f32 v151, v126, v127
    v_mfma_f32_32x32x8_bf16 v[112:127], v[218:219], v[106:107], 0
    v_exp_f32 v130, v130
    v_exp_f32 v131, v131
    v_exp_f32 v132, v132
    v_cvt_pk_bf16_f32 v152, v128, v129
    v_mfma_f32_32x32x16_bf16 v[160:175], v[204:207], v[148:151], v[160:175]
    global_load_dwordx4 a[48:51], v226, s[14:15] offset:2048 sc1
    v_exp_f32 v133, v133
    v_exp_f32 v134, v134
    v_cvt_pk_bf16_f32 v153, v130, v131
    v_mfma_f32_32x32x16_bf16 v[112:127], v[196:199], v[96:99], v[112:127]
    v_exp_f32 v135, v135
    v_exp_f32 v136, v136
    v_cvt_pk_bf16_f32 v154, v132, v133
    v_cvt_pk_bf16_f32 v155, v134, v135
    v_mfma_f32_32x32x16_bf16 v[64:79], a[52:55], a[44:47], v[64:79]
    v_exp_f32 v137, v137
    v_exp_f32 v138, v138
    v_exp_f32 v139, v139
    v_mfma_f32_32x32x16_bf16 v[176:191], v[200:203], v[152:155], v[176:191]
    global_load_dwordx4 a[52:55], v226, s[14:15] offset:3072 sc1
    v_exp_f32 v140, v140
    v_exp_f32 v141, v141
    v_cvt_pk_bf16_f32 v156, v136, v137
    v_mfma_f32_32x32x16_bf16 v[80:95], a[56:59], a[44:47], v[80:95]
    global_load_dwordx4 a[56:59], v227, s[14:15] offset:-4096 sc1
    global_load_dwordx4 a[44:47], v226, s[12:13] offset:1024 sc1
    s_waitcnt vmcnt(15) lgkmcnt(0)
    v_exp_f32 v142, v142
    v_exp_f32 v143, v143
    v_cvt_pk_bf16_f32 v157, v138, v139
    v_cvt_pk_bf16_f32 v158, v140, v141
    v_mfma_f32_32x32x16_bf16 v[0:15], a[68:71], a[60:63], v[0:15]
    ds_read_b128 v[200:203], v243 offset:14224
    v_exp_f32 v112, v112
    v_exp_f32 v113, v113
    v_cvt_pk_bf16_f32 v159, v142, v143
    v_mfma_f32_32x32x8_bf16 v[128:143], v[218:219], v[110:111], 0
    v_exp_f32 v114, v114
    v_exp_f32 v115, v115
    v_exp_f32 v116, v116
    v_cvt_pk_bf16_f32 v144, v112, v113
    v_mfma_f32_32x32x16_bf16 v[176:191], v[204:207], v[156:159], v[176:191]
    ds_read_b128 v[204:207], v243 offset:14832
    v_exp_f32 v117, v117
    v_exp_f32 v118, v118
    v_cvt_pk_bf16_f32 v145, v114, v115
    v_mfma_f32_32x32x16_bf16 v[128:143], v[196:199], v[100:103], v[128:143]
    v_exp_f32 v119, v119
    v_exp_f32 v120, v120
    v_cvt_pk_bf16_f32 v146, v116, v117
    v_cvt_pk_bf16_f32 v147, v118, v119
    v_mfma_f32_32x32x16_bf16 v[16:31], a[72:75], a[60:63], v[16:31]
    v_exp_f32 v121, v121
    v_exp_f32 v122, v122
    v_exp_f32 v123, v123
    v_mfma_f32_32x32x16_bf16 v[160:175], v[208:211], v[144:147], v[160:175]
    ds_read_b128 v[196:199], v224 offset:10624
    v_exp_f32 v124, v124
    v_exp_f32 v125, v125
    v_cvt_pk_bf16_f32 v148, v120, v121
    v_mfma_f32_32x32x16_bf16 v[32:47], a[76:79], a[60:63], v[32:47]
    v_exp_f32 v126, v126
    v_exp_f32 v127, v127
    v_cvt_pk_bf16_f32 v149, v122, v123
    v_cvt_pk_bf16_f32 v150, v124, v125
    v_mfma_f32_32x32x16_bf16 v[48:63], a[68:71], a[64:67], v[48:63]
    global_load_dwordx4 a[60:63], v226, s[12:13] offset:2048 sc1
    v_exp_f32 v128, v128
    v_exp_f32 v129, v129
    v_cvt_pk_bf16_f32 v151, v126, v127
    v_mfma_f32_32x32x8_bf16 v[112:127], v[220:221], v[104:105], 0
    v_exp_f32 v130, v130
    v_exp_f32 v131, v131
    v_exp_f32 v132, v132
    v_cvt_pk_bf16_f32 v152, v128, v129
    v_mfma_f32_32x32x16_bf16 v[160:175], v[212:215], v[148:151], v[160:175]
    global_load_dwordx4 a[68:71], v227, s[14:15] offset:-3072 sc1
    v_exp_f32 v133, v133
    v_exp_f32 v134, v134
    v_cvt_pk_bf16_f32 v153, v130, v131
    v_mfma_f32_32x32x16_bf16 v[112:127], v[192:195], v[96:99], v[112:127]
    v_exp_f32 v135, v135
    v_exp_f32 v136, v136
    v_cvt_pk_bf16_f32 v154, v132, v133
    v_cvt_pk_bf16_f32 v155, v134, v135
    v_mfma_f32_32x32x16_bf16 v[64:79], a[72:75], a[64:67], v[64:79]
    v_exp_f32 v137, v137
    v_exp_f32 v138, v138
    v_exp_f32 v139, v139
    v_mfma_f32_32x32x16_bf16 v[176:191], v[208:211], v[152:155], v[176:191]
    global_load_dwordx4 a[72:75], v227, s[14:15] offset:-2048 sc1
    v_exp_f32 v140, v140
    v_exp_f32 v141, v141
    v_cvt_pk_bf16_f32 v156, v136, v137
    v_mfma_f32_32x32x16_bf16 v[80:95], a[76:79], a[64:67], v[80:95]
    global_load_dwordx4 a[76:79], v227, s[14:15] offset:-1024 sc1
    global_load_dwordx4 a[64:67], v226, s[12:13] offset:3072 sc1
    s_waitcnt vmcnt(15) lgkmcnt(0)
    v_exp_f32 v142, v142
    v_exp_f32 v143, v143
    v_cvt_pk_bf16_f32 v157, v138, v139
    v_cvt_pk_bf16_f32 v158, v140, v141
    v_mfma_f32_32x32x16_bf16 v[0:15], a[8:11], a[0:3], v[0:15]
    ds_read_b128 v[208:211], v243 offset:15440
    v_exp_f32 v112, v112
    v_exp_f32 v113, v113
    v_cvt_pk_bf16_f32 v159, v142, v143
    v_mfma_f32_32x32x8_bf16 v[128:143], v[220:221], v[108:109], 0
    v_exp_f32 v114, v114
    v_exp_f32 v115, v115
    v_exp_f32 v116, v116
    v_cvt_pk_bf16_f32 v144, v112, v113
    v_mfma_f32_32x32x16_bf16 v[176:191], v[212:215], v[156:159], v[176:191]
    ds_read_b128 v[212:215], v243 offset:16048
    v_exp_f32 v117, v117
    v_exp_f32 v118, v118
    v_cvt_pk_bf16_f32 v145, v114, v115
    v_mfma_f32_32x32x16_bf16 v[128:143], v[192:195], v[100:103], v[128:143]
    v_exp_f32 v119, v119
    v_exp_f32 v120, v120
    v_cvt_pk_bf16_f32 v146, v116, v117
    v_cvt_pk_bf16_f32 v147, v118, v119
    v_mfma_f32_32x32x16_bf16 v[16:31], a[12:15], a[0:3], v[16:31]
    v_exp_f32 v121, v121
    v_exp_f32 v122, v122
    v_exp_f32 v123, v123
    v_mfma_f32_32x32x16_bf16 v[160:175], v[200:203], v[144:147], v[160:175]
    ds_read_b128 v[192:195], v224 offset:11648
    v_exp_f32 v124, v124
    v_exp_f32 v125, v125
    v_cvt_pk_bf16_f32 v148, v120, v121
    v_mfma_f32_32x32x16_bf16 v[32:47], a[16:19], a[0:3], v[32:47]
    v_exp_f32 v126, v126
    v_exp_f32 v127, v127
    v_cvt_pk_bf16_f32 v149, v122, v123
    v_cvt_pk_bf16_f32 v150, v124, v125
    v_mfma_f32_32x32x16_bf16 v[48:63], a[8:11], a[4:7], v[48:63]
    global_load_dwordx4 a[0:3], v227, s[12:13] offset:-4096 sc1
    v_exp_f32 v128, v128
    v_exp_f32 v129, v129
    v_cvt_pk_bf16_f32 v151, v126, v127
    v_mfma_f32_32x32x8_bf16 v[112:127], v[220:221], v[106:107], 0
    v_exp_f32 v130, v130
    v_exp_f32 v131, v131
    v_exp_f32 v132, v132
    v_cvt_pk_bf16_f32 v152, v128, v129
    v_mfma_f32_32x32x16_bf16 v[160:175], v[204:207], v[148:151], v[160:175]
    global_load_dwordx4 a[8:11], v227, s[14:15] offset:0 sc1
    v_exp_f32 v133, v133
    v_exp_f32 v134, v134
    v_cvt_pk_bf16_f32 v153, v130, v131
    v_mfma_f32_32x32x16_bf16 v[112:127], v[196:199], v[96:99], v[112:127]
    v_exp_f32 v135, v135
    v_exp_f32 v136, v136
    v_cvt_pk_bf16_f32 v154, v132, v133
    v_cvt_pk_bf16_f32 v155, v134, v135
    v_mfma_f32_32x32x16_bf16 v[64:79], a[12:15], a[4:7], v[64:79]
    v_exp_f32 v137, v137
    v_exp_f32 v138, v138
    v_exp_f32 v139, v139
    v_mfma_f32_32x32x16_bf16 v[176:191], v[200:203], v[152:155], v[176:191]
    global_load_dwordx4 a[12:15], v227, s[14:15] offset:1024 sc1
    v_exp_f32 v140, v140
    v_exp_f32 v141, v141
    v_cvt_pk_bf16_f32 v156, v136, v137
    v_mfma_f32_32x32x16_bf16 v[80:95], a[16:19], a[4:7], v[80:95]
    global_load_dwordx4 a[16:19], v227, s[14:15] offset:2048 sc1
    global_load_dwordx4 a[4:7], v227, s[12:13] offset:-3072 sc1
    s_waitcnt vmcnt(15) lgkmcnt(0)
    v_exp_f32 v142, v142
    v_exp_f32 v143, v143
    v_cvt_pk_bf16_f32 v157, v138, v139
    v_cvt_pk_bf16_f32 v158, v140, v141
    v_mfma_f32_32x32x16_bf16 v[0:15], a[28:31], a[20:23], v[0:15]
    ds_read_b128 v[200:203], v243 offset:16656
    v_exp_f32 v112, v112
    v_exp_f32 v113, v113
    v_cvt_pk_bf16_f32 v159, v142, v143
    v_mfma_f32_32x32x8_bf16 v[128:143], v[220:221], v[110:111], 0
    v_exp_f32 v114, v114
    v_exp_f32 v115, v115
    v_exp_f32 v116, v116
    v_cvt_pk_bf16_f32 v144, v112, v113
    v_mfma_f32_32x32x16_bf16 v[176:191], v[204:207], v[156:159], v[176:191]
    ds_read_b128 v[204:207], v243 offset:17264
    v_exp_f32 v117, v117
    v_exp_f32 v118, v118
    v_cvt_pk_bf16_f32 v145, v114, v115
    v_mfma_f32_32x32x16_bf16 v[128:143], v[196:199], v[100:103], v[128:143]
    v_exp_f32 v119, v119
    v_exp_f32 v120, v120
    v_cvt_pk_bf16_f32 v146, v116, v117
    v_cvt_pk_bf16_f32 v147, v118, v119
    v_mfma_f32_32x32x16_bf16 v[16:31], a[32:35], a[20:23], v[16:31]
    ds_read_b128 v[216:219], v225 offset:23296
    v_exp_f32 v121, v121
    v_exp_f32 v122, v122
    v_exp_f32 v123, v123
    v_mfma_f32_32x32x16_bf16 v[160:175], v[208:211], v[144:147], v[160:175]
    ds_read_b128 v[196:199], v224 offset:12672
    v_exp_f32 v124, v124
    v_exp_f32 v125, v125
    v_cvt_pk_bf16_f32 v148, v120, v121
    v_mfma_f32_32x32x16_bf16 v[32:47], a[36:39], a[20:23], v[32:47]
    v_exp_f32 v126, v126
    v_exp_f32 v127, v127
    v_cvt_pk_bf16_f32 v149, v122, v123
    v_cvt_pk_bf16_f32 v150, v124, v125
    v_mfma_f32_32x32x16_bf16 v[48:63], a[28:31], a[24:27], v[48:63]
    global_load_dwordx4 a[20:23], v227, s[12:13] offset:-2048 sc1
    v_exp_f32 v128, v128
    v_exp_f32 v129, v129
    v_cvt_pk_bf16_f32 v151, v126, v127
    v_mfma_f32_32x32x8_bf16 v[112:127], v[222:223], v[104:105], 0
    v_exp_f32 v130, v130
    v_exp_f32 v131, v131
    v_exp_f32 v132, v132
    v_cvt_pk_bf16_f32 v152, v128, v129
    v_mfma_f32_32x32x16_bf16 v[160:175], v[212:215], v[148:151], v[160:175]
    global_load_dwordx4 a[28:31], v227, s[14:15] offset:3072 sc1
    v_exp_f32 v133, v133
    v_exp_f32 v134, v134
    v_cvt_pk_bf16_f32 v153, v130, v131
    v_mfma_f32_32x32x16_bf16 v[112:127], v[192:195], v[96:99], v[112:127]
    v_exp_f32 v135, v135
    v_exp_f32 v136, v136
    v_cvt_pk_bf16_f32 v154, v132, v133
    v_cvt_pk_bf16_f32 v155, v134, v135
    v_mfma_f32_32x32x16_bf16 v[64:79], a[32:35], a[24:27], v[64:79]
    v_exp_f32 v137, v137
    v_exp_f32 v138, v138
    v_exp_f32 v139, v139
    v_mfma_f32_32x32x16_bf16 v[176:191], v[208:211], v[152:155], v[176:191]
    global_load_dwordx4 a[32:35], v228, s[14:15] offset:-4096 sc1
    v_exp_f32 v140, v140
    v_exp_f32 v141, v141
    v_cvt_pk_bf16_f32 v156, v136, v137
    v_mfma_f32_32x32x16_bf16 v[80:95], a[36:39], a[24:27], v[80:95]
    global_load_dwordx4 a[36:39], v228, s[14:15] offset:-3072 sc1
    global_load_dwordx4 a[24:27], v227, s[12:13] offset:-1024 sc1
    s_waitcnt vmcnt(15) lgkmcnt(0)
    v_exp_f32 v142, v142
    v_exp_f32 v143, v143
    v_cvt_pk_bf16_f32 v157, v138, v139
    v_cvt_pk_bf16_f32 v158, v140, v141
    v_mfma_f32_32x32x16_bf16 v[0:15], a[48:51], a[40:43], v[0:15]
    ds_read_b128 v[208:211], v243 offset:17872
    v_exp_f32 v112, v112
    v_exp_f32 v113, v113
    v_cvt_pk_bf16_f32 v159, v142, v143
    v_mfma_f32_32x32x8_bf16 v[128:143], v[222:223], v[108:109], 0
    v_exp_f32 v114, v114
    v_exp_f32 v115, v115
    v_exp_f32 v116, v116
    v_cvt_pk_bf16_f32 v144, v112, v113
    v_mfma_f32_32x32x16_bf16 v[176:191], v[212:215], v[156:159], v[176:191]
    ds_read_b128 v[212:215], v243 offset:18480
    v_exp_f32 v117, v117
    v_exp_f32 v118, v118
    v_cvt_pk_bf16_f32 v145, v114, v115
    v_mfma_f32_32x32x16_bf16 v[128:143], v[192:195], v[100:103], v[128:143]
    v_exp_f32 v119, v119
    v_exp_f32 v120, v120
    v_cvt_pk_bf16_f32 v146, v116, v117
    v_cvt_pk_bf16_f32 v147, v118, v119
    v_mfma_f32_32x32x16_bf16 v[16:31], a[52:55], a[40:43], v[16:31]
    v_exp_f32 v121, v121
    v_exp_f32 v122, v122
    v_exp_f32 v123, v123
    v_mfma_f32_32x32x16_bf16 v[160:175], v[200:203], v[144:147], v[160:175]
    ds_read_b128 v[192:195], v224 offset:19200
    v_exp_f32 v124, v124
    v_exp_f32 v125, v125
    v_cvt_pk_bf16_f32 v148, v120, v121
    v_mfma_f32_32x32x16_bf16 v[32:47], a[56:59], a[40:43], v[32:47]
    v_exp_f32 v126, v126
    v_exp_f32 v127, v127
    v_cvt_pk_bf16_f32 v149, v122, v123
    v_cvt_pk_bf16_f32 v150, v124, v125
    v_mfma_f32_32x32x16_bf16 v[48:63], a[48:51], a[44:47], v[48:63]
    global_load_dwordx4 a[40:43], v227, s[12:13] offset:0 sc1
    v_exp_f32 v128, v128
    v_exp_f32 v129, v129
    v_cvt_pk_bf16_f32 v151, v126, v127
    v_mfma_f32_32x32x8_bf16 v[112:127], v[222:223], v[106:107], 0
    v_exp_f32 v130, v130
    v_exp_f32 v131, v131
    v_exp_f32 v132, v132
    v_cvt_pk_bf16_f32 v152, v128, v129
    v_mfma_f32_32x32x16_bf16 v[160:175], v[204:207], v[148:151], v[160:175]
    global_load_dwordx4 a[48:51], v228, s[14:15] offset:-2048 sc1
    v_exp_f32 v133, v133
    v_exp_f32 v134, v134
    v_cvt_pk_bf16_f32 v153, v130, v131
    v_mfma_f32_32x32x16_bf16 v[112:127], v[196:199], v[96:99], v[112:127]
    v_exp_f32 v135, v135
    v_exp_f32 v136, v136
    v_cvt_pk_bf16_f32 v154, v132, v133
    v_cvt_pk_bf16_f32 v155, v134, v135
    v_mfma_f32_32x32x16_bf16 v[64:79], a[52:55], a[44:47], v[64:79]
    v_exp_f32 v137, v137
    v_exp_f32 v138, v138
    v_exp_f32 v139, v139
    v_mfma_f32_32x32x16_bf16 v[176:191], v[200:203], v[152:155], v[176:191]
    global_load_dwordx4 a[52:55], v228, s[14:15] offset:-1024 sc1
    v_exp_f32 v140, v140
    v_exp_f32 v141, v141
    v_cvt_pk_bf16_f32 v156, v136, v137
    v_mfma_f32_32x32x16_bf16 v[80:95], a[56:59], a[44:47], v[80:95]
    global_load_dwordx4 a[56:59], v228, s[14:15] offset:0 sc1
    global_load_dwordx4 a[44:47], v227, s[12:13] offset:1024 sc1
    s_waitcnt vmcnt(15) lgkmcnt(0)
    v_exp_f32 v142, v142
    v_exp_f32 v143, v143
    v_cvt_pk_bf16_f32 v157, v138, v139
    v_cvt_pk_bf16_f32 v158, v140, v141
    v_mfma_f32_32x32x16_bf16 v[0:15], a[68:71], a[60:63], v[0:15]
    ds_read_b128 v[200:203], v243 offset:23824
    v_exp_f32 v112, v112
    v_exp_f32 v113, v113
    v_cvt_pk_bf16_f32 v159, v142, v143
    v_mfma_f32_32x32x8_bf16 v[128:143], v[222:223], v[110:111], 0
    v_exp_f32 v114, v114
    v_exp_f32 v115, v115
    v_exp_f32 v116, v116
    v_cvt_pk_bf16_f32 v144, v112, v113
    v_mfma_f32_32x32x16_bf16 v[176:191], v[204:207], v[156:159], v[176:191]
    ds_read_b128 v[204:207], v243 offset:24432
    v_exp_f32 v117, v117
    v_exp_f32 v118, v118
    v_cvt_pk_bf16_f32 v145, v114, v115
    v_mfma_f32_32x32x16_bf16 v[128:143], v[196:199], v[100:103], v[128:143]
    v_exp_f32 v119, v119
    v_exp_f32 v120, v120
    v_cvt_pk_bf16_f32 v146, v116, v117
    v_cvt_pk_bf16_f32 v147, v118, v119
    v_mfma_f32_32x32x16_bf16 v[16:31], a[72:75], a[60:63], v[16:31]
    v_exp_f32 v121, v121
    v_exp_f32 v122, v122
    v_exp_f32 v123, v123
    v_mfma_f32_32x32x16_bf16 v[160:175], v[208:211], v[144:147], v[160:175]
    ds_read_b128 v[196:199], v224 offset:20224
    v_exp_f32 v124, v124
    v_exp_f32 v125, v125
    v_cvt_pk_bf16_f32 v148, v120, v121
    v_mfma_f32_32x32x16_bf16 v[32:47], a[76:79], a[60:63], v[32:47]
    v_exp_f32 v126, v126
    v_exp_f32 v127, v127
    v_cvt_pk_bf16_f32 v149, v122, v123
    v_cvt_pk_bf16_f32 v150, v124, v125
    v_mfma_f32_32x32x16_bf16 v[48:63], a[68:71], a[64:67], v[48:63]
    global_load_dwordx4 a[60:63], v227, s[12:13] offset:2048 sc1
    v_exp_f32 v128, v128
    v_exp_f32 v129, v129
    v_cvt_pk_bf16_f32 v151, v126, v127
    v_mfma_f32_32x32x8_bf16 v[112:127], v[216:217], v[104:105], 0
    v_exp_f32 v130, v130
    v_exp_f32 v131, v131
    v_exp_f32 v132, v132
    v_cvt_pk_bf16_f32 v152, v128, v129
    v_mfma_f32_32x32x16_bf16 v[160:175], v[212:215], v[148:151], v[160:175]
    global_load_dwordx4 a[68:71], v228, s[14:15] offset:1024 sc1
    v_exp_f32 v133, v133
    v_exp_f32 v134, v134
    v_cvt_pk_bf16_f32 v153, v130, v131
    v_mfma_f32_32x32x16_bf16 v[112:127], v[192:195], v[96:99], v[112:127]
    v_exp_f32 v135, v135
    v_exp_f32 v136, v136
    v_cvt_pk_bf16_f32 v154, v132, v133
    v_cvt_pk_bf16_f32 v155, v134, v135
    v_add_u32 v224, 19200, v224
    v_add_u32 v243, 19200, v243
    v_add_u32 v225, 19200, v225
    v_mfma_f32_32x32x16_bf16 v[64:79], a[72:75], a[64:67], v[64:79]
    v_exp_f32 v137, v137
    v_exp_f32 v138, v138
    v_exp_f32 v139, v139
    v_mfma_f32_32x32x16_bf16 v[176:191], v[208:211], v[152:155], v[176:191]
    global_load_dwordx4 a[72:75], v228, s[14:15] offset:2048 sc1
    v_exp_f32 v140, v140
    v_exp_f32 v141, v141
    v_cvt_pk_bf16_f32 v156, v136, v137
    v_mfma_f32_32x32x16_bf16 v[80:95], a[76:79], a[64:67], v[80:95]
    global_load_dwordx4 a[76:79], v228, s[14:15] offset:3072 sc1
    global_load_dwordx4 a[64:67], v227, s[12:13] offset:3072 sc1
    s_waitcnt vmcnt(15) lgkmcnt(0)
    v_exp_f32 v142, v142
    v_exp_f32 v143, v143
    v_cvt_pk_bf16_f32 v157, v138, v139
    v_cvt_pk_bf16_f32 v158, v140, v141
    s_add_u32 s12, s12, 16384
    s_addc_u32 s13, s13, 0
    s_add_u32 s14, s14, 24576
    s_addc_u32 s15, s15, 0
    s_sub_u32 s36, s36, 1
    s_cbranch_scc0 L_itM
    s_cmp_eq_u32 s37, 1
    s_cbranch_scc1 L_hchk
L_done:
    v_cvt_pk_bf16_f32 v159, v142, v143
    v_rcp_f32 v230, v170
    s_nop 0
    v_mfma_f32_32x32x16_bf16 v[176:191], v[212:215], v[156:159], v[176:191]
    v_mul_f32 v230, v230, v231
    v_mul_f32 v160, v160, v230
    v_mul_f32 v161, v161, v230
    s_cmp_eq_u32 s95, 3
    s_cbranch_scc1 L_helper_tail
    v_mfma_f32_32x32x16_bf16 v[0:15], a[88:91], a[80:83], v[0:15]
    v_mul_f32 v162, v162, v230
    v_mul_f32 v163, v163, v230
    v_mul_f32 v164, v164, v230
    v_mul_f32 v165, v165, v230
    v_mul_f32 v166, v166, v230
    v_mul_f32 v167, v167, v230
    v_mfma_f32_32x32x16_bf16 v[16:31], a[92:95], a[80:83], v[16:31]
    v_mul_f32 v168, v168, v230
    v_mul_f32 v169, v169, v230
    v_cvt_pk_bf16_f32 v192, v160, v161
    v_cvt_pk_bf16_f32 v193, v162, v163
    v_cvt_pk_bf16_f32 v194, v164, v165
    v_cvt_pk_bf16_f32 v195, v166, v167
    v_mfma_f32_32x32x16_bf16 v[32:47], a[96:99], a[80:83], v[32:47]
    v_cvt_pk_bf16_f32 v196, v168, v169
    s_mov_b32 s79, 0x5d800000
    v_add_f32 v247, v170, v186
    v_cmp_nlt_f32 vcc, v247, s79
    v_mfma_f32_32x32x16_bf16 v[48:63], a[88:91], a[84:87], v[48:63]
    s_cbranch_vccnz L_fallback
L_fb_ret:
    buffer_store_dwordx4 v[192:195], v233, s[44:47], s20 offen offset:0 sc1
    v_mfma_f32_32x32x16_bf16 v[64:79], a[92:95], a[84:87], v[64:79]
    v_rcp_f32 v230, v186
    s_nop 0
    v_mul_f32 v230, v230, v232
    v_mul_f32 v176, v176, v230
    v_mul_f32 v177, v177, v230
    v_mul_f32 v178, v178, v230
    v_mfma_f32_32x32x16_bf16 v[80:95], a[96:99], a[84:87], v[80:95]
    v_mul_f32 v179, v179, v230
    v_mul_f32 v180, v180, v230
    v_mul_f32 v181, v181, v230
    v_mul_f32 v182, v182, v230
    v_mul_f32 v183, v183, v230
    v_mul_f32 v184, v184, v230
    v_mfma_f32_32x32x16_bf16 v[0:15], a[108:111], a[100:103], v[0:15]
    v_mul_f32 v185, v185, v230
    v_cvt_pk_bf16_f32 v200, v176, v177
    v_cvt_pk_bf16_f32 v201, v178, v179
    v_cvt_pk_bf16_f32 v202, v180, v181
    v_cvt_pk_bf16_f32 v203, v182, v183
    v_cvt_pk_bf16_f32 v204, v184, v185
    v_mfma_f32_32x32x16_bf16 v[16:31], a[112:115], a[100:103], v[16:31]
    buffer_store_dwordx4 v[200:203], v233, s[44:47], s20 offen offset:1024 sc1
    s_nop 0
    v_permlane32_swap_b32 v196, v204
    buffer_store_dword v196, v250, s[44:47], s21 offen sc1
    v_mfma_f32_32x32x16_bf16 v[32:47], a[116:119], a[100:103], v[32:47]
    global_load_dwordx4 a[80:83], v226, s[12:13] offset:-4096 sc1
    s_lshl_b32 s76, s60, 11
    v_add_u32 v245, s76, v233
    v_add_u32 v246, 49152, v245
    v_mfma_f32_32x32x16_bf16 v[48:63], a[108:111], a[104:107], v[48:63]
    s_add_u32 s80, s4, s76
    s_lshl_b32 s76, s60, 13
    v_add_u32 v247, s76, v233
    v_mfma_f32_32x32x16_bf16 v[64:79], a[112:115], a[104:107], v[64:79]
    global_load_dwordx4 a[84:87], v226, s[12:13] offset:-3072 sc1
    v_add_u32 v248, 0x10000, v247
    v_and_b32 v249, s95, v241
    v_mul_u32_u24 v249, 24704, v249
    v_mfma_f32_32x32x16_bf16 v[80:95], a[116:119], a[104:107], v[80:95]
    v_add_u32 v249, 24576, v249
    s_mov_b32 s81, 0x10000
    s_add_u32 s78, s5, 36928
    v_mfma_f32_32x32x16_bf16 v[0:15], a[128:131], a[120:123], v[0:15]
    global_load_dwordx4 a[88:91], v226, s[14:15] offset:-4096 sc1
    s_movk_i32 s77, 128
    s_cmp_lt_u32 s60, 2
    s_cselect_b32 s77, s77, 36800
    s_cselect_b64 vcc, -1, 0
    v_mfma_f32_32x32x16_bf16 v[16:31], a[132:135], a[120:123], v[16:31]
    v_cndmask_b32 v234, v238, v235, vcc
    s_add_u32 s77, s77, s5
    v_mfma_f32_32x32x16_bf16 v[32:47], a[136:139], a[120:123], v[32:47]
    global_load_dwordx4 a[92:95], v226, s[14:15] offset:-3072 sc1
    s_add_u32 s79, s80, 24704
    s_cmp_eq_u32 s95, 0
    s_cselect_b32 s79, 1073741824, s79
    v_mfma_f32_32x32x16_bf16 v[48:63], a[128:131], a[124:127], v[48:63]
    s_barrier
    v_mfma_f32_32x32x16_bf16 v[64:79], a[132:135], a[124:127], v[64:79]
    global_load_dwordx4 a[96:99], v226, s[14:15] offset:-2048 sc1
    v_mfma_f32_32x32x16_bf16 v[80:95], a[136:139], a[124:127], v[80:95]
    v_lshrrev_b32 v236, 5, v241
    v_mul_u32_u24 v236, 896, v236
    v_add_u32 v236, v236, v250
    v_add_u32 v236, 0x4000, v236
    s_cmp_eq_u32 s95, 0
    s_cbranch_scc1 L_trail_even
    v_mfma_f32_32x32x16_bf16 v[0:15], a[8:11], a[0:3], v[0:15]
    global_load_dwordx4 a[100:103], v226, s[12:13] offset:-2048 sc1
    v_mfma_f32_32x32x16_bf16 v[16:31], a[12:15], a[0:3], v[16:31]
    v_mfma_f32_32x32x16_bf16 v[32:47], a[16:19], a[0:3], v[32:47]
    global_load_dwordx4 a[104:107], v226, s[12:13] offset:-1024 sc1
    v_mfma_f32_32x32x16_bf16 v[48:63], a[8:11], a[4:7], v[48:63]
    v_mfma_f32_32x32x16_bf16 v[64:79], a[12:15], a[4:7], v[64:79]
    global_load_dwordx4 a[108:111], v226, s[14:15] offset:-1024 sc1
    v_mfma_f32_32x32x16_bf16 v[80:95], a[16:19], a[4:7], v[80:95]
    s_waitcnt vmcnt(21)
    v_mfma_f32_32x32x16_bf16 v[0:15], a[28:31], a[20:23], v[0:15]
    global_load_dwordx4 a[112:115], v226, s[14:15] offset:0 sc1
    v_mfma_f32_32x32x16_bf16 v[16:31], a[32:35], a[20:23], v[16:31]
    v_mfma_f32_32x32x16_bf16 v[32:47], a[36:39], a[20:23], v[32:47]
    global_load_dwordx4 a[116:119], v226, s[14:15] offset:1024 sc1
    v_mfma_f32_32x32x16_bf16 v[48:63], a[28:31], a[24:27], v[48:63]
    v_mfma_f32_32x32x16_bf16 v[64:79], a[32:35], a[24:27], v[64:79]
    global_load_dwordx4 a[120:123], v226, s[12:13] offset:0 sc1
    v_mfma_f32_32x32x16_bf16 v[80:95], a[36:39], a[24:27], v[80:95]
    s_waitcnt vmcnt(19)
    v_mfma_f32_32x32x16_bf16 v[0:15], a[48:51], a[40:43], v[0:15]
    global_load_dwordx4 a[124:127], v226, s[12:13] offset:1024 sc1
    v_mfma_f32_32x32x16_bf16 v[16:31], a[52:55], a[40:43], v[16:31]
    v_mfma_f32_32x32x16_bf16 v[32:47], a[56:59], a[40:43], v[32:47]
    global_load_dwordx4 a[128:131], v226, s[14:15] offset:2048 sc1
    v_mfma_f32_32x32x16_bf16 v[48:63], a[48:51], a[44:47], v[48:63]
    v_mfma_f32_32x32x16_bf16 v[64:79], a[52:55], a[44:47], v[64:79]
    global_load_dwordx4 a[132:135], v226, s[14:15] offset:3072 sc1
    v_mfma_f32_32x32x16_bf16 v[80:95], a[56:59], a[44:47], v[80:95]
    s_waitcnt vmcnt(17)
    v_mfma_f32_32x32x16_bf16 v[0:15], a[68:71], a[60:63], v[0:15]
    global_load_dwordx4 a[136:139], v227, s[14:15] offset:-4096 sc1
    v_mfma_f32_32x32x16_bf16 v[16:31], a[72:75], a[60:63], v[16:31]
    v_mfma_f32_32x32x16_bf16 v[32:47], a[76:79], a[60:63], v[32:47]
    v_mfma_f32_32x32x16_bf16 v[48:63], a[68:71], a[64:67], v[48:63]
    v_mfma_f32_32x32x16_bf16 v[64:79], a[72:75], a[64:67], v[64:79]
    v_mfma_f32_32x32x16_bf16 v[80:95], a[76:79], a[64:67], v[80:95]
    s_waitcnt vmcnt(10)
    v_mfma_f32_32x32x16_bf16 v[0:15], a[88:91], a[80:83], v[0:15]
    s_waitcnt vmcnt(15)
    global_load_dwordx4 v[96:99], v226, s[16:17] offset:-4096 sc1
    v_mfma_f32_32x32x16_bf16 v[16:31], a[92:95], a[80:83], v[16:31]
    v_mfma_f32_32x32x16_bf16 v[32:47], a[96:99], a[80:83], v[32:47]
    global_load_dwordx4 v[100:103], v226, s[16:17] offset:-2048 sc1
    v_mfma_f32_32x32x16_bf16 v[48:63], a[88:91], a[84:87], v[48:63]
    v_mfma_f32_32x32x16_bf16 v[64:79], a[92:95], a[84:87], v[64:79]
    global_load_dwordx4 v[104:107], v226, s[16:17] offset:0 sc1
    v_mfma_f32_32x32x16_bf16 v[80:95], a[96:99], a[84:87], v[80:95]
    s_waitcnt vmcnt(8)
    v_mfma_f32_32x32x16_bf16 v[0:15], a[108:111], a[100:103], v[0:15]
    global_load_dwordx4 v[108:111], v226, s[16:17] offset:2048 sc1
    v_mfma_f32_32x32x16_bf16 v[16:31], a[112:115], a[100:103], v[16:31]
    v_mfma_f32_32x32x16_bf16 v[32:47], a[116:119], a[100:103], v[32:47]
    global_load_dwordx4 v[112:115], v227, s[16:17] offset:-4096 sc1
    v_mfma_f32_32x32x16_bf16 v[48:63], a[108:111], a[104:107], v[48:63]
    v_mfma_f32_32x32x16_bf16 v[64:79], a[112:115], a[104:107], v[64:79]
    global_load_dwordx4 v[116:119], v227, s[16:17] offset:-2048 sc1
    v_mfma_f32_32x32x16_bf16 v[80:95], a[116:119], a[104:107], v[80:95]
    s_waitcnt vmcnt(6)
    v_mfma_f32_32x32x16_bf16 v[0:15], a[128:131], a[120:123], v[0:15]
    global_load_dwordx4 v[120:123], v227, s[16:17] offset:0 sc1
    v_mfma_f32_32x32x16_bf16 v[16:31], a[132:135], a[120:123], v[16:31]
    v_mfma_f32_32x32x16_bf16 v[32:47], a[136:139], a[120:123], v[32:47]
    global_load_dwordx4 v[124:127], v227, s[16:17] offset:2048 sc1
    v_mfma_f32_32x32x16_bf16 v[48:63], a[128:131], a[124:127], v[48:63]
    v_mfma_f32_32x32x16_bf16 v[64:79], a[132:135], a[124:127], v[64:79]
    global_load_dword v128, v236, s[16:17] offset:0 sc1
    global_load_dword v129, v236, s[16:17] offset:256 sc1
    global_load_dword v130, v236, s[16:17] offset:512 sc1
    global_load_dword v131, v236, s[16:17] offset:768 sc1
    v_mfma_f32_32x32x16_bf16 v[80:95], a[136:139], a[124:127], v[80:95]
L_join:
    s_waitcnt vmcnt(9)
    v_max3_u32 v244, v96, v97, v98
    v_max3_u32 v244, v244, v99, v100
    v_max3_u32 v244, v244, v101, v102
    v_max3_u32 v244, v244, v103, v104
    v_max3_u32 v244, v244, v105, v106
    v_max_u32 v244, v244, v107
    v_cmp_eq_u32 vcc, -1, v244
    s_cbranch_vccnz L_ore0
L_ook0:
    v_mfma_f32_32x32x16_bf16 v[0:15], a[140:143], v[96:99], v[0:15]
    global_load_dwordx4 v[132:135], v226, s[16:17] offset:-3072 sc1
    v_mfma_f32_32x32x16_bf16 v[16:31], a[144:147], v[96:99], v[16:31]
    v_mfma_f32_32x32x16_bf16 v[0:15], a[152:155], v[100:103], v[0:15]
    global_load_dwordx4 v[136:139], v226, s[16:17] offset:-1024 sc1
    v_mfma_f32_32x32x16_bf16 v[16:31], a[156:159], v[100:103], v[16:31]
    s_waitcnt vmcnt(8)
    v_max3_u32 v244, v108, v109, v110
    v_max3_u32 v244, v244, v111, v112
    v_max3_u32 v244, v244, v113, v114
    v_mfma_f32_32x32x16_bf16 v[0:15], a[164:167], v[104:107], v[0:15]
    global_load_dwordx4 v[140:143], v226, s[16:17] offset:1024 sc1
    v_max3_u32 v244, v244, v115, v116
    v_max3_u32 v244, v244, v117, v118
    v_max_u32 v244, v244, v119
    v_cmp_eq_u32 vcc, -1, v244
    v_mfma_f32_32x32x16_bf16 v[16:31], a[168:171], v[104:107], v[16:31]
    s_cbranch_vccnz L_ore1
L_ook1:
    v_mfma_f32_32x32x16_bf16 v[0:15], a[176:179], v[108:111], v[0:15]
    global_load_dwordx4 v[144:147], v226, s[16:17] offset:3072 sc1
    v_mfma_f32_32x32x16_bf16 v[16:31], a[180:183], v[108:111], v[16:31]
    v_mfma_f32_32x32x16_bf16 v[0:15], a[188:191], v[112:115], v[0:15]
    global_load_dwordx4 v[148:151], v227, s[16:17] offset:-3072 sc1
    v_mfma_f32_32x32x16_bf16 v[16:31], a[192:195], v[112:115], v[16:31]
    s_waitcnt vmcnt(5)
    v_max3_u32 v244, v120, v121, v122
    v_max3_u32 v244, v244, v123, v124
    v_max3_u32 v244, v244, v125, v126
    v_mfma_f32_32x32x16_bf16 v[0:15], a[200:203], v[116:119], v[0:15]
    global_load_dwordx4 v[152:155], v227, s[16:17] offset:-1024 sc1
    v_max3_u32 v244, v244, v127, v128
    v_max3_u32 v244, v244, v129, v130
    v_max_u32 v244, v244, v131
    v_cmp_eq_u32 vcc, -1, v244
    v_mfma_f32_32x32x16_bf16 v[16:31], a[204:207], v[116:119], v[16:31]
    s_cbranch_vccnz L_ore2
L_ook2:
    v_mfma_f32_32x32x16_bf16 v[0:15], a[212:215], v[120:123], v[0:15]
    global_load_dwordx4 v[156:159], v227, s[16:17] offset:1024 sc1
    v_mfma_f32_32x32x16_bf16 v[16:31], a[216:219], v[120:123], v[16:31]
    v_mfma_f32_32x32x16_bf16 v[0:15], a[224:227], v[124:127], v[0:15]
    global_load_dwordx4 v[160:163], v227, s[16:17] offset:3072 sc1
    v_mfma_f32_32x32x16_bf16 v[16:31], a[228:231], v[124:127], v[16:31]
    v_mfma_f32_32x32x16_bf16 v[0:15], a[236:239], v[128:131], v[0:15]
    global_load_dword v164, v236, s[16:17] offset:128 sc1
    global_load_dword v165, v236, s[16:17] offset:384 sc1
    global_load_dword v166, v236, s[16:17] offset:640 sc1
    global_load_dword v167, v236, s[16:17] offset:896 sc1
    v_mfma_f32_32x32x16_bf16 v[16:31], a[240:243], v[128:131], v[16:31]
    s_nop 7
    v_mfma_f32_32x32x16_bf16 v[32:47], a[148:151], v[96:99], v[32:47]
    v_mfma_f32_32x32x16_bf16 v[32:47], a[160:163], v[100:103], v[32:47]
    v_mfma_f32_32x32x16_bf16 v[32:47], a[172:175], v[104:107], v[32:47]
    ds_write_b128 v245, v[0:3] offset:0
    v_mfma_f32_32x32x16_bf16 v[32:47], a[184:187], v[108:111], v[32:47]
    ds_write_b128 v245, v[4:7] offset:1024
    v_mfma_f32_32x32x16_bf16 v[32:47], a[196:199], v[112:115], v[32:47]
    v_mfma_f32_32x32x16_bf16 v[32:47], a[208:211], v[116:119], v[32:47]
    ds_write_b128 v245, v[8:11] offset:8192
    v_mfma_f32_32x32x16_bf16 v[32:47], a[220:223], v[120:123], v[32:47]
    ds_write_b128 v245, v[12:15] offset:9216
    s_waitcnt vmcnt(9)
    v_max3_u32 v244, v132, v133, v134
    v_max3_u32 v244, v244, v135, v136
    v_max3_u32 v244, v244, v137, v138
    v_mfma_f32_32x32x16_bf16 v[32:47], a[232:235], v[124:127], v[32:47]
    v_max3_u32 v244, v244, v139, v140
    v_max3_u32 v244, v244, v141, v142
    v_max_u32 v244, v244, v143
    v_cmp_eq_u32 vcc, -1, v244
    v_mfma_f32_32x32x16_bf16 v[32:47], a[244:247], v[128:131], v[32:47]
    ds_write_b128 v245, v[16:19] offset:16384
    s_cbranch_vccnz L_ore3
L_ook3:
    buffer_load_dword v251, v249, s[44:47], s4 offen sc1
    v_mfma_f32_32x32x16_bf16 v[48:63], a[140:143], v[132:135], v[48:63]
    ds_write_b128 v245, v[20:23] offset:17408
    s_waitcnt vmcnt(7)
    v_max3_u32 v244, v144, v145, v146
    v_max3_u32 v244, v244, v147, v148
    v_max3_u32 v244, v244, v149, v150
    v_mfma_f32_32x32x16_bf16 v[48:63], a[152:155], v[136:139], v[48:63]
    v_max3_u32 v244, v244, v151, v152
    v_max3_u32 v244, v244, v153, v154
    v_max_u32 v244, v244, v155
    v_cmp_eq_u32 vcc, -1, v244
    v_mfma_f32_32x32x16_bf16 v[48:63], a[164:167], v[140:143], v[48:63]
    ds_write_b128 v245, v[24:27] offset:24576
    s_cbranch_vccnz L_ore4
L_ook4:
    v_mfma_f32_32x32x16_bf16 v[48:63], a[176:179], v[144:147], v[48:63]
    ds_write_b128 v245, v[28:31] offset:25600
    s_waitcnt vmcnt(1)
    v_max3_u32 v244, v156, v157, v158
    v_max3_u32 v244, v244, v159, v160
    v_max3_u32 v244, v244, v161, v162
    v_mfma_f32_32x32x16_bf16 v[48:63], a[188:191], v[148:151], v[48:63]
    v_max3_u32 v244, v244, v163, v164
    v_max3_u32 v244, v244, v165, v166
    v_max_u32 v244, v244, v167
    v_cmp_eq_u32 vcc, -1, v244
    v_mfma_f32_32x32x16_bf16 v[48:63], a[200:203], v[152:155], v[48:63]
    ds_write_b128 v245, v[32:35] offset:32768
    s_cbranch_vccnz L_ore5
L_ook5:
    v_mfma_f32_32x32x16_bf16 v[48:63], a[212:215], v[156:159], v[48:63]
    s_waitcnt lgkmcnt(1)
    s_barrier
    v_mfma_f32_32x32x16_bf16 v[48:63], a[224:227], v[160:163], v[48:63]
    ds_write_b128 v245, v[36:39] offset:33792
    ds_read_b128 v[0:3], v247 offset:0
    ds_read_b128 v[4:7], v247 offset:1024
    ds_read_b128 v[8:11], v247 offset:2048
    ds_read_b128 v[12:15], v247 offset:3072
    v_mfma_f32_32x32x16_bf16 v[48:63], a[236:239], v[164:167], v[48:63]
    ds_read_b128 v[16:19], v247 offset:4096
    ds_read_b128 v[20:23], v247 offset:5120
    ds_read_b128 v[24:27], v247 offset:6144
    ds_read_b128 v[28:31], v247 offset:7168
    v_mfma_f32_32x32x16_bf16 v[64:79], a[144:147], v[132:135], v[64:79]
    ds_write_b128 v245, v[40:43] offset:40960
    v_mfma_f32_32x32x16_bf16 v[64:79], a[156:159], v[136:139], v[64:79]
    s_waitcnt lgkmcnt(1)
    v_add_f32 v0, v0, v8
    v_add_f32 v1, v1, v9
    v_add_f32 v2, v2, v10
    v_add_f32 v3, v3, v11
    v_mfma_f32_32x32x16_bf16 v[64:79], a[168:171], v[140:143], v[64:79]
    ds_write_b128 v245, v[44:47] offset:41984
    v_add_f32 v4, v4, v12
    v_add_f32 v5, v5, v13
    v_add_f32 v6, v6, v14
    v_add_f32 v7, v7, v15
    v_add_f32 v16, v16, v24
    v_mfma_f32_32x32x16_bf16 v[64:79], a[180:183], v[144:147], v[64:79]
    v_add_f32 v17, v17, v25
    v_add_f32 v18, v18, v26
    v_add_f32 v19, v19, v27
    v_add_f32 v20, v20, v28
    v_add_f32 v21, v21, v29
    v_mfma_f32_32x32x16_bf16 v[64:79], a[192:195], v[148:151], v[64:79]
    ds_write_b128 v246, v[48:51] offset:0
    v_add_f32 v22, v22, v30
    v_add_f32 v23, v23, v31
    v_add_f32 v0, v0, v16
    v_add_f32 v1, v1, v17
    v_add_f32 v2, v2, v18
    v_mfma_f32_32x32x16_bf16 v[64:79], a[204:207], v[152:155], v[64:79]
    ds_write_b128 v246, v[52:55] offset:1024
    v_add_f32 v3, v3, v19
    v_add_f32 v4, v4, v20
    v_add_f32 v5, v5, v21
    v_add_f32 v6, v6, v22
    v_add_f32 v7, v7, v23
    v_mfma_f32_32x32x16_bf16 v[64:79], a[216:219], v[156:159], v[64:79]
    s_waitcnt vmcnt(0)
    v_cmp_eq_u32 vcc, 0, v251
    v_mfma_f32_32x32x16_bf16 v[64:79], a[228:231], v[160:163], v[64:79]
    ds_write_b128 v246, v[56:59] offset:8192
    s_cbranch_vccnz L_pspin
L_pok:
    buffer_load_dwordx4 v[192:195], v233, s[44:47], s80 offen sc1
    buffer_load_dwordx4 v[204:207], v233, s[44:47], s79 offen sc1
    s_add_u32 s80, s80, 8192
    s_add_u32 s79, s79, 8192
    v_mfma_f32_32x32x16_bf16 v[64:79], a[240:243], v[164:167], v[64:79]
    ds_write_b128 v246, v[60:63] offset:9216
    v_mfma_f32_32x32x16_bf16 v[80:95], a[148:151], v[132:135], v[80:95]
    buffer_load_dwordx4 v[196:199], v233, s[44:47], s80 offen sc1
    buffer_load_dwordx4 v[208:211], v233, s[44:47], s79 offen sc1
    s_add_u32 s80, s80, 8192
    s_add_u32 s79, s79, 8192
    v_mfma_f32_32x32x16_bf16 v[80:95], a[160:163], v[136:139], v[80:95]
    buffer_load_dwordx4 v[200:203], v233, s[44:47], s80 offen sc1
    buffer_load_dwordx4 v[212:215], v233, s[44:47], s79 offen sc1
    v_mfma_f32_32x32x16_bf16 v[80:95], a[172:175], v[140:143], v[80:95]
    s_waitcnt lgkmcnt(0)
    s_barrier
    v_mfma_f32_32x32x16_bf16 v[80:95], a[184:187], v[144:147], v[80:95]
    ds_read_b128 v[32:35], v247 offset:32768
    ds_read_b128 v[36:39], v247 offset:33792
    ds_read_b128 v[40:43], v247 offset:34816
    ds_read_b128 v[44:47], v247 offset:35840
    v_mfma_f32_32x32x16_bf16 v[80:95], a[196:199], v[148:151], v[80:95]
    ds_write_b128 v246, v[64:67] offset:16384
    ds_read_b128 v[48:51], v247 offset:36864
    ds_read_b128 v[52:55], v247 offset:37888
    ds_read_b128 v[56:59], v247 offset:38912
    ds_read_b128 v[60:63], v247 offset:39936
    v_mfma_f32_32x32x16_bf16 v[80:95], a[208:211], v[152:155], v[80:95]
    ds_write_b128 v246, v[68:71] offset:17408
    v_mfma_f32_32x32x16_bf16 v[80:95], a[220:223], v[156:159], v[80:95]
    s_waitcnt lgkmcnt(1)
    v_add_f32 v32, v32, v40
    v_add_f32 v33, v33, v41
    v_add_f32 v34, v34, v42
    v_add_f32 v35, v35, v43
    v_mfma_f32_32x32x16_bf16 v[80:95], a[232:235], v[160:163], v[80:95]
    ds_write_b128 v246, v[72:75] offset:24576
    v_add_f32 v36, v36, v44
    v_add_f32 v37, v37, v45
    v_add_f32 v38, v38, v46
    v_add_f32 v39, v39, v47
    v_add_f32 v48, v48, v56
    v_mfma_f32_32x32x16_bf16 v[80:95], a[244:247], v[164:167], v[80:95]
    ds_write_b128 v246, v[76:79] offset:25600
    v_add_f32 v49, v49, v57
    v_add_f32 v50, v50, v58
    v_add_f32 v51, v51, v59
    v_add_f32 v52, v52, v60
    v_add_f32 v53, v53, v61
    v_add_f32 v54, v54, v62
    v_add_f32 v55, v55, v63
    v_add_f32 v32, v32, v48
    v_add_f32 v33, v33, v49
    v_add_f32 v34, v34, v50
    v_add_f32 v35, v35, v51
    v_add_f32 v36, v36, v52
    v_add_f32 v37, v37, v53
    v_add_f32 v38, v38, v54
    v_add_f32 v39, v39, v55
    ds_write_b128 v246, v[80:83] offset:32768
    ds_write_b128 v246, v[84:87] offset:33792
    ds_write_b128 v246, v[88:91] offset:40960
    ds_write_b128 v246, v[92:95] offset:41984
    s_mov_b32 s76, 0xffff0000
    s_waitcnt vmcnt(0)
    v_lshlrev_b32 v168, 16, v192
    v_and_b32 v169, s76, v192
    v_lshlrev_b32 v170, 16, v193
    v_and_b32 v171, s76, v193
    v_lshlrev_b32 v172, 16, v194
    v_and_b32 v173, s76, v194
    v_lshlrev_b32 v174, 16, v195
    v_and_b32 v175, s76, v195
    v_lshlrev_b32 v96, 16, v204
    v_and_b32 v97, s76, v204
    v_lshlrev_b32 v98, 16, v205
    v_and_b32 v99, s76, v205
    v_lshlrev_b32 v100, 16, v206
    v_and_b32 v101, s76, v206
    v_lshlrev_b32 v102, 16, v207
    v_and_b32 v103, s76, v207
    v_pk_add_f32 v[168:169], v[168:169], v[96:97]
    v_pk_add_f32 v[170:171], v[170:171], v[98:99]
    v_pk_add_f32 v[172:173], v[172:173], v[100:101]
    v_pk_add_f32 v[174:175], v[174:175], v[102:103]
    v_pk_add_f32 v[0:1], v[0:1], v[168:169]
    v_pk_add_f32 v[2:3], v[2:3], v[170:171]
    v_pk_add_f32 v[4:5], v[4:5], v[172:173]
    v_pk_add_f32 v[6:7], v[6:7], v[174:175]
    v_pk_mul_f32 v[0:1], v[0:1], v[234:235] op_sel:[0,1] op_sel_hi:[1,1]
    v_pk_mul_f32 v[2:3], v[2:3], v[234:235] op_sel:[0,1] op_sel_hi:[1,1]
    v_pk_mul_f32 v[4:5], v[4:5], v[234:235] op_sel:[0,1] op_sel_hi:[1,1]
    v_pk_mul_f32 v[6:7], v[6:7], v[234:235] op_sel:[0,1] op_sel_hi:[1,1]
    v_cvt_pk_bf16_f32 v16, v0, v1
    v_cvt_pk_bf16_f32 v17, v2, v3
    v_cvt_pk_bf16_f32 v18, v4, v5
    v_cvt_pk_bf16_f32 v19, v6, v7
    buffer_store_dwordx4 v[16:19], v242, s[24:27], s5 offen
    v_lshlrev_b32 v176, 16, v196
    v_and_b32 v177, s76, v196
    v_lshlrev_b32 v178, 16, v197
    v_and_b32 v179, s76, v197
    v_lshlrev_b32 v180, 16, v198
    v_and_b32 v181, s76, v198
    v_lshlrev_b32 v182, 16, v199
    v_and_b32 v183, s76, v199
    v_lshlrev_b32 v96, 16, v208
    v_and_b32 v97, s76, v208
    v_lshlrev_b32 v98, 16, v209
    v_and_b32 v99, s76, v209
    v_lshlrev_b32 v100, 16, v210
    v_and_b32 v101, s76, v210
    v_lshlrev_b32 v102, 16, v211
    v_and_b32 v103, s76, v211
    v_pk_add_f32 v[176:177], v[176:177], v[96:97]
    v_pk_add_f32 v[178:179], v[178:179], v[98:99]
    v_pk_add_f32 v[180:181], v[180:181], v[100:101]
    v_pk_add_f32 v[182:183], v[182:183], v[102:103]
    s_waitcnt lgkmcnt(0)
    s_barrier
    ds_read_b128 v[64:67], v248 offset:0
    ds_read_b128 v[68:71], v248 offset:1024
    ds_read_b128 v[72:75], v248 offset:2048
    ds_read_b128 v[76:79], v248 offset:3072
    ds_read_b128 v[80:83], v248 offset:4096
    ds_read_b128 v[84:87], v248 offset:5120
    ds_read_b128 v[88:91], v248 offset:6144
    ds_read_b128 v[92:95], v248 offset:7168
    v_pk_add_f32 v[32:33], v[32:33], v[176:177]
    v_pk_add_f32 v[34:35], v[34:35], v[178:179]
    v_pk_add_f32 v[36:37], v[36:37], v[180:181]
    v_pk_add_f32 v[38:39], v[38:39], v[182:183]
    v_pk_mul_f32 v[32:33], v[32:33], v[234:235] op_sel_hi:[1,0]
    v_pk_mul_f32 v[34:35], v[34:35], v[234:235] op_sel_hi:[1,0]
    v_pk_mul_f32 v[36:37], v[36:37], v[234:235] op_sel_hi:[1,0]
    v_pk_mul_f32 v[38:39], v[38:39], v[234:235] op_sel_hi:[1,0]
    v_cvt_pk_bf16_f32 v48, v32, v33
    v_cvt_pk_bf16_f32 v49, v34, v35
    v_cvt_pk_bf16_f32 v50, v36, v37
    v_cvt_pk_bf16_f32 v51, v38, v39
    buffer_store_dwordx4 v[48:51], v242, s[24:27], s77 offen
    v_lshlrev_b32 v184, 16, v200
    v_and_b32 v185, s76, v200
    v_lshlrev_b32 v186, 16, v201
    v_and_b32 v187, s76, v201
    v_lshlrev_b32 v188, 16, v202
    v_and_b32 v189, s76, v202
    v_lshlrev_b32 v190, 16, v203
    v_and_b32 v191, s76, v203
    v_lshlrev_b32 v96, 16, v212
    v_and_b32 v97, s76, v212
    v_lshlrev_b32 v98, 16, v213
    v_and_b32 v99, s76, v213
    v_lshlrev_b32 v100, 16, v214
    v_and_b32 v101, s76, v214
    v_lshlrev_b32 v102, 16, v215
    v_and_b32 v103, s76, v215
    v_pk_add_f32 v[184:185], v[184:185], v[96:97]
    v_pk_add_f32 v[186:187], v[186:187], v[98:99]
    v_pk_add_f32 v[188:189], v[188:189], v[100:101]
    v_pk_add_f32 v[190:191], v[190:191], v[102:103]
    s_waitcnt vmcnt(2) lgkmcnt(0)
    v_pk_add_f32 v[64:65], v[64:65], v[72:73]
    v_pk_add_f32 v[66:67], v[66:67], v[74:75]
    v_pk_add_f32 v[68:69], v[68:69], v[76:77]
    v_pk_add_f32 v[70:71], v[70:71], v[78:79]
    v_pk_add_f32 v[80:81], v[80:81], v[88:89]
    v_pk_add_f32 v[82:83], v[82:83], v[90:91]
    v_pk_add_f32 v[84:85], v[84:85], v[92:93]
    v_pk_add_f32 v[86:87], v[86:87], v[94:95]
    v_pk_add_f32 v[64:65], v[64:65], v[80:81]
    v_pk_add_f32 v[66:67], v[66:67], v[82:83]
    v_pk_add_f32 v[68:69], v[68:69], v[84:85]
    v_pk_add_f32 v[70:71], v[70:71], v[86:87]
    v_pk_add_f32 v[64:65], v[64:65], v[184:185]
    v_pk_add_f32 v[66:67], v[66:67], v[186:187]
    v_pk_add_f32 v[68:69], v[68:69], v[188:189]
    v_pk_add_f32 v[70:71], v[70:71], v[190:191]
    v_pk_mul_f32 v[64:65], v[64:65], v[238:239] op_sel_hi:[1,0]
    v_pk_mul_f32 v[66:67], v[66:67], v[238:239] op_sel_hi:[1,0]
    v_pk_mul_f32 v[68:69], v[68:69], v[238:239] op_sel_hi:[1,0]
    v_pk_mul_f32 v[70:71], v[70:71], v[238:239] op_sel_hi:[1,0]
    v_cvt_pk_bf16_f32 v80, v64, v65
    v_cvt_pk_bf16_f32 v81, v66, v67
    v_cvt_pk_bf16_f32 v82, v68, v69
    v_cvt_pk_bf16_f32 v83, v70, v71
    buffer_store_dwordx4 v[80:83], v242, s[24:27], s78 offen
L_fin:
L_end:
    s_endpgm
L_hchk:
    s_mov_b32 s37, 0
    s_mov_b32 s36, 4
    v_cmp_eq_u32 vcc, 0, v244
    s_cbranch_vccz L_itM
    s_mov_b32 s81, 0x40000
L_hspin:
    buffer_load_dword v244, v248, s[44:47], s74 offen sc1
    s_sub_u32 s81, s81, 1
    s_cbranch_scc1 L_itM
    s_waitcnt vmcnt(0)
    v_cmp_eq_u32 vcc, 0, v244
    s_cbranch_vccz L_itM
    s_sleep 8
    s_branch L_hspin
L_qspin:
    s_mov_b32 s81, 0x40000
L_qspin_l:
    buffer_load_dwordx4 v[244:247], v233, s[44:47], s74 offen sc1
    s_sub_u32 s81, s81, 1
    s_cbranch_scc1 L_qok
    s_waitcnt vmcnt(0)
    v_min3_u32 v244, v244, v245, v246
    v_min_u32 v244, v244, v247
    v_cmp_eq_u32 vcc, 0, v244
    s_cbranch_vccz L_qok
    s_sleep 16
    s_branch L_qspin_l
L_helper_tail:
    v_mul_f32 v162, v162, v230
    v_mul_f32 v163, v163, v230
    v_mul_f32 v164, v164, v230
    v_mul_f32 v165, v165, v230
    v_mul_f32 v166, v166, v230
    v_mul_f32 v167, v167, v230
    v_mul_f32 v168, v168, v230
    v_mul_f32 v169, v169, v230
    v_cvt_pk_bf16_f32 v192, v160, v161
    v_cvt_pk_bf16_f32 v193, v162, v163
    v_cvt_pk_bf16_f32 v194, v164, v165
    v_cvt_pk_bf16_f32 v195, v166, v167
    v_cvt_pk_bf16_f32 v196, v168, v169
    s_mov_b32 s79, 0x5d800000
    v_add_f32 v247, v170, v186
    v_cmp_nlt_f32 vcc, v247, s79
    s_cbranch_vccnz L_fallback
L_fb_ret_h:
    v_mfma_f32_32x32x16_bf16 v[0:15], a[8:11], a[0:3], v[0:15]
    buffer_store_dwordx4 v[192:195], v233, s[44:47], s20 offen offset:0 sc1
    v_rcp_f32 v230, v186
    s_nop 0
    v_mul_f32 v230, v230, v232
    v_mul_f32 v176, v176, v230
    v_mfma_f32_32x32x16_bf16 v[16:31], a[12:15], a[0:3], v[16:31]
    v_mul_f32 v177, v177, v230
    v_mul_f32 v178, v178, v230
    v_mul_f32 v179, v179, v230
    v_mul_f32 v180, v180, v230
    v_mul_f32 v181, v181, v230
    v_mfma_f32_32x32x16_bf16 v[32:47], a[16:19], a[0:3], v[32:47]
    v_mul_f32 v182, v182, v230
    v_mul_f32 v183, v183, v230
    v_mul_f32 v184, v184, v230
    v_mul_f32 v185, v185, v230
    v_cvt_pk_bf16_f32 v200, v176, v177
    v_mfma_f32_32x32x16_bf16 v[48:63], a[8:11], a[4:7], v[48:63]
    v_cvt_pk_bf16_f32 v201, v178, v179
    v_cvt_pk_bf16_f32 v202, v180, v181
    v_cvt_pk_bf16_f32 v203, v182, v183
    v_cvt_pk_bf16_f32 v204, v184, v185
    buffer_store_dwordx4 v[200:203], v233, s[44:47], s20 offen offset:1024 sc1
    v_mfma_f32_32x32x16_bf16 v[64:79], a[12:15], a[4:7], v[64:79]
    s_nop 0
    v_permlane32_swap_b32 v196, v204
    buffer_store_dword v196, v250, s[44:47], s21 offen sc1
    v_mfma_f32_32x32x16_bf16 v[80:95], a[16:19], a[4:7], v[80:95]
    s_waitcnt vmcnt(13)
    v_mfma_f32_32x32x16_bf16 v[0:15], a[28:31], a[20:23], v[0:15]
    v_mfma_f32_32x32x16_bf16 v[16:31], a[32:35], a[20:23], v[16:31]
    v_mfma_f32_32x32x16_bf16 v[32:47], a[36:39], a[20:23], v[32:47]
    v_mfma_f32_32x32x16_bf16 v[48:63], a[28:31], a[24:27], v[48:63]
    v_mfma_f32_32x32x16_bf16 v[64:79], a[32:35], a[24:27], v[64:79]
    v_mfma_f32_32x32x16_bf16 v[80:95], a[36:39], a[24:27], v[80:95]
    s_waitcnt vmcnt(8)
    v_mfma_f32_32x32x16_bf16 v[0:15], a[48:51], a[40:43], v[0:15]
    v_mfma_f32_32x32x16_bf16 v[16:31], a[52:55], a[40:43], v[16:31]
    v_mfma_f32_32x32x16_bf16 v[32:47], a[56:59], a[40:43], v[32:47]
    v_mfma_f32_32x32x16_bf16 v[48:63], a[48:51], a[44:47], v[48:63]
    v_mfma_f32_32x32x16_bf16 v[64:79], a[52:55], a[44:47], v[64:79]
    v_mfma_f32_32x32x16_bf16 v[80:95], a[56:59], a[44:47], v[80:95]
    s_waitcnt vmcnt(3)
    v_mfma_f32_32x32x16_bf16 v[0:15], a[68:71], a[60:63], v[0:15]
    v_mfma_f32_32x32x16_bf16 v[16:31], a[72:75], a[60:63], v[16:31]
    v_mfma_f32_32x32x16_bf16 v[32:47], a[76:79], a[60:63], v[32:47]
    v_mfma_f32_32x32x16_bf16 v[48:63], a[68:71], a[64:67], v[48:63]
    v_mfma_f32_32x32x16_bf16 v[64:79], a[72:75], a[64:67], v[64:79]
    v_mfma_f32_32x32x16_bf16 v[80:95], a[76:79], a[64:67], v[80:95]
    s_nop 6
    v_mov_b32 v249, 24576
    s_nop 0
    s_mov_b32 s80, s4
    s_nop 3
    v_cvt_pk_bf16_f32 v96, v0, v1
    v_cvt_pk_bf16_f32 v97, v2, v3
    v_cvt_pk_bf16_f32 v98, v4, v5
    v_cvt_pk_bf16_f32 v99, v6, v7
    buffer_store_dwordx4 v[96:99], v233, s[44:47], s80 offen offset:0 sc1
    v_cvt_pk_bf16_f32 v100, v8, v9
    v_cvt_pk_bf16_f32 v101, v10, v11
    v_cvt_pk_bf16_f32 v102, v12, v13
    v_cvt_pk_bf16_f32 v103, v14, v15
    buffer_store_dwordx4 v[100:103], v233, s[44:47], s80 offen offset:2048 sc1
    v_cvt_pk_bf16_f32 v104, v16, v17
    v_cvt_pk_bf16_f32 v105, v18, v19
    v_cvt_pk_bf16_f32 v106, v20, v21
    v_cvt_pk_bf16_f32 v107, v22, v23
    s_add_u32 s80, s80, 4096
    buffer_store_dwordx4 v[104:107], v233, s[44:47], s80 offen offset:0 sc1
    v_cvt_pk_bf16_f32 v108, v24, v25
    v_cvt_pk_bf16_f32 v109, v26, v27
    v_cvt_pk_bf16_f32 v110, v28, v29
    v_cvt_pk_bf16_f32 v111, v30, v31
    buffer_store_dwordx4 v[108:111], v233, s[44:47], s80 offen offset:2048 sc1
    v_cvt_pk_bf16_f32 v112, v32, v33
    v_cvt_pk_bf16_f32 v113, v34, v35
    v_cvt_pk_bf16_f32 v114, v36, v37
    v_cvt_pk_bf16_f32 v115, v38, v39
    s_add_u32 s80, s80, 4096
    buffer_store_dwordx4 v[112:115], v233, s[44:47], s80 offen offset:0 sc1
    v_cvt_pk_bf16_f32 v116, v40, v41
    v_cvt_pk_bf16_f32 v117, v42, v43
    v_cvt_pk_bf16_f32 v118, v44, v45
    v_cvt_pk_bf16_f32 v119, v46, v47
    buffer_store_dwordx4 v[116:119], v233, s[44:47], s80 offen offset:2048 sc1
    v_cvt_pk_bf16_f32 v120, v48, v49
    v_cvt_pk_bf16_f32 v121, v50, v51
    v_cvt_pk_bf16_f32 v122, v52, v53
    v_cvt_pk_bf16_f32 v123, v54, v55
    s_add_u32 s80, s80, 4096
    buffer_store_dwordx4 v[120:123], v233, s[44:47], s80 offen offset:0 sc1
    v_cvt_pk_bf16_f32 v124, v56, v57
    v_cvt_pk_bf16_f32 v125, v58, v59
    v_cvt_pk_bf16_f32 v126, v60, v61
    v_cvt_pk_bf16_f32 v127, v62, v63
    buffer_store_dwordx4 v[124:127], v233, s[44:47], s80 offen offset:2048 sc1
    v_cvt_pk_bf16_f32 v128, v64, v65
    v_cvt_pk_bf16_f32 v129, v66, v67
    v_cvt_pk_bf16_f32 v130, v68, v69
    v_cvt_pk_bf16_f32 v131, v70, v71
    s_add_u32 s80, s80, 4096
    buffer_store_dwordx4 v[128:131], v233, s[44:47], s80 offen offset:0 sc1
    v_cvt_pk_bf16_f32 v132, v72, v73
    v_cvt_pk_bf16_f32 v133, v74, v75
    v_cvt_pk_bf16_f32 v134, v76, v77
    v_cvt_pk_bf16_f32 v135, v78, v79
    buffer_store_dwordx4 v[132:135], v233, s[44:47], s80 offen offset:2048 sc1
    v_cvt_pk_bf16_f32 v136, v80, v81
    v_cvt_pk_bf16_f32 v137, v82, v83
    v_cvt_pk_bf16_f32 v138, v84, v85
    v_cvt_pk_bf16_f32 v139, v86, v87
    s_add_u32 s80, s80, 4096
    buffer_store_dwordx4 v[136:139], v233, s[44:47], s80 offen offset:0 sc1
    v_cvt_pk_bf16_f32 v140, v88, v89
    v_cvt_pk_bf16_f32 v141, v90, v91
    v_cvt_pk_bf16_f32 v142, v92, v93
    v_cvt_pk_bf16_f32 v143, v94, v95
    buffer_store_dwordx4 v[140:143], v233, s[44:47], s80 offen offset:2048 sc1
    s_waitcnt vmcnt(0)
    buffer_store_dword v240, v249, s[44:47], s4 offen sc1
    s_branch L_fin
L_pfspin:
    s_mov_b32 s81, 0x40000
L_pfspin_l:
    buffer_load_dword v244, v248, s[44:47], s74 offen sc1
    s_sub_u32 s81, s81, 1
    s_cbranch_scc1 L_itL
    s_waitcnt vmcnt(0)
    v_cmp_eq_u32 vcc, 0, v244
    s_cbranch_vccz L_itL
    s_sleep 8
    s_branch L_pfspin_l
L_pspin:
    s_sleep 2
    buffer_load_dword v251, v249, s[44:47], s4 offen sc1
    s_sub_u32 s81, s81, 1
    s_cbranch_scc1 L_pok
    s_waitcnt vmcnt(0)
    v_cmp_eq_u32 vcc, 0, v251
    s_cbranch_vccnz L_pspin
    s_branch L_pok
L_ore0:
    s_sleep 1
    global_load_dwordx4 v[96:99], v226, s[16:17] offset:-4096 sc1
    global_load_dwordx4 v[100:103], v226, s[16:17] offset:-2048 sc1
    global_load_dwordx4 v[104:107], v226, s[16:17] offset:0 sc1
    s_sub_u32 s81, s81, 1
    s_cbranch_scc1 L_fin
    s_waitcnt vmcnt(0)
    v_max3_u32 v244, v96, v97, v98
    v_max3_u32 v244, v244, v99, v100
    v_max3_u32 v244, v244, v101, v102
    v_max3_u32 v244, v244, v103, v104
    v_max3_u32 v244, v244, v105, v106
    v_max_u32 v244, v244, v107
    v_cmp_eq_u32 vcc, -1, v244
    s_cbranch_vccnz L_ore0
    global_load_dwordx4 v[108:111], v226, s[16:17] offset:2048 sc1
    global_load_dwordx4 v[112:115], v227, s[16:17] offset:-4096 sc1
    global_load_dwordx4 v[116:119], v227, s[16:17] offset:-2048 sc1
    global_load_dwordx4 v[120:123], v227, s[16:17] offset:0 sc1
    global_load_dwordx4 v[124:127], v227, s[16:17] offset:2048 sc1
    global_load_dword v128, v236, s[16:17] offset:0 sc1
    global_load_dword v129, v236, s[16:17] offset:256 sc1
    global_load_dword v130, v236, s[16:17] offset:512 sc1
    global_load_dword v131, v236, s[16:17] offset:768 sc1
    s_branch L_ook0
L_ore1:
    s_sleep 1
    global_load_dwordx4 v[108:111], v226, s[16:17] offset:2048 sc1
    global_load_dwordx4 v[112:115], v227, s[16:17] offset:-4096 sc1
    global_load_dwordx4 v[116:119], v227, s[16:17] offset:-2048 sc1
    s_sub_u32 s81, s81, 1
    s_cbranch_scc1 L_fin
    s_waitcnt vmcnt(0)
    v_max3_u32 v244, v108, v109, v110
    v_max3_u32 v244, v244, v111, v112
    v_max3_u32 v244, v244, v113, v114
    v_max3_u32 v244, v244, v115, v116
    v_max3_u32 v244, v244, v117, v118
    v_max_u32 v244, v244, v119
    v_cmp_eq_u32 vcc, -1, v244
    s_cbranch_vccnz L_ore1
    global_load_dwordx4 v[120:123], v227, s[16:17] offset:0 sc1
    global_load_dwordx4 v[124:127], v227, s[16:17] offset:2048 sc1
    global_load_dword v128, v236, s[16:17] offset:0 sc1
    global_load_dword v129, v236, s[16:17] offset:256 sc1
    global_load_dword v130, v236, s[16:17] offset:512 sc1
    global_load_dword v131, v236, s[16:17] offset:768 sc1
    global_load_dwordx4 v[132:135], v226, s[16:17] offset:-3072 sc1
    global_load_dwordx4 v[136:139], v226, s[16:17] offset:-1024 sc1
    global_load_dwordx4 v[140:143], v226, s[16:17] offset:1024 sc1
    s_branch L_ook1
L_ore2:
    s_sleep 1
    global_load_dwordx4 v[120:123], v227, s[16:17] offset:0 sc1
    global_load_dwordx4 v[124:127], v227, s[16:17] offset:2048 sc1
    global_load_dword v128, v236, s[16:17] offset:0 sc1
    global_load_dword v129, v236, s[16:17] offset:256 sc1
    global_load_dword v130, v236, s[16:17] offset:512 sc1
    global_load_dword v131, v236, s[16:17] offset:768 sc1
    s_sub_u32 s81, s81, 1
    s_cbranch_scc1 L_fin
    s_waitcnt vmcnt(0)
    v_max3_u32 v244, v120, v121, v122
    v_max3_u32 v244, v244, v123, v124
    v_max3_u32 v244, v244, v125, v126
    v_max3_u32 v244, v244, v127, v128
    v_max3_u32 v244, v244, v129, v130
    v_max_u32 v244, v244, v131
    v_cmp_eq_u32 vcc, -1, v244
    s_cbranch_vccnz L_ore2
    global_load_dwordx4 v[132:135], v226, s[16:17] offset:-3072 sc1
    global_load_dwordx4 v[136:139], v226, s[16:17] offset:-1024 sc1
    global_load_dwordx4 v[140:143], v226, s[16:17] offset:1024 sc1
    global_load_dwordx4 v[144:147], v226, s[16:17] offset:3072 sc1
    global_load_dwordx4 v[148:151], v227, s[16:17] offset:-3072 sc1
    global_load_dwordx4 v[152:155], v227, s[16:17] offset:-1024 sc1
    s_branch L_ook2
L_ore3:
    s_sleep 1
    global_load_dwordx4 v[132:135], v226, s[16:17] offset:-3072 sc1
    global_load_dwordx4 v[136:139], v226, s[16:17] offset:-1024 sc1
    global_load_dwordx4 v[140:143], v226, s[16:17] offset:1024 sc1
    s_sub_u32 s81, s81, 1
    s_cbranch_scc1 L_fin
    s_waitcnt vmcnt(0)
    v_max3_u32 v244, v132, v133, v134
    v_max3_u32 v244, v244, v135, v136
    v_max3_u32 v244, v244, v137, v138
    v_max3_u32 v244, v244, v139, v140
    v_max3_u32 v244, v244, v141, v142
    v_max_u32 v244, v244, v143
    v_cmp_eq_u32 vcc, -1, v244
    s_cbranch_vccnz L_ore3
    global_load_dwordx4 v[144:147], v226, s[16:17] offset:3072 sc1
    global_load_dwordx4 v[148:151], v227, s[16:17] offset:-3072 sc1
    global_load_dwordx4 v[152:155], v227, s[16:17] offset:-1024 sc1
    global_load_dwordx4 v[156:159], v227, s[16:17] offset:1024 sc1
    global_load_dwordx4 v[160:163], v227, s[16:17] offset:3072 sc1
    global_load_dword v164, v236, s[16:17] offset:128 sc1
    global_load_dword v165, v236, s[16:17] offset:384 sc1
    global_load_dword v166, v236, s[16:17] offset:640 sc1
    global_load_dword v167, v236, s[16:17] offset:896 sc1
    s_branch L_ook3
L_ore4:
    s_sleep 1
    global_load_dwordx4 v[144:147], v226, s[16:17] offset:3072 sc1
    global_load_dwordx4 v[148:151], v227, s[16:17] offset:-3072 sc1
    global_load_dwordx4 v[152:155], v227, s[16:17] offset:-1024 sc1
    s_sub_u32 s81, s81, 1
    s_cbranch_scc1 L_fin
    s_waitcnt vmcnt(0)
    v_max3_u32 v244, v144, v145, v146
    v_max3_u32 v244, v244, v147, v148
    v_max3_u32 v244, v244, v149, v150
    v_max3_u32 v244, v244, v151, v152
    v_max3_u32 v244, v244, v153, v154
    v_max_u32 v244, v244, v155
    v_cmp_eq_u32 vcc, -1, v244
    s_cbranch_vccnz L_ore4
    global_load_dwordx4 v[156:159], v227, s[16:17] offset:1024 sc1
    global_load_dwordx4 v[160:163], v227, s[16:17] offset:3072 sc1
    global_load_dword v164, v236, s[16:17] offset:128 sc1
    global_load_dword v165, v236, s[16:17] offset:384 sc1
    global_load_dword v166, v236, s[16:17] offset:640 sc1
    global_load_dword v167, v236, s[16:17] offset:896 sc1
    s_branch L_ook4
L_ore5:
    s_sleep 1
    global_load_dwordx4 v[156:159], v227, s[16:17] offset:1024 sc1
    global_load_dwordx4 v[160:163], v227, s[16:17] offset:3072 sc1
    global_load_dword v164, v236, s[16:17] offset:128 sc1
    global_load_dword v165, v236, s[16:17] offset:384 sc1
    global_load_dword v166, v236, s[16:17] offset:640 sc1
    global_load_dword v167, v236, s[16:17] offset:896 sc1
    s_sub_u32 s81, s81, 1
    s_cbranch_scc1 L_fin
    s_waitcnt vmcnt(0)
    v_max3_u32 v244, v156, v157, v158
    v_max3_u32 v244, v244, v159, v160
    v_max3_u32 v244, v244, v161, v162
    v_max3_u32 v244, v244, v163, v164
    v_max3_u32 v244, v244, v165, v166
    v_max_u32 v244, v244, v167
    v_cmp_eq_u32 vcc, -1, v244
    s_cbranch_vccnz L_ore5
    s_branch L_ook5
L_trail_even:
    v_mfma_f32_32x32x16_bf16 v[0:15], a[8:11], a[0:3], v[0:15]
    global_load_dwordx4 a[100:103], v226, s[12:13] offset:-2048 sc1
    v_mfma_f32_32x32x16_bf16 v[16:31], a[12:15], a[0:3], v[16:31]
    v_mfma_f32_32x32x16_bf16 v[32:47], a[16:19], a[0:3], v[32:47]
    global_load_dwordx4 a[104:107], v226, s[12:13] offset:-1024 sc1
    v_mfma_f32_32x32x16_bf16 v[48:63], a[8:11], a[4:7], v[48:63]
    global_load_dwordx4 a[108:111], v226, s[14:15] offset:-1024 sc1
    v_mfma_f32_32x32x16_bf16 v[64:79], a[12:15], a[4:7], v[64:79]
    global_load_dwordx4 a[112:115], v226, s[14:15] offset:0 sc1
    v_mfma_f32_32x32x16_bf16 v[80:95], a[16:19], a[4:7], v[80:95]
    s_waitcnt vmcnt(22)
    v_mfma_f32_32x32x16_bf16 v[0:15], a[28:31], a[20:23], v[0:15]
    global_load_dwordx4 a[116:119], v226, s[14:15] offset:1024 sc1
    v_mfma_f32_32x32x16_bf16 v[16:31], a[32:35], a[20:23], v[16:31]
    v_mfma_f32_32x32x16_bf16 v[32:47], a[36:39], a[20:23], v[32:47]
    global_load_dwordx4 a[120:123], v226, s[12:13] offset:0 sc1
    v_mfma_f32_32x32x16_bf16 v[48:63], a[28:31], a[24:27], v[48:63]
    global_load_dwordx4 a[124:127], v226, s[12:13] offset:1024 sc1
    v_mfma_f32_32x32x16_bf16 v[64:79], a[32:35], a[24:27], v[64:79]
    global_load_dwordx4 a[128:131], v226, s[14:15] offset:2048 sc1
    v_mfma_f32_32x32x16_bf16 v[80:95], a[36:39], a[24:27], v[80:95]
    s_waitcnt vmcnt(21)
    v_mfma_f32_32x32x16_bf16 v[0:15], a[48:51], a[40:43], v[0:15]
    global_load_dwordx4 a[132:135], v226, s[14:15] offset:3072 sc1
    v_mfma_f32_32x32x16_bf16 v[16:31], a[52:55], a[40:43], v[16:31]
    v_mfma_f32_32x32x16_bf16 v[32:47], a[56:59], a[40:43], v[32:47]
    global_load_dwordx4 a[136:139], v227, s[14:15] offset:-4096 sc1
    v_mfma_f32_32x32x16_bf16 v[48:63], a[48:51], a[44:47], v[48:63]
    global_load_dwordx4 a[0:3], v226, s[12:13] offset:2048 sc1
    v_mfma_f32_32x32x16_bf16 v[64:79], a[52:55], a[44:47], v[64:79]
    global_load_dwordx4 a[4:7], v226, s[12:13] offset:3072 sc1
    v_mfma_f32_32x32x16_bf16 v[80:95], a[56:59], a[44:47], v[80:95]
    s_waitcnt vmcnt(20)
    v_mfma_f32_32x32x16_bf16 v[0:15], a[68:71], a[60:63], v[0:15]
    global_load_dwordx4 a[8:11], v227, s[14:15] offset:-3072 sc1
    v_mfma_f32_32x32x16_bf16 v[16:31], a[72:75], a[60:63], v[16:31]
    v_mfma_f32_32x32x16_bf16 v[32:47], a[76:79], a[60:63], v[32:47]
    global_load_dwordx4 a[12:15], v227, s[14:15] offset:-2048 sc1
    v_mfma_f32_32x32x16_bf16 v[48:63], a[68:71], a[64:67], v[48:63]
    global_load_dwordx4 a[16:19], v227, s[14:15] offset:-1024 sc1
    v_mfma_f32_32x32x16_bf16 v[64:79], a[72:75], a[64:67], v[64:79]
    global_load_dwordx4 a[20:23], v227, s[12:13] offset:-4096 sc1
    v_mfma_f32_32x32x16_bf16 v[80:95], a[76:79], a[64:67], v[80:95]
    s_waitcnt vmcnt(16)
    v_mfma_f32_32x32x16_bf16 v[0:15], a[88:91], a[80:83], v[0:15]
    global_load_dwordx4 a[24:27], v227, s[12:13] offset:-3072 sc1
    v_mfma_f32_32x32x16_bf16 v[16:31], a[92:95], a[80:83], v[16:31]
    v_mfma_f32_32x32x16_bf16 v[32:47], a[96:99], a[80:83], v[32:47]
    global_load_dwordx4 a[28:31], v227, s[14:15] offset:0 sc1
    v_mfma_f32_32x32x16_bf16 v[48:63], a[88:91], a[84:87], v[48:63]
    global_load_dwordx4 a[32:35], v227, s[14:15] offset:1024 sc1
    v_mfma_f32_32x32x16_bf16 v[64:79], a[92:95], a[84:87], v[64:79]
    global_load_dwordx4 a[36:39], v227, s[14:15] offset:2048 sc1
    v_mfma_f32_32x32x16_bf16 v[80:95], a[96:99], a[84:87], v[80:95]
    s_waitcnt vmcnt(15)
    v_mfma_f32_32x32x16_bf16 v[0:15], a[108:111], a[100:103], v[0:15]
    global_load_dwordx4 a[40:43], v227, s[12:13] offset:-2048 sc1
    v_mfma_f32_32x32x16_bf16 v[16:31], a[112:115], a[100:103], v[16:31]
    v_mfma_f32_32x32x16_bf16 v[32:47], a[116:119], a[100:103], v[32:47]
    global_load_dwordx4 a[44:47], v227, s[12:13] offset:-1024 sc1
    v_mfma_f32_32x32x16_bf16 v[48:63], a[108:111], a[104:107], v[48:63]
    global_load_dwordx4 a[48:51], v227, s[14:15] offset:3072 sc1
    v_mfma_f32_32x32x16_bf16 v[64:79], a[112:115], a[104:107], v[64:79]
    global_load_dwordx4 a[52:55], v228, s[14:15] offset:-4096 sc1
    v_mfma_f32_32x32x16_bf16 v[80:95], a[116:119], a[104:107], v[80:95]
    s_waitcnt vmcnt(14)
    v_mfma_f32_32x32x16_bf16 v[0:15], a[128:131], a[120:123], v[0:15]
    global_load_dwordx4 a[56:59], v228, s[14:15] offset:-3072 sc1
    v_mfma_f32_32x32x16_bf16 v[16:31], a[132:135], a[120:123], v[16:31]
    v_mfma_f32_32x32x16_bf16 v[32:47], a[136:139], a[120:123], v[32:47]
    v_mfma_f32_32x32x16_bf16 v[48:63], a[128:131], a[124:127], v[48:63]
    v_mfma_f32_32x32x16_bf16 v[64:79], a[132:135], a[124:127], v[64:79]
    v_mfma_f32_32x32x16_bf16 v[80:95], a[136:139], a[124:127], v[80:95]
    s_waitcnt vmcnt(10)
    v_mfma_f32_32x32x16_bf16 v[0:15], a[8:11], a[0:3], v[0:15]
    s_waitcnt vmcnt(30)
    global_load_dwordx4 v[96:99], v226, s[16:17] offset:-4096 sc1
    v_mfma_f32_32x32x16_bf16 v[16:31], a[12:15], a[0:3], v[16:31]
    v_mfma_f32_32x32x16_bf16 v[32:47], a[16:19], a[0:3], v[32:47]
    global_load_dwordx4 v[100:103], v226, s[16:17] offset:-2048 sc1
    v_mfma_f32_32x32x16_bf16 v[48:63], a[8:11], a[4:7], v[48:63]
    v_mfma_f32_32x32x16_bf16 v[64:79], a[12:15], a[4:7], v[64:79]
    global_load_dwordx4 v[104:107], v226, s[16:17] offset:0 sc1
    v_mfma_f32_32x32x16_bf16 v[80:95], a[16:19], a[4:7], v[80:95]
    s_waitcnt vmcnt(8)
    v_mfma_f32_32x32x16_bf16 v[0:15], a[28:31], a[20:23], v[0:15]
    global_load_dwordx4 v[108:111], v226, s[16:17] offset:2048 sc1
    v_mfma_f32_32x32x16_bf16 v[16:31], a[32:35], a[20:23], v[16:31]
    v_mfma_f32_32x32x16_bf16 v[32:47], a[36:39], a[20:23], v[32:47]
    global_load_dwordx4 v[112:115], v227, s[16:17] offset:-4096 sc1
    v_mfma_f32_32x32x16_bf16 v[48:63], a[28:31], a[24:27], v[48:63]
    v_mfma_f32_32x32x16_bf16 v[64:79], a[32:35], a[24:27], v[64:79]
    global_load_dwordx4 v[116:119], v227, s[16:17] offset:-2048 sc1
    v_mfma_f32_32x32x16_bf16 v[80:95], a[36:39], a[24:27], v[80:95]
    s_waitcnt vmcnt(6)
    v_mfma_f32_32x32x16_bf16 v[0:15], a[48:51], a[40:43], v[0:15]
    global_load_dwordx4 v[120:123], v227, s[16:17] offset:0 sc1
    v_mfma_f32_32x32x16_bf16 v[16:31], a[52:55], a[40:43], v[16:31]
    v_mfma_f32_32x32x16_bf16 v[32:47], a[56:59], a[40:43], v[32:47]
    global_load_dwordx4 v[124:127], v227, s[16:17] offset:2048 sc1
    v_mfma_f32_32x32x16_bf16 v[48:63], a[48:51], a[44:47], v[48:63]
    v_mfma_f32_32x32x16_bf16 v[64:79], a[52:55], a[44:47], v[64:79]
    global_load_dword v128, v236, s[16:17] offset:0 sc1
    global_load_dword v129, v236, s[16:17] offset:256 sc1
    global_load_dword v130, v236, s[16:17] offset:512 sc1
    global_load_dword v131, v236, s[16:17] offset:768 sc1
    v_mfma_f32_32x32x16_bf16 v[80:95], a[56:59], a[44:47], v[80:95]
    s_branch L_join
L_fallback:
    v_cmp_gt_u32 vcc, 32, v241
    v_add_u32 v224, 0xfffda800, v224
    v_add_u32 v243, 0xfffda800, v243
    v_add_u32 v225, 0xfffda800, v225
    s_mov_b32 s76, 16
    v_cndmask_b32 v104, 0, v236, vcc
    v_mov_b32 v105, 0
    v_mov_b32 v106, 0
    v_cndmask_b32 v107, 0, v236, vcc
    v_mov_b32 v246, 0xff800000
    v_cndmask_b32 v108, 0, v237, vcc
    v_mov_b32 v109, 0
    v_mov_b32 v110, 0
    v_cndmask_b32 v111, 0, v237, vcc
    v_mov_b32 v247, 0xff800000
L_fbmax:
    ds_read_b128 v[216:219], v225 offset:4096
    ds_read_b128 v[192:195], v224 offset:0
    s_waitcnt lgkmcnt(0)
    v_mfma_f32_32x32x8_bf16 v[112:127], v[216:217], v[104:105], 0
    v_mfma_f32_32x32x8_bf16 v[128:143], v[216:217], v[108:109], 0
    s_nop 15
    v_mfma_f32_32x32x16_bf16 v[112:127], v[192:195], v[96:99], v[112:127]
    v_mfma_f32_32x32x16_bf16 v[128:143], v[192:195], v[100:103], v[128:143]
    s_nop 15
    v_max3_f32 v246, v246, v112, v113
    v_max3_f32 v246, v246, v114, v115
    v_max3_f32 v246, v246, v116, v117
    v_max3_f32 v246, v246, v118, v119
    v_max3_f32 v246, v246, v120, v121
    v_max3_f32 v246, v246, v122, v123
    v_max3_f32 v246, v246, v124, v125
    v_max3_f32 v246, v246, v126, v127
    v_max3_f32 v247, v247, v128, v129
    v_max3_f32 v247, v247, v130, v131
    v_max3_f32 v247, v247, v132, v133
    v_max3_f32 v247, v247, v134, v135
    v_max3_f32 v247, v247, v136, v137
    v_max3_f32 v247, v247, v138, v139
    v_max3_f32 v247, v247, v140, v141
    v_max3_f32 v247, v247, v142, v143
    ds_read_b128 v[196:199], v224 offset:1024
    s_waitcnt lgkmcnt(0)
    v_mfma_f32_32x32x8_bf16 v[112:127], v[216:217], v[106:107], 0
    v_mfma_f32_32x32x8_bf16 v[128:143], v[216:217], v[110:111], 0
    s_nop 15
    v_mfma_f32_32x32x16_bf16 v[112:127], v[196:199], v[96:99], v[112:127]
    v_mfma_f32_32x32x16_bf16 v[128:143], v[196:199], v[100:103], v[128:143]
    s_nop 15
    v_max3_f32 v246, v246, v112, v113
    v_max3_f32 v246, v246, v114, v115
    v_max3_f32 v246, v246, v116, v117
    v_max3_f32 v246, v246, v118, v119
    v_max3_f32 v246, v246, v120, v121
    v_max3_f32 v246, v246, v122, v123
    v_max3_f32 v246, v246, v124, v125
    v_max3_f32 v246, v246, v126, v127
    v_max3_f32 v247, v247, v128, v129
    v_max3_f32 v247, v247, v130, v131
    v_max3_f32 v247, v247, v132, v133
    v_max3_f32 v247, v247, v134, v135
    v_max3_f32 v247, v247, v136, v137
    v_max3_f32 v247, v247, v138, v139
    v_max3_f32 v247, v247, v140, v141
    v_max3_f32 v247, v247, v142, v143
    ds_read_b128 v[192:195], v224 offset:2048
    s_waitcnt lgkmcnt(0)
    v_mfma_f32_32x32x8_bf16 v[112:127], v[218:219], v[104:105], 0
    v_mfma_f32_32x32x8_bf16 v[128:143], v[218:219], v[108:109], 0
    s_nop 15
    v_mfma_f32_32x32x16_bf16 v[112:127], v[192:195], v[96:99], v[112:127]
    v_mfma_f32_32x32x16_bf16 v[128:143], v[192:195], v[100:103], v[128:143]
    s_nop 15
    v_max3_f32 v246, v246, v112, v113
    v_max3_f32 v246, v246, v114, v115
    v_max3_f32 v246, v246, v116, v117
    v_max3_f32 v246, v246, v118, v119
    v_max3_f32 v246, v246, v120, v121
    v_max3_f32 v246, v246, v122, v123
    v_max3_f32 v246, v246, v124, v125
    v_max3_f32 v246, v246, v126, v127
    v_max3_f32 v247, v247, v128, v129
    v_max3_f32 v247, v247, v130, v131
    v_max3_f32 v247, v247, v132, v133
    v_max3_f32 v247, v247, v134, v135
    v_max3_f32 v247, v247, v136, v137
    v_max3_f32 v247, v247, v138, v139
    v_max3_f32 v247, v247, v140, v141
    v_max3_f32 v247, v247, v142, v143
    ds_read_b128 v[196:199], v224 offset:3072
    s_waitcnt lgkmcnt(0)
    v_mfma_f32_32x32x8_bf16 v[112:127], v[218:219], v[106:107], 0
    v_mfma_f32_32x32x8_bf16 v[128:143], v[218:219], v[110:111], 0
    s_nop 15
    v_mfma_f32_32x32x16_bf16 v[112:127], v[196:199], v[96:99], v[112:127]
    v_mfma_f32_32x32x16_bf16 v[128:143], v[196:199], v[100:103], v[128:143]
    s_nop 15
    v_max3_f32 v246, v246, v112, v113
    v_max3_f32 v246, v246, v114, v115
    v_max3_f32 v246, v246, v116, v117
    v_max3_f32 v246, v246, v118, v119
    v_max3_f32 v246, v246, v120, v121
    v_max3_f32 v246, v246, v122, v123
    v_max3_f32 v246, v246, v124, v125
    v_max3_f32 v246, v246, v126, v127
    v_max3_f32 v247, v247, v128, v129
    v_max3_f32 v247, v247, v130, v131
    v_max3_f32 v247, v247, v132, v133
    v_max3_f32 v247, v247, v134, v135
    v_max3_f32 v247, v247, v136, v137
    v_max3_f32 v247, v247, v138, v139
    v_max3_f32 v247, v247, v140, v141
    v_max3_f32 v247, v247, v142, v143
    v_add_u32 v224, 9600, v224
    v_add_u32 v243, 9600, v243
    v_add_u32 v225, 9600, v225
    s_sub_u32 s76, s76, 1
    s_cmp_lg_u32 s76, 0
    s_cbranch_scc1 L_fbmax
    v_mov_b32 v244, v246
    s_nop 1
    v_permlane32_swap_b32 v246, v244
    s_nop 1
    v_max_f32 v246, v246, v244
    v_and_b32 v244, 0xffff0000, v246
    v_sub_f32 v245, v246, v244
    v_and_b32 v248, 0xffff0000, v245
    v_sub_f32 v245, v245, v248
    v_lshrrev_b32 v244, 16, v244
    v_or_b32 v244, v244, v248
    v_xor_b32 v244, 0x80008000, v244
    v_lshrrev_b32 v245, 16, v245
    v_xor_b32 v245, 0x8000, v245
    v_cndmask_b32 v104, v244, v236, vcc
    v_cndmask_b32 v105, v245, 0, vcc
    v_cndmask_b32 v106, v244, 0, vcc
    v_cndmask_b32 v107, v245, v236, vcc
    v_mov_b32 v244, v247
    s_nop 1
    v_permlane32_swap_b32 v247, v244
    s_nop 1
    v_max_f32 v247, v247, v244
    v_and_b32 v244, 0xffff0000, v247
    v_sub_f32 v245, v247, v244
    v_and_b32 v248, 0xffff0000, v245
    v_sub_f32 v245, v245, v248
    v_lshrrev_b32 v244, 16, v244
    v_or_b32 v244, v244, v248
    v_xor_b32 v244, 0x80008000, v244
    v_lshrrev_b32 v245, 16, v245
    v_xor_b32 v245, 0x8000, v245
    v_cndmask_b32 v108, v244, v237, vcc
    v_cndmask_b32 v109, v245, 0, vcc
    v_cndmask_b32 v110, v244, 0, vcc
    v_cndmask_b32 v111, v245, v237, vcc
    v_mov_b32 v160, 0
    v_mov_b32 v161, 0
    v_mov_b32 v162, 0
    v_mov_b32 v163, 0
    v_mov_b32 v164, 0
    v_mov_b32 v165, 0
    v_mov_b32 v166, 0
    v_mov_b32 v167, 0
    v_mov_b32 v168, 0
    v_mov_b32 v169, 0
    v_mov_b32 v170, 0
    v_mov_b32 v171, 0
    v_mov_b32 v172, 0
    v_mov_b32 v173, 0
    v_mov_b32 v174, 0
    v_mov_b32 v175, 0
    v_mov_b32 v176, 0
    v_mov_b32 v177, 0
    v_mov_b32 v178, 0
    v_mov_b32 v179, 0
    v_mov_b32 v180, 0
    v_mov_b32 v181, 0
    v_mov_b32 v182, 0
    v_mov_b32 v183, 0
    v_mov_b32 v184, 0
    v_mov_b32 v185, 0
    v_mov_b32 v186, 0
    v_mov_b32 v187, 0
    v_mov_b32 v188, 0
    v_mov_b32 v189, 0
    v_mov_b32 v190, 0
    v_mov_b32 v191, 0
    v_add_u32 v224, 0xfffda800, v224
    v_add_u32 v243, 0xfffda800, v243
    v_add_u32 v225, 0xfffda800, v225
    s_mov_b32 s76, 16
L_fbexp:
    ds_read_b128 v[216:219], v225 offset:4096
    ds_read_b128 v[192:195], v224 offset:0
    ds_read_b128 v[200:203], v243 offset:4624
    ds_read_b128 v[204:207], v243 offset:5232
    s_waitcnt lgkmcnt(0)
    v_mfma_f32_32x32x8_bf16 v[112:127], v[216:217], v[104:105], 0
    v_mfma_f32_32x32x8_bf16 v[128:143], v[216:217], v[108:109], 0
    s_nop 15
    v_mfma_f32_32x32x16_bf16 v[112:127], v[192:195], v[96:99], v[112:127]
    v_mfma_f32_32x32x16_bf16 v[128:143], v[192:195], v[100:103], v[128:143]
    s_nop 15
    v_exp_f32 v112, v112
    v_exp_f32 v113, v113
    v_exp_f32 v114, v114
    v_exp_f32 v115, v115
    v_exp_f32 v116, v116
    v_exp_f32 v117, v117
    v_exp_f32 v118, v118
    v_exp_f32 v119, v119
    v_exp_f32 v120, v120
    v_exp_f32 v121, v121
    v_exp_f32 v122, v122
    v_exp_f32 v123, v123
    v_exp_f32 v124, v124
    v_exp_f32 v125, v125
    v_exp_f32 v126, v126
    v_exp_f32 v127, v127
    s_nop 0
    v_cvt_pk_bf16_f32 v144, v112, v113
    v_cvt_pk_bf16_f32 v145, v114, v115
    v_cvt_pk_bf16_f32 v146, v116, v117
    v_cvt_pk_bf16_f32 v147, v118, v119
    v_cvt_pk_bf16_f32 v148, v120, v121
    v_cvt_pk_bf16_f32 v149, v122, v123
    v_cvt_pk_bf16_f32 v150, v124, v125
    v_cvt_pk_bf16_f32 v151, v126, v127
    s_nop 1
    v_mfma_f32_32x32x16_bf16 v[160:175], v[200:203], v[144:147], v[160:175]
    v_mfma_f32_32x32x16_bf16 v[160:175], v[204:207], v[148:151], v[160:175]
    v_exp_f32 v128, v128
    v_exp_f32 v129, v129
    v_exp_f32 v130, v130
    v_exp_f32 v131, v131
    v_exp_f32 v132, v132
    v_exp_f32 v133, v133
    v_exp_f32 v134, v134
    v_exp_f32 v135, v135
    v_exp_f32 v136, v136
    v_exp_f32 v137, v137
    v_exp_f32 v138, v138
    v_exp_f32 v139, v139
    v_exp_f32 v140, v140
    v_exp_f32 v141, v141
    v_exp_f32 v142, v142
    v_exp_f32 v143, v143
    s_nop 0
    v_cvt_pk_bf16_f32 v152, v128, v129
    v_cvt_pk_bf16_f32 v153, v130, v131
    v_cvt_pk_bf16_f32 v154, v132, v133
    v_cvt_pk_bf16_f32 v155, v134, v135
    v_cvt_pk_bf16_f32 v156, v136, v137
    v_cvt_pk_bf16_f32 v157, v138, v139
    v_cvt_pk_bf16_f32 v158, v140, v141
    v_cvt_pk_bf16_f32 v159, v142, v143
    s_nop 1
    v_mfma_f32_32x32x16_bf16 v[176:191], v[200:203], v[152:155], v[176:191]
    v_mfma_f32_32x32x16_bf16 v[176:191], v[204:207], v[156:159], v[176:191]
    ds_read_b128 v[196:199], v224 offset:1024
    ds_read_b128 v[208:211], v243 offset:5840
    ds_read_b128 v[212:215], v243 offset:6448
    s_waitcnt lgkmcnt(0)
    v_mfma_f32_32x32x8_bf16 v[112:127], v[216:217], v[106:107], 0
    v_mfma_f32_32x32x8_bf16 v[128:143], v[216:217], v[110:111], 0
    s_nop 15
    v_mfma_f32_32x32x16_bf16 v[112:127], v[196:199], v[96:99], v[112:127]
    v_mfma_f32_32x32x16_bf16 v[128:143], v[196:199], v[100:103], v[128:143]
    s_nop 15
    v_exp_f32 v112, v112
    v_exp_f32 v113, v113
    v_exp_f32 v114, v114
    v_exp_f32 v115, v115
    v_exp_f32 v116, v116
    v_exp_f32 v117, v117
    v_exp_f32 v118, v118
    v_exp_f32 v119, v119
    v_exp_f32 v120, v120
    v_exp_f32 v121, v121
    v_exp_f32 v122, v122
    v_exp_f32 v123, v123
    v_exp_f32 v124, v124
    v_exp_f32 v125, v125
    v_exp_f32 v126, v126
    v_exp_f32 v127, v127
    s_nop 0
    v_cvt_pk_bf16_f32 v144, v112, v113
    v_cvt_pk_bf16_f32 v145, v114, v115
    v_cvt_pk_bf16_f32 v146, v116, v117
    v_cvt_pk_bf16_f32 v147, v118, v119
    v_cvt_pk_bf16_f32 v148, v120, v121
    v_cvt_pk_bf16_f32 v149, v122, v123
    v_cvt_pk_bf16_f32 v150, v124, v125
    v_cvt_pk_bf16_f32 v151, v126, v127
    s_nop 1
    v_mfma_f32_32x32x16_bf16 v[160:175], v[208:211], v[144:147], v[160:175]
    v_mfma_f32_32x32x16_bf16 v[160:175], v[212:215], v[148:151], v[160:175]
    v_exp_f32 v128, v128
    v_exp_f32 v129, v129
    v_exp_f32 v130, v130
    v_exp_f32 v131, v131
    v_exp_f32 v132, v132
    v_exp_f32 v133, v133
    v_exp_f32 v134, v134
    v_exp_f32 v135, v135
    v_exp_f32 v136, v136
    v_exp_f32 v137, v137
    v_exp_f32 v138, v138
    v_exp_f32 v139, v139
    v_exp_f32 v140, v140
    v_exp_f32 v141, v141
    v_exp_f32 v142, v142
    v_exp_f32 v143, v143
    s_nop 0
    v_cvt_pk_bf16_f32 v152, v128, v129
    v_cvt_pk_bf16_f32 v153, v130, v131
    v_cvt_pk_bf16_f32 v154, v132, v133
    v_cvt_pk_bf16_f32 v155, v134, v135
    v_cvt_pk_bf16_f32 v156, v136, v137
    v_cvt_pk_bf16_f32 v157, v138, v139
    v_cvt_pk_bf16_f32 v158, v140, v141
    v_cvt_pk_bf16_f32 v159, v142, v143
    s_nop 1
    v_mfma_f32_32x32x16_bf16 v[176:191], v[208:211], v[152:155], v[176:191]
    v_mfma_f32_32x32x16_bf16 v[176:191], v[212:215], v[156:159], v[176:191]
    ds_read_b128 v[192:195], v224 offset:2048
    ds_read_b128 v[200:203], v243 offset:7056
    ds_read_b128 v[204:207], v243 offset:7664
    s_waitcnt lgkmcnt(0)
    v_mfma_f32_32x32x8_bf16 v[112:127], v[218:219], v[104:105], 0
    v_mfma_f32_32x32x8_bf16 v[128:143], v[218:219], v[108:109], 0
    s_nop 15
    v_mfma_f32_32x32x16_bf16 v[112:127], v[192:195], v[96:99], v[112:127]
    v_mfma_f32_32x32x16_bf16 v[128:143], v[192:195], v[100:103], v[128:143]
    s_nop 15
    v_exp_f32 v112, v112
    v_exp_f32 v113, v113
    v_exp_f32 v114, v114
    v_exp_f32 v115, v115
    v_exp_f32 v116, v116
    v_exp_f32 v117, v117
    v_exp_f32 v118, v118
    v_exp_f32 v119, v119
    v_exp_f32 v120, v120
    v_exp_f32 v121, v121
    v_exp_f32 v122, v122
    v_exp_f32 v123, v123
    v_exp_f32 v124, v124
    v_exp_f32 v125, v125
    v_exp_f32 v126, v126
    v_exp_f32 v127, v127
    s_nop 0
    v_cvt_pk_bf16_f32 v144, v112, v113
    v_cvt_pk_bf16_f32 v145, v114, v115
    v_cvt_pk_bf16_f32 v146, v116, v117
    v_cvt_pk_bf16_f32 v147, v118, v119
    v_cvt_pk_bf16_f32 v148, v120, v121
    v_cvt_pk_bf16_f32 v149, v122, v123
    v_cvt_pk_bf16_f32 v150, v124, v125
    v_cvt_pk_bf16_f32 v151, v126, v127
    s_nop 1
    v_mfma_f32_32x32x16_bf16 v[160:175], v[200:203], v[144:147], v[160:175]
    v_mfma_f32_32x32x16_bf16 v[160:175], v[204:207], v[148:151], v[160:175]
    v_exp_f32 v128, v128
    v_exp_f32 v129, v129
    v_exp_f32 v130, v130
    v_exp_f32 v131, v131
    v_exp_f32 v132, v132
    v_exp_f32 v133, v133
    v_exp_f32 v134, v134
    v_exp_f32 v135, v135
    v_exp_f32 v136, v136
    v_exp_f32 v137, v137
    v_exp_f32 v138, v138
    v_exp_f32 v139, v139
    v_exp_f32 v140, v140
    v_exp_f32 v141, v141
    v_exp_f32 v142, v142
    v_exp_f32 v143, v143
    s_nop 0
    v_cvt_pk_bf16_f32 v152, v128, v129
    v_cvt_pk_bf16_f32 v153, v130, v131
    v_cvt_pk_bf16_f32 v154, v132, v133
    v_cvt_pk_bf16_f32 v155, v134, v135
    v_cvt_pk_bf16_f32 v156, v136, v137
    v_cvt_pk_bf16_f32 v157, v138, v139
    v_cvt_pk_bf16_f32 v158, v140, v141
    v_cvt_pk_bf16_f32 v159, v142, v143
    s_nop 1
    v_mfma_f32_32x32x16_bf16 v[176:191], v[200:203], v[152:155], v[176:191]
    v_mfma_f32_32x32x16_bf16 v[176:191], v[204:207], v[156:159], v[176:191]
    ds_read_b128 v[196:199], v224 offset:3072
    ds_read_b128 v[208:211], v243 offset:8272
    ds_read_b128 v[212:215], v243 offset:8880
    s_waitcnt lgkmcnt(0)
    v_mfma_f32_32x32x8_bf16 v[112:127], v[218:219], v[106:107], 0
    v_mfma_f32_32x32x8_bf16 v[128:143], v[218:219], v[110:111], 0
    s_nop 15
    v_mfma_f32_32x32x16_bf16 v[112:127], v[196:199], v[96:99], v[112:127]
    v_mfma_f32_32x32x16_bf16 v[128:143], v[196:199], v[100:103], v[128:143]
    s_nop 15
    v_exp_f32 v112, v112
    v_exp_f32 v113, v113
    v_exp_f32 v114, v114
    v_exp_f32 v115, v115
    v_exp_f32 v116, v116
    v_exp_f32 v117, v117
    v_exp_f32 v118, v118
    v_exp_f32 v119, v119
    v_exp_f32 v120, v120
    v_exp_f32 v121, v121
    v_exp_f32 v122, v122
    v_exp_f32 v123, v123
    v_exp_f32 v124, v124
    v_exp_f32 v125, v125
    v_exp_f32 v126, v126
    v_exp_f32 v127, v127
    s_nop 0
    v_cvt_pk_bf16_f32 v144, v112, v113
    v_cvt_pk_bf16_f32 v145, v114, v115
    v_cvt_pk_bf16_f32 v146, v116, v117
    v_cvt_pk_bf16_f32 v147, v118, v119
    v_cvt_pk_bf16_f32 v148, v120, v121
    v_cvt_pk_bf16_f32 v149, v122, v123
    v_cvt_pk_bf16_f32 v150, v124, v125
    v_cvt_pk_bf16_f32 v151, v126, v127
    s_nop 1
    v_mfma_f32_32x32x16_bf16 v[160:175], v[208:211], v[144:147], v[160:175]
    v_mfma_f32_32x32x16_bf16 v[160:175], v[212:215], v[148:151], v[160:175]
    v_exp_f32 v128, v128
    v_exp_f32 v129, v129
    v_exp_f32 v130, v130
    v_exp_f32 v131, v131
    v_exp_f32 v132, v132
    v_exp_f32 v133, v133
    v_exp_f32 v134, v134
    v_exp_f32 v135, v135
    v_exp_f32 v136, v136
    v_exp_f32 v137, v137
    v_exp_f32 v138, v138
    v_exp_f32 v139, v139
    v_exp_f32 v140, v140
    v_exp_f32 v141, v141
    v_exp_f32 v142, v142
    v_exp_f32 v143, v143
    s_nop 0
    v_cvt_pk_bf16_f32 v152, v128, v129
    v_cvt_pk_bf16_f32 v153, v130, v131
    v_cvt_pk_bf16_f32 v154, v132, v133
    v_cvt_pk_bf16_f32 v155, v134, v135
    v_cvt_pk_bf16_f32 v156, v136, v137
    v_cvt_pk_bf16_f32 v157, v138, v139
    v_cvt_pk_bf16_f32 v158, v140, v141
    v_cvt_pk_bf16_f32 v159, v142, v143
    s_nop 1
    v_mfma_f32_32x32x16_bf16 v[176:191], v[208:211], v[152:155], v[176:191]
    v_mfma_f32_32x32x16_bf16 v[176:191], v[212:215], v[156:159], v[176:191]
    v_add_u32 v224, 9600, v224
    v_add_u32 v243, 9600, v243
    v_add_u32 v225, 9600, v225
    s_sub_u32 s76, s76, 1
    s_cmp_lg_u32 s76, 0
    s_cbranch_scc1 L_fbexp
    s_nop 15
    v_rcp_f32 v230, v170
    s_nop 0
    v_mul_f32 v230, v230, v231
    v_mul_f32 v160, v160, v230
    v_mul_f32 v161, v161, v230
    v_mul_f32 v162, v162, v230
    v_mul_f32 v163, v163, v230
    v_mul_f32 v164, v164, v230
    v_mul_f32 v165, v165, v230
    v_mul_f32 v166, v166, v230
    v_mul_f32 v167, v167, v230
    v_mul_f32 v168, v168, v230
    v_mul_f32 v169, v169, v230
    v_cvt_pk_bf16_f32 v192, v160, v161
    v_cvt_pk_bf16_f32 v193, v162, v163
    v_cvt_pk_bf16_f32 v194, v164, v165
    v_cvt_pk_bf16_f32 v195, v166, v167
    v_cvt_pk_bf16_f32 v196, v168, v169
    s_cmp_eq_u32 s95, 3
    s_cbranch_scc1 L_fb_ret_h
    s_branch L_fb_ret
L_sp1:
    v_bfe_u32 v230, v241, 4, 1
    v_lshlrev_b32 v230, 10, v230
    v_sub_u32 v230, v254, v230
    s_call_b64 s[82:83], L_special
    s_waitcnt lgkmcnt(4)
    v_mfma_f32_16x16x32_bf16 v[64:67], v[128:131], a[0:3], 0
    ds_read_b64_tr_b16 v[144:145], v224 offset:8192
    v_mfma_f32_16x16x32_bf16 v[64:67], v[132:135], a[4:7], v[64:67]
    v_mfma_f32_16x16x32_bf16 v[80:83], v[128:131], a[8:11], 0
    ds_read_b64_tr_b16 v[146:147], v224 offset:8704
    s_add_u32 m0, s68, 49152
    v_mfma_f32_16x16x32_bf16 v[80:83], v[132:135], a[12:15], v[80:83]
    s_add_u32 s61, s61, s62
    s_cmp_eq_u32 s61, s101
    v_mfma_f32_16x16x32_bf16 v[96:99], v[128:131], a[16:19], 0
    s_cselect_b32 s61, s100, s61
    ds_read_b64_tr_b16 v[148:149], v224 offset:10240
    v_mfma_f32_16x16x32_bf16 v[96:99], v[132:135], a[20:23], v[96:99]
    buffer_load_dwordx4 v220, s[32:35], s61 offen offset:0 sc1 lds
    v_mfma_f32_16x16x32_bf16 v[112:115], v[128:131], a[24:27], 0
    ds_read_b64_tr_b16 v[150:151], v224 offset:10752
    v_mfma_f32_16x16x32_bf16 v[112:115], v[132:135], a[28:31], v[112:115]
    s_waitcnt lgkmcnt(4)
    v_mfma_f32_16x16x32_bf16 v[68:71], v[136:139], a[0:3], 0
    ds_read_b64_tr_b16 v[128:129], v225 offset:8192
    v_cvt_pk_bf16_f32 v184, v0, v1
    v_mfma_f32_16x16x32_bf16 v[68:71], v[140:143], a[4:7], v[68:71]
    buffer_load_dwordx4 v221, s[32:35], s61 offen offset:1024 sc1 lds
    v_mfma_f32_16x16x32_bf16 v[84:87], v[136:139], a[8:11], 0
    ds_read_b64_tr_b16 v[130:131], v225 offset:8704
    v_cvt_pk_bf16_f32 v186, v4, v5
    v_mfma_f32_16x16x32_bf16 v[84:87], v[140:143], a[12:15], v[84:87]
    v_cvt_pk_bf16_f32 v185, v2, v3
    v_cvt_pk_bf16_f32 v187, v6, v7
    v_mfma_f32_16x16x32_bf16 v[100:103], v[136:139], a[16:19], 0
    ds_read_b64_tr_b16 v[132:133], v225 offset:10240
    v_cvt_pk_bf16_f32 v188, v8, v9
    v_mfma_f32_16x16x32_bf16 v[100:103], v[140:143], a[20:23], v[100:103]
    buffer_load_dwordx4 v222, s[32:35], s61 offen offset:2048 sc1 lds
    v_mfma_f32_16x16x32_bf16 v[116:119], v[136:139], a[24:27], 0
    ds_read_b64_tr_b16 v[134:135], v225 offset:10752
    v_cvt_pk_bf16_f32 v190, v12, v13
    v_mfma_f32_16x16x32_bf16 v[116:119], v[140:143], a[28:31], v[116:119]
    v_cvt_pk_bf16_f32 v189, v10, v11
    s_waitcnt lgkmcnt(4)
    v_mfma_f32_16x16x32_bf16 v[72:75], v[144:147], a[0:3], 0
    ds_read_b64_tr_b16 v[136:137], v224 offset:16384
    v_cvt_pk_bf16_f32 v191, v14, v15
    v_mfma_f32_16x16x32_bf16 v[72:75], v[148:151], a[4:7], v[72:75]
    v_permlane16_swap_b32 v184, v186
    v_mfma_f32_16x16x32_bf16 v[88:91], v[144:147], a[8:11], 0
    ds_read_b64_tr_b16 v[138:139], v224 offset:16896
    v_cvt_pk_bf16_f32 v192, v16, v17
    v_mfma_f32_16x16x32_bf16 v[88:91], v[148:151], a[12:15], v[88:91]
    v_permlane16_swap_b32 v185, v187
    v_mfma_f32_16x16x32_bf16 v[104:107], v[144:147], a[16:19], 0
    ds_read_b64_tr_b16 v[140:141], v224 offset:18432
    buffer_load_dwordx4 v223, s[32:35], s61 offen offset:3072 sc1 lds
    v_mfma_f32_16x16x32_bf16 v[104:107], v[148:151], a[20:23], v[104:107]
    buffer_store_dwordx4 v[184:187], v230, s[44:47], s76 offen offset:0 sc1
    v_mfma_f32_16x16x32_bf16 v[120:123], v[144:147], a[24:27], 0
    ds_read_b64_tr_b16 v[142:143], v224 offset:18944
    s_add_u32 m0, s68, 65536
    s_add_u32 s61, s61, s62
    v_mfma_f32_16x16x32_bf16 v[120:123], v[148:151], a[28:31], v[120:123]
    s_cmp_eq_u32 s61, s101
    s_cselect_b32 s61, s100, s61
    s_waitcnt lgkmcnt(4)
    v_mfma_f32_16x16x32_bf16 v[76:79], v[128:131], a[0:3], 0
    ds_read_b64_tr_b16 v[144:145], v225 offset:16384
    v_cvt_pk_bf16_f32 v194, v20, v21
    v_mfma_f32_16x16x32_bf16 v[76:79], v[132:135], a[4:7], v[76:79]
    buffer_load_dwordx4 v220, s[32:35], s61 offen offset:0 sc1 lds
    v_mfma_f32_16x16x32_bf16 v[92:95], v[128:131], a[8:11], 0
    ds_read_b64_tr_b16 v[146:147], v225 offset:16896
    v_cvt_pk_bf16_f32 v193, v18, v19
    v_mfma_f32_16x16x32_bf16 v[92:95], v[132:135], a[12:15], v[92:95]
    v_permlane16_swap_b32 v188, v190
    v_mfma_f32_16x16x32_bf16 v[108:111], v[128:131], a[16:19], 0
    ds_read_b64_tr_b16 v[148:149], v225 offset:18432
    v_mfma_f32_16x16x32_bf16 v[108:111], v[132:135], a[20:23], v[108:111]
    buffer_load_dwordx4 v221, s[32:35], s61 offen offset:1024 sc1 lds
    v_mfma_f32_16x16x32_bf16 v[124:127], v[128:131], a[24:27], 0
    ds_read_b64_tr_b16 v[150:151], v225 offset:18944
    v_cvt_pk_bf16_f32 v195, v22, v23
    v_mfma_f32_16x16x32_bf16 v[124:127], v[132:135], a[28:31], v[124:127]
    v_cvt_pk_bf16_f32 v196, v24, v25
    s_waitcnt lgkmcnt(4)
    v_mfma_f32_16x16x32_bf16 v[64:67], v[136:139], a[32:35], v[64:67]
    ds_read_b64_tr_b16 v[128:129], v224 offset:24576
    v_cvt_pk_bf16_f32 v198, v28, v29
    v_mfma_f32_16x16x32_bf16 v[64:67], v[140:143], a[36:39], v[64:67]
    v_permlane16_swap_b32 v189, v191
    v_mfma_f32_16x16x32_bf16 v[80:83], v[136:139], a[40:43], v[80:83]
    ds_read_b64_tr_b16 v[130:131], v224 offset:25088
    v_cvt_pk_bf16_f32 v197, v26, v27
    v_mfma_f32_16x16x32_bf16 v[80:83], v[140:143], a[44:47], v[80:83]
    buffer_store_dwordx4 v[188:191], v230, s[44:47], s78 offen offset:0 sc1
    v_mfma_f32_16x16x32_bf16 v[96:99], v[136:139], a[48:51], v[96:99]
    ds_read_b64_tr_b16 v[132:133], v224 offset:26624
    v_mfma_f32_16x16x32_bf16 v[96:99], v[140:143], a[52:55], v[96:99]
    buffer_load_dwordx4 v222, s[32:35], s61 offen offset:2048 sc1 lds
    v_mfma_f32_16x16x32_bf16 v[112:115], v[136:139], a[56:59], v[112:115]
    ds_read_b64_tr_b16 v[134:135], v224 offset:27136
    v_cvt_pk_bf16_f32 v199, v30, v31
    v_mfma_f32_16x16x32_bf16 v[112:115], v[140:143], a[60:63], v[112:115]
    v_cvt_pk_bf16_f32 v184, v32, v33
    s_waitcnt lgkmcnt(4)
    v_mfma_f32_16x16x32_bf16 v[68:71], v[144:147], a[32:35], v[68:71]
    ds_read_b64_tr_b16 v[136:137], v225 offset:24576
    v_cvt_pk_bf16_f32 v186, v36, v37
    v_mfma_f32_16x16x32_bf16 v[68:71], v[148:151], a[36:39], v[68:71]
    buffer_load_dwordx4 v223, s[32:35], s61 offen offset:3072 sc1 lds
    v_mfma_f32_16x16x32_bf16 v[84:87], v[144:147], a[40:43], v[84:87]
    ds_read_b64_tr_b16 v[138:139], v225 offset:25088
    s_add_u32 m0, s68, 81920
    v_mfma_f32_16x16x32_bf16 v[84:87], v[148:151], a[44:47], v[84:87]
    s_add_u32 s61, s61, s62
    s_cmp_eq_u32 s61, s101
    v_mfma_f32_16x16x32_bf16 v[100:103], v[144:147], a[48:51], v[100:103]
    s_cselect_b32 s61, s100, s61
    ds_read_b64_tr_b16 v[140:141], v225 offset:26624
    v_mfma_f32_16x16x32_bf16 v[100:103], v[148:151], a[52:55], v[100:103]
    buffer_load_dwordx4 v220, s[32:35], s61 offen offset:0 sc1 lds
    v_mfma_f32_16x16x32_bf16 v[116:119], v[144:147], a[56:59], v[116:119]
    ds_read_b64_tr_b16 v[142:143], v225 offset:27136
    v_cvt_pk_bf16_f32 v185, v34, v35
    v_mfma_f32_16x16x32_bf16 v[116:119], v[148:151], a[60:63], v[116:119]
    v_cvt_pk_bf16_f32 v187, v38, v39
    s_waitcnt lgkmcnt(4)
    v_mfma_f32_16x16x32_bf16 v[72:75], v[128:131], a[32:35], v[72:75]
    ds_read_b64_tr_b16 v[144:145], v224 offset:32768
    v_cvt_pk_bf16_f32 v188, v40, v41
    v_mfma_f32_16x16x32_bf16 v[72:75], v[132:135], a[36:39], v[72:75]
    v_permlane16_swap_b32 v192, v194
    v_mfma_f32_16x16x32_bf16 v[88:91], v[128:131], a[40:43], v[88:91]
    ds_read_b64_tr_b16 v[146:147], v224 offset:33280
    v_cvt_pk_bf16_f32 v190, v44, v45
    v_mfma_f32_16x16x32_bf16 v[88:91], v[132:135], a[44:47], v[88:91]
    v_permlane16_swap_b32 v193, v195
    v_mfma_f32_16x16x32_bf16 v[104:107], v[128:131], a[48:51], v[104:107]
    ds_read_b64_tr_b16 v[148:149], v224 offset:34816
    v_mfma_f32_16x16x32_bf16 v[104:107], v[132:135], a[52:55], v[104:107]
    buffer_load_dwordx4 v221, s[32:35], s61 offen offset:1024 sc1 lds
    v_mfma_f32_16x16x32_bf16 v[120:123], v[128:131], a[56:59], v[120:123]
    ds_read_b64_tr_b16 v[150:151], v224 offset:35328
    v_cvt_pk_bf16_f32 v189, v42, v43
    v_mfma_f32_16x16x32_bf16 v[120:123], v[132:135], a[60:63], v[120:123]
    v_cvt_pk_bf16_f32 v191, v46, v47
    s_waitcnt lgkmcnt(4)
    v_mfma_f32_16x16x32_bf16 v[76:79], v[136:139], a[32:35], v[76:79]
    ds_read_b64_tr_b16 v[128:129], v225 offset:32768
    v_mfma_f32_16x16x32_bf16 v[76:79], v[140:143], a[36:39], v[76:79]
    buffer_load_dwordx4 v222, s[32:35], s61 offen offset:2048 sc1 lds
    v_mfma_f32_16x16x32_bf16 v[92:95], v[136:139], a[40:43], v[92:95]
    ds_read_b64_tr_b16 v[130:131], v225 offset:33280
    v_mfma_f32_16x16x32_bf16 v[92:95], v[140:143], a[44:47], v[92:95]
    buffer_store_dwordx4 v[192:195], v230, s[44:47], s76 offen offset:256 sc1
    v_mfma_f32_16x16x32_bf16 v[108:111], v[136:139], a[48:51], v[108:111]
    ds_read_b64_tr_b16 v[132:133], v225 offset:34816
    v_cvt_pk_bf16_f32 v192, v48, v49
    v_mfma_f32_16x16x32_bf16 v[108:111], v[140:143], a[52:55], v[108:111]
    buffer_load_dwordx4 v223, s[32:35], s61 offen offset:3072 sc1 lds
    v_mfma_f32_16x16x32_bf16 v[124:127], v[136:139], a[56:59], v[124:127]
    ds_read_b64_tr_b16 v[134:135], v225 offset:35328
    v_cvt_pk_bf16_f32 v194, v52, v53
    v_mfma_f32_16x16x32_bf16 v[124:127], v[140:143], a[60:63], v[124:127]
    v_cvt_pk_bf16_f32 v193, v50, v51
    s_waitcnt lgkmcnt(4)
    v_mfma_f32_16x16x32_bf16 v[64:67], v[144:147], a[64:67], v[64:67]
    ds_read_b64_tr_b16 v[136:137], v224 offset:40960
    v_cvt_pk_bf16_f32 v195, v54, v55
    v_mfma_f32_16x16x32_bf16 v[64:67], v[148:151], a[68:71], v[64:67]
    v_permlane16_swap_b32 v196, v198
    v_mfma_f32_16x16x32_bf16 v[80:83], v[144:147], a[72:75], v[80:83]
    ds_read_b64_tr_b16 v[138:139], v224 offset:41472
    s_add_u32 m0, s68, 98304
    v_mfma_f32_16x16x32_bf16 v[80:83], v[148:151], a[76:79], v[80:83]
    s_add_u32 s61, s61, s62
    s_cmp_eq_u32 s61, s101
    v_mfma_f32_16x16x32_bf16 v[96:99], v[144:147], a[80:83], v[96:99]
    s_cselect_b32 s61, s100, s61
    ds_read_b64_tr_b16 v[140:141], v224 offset:43008
    v_mfma_f32_16x16x32_bf16 v[96:99], v[148:151], a[84:87], v[96:99]
    buffer_load_dwordx4 v220, s[32:35], s61 offen offset:0 sc1 lds
    v_mfma_f32_16x16x32_bf16 v[112:115], v[144:147], a[88:91], v[112:115]
    ds_read_b64_tr_b16 v[142:143], v224 offset:43520
    v_mfma_f32_16x16x32_bf16 v[112:115], v[148:151], a[92:95], v[112:115]
    s_waitcnt lgkmcnt(4)
    v_mfma_f32_16x16x32_bf16 v[68:71], v[128:131], a[64:67], v[68:71]
    ds_read_b64_tr_b16 v[144:145], v225 offset:40960
    v_mfma_f32_16x16x32_bf16 v[68:71], v[132:135], a[68:71], v[68:71]
    buffer_load_dwordx4 v221, s[32:35], s61 offen offset:1024 sc1 lds
    v_mfma_f32_16x16x32_bf16 v[84:87], v[128:131], a[72:75], v[84:87]
    ds_read_b64_tr_b16 v[146:147], v225 offset:41472
    v_mfma_f32_16x16x32_bf16 v[84:87], v[132:135], a[76:79], v[84:87]
    v_permlane16_swap_b32 v197, v199
    v_mfma_f32_16x16x32_bf16 v[100:103], v[128:131], a[80:83], v[100:103]
    ds_read_b64_tr_b16 v[148:149], v225 offset:43008
    v_mfma_f32_16x16x32_bf16 v[100:103], v[132:135], a[84:87], v[100:103]
    buffer_load_dwordx4 v222, s[32:35], s61 offen offset:2048 sc1 lds
    v_mfma_f32_16x16x32_bf16 v[116:119], v[128:131], a[88:91], v[116:119]
    ds_read_b64_tr_b16 v[150:151], v225 offset:43520
    v_mfma_f32_16x16x32_bf16 v[116:119], v[132:135], a[92:95], v[116:119]
    s_waitcnt lgkmcnt(4)
    v_mfma_f32_16x16x32_bf16 v[72:75], v[136:139], a[64:67], v[72:75]
    s_waitcnt vmcnt(8)
    s_barrier
    v_mfma_f32_16x16x32_bf16 v[72:75], v[140:143], a[68:71], v[72:75]
    buffer_store_dwordx4 v[196:199], v230, s[44:47], s78 offen offset:256 sc1
    v_mfma_f32_16x16x32_bf16 v[88:91], v[136:139], a[72:75], v[88:91]
    ds_read_b64_tr_b16 v[128:129], v226 offset:0
    ds_read_b64_tr_b16 v[130:131], v226 offset:512
    v_mfma_f32_16x16x32_bf16 v[88:91], v[140:143], a[76:79], v[88:91]
    buffer_store_dword v240, v239, s[44:47], s92 offen sc1
    ds_read_b64_tr_b16 v[208:209], v236 offset:0
    v_mfma_f32_16x16x32_bf16 v[104:107], v[136:139], a[80:83], v[104:107]
    ds_read_b64_tr_b16 v[132:133], v226 offset:2048
    buffer_load_dwordx4 v223, s[32:35], s61 offen offset:3072 sc1 lds
    v_mfma_f32_16x16x32_bf16 v[104:107], v[140:143], a[84:87], v[104:107]
    ds_read_b64_tr_b16 v[210:211], v236 offset:512
    v_cvt_pk_bf16_f32 v196, v56, v57
    v_mfma_f32_16x16x32_bf16 v[120:123], v[136:139], a[88:91], v[120:123]
    ds_read_b64_tr_b16 v[134:135], v226 offset:2560
    s_add_u32 m0, s68, 114688
    s_add_u32 s61, s61, s62
    v_mfma_f32_16x16x32_bf16 v[120:123], v[140:143], a[92:95], v[120:123]
    s_cmp_eq_u32 s61, s101
    s_cselect_b32 s61, s100, s61
    ds_read_b64_tr_b16 v[212:213], v236 offset:64
    ds_read_b64_tr_b16 v[214:215], v236 offset:576
    s_waitcnt lgkmcnt(8)
    v_mfma_f32_16x16x32_bf16 v[76:79], v[144:147], a[64:67], v[76:79]
    ds_read_b64_tr_b16 v[136:137], v227 offset:0
    v_cvt_pk_bf16_f32 v198, v60, v61
    v_mfma_f32_16x16x32_bf16 v[76:79], v[148:151], a[68:71], v[76:79]
    buffer_load_dwordx4 v220, s[32:35], s61 offen offset:0 sc1 lds
    v_mfma_f32_16x16x32_bf16 v[92:95], v[144:147], a[72:75], v[92:95]
    ds_read_b64_tr_b16 v[138:139], v227 offset:512
    v_cvt_pk_bf16_f32 v197, v58, v59
    v_mfma_f32_16x16x32_bf16 v[92:95], v[148:151], a[76:79], v[92:95]
    v_permlane16_swap_b32 v184, v186
    v_mfma_f32_16x16x32_bf16 v[108:111], v[144:147], a[80:83], v[108:111]
    ds_read_b64_tr_b16 v[140:141], v227 offset:2048
    v_cvt_pk_bf16_f32 v199, v62, v63
    v_mfma_f32_16x16x32_bf16 v[108:111], v[148:151], a[84:87], v[108:111]
    buffer_load_dwordx4 v221, s[32:35], s61 offen offset:1024 sc1 lds
    v_mfma_f32_16x16x32_bf16 v[124:127], v[144:147], a[88:91], v[124:127]
    ds_read_b64_tr_b16 v[142:143], v227 offset:2560
    v_mfma_f32_16x16x32_bf16 v[124:127], v[148:151], a[92:95], v[124:127]
    s_waitcnt lgkmcnt(6)
    v_mfma_f32_16x16x32_bf16 v[64:67], v[128:131], a[96:99], v[64:67]
    ds_read_b64_tr_b16 v[144:145], v226 offset:8192
    v_mfma_f32_16x16x32_bf16 v[64:67], v[132:135], a[100:103], v[64:67]
    v_permlane16_swap_b32 v185, v187
    v_mfma_f32_16x16x32_bf16 v[80:83], v[128:131], a[104:107], v[80:83]
    ds_read_b64_tr_b16 v[146:147], v226 offset:8704
    v_mfma_f32_16x16x32_bf16 v[80:83], v[132:135], a[108:111], v[80:83]
    buffer_store_dwordx4 v[184:187], v230, s[44:47], s77 offen offset:0 sc1
    v_mfma_f32_16x16x32_bf16 v[96:99], v[128:131], a[112:115], v[96:99]
    ds_read_b64_tr_b16 v[148:149], v226 offset:10240
    v_mfma_f32_16x16x32_bf16 v[96:99], v[132:135], a[116:119], v[96:99]
    buffer_load_dwordx4 v222, s[32:35], s61 offen offset:2048 sc1 lds
    v_mfma_f32_16x16x32_bf16 v[112:115], v[128:131], a[120:123], v[112:115]
    ds_read_b64_tr_b16 v[150:151], v226 offset:10752
    v_permlane16_swap_b32 v188, v190
    v_mfma_f32_16x16x32_bf16 v[112:115], v[132:135], a[124:127], v[112:115]
    v_permlane16_swap_b32 v189, v191
    s_waitcnt lgkmcnt(4)
    v_mfma_f32_16x16x32_bf16 v[68:71], v[136:139], a[96:99], v[68:71]
    ds_read_b64_tr_b16 v[128:129], v227 offset:8192
    v_mfma_f32_16x16x32_bf16 v[68:71], v[140:143], a[100:103], v[68:71]
    buffer_load_dwordx4 v223, s[32:35], s61 offen offset:3072 sc1 lds
    v_mfma_f32_16x16x32_bf16 v[84:87], v[136:139], a[104:107], v[84:87]
    ds_read_b64_tr_b16 v[130:131], v227 offset:8704
    s_add_u32 m0, s68, 131072
    v_mfma_f32_16x16x32_bf16 v[84:87], v[140:143], a[108:111], v[84:87]
    s_add_u32 s61, s61, s62
    s_cmp_eq_u32 s61, s101
    v_mfma_f32_16x16x32_bf16 v[100:103], v[136:139], a[112:115], v[100:103]
    s_cselect_b32 s61, s100, s61
    ds_read_b64_tr_b16 v[132:133], v227 offset:10240
    v_mfma_f32_16x16x32_bf16 v[100:103], v[140:143], a[116:119], v[100:103]
    buffer_load_dwordx4 v220, s[32:35], s61 offen offset:0 sc1 lds
    v_mfma_f32_16x16x32_bf16 v[116:119], v[136:139], a[120:123], v[116:119]
    ds_read_b64_tr_b16 v[134:135], v227 offset:10752
    buffer_store_dwordx4 v[188:191], v230, s[44:47], s80 offen offset:0 sc1
    v_mfma_f32_16x16x32_bf16 v[116:119], v[140:143], a[124:127], v[116:119]
    s_waitcnt lgkmcnt(4)
    v_mfma_f32_16x16x32_bf16 v[72:75], v[144:147], a[96:99], v[72:75]
    ds_read_b64_tr_b16 v[136:137], v226 offset:16384
    v_mfma_f32_16x16x32_bf16 v[72:75], v[148:151], a[100:103], v[72:75]
    buffer_store_dwordx4 v[208:211], v233, s[56:59], s72 offen offset:0 sc1
    v_mfma_f32_16x16x32_bf16 v[88:91], v[144:147], a[104:107], v[88:91]
    ds_read_b64_tr_b16 v[138:139], v226 offset:16896
    v_permlane16_swap_b32 v192, v194
    v_mfma_f32_16x16x32_bf16 v[88:91], v[148:151], a[108:111], v[88:91]
    v_permlane16_swap_b32 v193, v195
    v_mfma_f32_16x16x32_bf16 v[104:107], v[144:147], a[112:115], v[104:107]
    ds_read_b64_tr_b16 v[140:141], v226 offset:18432
    v_mfma_f32_16x16x32_bf16 v[104:107], v[148:151], a[116:119], v[104:107]
    buffer_load_dwordx4 v221, s[32:35], s61 offen offset:1024 sc1 lds
    v_mfma_f32_16x16x32_bf16 v[120:123], v[144:147], a[120:123], v[120:123]
    ds_read_b64_tr_b16 v[142:143], v226 offset:18944
    buffer_store_dwordx4 v[192:195], v230, s[44:47], s77 offen offset:256 sc1
    v_mfma_f32_16x16x32_bf16 v[120:123], v[148:151], a[124:127], v[120:123]
    s_waitcnt lgkmcnt(4)
    v_mfma_f32_16x16x32_bf16 v[76:79], v[128:131], a[96:99], v[76:79]
    ds_read_b64_tr_b16 v[144:145], v227 offset:16384
    v_mfma_f32_16x16x32_bf16 v[76:79], v[132:135], a[100:103], v[76:79]
    buffer_load_dwordx4 v222, s[32:35], s61 offen offset:2048 sc1 lds
    v_mfma_f32_16x16x32_bf16 v[92:95], v[128:131], a[104:107], v[92:95]
    ds_read_b64_tr_b16 v[146:147], v227 offset:16896
    v_permlane16_swap_b32 v196, v198
    v_mfma_f32_16x16x32_bf16 v[92:95], v[132:135], a[108:111], v[92:95]
    v_permlane16_swap_b32 v197, v199
    v_mfma_f32_16x16x32_bf16 v[108:111], v[128:131], a[112:115], v[108:111]
    ds_read_b64_tr_b16 v[148:149], v227 offset:18432
    buffer_load_dwordx4 v223, s[32:35], s61 offen offset:3072 sc1 lds
    v_mfma_f32_16x16x32_bf16 v[108:111], v[132:135], a[116:119], v[108:111]
    buffer_store_dwordx4 v[196:199], v230, s[44:47], s80 offen offset:256 sc1
    v_mfma_f32_16x16x32_bf16 v[124:127], v[128:131], a[120:123], v[124:127]
    ds_read_b64_tr_b16 v[150:151], v227 offset:18944
    s_mov_b64 s[32:33], s[36:37]
    s_mov_b32 s34, s38
    v_mfma_f32_16x16x32_bf16 v[124:127], v[132:135], a[124:127], v[124:127]
    s_mov_b32 s62, s63
    v_mov_b32 v220, v231
    s_waitcnt lgkmcnt(4)
    v_mfma_f32_16x16x32_bf16 v[64:67], v[136:139], a[128:131], v[64:67]
    ds_read_b64_tr_b16 v[128:129], v226 offset:24576
    s_mov_b32 s100, s88
    v_mfma_f32_16x16x32_bf16 v[64:67], v[140:143], a[132:135], v[64:67]
    s_lshl3_add_u32 s101, s63, s88
    v_mfma_f32_16x16x32_bf16 v[80:83], v[136:139], a[136:139], v[80:83]
    ds_read_b64_tr_b16 v[130:131], v226 offset:25088
    s_add_u32 m0, s68, 0
    v_mfma_f32_16x16x32_bf16 v[80:83], v[140:143], a[140:143], v[80:83]
    s_mov_b32 s61, s101
    v_mfma_f32_16x16x32_bf16 v[96:99], v[136:139], a[144:147], v[96:99]
    ds_read_b64_tr_b16 v[132:133], v226 offset:26624
    v_mfma_f32_16x16x32_bf16 v[96:99], v[140:143], a[148:151], v[96:99]
    buffer_load_dwordx4 v220, s[32:35], s61 offen offset:0 sc1 lds
    v_mfma_f32_16x16x32_bf16 v[112:115], v[136:139], a[152:155], v[112:115]
    ds_read_b64_tr_b16 v[134:135], v226 offset:27136
    v_add_u32 v221, s75, v220
    v_add_u32 v222, s75, v221
    v_mfma_f32_16x16x32_bf16 v[112:115], v[140:143], a[156:159], v[112:115]
    v_add_u32 v223, s75, v222
    s_waitcnt lgkmcnt(4)
    v_mfma_f32_16x16x32_bf16 v[68:71], v[144:147], a[128:131], v[68:71]
    ds_read_b64_tr_b16 v[136:137], v227 offset:24576
    v_mfma_f32_16x16x32_bf16 v[68:71], v[148:151], a[132:135], v[68:71]
    buffer_load_dwordx4 v221, s[32:35], s61 offen offset:1024 sc1 lds
    v_mfma_f32_16x16x32_bf16 v[84:87], v[144:147], a[136:139], v[84:87]
    ds_read_b64_tr_b16 v[138:139], v227 offset:25088
    v_mfma_f32_16x16x32_bf16 v[84:87], v[148:151], a[140:143], v[84:87]
    v_mfma_f32_16x16x32_bf16 v[100:103], v[144:147], a[144:147], v[100:103]
    ds_read_b64_tr_b16 v[140:141], v227 offset:26624
    v_mfma_f32_16x16x32_bf16 v[100:103], v[148:151], a[148:151], v[100:103]
    buffer_load_dwordx4 v222, s[32:35], s61 offen offset:2048 sc1 lds
    v_mfma_f32_16x16x32_bf16 v[116:119], v[144:147], a[152:155], v[116:119]
    ds_read_b64_tr_b16 v[142:143], v227 offset:27136
    v_mfma_f32_16x16x32_bf16 v[116:119], v[148:151], a[156:159], v[116:119]
    s_waitcnt lgkmcnt(4)
    v_mfma_f32_16x16x32_bf16 v[72:75], v[128:131], a[128:131], v[72:75]
    s_waitcnt vmcnt(11)
    s_barrier
    v_mfma_f32_16x16x32_bf16 v[72:75], v[132:135], a[132:135], v[72:75]
    v_mfma_f32_16x16x32_bf16 v[88:91], v[128:131], a[136:139], v[88:91]
    ds_read_b64_tr_b16 v[144:145], v226 offset:32768
    ds_read_b64_tr_b16 v[146:147], v226 offset:33280
    v_mfma_f32_16x16x32_bf16 v[88:91], v[132:135], a[140:143], v[88:91]
    v_mfma_f32_16x16x32_bf16 v[104:107], v[128:131], a[144:147], v[104:107]
    ds_read_b64_tr_b16 v[148:149], v226 offset:34816
    v_mfma_f32_16x16x32_bf16 v[104:107], v[132:135], a[148:151], v[104:107]
    buffer_load_dwordx4 v223, s[32:35], s61 offen offset:3072 sc1 lds
    v_mfma_f32_16x16x32_bf16 v[120:123], v[128:131], a[152:155], v[120:123]
    ds_read_b64_tr_b16 v[150:151], v226 offset:35328
    s_add_u32 m0, s68, 16384
    v_mfma_f32_16x16x32_bf16 v[120:123], v[132:135], a[156:159], v[120:123]
    s_mov_b32 s61, s31
    s_waitcnt lgkmcnt(4)
    v_mfma_f32_16x16x32_bf16 v[76:79], v[136:139], a[128:131], v[76:79]
    ds_read_b64_tr_b16 v[128:129], v227 offset:32768
    v_mfma_f32_16x16x32_bf16 v[76:79], v[140:143], a[132:135], v[76:79]
    buffer_load_dwordx4 v220, s[32:35], s61 offen offset:0 sc1 lds
    v_mfma_f32_16x16x32_bf16 v[92:95], v[136:139], a[136:139], v[92:95]
    ds_read_b64_tr_b16 v[130:131], v227 offset:33280
    s_lshr_b64 s[66:67], s[66:67], 8
    v_mfma_f32_16x16x32_bf16 v[92:95], v[140:143], a[140:143], v[92:95]
    v_mfma_f32_16x16x32_bf16 v[108:111], v[136:139], a[144:147], v[108:111]
    ds_read_b64_tr_b16 v[132:133], v227 offset:34816
    v_mfma_f32_16x16x32_bf16 v[108:111], v[140:143], a[148:151], v[108:111]
    buffer_load_dwordx4 v221, s[32:35], s61 offen offset:1024 sc1 lds
    v_mfma_f32_16x16x32_bf16 v[124:127], v[136:139], a[152:155], v[124:127]
    ds_read_b64_tr_b16 v[134:135], v227 offset:35328
    v_mfma_f32_16x16x32_bf16 v[124:127], v[140:143], a[156:159], v[124:127]
    s_waitcnt lgkmcnt(4)
    v_mfma_f32_16x16x32_bf16 v[64:67], v[144:147], a[160:163], v[64:67]
    ds_read_b64_tr_b16 v[136:137], v226 offset:40960
    v_mfma_f32_16x16x32_bf16 v[64:67], v[148:151], a[164:167], v[64:67]
    buffer_store_dwordx4 v[212:215], v233, s[56:59], s72 offen offset:1024 sc1
    v_mfma_f32_16x16x32_bf16 v[80:83], v[144:147], a[168:171], v[80:83]
    ds_read_b64_tr_b16 v[138:139], v226 offset:41472
    v_mfma_f32_16x16x32_bf16 v[80:83], v[148:151], a[172:175], v[80:83]
    v_mfma_f32_16x16x32_bf16 v[96:99], v[144:147], a[176:179], v[96:99]
    ds_read_b64_tr_b16 v[140:141], v226 offset:43008
    v_mfma_f32_16x16x32_bf16 v[96:99], v[148:151], a[180:183], v[96:99]
    buffer_load_dwordx4 v222, s[32:35], s61 offen offset:2048 sc1 lds
    v_mfma_f32_16x16x32_bf16 v[112:115], v[144:147], a[184:187], v[112:115]
    ds_read_b64_tr_b16 v[142:143], v226 offset:43520
    v_mfma_f32_16x16x32_bf16 v[112:115], v[148:151], a[188:191], v[112:115]
    s_waitcnt lgkmcnt(4)
    v_mfma_f32_16x16x32_bf16 v[68:71], v[128:131], a[160:163], v[68:71]
    ds_read_b64_tr_b16 v[144:145], v227 offset:40960
    v_mfma_f32_16x16x32_bf16 v[68:71], v[132:135], a[164:167], v[68:71]
    buffer_load_dwordx4 v223, s[32:35], s61 offen offset:3072 sc1 lds
    v_mfma_f32_16x16x32_bf16 v[84:87], v[128:131], a[168:171], v[84:87]
    ds_read_b64_tr_b16 v[146:147], v227 offset:41472
    s_add_u32 m0, s68, 32768
    v_mfma_f32_16x16x32_bf16 v[84:87], v[132:135], a[172:175], v[84:87]
    s_add_u32 s61, s61, s62
    s_cmp_eq_u32 s61, s101
    v_mfma_f32_16x16x32_bf16 v[100:103], v[128:131], a[176:179], v[100:103]
    s_cselect_b32 s61, s100, s61
    ds_read_b64_tr_b16 v[148:149], v227 offset:43008
    v_mfma_f32_16x16x32_bf16 v[100:103], v[132:135], a[180:183], v[100:103]
    buffer_load_dwordx4 v220, s[32:35], s61 offen offset:0 sc1 lds
    v_mfma_f32_16x16x32_bf16 v[116:119], v[128:131], a[184:187], v[116:119]
    ds_read_b64_tr_b16 v[150:151], v227 offset:43520
    v_mfma_f32_16x16x32_bf16 v[116:119], v[132:135], a[188:191], v[116:119]
    s_waitcnt lgkmcnt(4)
    v_mfma_f32_16x16x32_bf16 v[72:75], v[136:139], a[160:163], v[72:75]
    ds_read_b64_tr_b16 v[128:129], v228 offset:0
    v_mfma_f32_16x16x32_bf16 v[72:75], v[140:143], a[164:167], v[72:75]
    v_mfma_f32_16x16x32_bf16 v[88:91], v[136:139], a[168:171], v[88:91]
    ds_read_b64_tr_b16 v[130:131], v228 offset:512
    v_mfma_f32_16x16x32_bf16 v[88:91], v[140:143], a[172:175], v[88:91]
    v_mfma_f32_16x16x32_bf16 v[104:107], v[136:139], a[176:179], v[104:107]
    ds_read_b64_tr_b16 v[132:133], v228 offset:2048
    v_mfma_f32_16x16x32_bf16 v[104:107], v[140:143], a[180:183], v[104:107]
    buffer_load_dwordx4 v221, s[32:35], s61 offen offset:1024 sc1 lds
    v_mfma_f32_16x16x32_bf16 v[120:123], v[136:139], a[184:187], v[120:123]
    ds_read_b64_tr_b16 v[134:135], v228 offset:2560
    v_mfma_f32_16x16x32_bf16 v[120:123], v[140:143], a[188:191], v[120:123]
    s_waitcnt lgkmcnt(4)
    v_mfma_f32_16x16x32_bf16 v[76:79], v[144:147], a[160:163], v[76:79]
    ds_read_b64_tr_b16 v[136:137], v229 offset:0
    v_mfma_f32_16x16x32_bf16 v[76:79], v[148:151], a[164:167], v[76:79]
    buffer_load_dwordx4 v222, s[32:35], s61 offen offset:2048 sc1 lds
    v_mfma_f32_16x16x32_bf16 v[92:95], v[144:147], a[168:171], v[92:95]
    ds_read_b64_tr_b16 v[138:139], v229 offset:512
    v_mfma_f32_16x16x32_bf16 v[92:95], v[148:151], a[172:175], v[92:95]
    v_mfma_f32_16x16x32_bf16 v[108:111], v[144:147], a[176:179], v[108:111]
    ds_read_b64_tr_b16 v[140:141], v229 offset:2048
    v_mfma_f32_16x16x32_bf16 v[108:111], v[148:151], a[180:183], v[108:111]
    buffer_load_dwordx4 v223, s[32:35], s61 offen offset:3072 sc1 lds
    v_mfma_f32_16x16x32_bf16 v[124:127], v[144:147], a[184:187], v[124:127]
    ds_read_b64_tr_b16 v[142:143], v229 offset:2560
    v_mfma_f32_16x16x32_bf16 v[124:127], v[148:151], a[188:191], v[124:127]
    s_waitcnt lgkmcnt(4)
    v_mfma_f32_16x16x32_bf16 v[64:67], v[128:131], a[192:195], v[64:67]
    ds_read_b64_tr_b16 v[144:145], v228 offset:8192
    v_mfma_f32_16x16x32_bf16 v[64:67], v[132:135], a[196:199], v[64:67]
    v_mfma_f32_16x16x32_bf16 v[80:83], v[128:131], a[200:203], v[80:83]
    ds_read_b64_tr_b16 v[146:147], v228 offset:8704
    v_mfma_f32_16x16x32_bf16 v[80:83], v[132:135], a[204:207], v[80:83]
    v_mfma_f32_16x16x32_bf16 v[96:99], v[128:131], a[208:211], v[96:99]
    ds_read_b64_tr_b16 v[148:149], v228 offset:10240
    s_add_u32 m0, s68, 147456
    v_mfma_f32_16x16x32_bf16 v[96:99], v[132:135], a[212:215], v[96:99]
    s_add_u32 s70, s70, 128
    v_mfma_f32_16x16x32_bf16 v[112:115], v[128:131], a[216:219], v[112:115]
    buffer_load_dwordx4 v235, s[52:55], s70 offen offset:0 nt lds
    v_mfma_f32_16x16x32_bf16 v[112:115], v[132:135], a[220:223], v[112:115]
    ds_read_b64_tr_b16 v[150:151], v228 offset:10752
    s_waitcnt lgkmcnt(4)
    v_mfma_f32_16x16x32_bf16 v[68:71], v[136:139], a[192:195], v[68:71]
    ds_read_b64_tr_b16 v[128:129], v229 offset:8192
    s_add_u32 s71, s71, 128
    v_mfma_f32_16x16x32_bf16 v[68:71], v[140:143], a[196:199], v[68:71]
    buffer_load_dwordx4 v235, s[52:55], s71 offen offset:1024 nt lds
    v_mfma_f32_16x16x32_bf16 v[84:87], v[136:139], a[200:203], v[84:87]
    ds_read_b64_tr_b16 v[130:131], v229 offset:8704
    v_mfma_f32_16x16x32_bf16 v[84:87], v[140:143], a[204:207], v[84:87]
    v_mfma_f32_16x16x32_bf16 v[100:103], v[136:139], a[208:211], v[100:103]
    ds_read_b64_tr_b16 v[132:133], v229 offset:10240
    v_mfma_f32_16x16x32_bf16 v[100:103], v[140:143], a[212:215], v[100:103]
    v_mfma_f32_16x16x32_bf16 v[116:119], v[136:139], a[216:219], v[116:119]
    ds_read_b64_tr_b16 v[134:135], v229 offset:10752
    v_mfma_f32_16x16x32_bf16 v[116:119], v[140:143], a[220:223], v[116:119]
    s_waitcnt lgkmcnt(4)
    v_mfma_f32_16x16x32_bf16 v[72:75], v[144:147], a[192:195], v[72:75]
    ds_read_b64_tr_b16 v[136:137], v228 offset:16384
    v_mfma_f32_16x16x32_bf16 v[72:75], v[148:151], a[196:199], v[72:75]
    v_mfma_f32_16x16x32_bf16 v[88:91], v[144:147], a[200:203], v[88:91]
    ds_read_b64_tr_b16 v[138:139], v228 offset:16896
    v_mfma_f32_16x16x32_bf16 v[88:91], v[148:151], a[204:207], v[88:91]
    v_mfma_f32_16x16x32_bf16 v[104:107], v[144:147], a[208:211], v[104:107]
    ds_read_b64_tr_b16 v[140:141], v228 offset:18432
    v_mfma_f32_16x16x32_bf16 v[104:107], v[148:151], a[212:215], v[104:107]
    v_mfma_f32_16x16x32_bf16 v[120:123], v[144:147], a[216:219], v[120:123]
    ds_read_b64_tr_b16 v[142:143], v228 offset:18944
    v_mfma_f32_16x16x32_bf16 v[120:123], v[148:151], a[220:223], v[120:123]
    s_waitcnt lgkmcnt(4)
    v_mfma_f32_16x16x32_bf16 v[76:79], v[128:131], a[192:195], v[76:79]
    ds_read_b64_tr_b16 v[144:145], v229 offset:16384
    v_mfma_f32_16x16x32_bf16 v[76:79], v[132:135], a[196:199], v[76:79]
    v_mfma_f32_16x16x32_bf16 v[92:95], v[128:131], a[200:203], v[92:95]
    ds_read_b64_tr_b16 v[146:147], v229 offset:16896
    v_mfma_f32_16x16x32_bf16 v[92:95], v[132:135], a[204:207], v[92:95]
    v_mfma_f32_16x16x32_bf16 v[108:111], v[128:131], a[208:211], v[108:111]
    ds_read_b64_tr_b16 v[148:149], v229 offset:18432
    v_mfma_f32_16x16x32_bf16 v[108:111], v[132:135], a[212:215], v[108:111]
    v_mfma_f32_16x16x32_bf16 v[124:127], v[128:131], a[216:219], v[124:127]
    ds_read_b64_tr_b16 v[150:151], v229 offset:18944
    v_mfma_f32_16x16x32_bf16 v[124:127], v[132:135], a[220:223], v[124:127]
    s_waitcnt lgkmcnt(4)
    v_mfma_f32_16x16x32_bf16 v[64:67], v[136:139], a[224:227], v[64:67]
    ds_read_b64_tr_b16 v[128:129], v228 offset:24576
    v_mfma_f32_16x16x32_bf16 v[64:67], v[140:143], a[228:231], v[64:67]
    v_mfma_f32_16x16x32_bf16 v[80:83], v[136:139], a[232:235], v[80:83]
    ds_read_b64_tr_b16 v[130:131], v228 offset:25088
    v_mfma_f32_16x16x32_bf16 v[80:83], v[140:143], a[236:239], v[80:83]
    v_mfma_f32_16x16x32_bf16 v[96:99], v[136:139], a[240:243], v[96:99]
    ds_read_b64_tr_b16 v[132:133], v228 offset:26624
    v_mfma_f32_16x16x32_bf16 v[96:99], v[140:143], a[244:247], v[96:99]
    v_mfma_f32_16x16x32_bf16 v[112:115], v[136:139], a[248:251], v[112:115]
    ds_read_b64_tr_b16 v[134:135], v228 offset:27136
    v_mfma_f32_16x16x32_bf16 v[112:115], v[140:143], a[252:255], v[112:115]
    s_waitcnt lgkmcnt(4)
    v_mfma_f32_16x16x32_bf16 v[68:71], v[144:147], a[224:227], v[68:71]
    ds_read_b64_tr_b16 v[136:137], v229 offset:24576
    v_mfma_f32_16x16x32_bf16 v[68:71], v[148:151], a[228:231], v[68:71]
    v_mfma_f32_16x16x32_bf16 v[84:87], v[144:147], a[232:235], v[84:87]
    ds_read_b64_tr_b16 v[138:139], v229 offset:25088
    v_mfma_f32_16x16x32_bf16 v[84:87], v[148:151], a[236:239], v[84:87]
    v_mfma_f32_16x16x32_bf16 v[100:103], v[144:147], a[240:243], v[100:103]
    ds_read_b64_tr_b16 v[140:141], v229 offset:26624
    v_mfma_f32_16x16x32_bf16 v[100:103], v[148:151], a[244:247], v[100:103]
    v_mfma_f32_16x16x32_bf16 v[116:119], v[144:147], a[248:251], v[116:119]
    ds_read_b64_tr_b16 v[142:143], v229 offset:27136
    v_mfma_f32_16x16x32_bf16 v[116:119], v[148:151], a[252:255], v[116:119]
    s_waitcnt lgkmcnt(4)
    v_mfma_f32_16x16x32_bf16 v[72:75], v[128:131], a[224:227], v[72:75]
    s_waitcnt vmcnt(2)
    s_barrier
    v_mfma_f32_16x16x32_bf16 v[72:75], v[132:135], a[228:231], v[72:75]
    v_mfma_f32_16x16x32_bf16 v[88:91], v[128:131], a[232:235], v[88:91]
    ds_read_b64_tr_b16 v[144:145], v228 offset:32768
    v_mfma_f32_16x16x32_bf16 v[88:91], v[132:135], a[236:239], v[88:91]
    ds_read_b64_tr_b16 v[146:147], v228 offset:33280
    v_mfma_f32_16x16x32_bf16 v[104:107], v[128:131], a[240:243], v[104:107]
    ds_read_b64_tr_b16 v[148:149], v228 offset:34816
    v_mfma_f32_16x16x32_bf16 v[104:107], v[132:135], a[244:247], v[104:107]
    v_mfma_f32_16x16x32_bf16 v[120:123], v[128:131], a[248:251], v[120:123]
    ds_read_b64_tr_b16 v[150:151], v228 offset:35328
    v_mfma_f32_16x16x32_bf16 v[120:123], v[132:135], a[252:255], v[120:123]
    s_waitcnt lgkmcnt(4)
    v_mfma_f32_16x16x32_bf16 v[76:79], v[136:139], a[224:227], v[76:79]
    ds_read_b64_tr_b16 v[128:129], v229 offset:32768
    v_mfma_f32_16x16x32_bf16 v[76:79], v[140:143], a[228:231], v[76:79]
    v_mfma_f32_16x16x32_bf16 v[92:95], v[136:139], a[232:235], v[92:95]
    ds_read_b64_tr_b16 v[130:131], v229 offset:33280
    v_mfma_f32_16x16x32_bf16 v[92:95], v[140:143], a[236:239], v[92:95]
    v_mfma_f32_16x16x32_bf16 v[108:111], v[136:139], a[240:243], v[108:111]
    ds_read_b64_tr_b16 v[132:133], v229 offset:34816
    v_mfma_f32_16x16x32_bf16 v[108:111], v[140:143], a[244:247], v[108:111]
    v_mfma_f32_16x16x32_bf16 v[124:127], v[136:139], a[248:251], v[124:127]
    ds_read_b64_tr_b16 v[134:135], v229 offset:35328
    v_mfma_f32_16x16x32_bf16 v[124:127], v[140:143], a[252:255], v[124:127]
    s_waitcnt lgkmcnt(4)
    v_mfma_f32_16x16x32_bf16 v[64:67], v[144:147], v[152:155], v[64:67]
    ds_read_b64_tr_b16 v[136:137], v228 offset:40960
    v_mfma_f32_16x16x32_bf16 v[64:67], v[148:151], v[156:159], v[64:67]
    v_mfma_f32_16x16x32_bf16 v[80:83], v[144:147], v[160:163], v[80:83]
    ds_read_b64_tr_b16 v[138:139], v228 offset:41472
    v_mfma_f32_16x16x32_bf16 v[80:83], v[148:151], v[164:167], v[80:83]
    v_mfma_f32_16x16x32_bf16 v[96:99], v[144:147], v[168:171], v[96:99]
    ds_read_b64_tr_b16 v[140:141], v228 offset:43008
    v_mfma_f32_16x16x32_bf16 v[96:99], v[148:151], v[172:175], v[96:99]
    v_mfma_f32_16x16x32_bf16 v[112:115], v[144:147], v[176:179], v[112:115]
    ds_read_b64_tr_b16 v[142:143], v228 offset:43520
    v_mfma_f32_16x16x32_bf16 v[112:115], v[148:151], v[180:183], v[112:115]
    s_waitcnt lgkmcnt(4)
    v_mfma_f32_16x16x32_bf16 v[68:71], v[128:131], v[152:155], v[68:71]
    ds_read_b64_tr_b16 v[144:145], v229 offset:40960
    v_mfma_f32_16x16x32_bf16 v[68:71], v[132:135], v[156:159], v[68:71]
    v_mfma_f32_16x16x32_bf16 v[84:87], v[128:131], v[160:163], v[84:87]
    ds_read_b64_tr_b16 v[146:147], v229 offset:41472
    v_mfma_f32_16x16x32_bf16 v[84:87], v[132:135], v[164:167], v[84:87]
    v_mfma_f32_16x16x32_bf16 v[100:103], v[128:131], v[168:171], v[100:103]
    ds_read_b64_tr_b16 v[148:149], v229 offset:43008
    v_mfma_f32_16x16x32_bf16 v[100:103], v[132:135], v[172:175], v[100:103]
    v_mfma_f32_16x16x32_bf16 v[116:119], v[128:131], v[176:179], v[116:119]
    ds_read_b64_tr_b16 v[150:151], v229 offset:43520
    v_mfma_f32_16x16x32_bf16 v[116:119], v[132:135], v[180:183], v[116:119]
    s_waitcnt lgkmcnt(4)
    v_mfma_f32_16x16x32_bf16 v[72:75], v[136:139], v[152:155], v[72:75]
    ds_read_b64_tr_b16 v[128:129], v224 offset:0
    v_mfma_f32_16x16x32_bf16 v[72:75], v[140:143], v[156:159], v[72:75]
    v_mfma_f32_16x16x32_bf16 v[88:91], v[136:139], v[160:163], v[88:91]
    ds_read_b64_tr_b16 v[130:131], v224 offset:512
    v_mfma_f32_16x16x32_bf16 v[88:91], v[140:143], v[164:167], v[88:91]
    v_mfma_f32_16x16x32_bf16 v[104:107], v[136:139], v[168:171], v[104:107]
    ds_read_b64_tr_b16 v[132:133], v224 offset:2048
    v_mfma_f32_16x16x32_bf16 v[104:107], v[140:143], v[172:175], v[104:107]
    v_mfma_f32_16x16x32_bf16 v[120:123], v[136:139], v[176:179], v[120:123]
    ds_read_b64_tr_b16 v[134:135], v224 offset:2560
    v_mfma_f32_16x16x32_bf16 v[120:123], v[140:143], v[180:183], v[120:123]
    s_waitcnt lgkmcnt(4)
    v_mfma_f32_16x16x32_bf16 v[76:79], v[144:147], v[152:155], v[76:79]
    ds_read_b64_tr_b16 v[136:137], v225 offset:0
    v_mfma_f32_16x16x32_bf16 v[76:79], v[148:151], v[156:159], v[76:79]
    v_mfma_f32_16x16x32_bf16 v[92:95], v[144:147], v[160:163], v[92:95]
    ds_read_b64_tr_b16 v[138:139], v225 offset:512
    v_mfma_f32_16x16x32_bf16 v[92:95], v[148:151], v[164:167], v[92:95]
    v_mfma_f32_16x16x32_bf16 v[108:111], v[144:147], v[168:171], v[108:111]
    ds_read_b64_tr_b16 v[140:141], v225 offset:2048
    v_mfma_f32_16x16x32_bf16 v[108:111], v[148:151], v[172:175], v[108:111]
    v_mfma_f32_16x16x32_bf16 v[124:127], v[144:147], v[176:179], v[124:127]
    ds_read_b64_tr_b16 v[142:143], v225 offset:2560
    v_mfma_f32_16x16x32_bf16 v[124:127], v[148:151], v[180:183], v[124:127]
    s_call_b64 s[82:83], L_special
    s_waitcnt lgkmcnt(4)
    v_mfma_f32_16x16x32_bf16 v[0:3], v[128:131], a[0:3], 0
    ds_read_b64_tr_b16 v[144:145], v224 offset:8192
    v_mfma_f32_16x16x32_bf16 v[0:3], v[132:135], a[4:7], v[0:3]
    v_mfma_f32_16x16x32_bf16 v[16:19], v[128:131], a[8:11], 0
    ds_read_b64_tr_b16 v[146:147], v224 offset:8704
    s_add_u32 m0, s68, 49152
    v_mfma_f32_16x16x32_bf16 v[16:19], v[132:135], a[12:15], v[16:19]
    s_add_u32 s61, s61, s62
    s_cmp_eq_u32 s61, s101
    v_mfma_f32_16x16x32_bf16 v[32:35], v[128:131], a[16:19], 0
    s_cselect_b32 s61, s100, s61
    ds_read_b64_tr_b16 v[148:149], v224 offset:10240
    v_mfma_f32_16x16x32_bf16 v[32:35], v[132:135], a[20:23], v[32:35]
    buffer_load_dwordx4 v220, s[32:35], s61 offen offset:0 sc1 lds
    v_mfma_f32_16x16x32_bf16 v[48:51], v[128:131], a[24:27], 0
    ds_read_b64_tr_b16 v[150:151], v224 offset:10752
    v_mfma_f32_16x16x32_bf16 v[48:51], v[132:135], a[28:31], v[48:51]
    s_waitcnt lgkmcnt(4)
    v_mfma_f32_16x16x32_bf16 v[4:7], v[136:139], a[0:3], 0
    ds_read_b64_tr_b16 v[128:129], v225 offset:8192
    v_cvt_pk_bf16_f32 v184, v64, v65
    v_mfma_f32_16x16x32_bf16 v[4:7], v[140:143], a[4:7], v[4:7]
    buffer_load_dwordx4 v221, s[32:35], s61 offen offset:1024 sc1 lds
    v_mfma_f32_16x16x32_bf16 v[20:23], v[136:139], a[8:11], 0
    ds_read_b64_tr_b16 v[130:131], v225 offset:8704
    v_cvt_pk_bf16_f32 v186, v68, v69
    v_mfma_f32_16x16x32_bf16 v[20:23], v[140:143], a[12:15], v[20:23]
    v_cvt_pk_bf16_f32 v185, v66, v67
    v_cvt_pk_bf16_f32 v187, v70, v71
    v_mfma_f32_16x16x32_bf16 v[36:39], v[136:139], a[16:19], 0
    ds_read_b64_tr_b16 v[132:133], v225 offset:10240
    v_cvt_pk_bf16_f32 v188, v72, v73
    v_mfma_f32_16x16x32_bf16 v[36:39], v[140:143], a[20:23], v[36:39]
    buffer_load_dwordx4 v222, s[32:35], s61 offen offset:2048 sc1 lds
    v_mfma_f32_16x16x32_bf16 v[52:55], v[136:139], a[24:27], 0
    ds_read_b64_tr_b16 v[134:135], v225 offset:10752
    v_cvt_pk_bf16_f32 v190, v76, v77
    v_mfma_f32_16x16x32_bf16 v[52:55], v[140:143], a[28:31], v[52:55]
    v_cvt_pk_bf16_f32 v189, v74, v75
    s_waitcnt lgkmcnt(4)
    v_mfma_f32_16x16x32_bf16 v[8:11], v[144:147], a[0:3], 0
    ds_read_b64_tr_b16 v[136:137], v224 offset:16384
    v_cvt_pk_bf16_f32 v191, v78, v79
    v_mfma_f32_16x16x32_bf16 v[8:11], v[148:151], a[4:7], v[8:11]
    v_permlane16_swap_b32 v184, v186
    v_mfma_f32_16x16x32_bf16 v[24:27], v[144:147], a[8:11], 0
    ds_read_b64_tr_b16 v[138:139], v224 offset:16896
    v_cvt_pk_bf16_f32 v192, v80, v81
    v_mfma_f32_16x16x32_bf16 v[24:27], v[148:151], a[12:15], v[24:27]
    v_permlane16_swap_b32 v185, v187
    v_mfma_f32_16x16x32_bf16 v[40:43], v[144:147], a[16:19], 0
    ds_read_b64_tr_b16 v[140:141], v224 offset:18432
    buffer_load_dwordx4 v223, s[32:35], s61 offen offset:3072 sc1 lds
    v_mfma_f32_16x16x32_bf16 v[40:43], v[148:151], a[20:23], v[40:43]
    buffer_store_dwordx4 v[184:187], v230, s[44:47], s76 offen offset:0 sc1
    v_mfma_f32_16x16x32_bf16 v[56:59], v[144:147], a[24:27], 0
    ds_read_b64_tr_b16 v[142:143], v224 offset:18944
    s_add_u32 m0, s68, 65536
    s_add_u32 s61, s61, s62
    v_mfma_f32_16x16x32_bf16 v[56:59], v[148:151], a[28:31], v[56:59]
    s_cmp_eq_u32 s61, s101
    s_cselect_b32 s61, s100, s61
    s_waitcnt lgkmcnt(4)
    v_mfma_f32_16x16x32_bf16 v[12:15], v[128:131], a[0:3], 0
    ds_read_b64_tr_b16 v[144:145], v225 offset:16384
    v_cvt_pk_bf16_f32 v194, v84, v85
    v_mfma_f32_16x16x32_bf16 v[12:15], v[132:135], a[4:7], v[12:15]
    buffer_load_dwordx4 v220, s[32:35], s61 offen offset:0 sc1 lds
    v_mfma_f32_16x16x32_bf16 v[28:31], v[128:131], a[8:11], 0
    ds_read_b64_tr_b16 v[146:147], v225 offset:16896
    v_cvt_pk_bf16_f32 v193, v82, v83
    v_mfma_f32_16x16x32_bf16 v[28:31], v[132:135], a[12:15], v[28:31]
    v_permlane16_swap_b32 v188, v190
    v_mfma_f32_16x16x32_bf16 v[44:47], v[128:131], a[16:19], 0
    ds_read_b64_tr_b16 v[148:149], v225 offset:18432
    v_cvt_pk_bf16_f32 v195, v86, v87
    v_mfma_f32_16x16x32_bf16 v[44:47], v[132:135], a[20:23], v[44:47]
    buffer_load_dwordx4 v221, s[32:35], s61 offen offset:1024 sc1 lds
    v_mfma_f32_16x16x32_bf16 v[60:63], v[128:131], a[24:27], 0
    ds_read_b64_tr_b16 v[150:151], v225 offset:18944
    v_cvt_pk_bf16_f32 v196, v88, v89
    v_mfma_f32_16x16x32_bf16 v[60:63], v[132:135], a[28:31], v[60:63]
    v_cvt_pk_bf16_f32 v198, v92, v93
    s_waitcnt lgkmcnt(4)
    v_mfma_f32_16x16x32_bf16 v[0:3], v[136:139], a[32:35], v[0:3]
    ds_read_b64_tr_b16 v[128:129], v224 offset:24576
    v_cvt_pk_bf16_f32 v197, v90, v91
    v_mfma_f32_16x16x32_bf16 v[0:3], v[140:143], a[36:39], v[0:3]
    v_permlane16_swap_b32 v189, v191
    v_mfma_f32_16x16x32_bf16 v[16:19], v[136:139], a[40:43], v[16:19]
    ds_read_b64_tr_b16 v[130:131], v224 offset:25088
    v_mfma_f32_16x16x32_bf16 v[16:19], v[140:143], a[44:47], v[16:19]
    buffer_store_dwordx4 v[188:191], v230, s[44:47], s78 offen offset:0 sc1
    v_mfma_f32_16x16x32_bf16 v[32:35], v[136:139], a[48:51], v[32:35]
    ds_read_b64_tr_b16 v[132:133], v224 offset:26624
    v_mfma_f32_16x16x32_bf16 v[32:35], v[140:143], a[52:55], v[32:35]
    buffer_load_dwordx4 v222, s[32:35], s61 offen offset:2048 sc1 lds
    v_mfma_f32_16x16x32_bf16 v[48:51], v[136:139], a[56:59], v[48:51]
    ds_read_b64_tr_b16 v[134:135], v224 offset:27136
    v_cvt_pk_bf16_f32 v199, v94, v95
    v_mfma_f32_16x16x32_bf16 v[48:51], v[140:143], a[60:63], v[48:51]
    v_cvt_pk_bf16_f32 v184, v96, v97
    s_waitcnt lgkmcnt(4)
    v_mfma_f32_16x16x32_bf16 v[4:7], v[144:147], a[32:35], v[4:7]
    ds_read_b64_tr_b16 v[136:137], v225 offset:24576
    v_cvt_pk_bf16_f32 v186, v100, v101
    v_mfma_f32_16x16x32_bf16 v[4:7], v[148:151], a[36:39], v[4:7]
    buffer_load_dwordx4 v223, s[32:35], s61 offen offset:3072 sc1 lds
    v_mfma_f32_16x16x32_bf16 v[20:23], v[144:147], a[40:43], v[20:23]
    ds_read_b64_tr_b16 v[138:139], v225 offset:25088
    s_add_u32 m0, s68, 81920
    v_mfma_f32_16x16x32_bf16 v[20:23], v[148:151], a[44:47], v[20:23]
    s_add_u32 s61, s61, s62
    s_cmp_eq_u32 s61, s101
    v_mfma_f32_16x16x32_bf16 v[36:39], v[144:147], a[48:51], v[36:39]
    s_cselect_b32 s61, s100, s61
    ds_read_b64_tr_b16 v[140:141], v225 offset:26624
    v_mfma_f32_16x16x32_bf16 v[36:39], v[148:151], a[52:55], v[36:39]
    buffer_load_dwordx4 v220, s[32:35], s61 offen offset:0 sc1 lds
    v_mfma_f32_16x16x32_bf16 v[52:55], v[144:147], a[56:59], v[52:55]
    ds_read_b64_tr_b16 v[142:143], v225 offset:27136
    v_cvt_pk_bf16_f32 v185, v98, v99
    v_mfma_f32_16x16x32_bf16 v[52:55], v[148:151], a[60:63], v[52:55]
    v_cvt_pk_bf16_f32 v187, v102, v103
    s_waitcnt lgkmcnt(4)
    v_mfma_f32_16x16x32_bf16 v[8:11], v[128:131], a[32:35], v[8:11]
    ds_read_b64_tr_b16 v[144:145], v224 offset:32768
    v_cvt_pk_bf16_f32 v188, v104, v105
    v_mfma_f32_16x16x32_bf16 v[8:11], v[132:135], a[36:39], v[8:11]
    v_permlane16_swap_b32 v192, v194
    v_mfma_f32_16x16x32_bf16 v[24:27], v[128:131], a[40:43], v[24:27]
    ds_read_b64_tr_b16 v[146:147], v224 offset:33280
    v_cvt_pk_bf16_f32 v190, v108, v109
    v_mfma_f32_16x16x32_bf16 v[24:27], v[132:135], a[44:47], v[24:27]
    v_permlane16_swap_b32 v193, v195
    v_mfma_f32_16x16x32_bf16 v[40:43], v[128:131], a[48:51], v[40:43]
    ds_read_b64_tr_b16 v[148:149], v224 offset:34816
    v_cvt_pk_bf16_f32 v189, v106, v107
    v_mfma_f32_16x16x32_bf16 v[40:43], v[132:135], a[52:55], v[40:43]
    buffer_load_dwordx4 v221, s[32:35], s61 offen offset:1024 sc1 lds
    v_mfma_f32_16x16x32_bf16 v[56:59], v[128:131], a[56:59], v[56:59]
    ds_read_b64_tr_b16 v[150:151], v224 offset:35328
    v_cvt_pk_bf16_f32 v191, v110, v111
    v_mfma_f32_16x16x32_bf16 v[56:59], v[132:135], a[60:63], v[56:59]
    s_waitcnt lgkmcnt(4)
    v_mfma_f32_16x16x32_bf16 v[12:15], v[136:139], a[32:35], v[12:15]
    ds_read_b64_tr_b16 v[128:129], v225 offset:32768
    v_mfma_f32_16x16x32_bf16 v[12:15], v[140:143], a[36:39], v[12:15]
    buffer_load_dwordx4 v222, s[32:35], s61 offen offset:2048 sc1 lds
    v_mfma_f32_16x16x32_bf16 v[28:31], v[136:139], a[40:43], v[28:31]
    ds_read_b64_tr_b16 v[130:131], v225 offset:33280
    v_mfma_f32_16x16x32_bf16 v[28:31], v[140:143], a[44:47], v[28:31]
    buffer_store_dwordx4 v[192:195], v230, s[44:47], s76 offen offset:256 sc1
    v_mfma_f32_16x16x32_bf16 v[44:47], v[136:139], a[48:51], v[44:47]
    ds_read_b64_tr_b16 v[132:133], v225 offset:34816
    v_cvt_pk_bf16_f32 v192, v112, v113
    v_mfma_f32_16x16x32_bf16 v[44:47], v[140:143], a[52:55], v[44:47]
    buffer_load_dwordx4 v223, s[32:35], s61 offen offset:3072 sc1 lds
    v_mfma_f32_16x16x32_bf16 v[60:63], v[136:139], a[56:59], v[60:63]
    ds_read_b64_tr_b16 v[134:135], v225 offset:35328
    v_cvt_pk_bf16_f32 v194, v116, v117
    v_mfma_f32_16x16x32_bf16 v[60:63], v[140:143], a[60:63], v[60:63]
    v_cvt_pk_bf16_f32 v193, v114, v115
    s_waitcnt lgkmcnt(4)
    v_mfma_f32_16x16x32_bf16 v[0:3], v[144:147], a[64:67], v[0:3]
    ds_read_b64_tr_b16 v[136:137], v224 offset:40960
    v_cvt_pk_bf16_f32 v195, v118, v119
    v_mfma_f32_16x16x32_bf16 v[0:3], v[148:151], a[68:71], v[0:3]
    v_permlane16_swap_b32 v196, v198
    v_mfma_f32_16x16x32_bf16 v[16:19], v[144:147], a[72:75], v[16:19]
    ds_read_b64_tr_b16 v[138:139], v224 offset:41472
    s_add_u32 m0, s68, 98304
    v_mfma_f32_16x16x32_bf16 v[16:19], v[148:151], a[76:79], v[16:19]
    s_add_u32 s61, s61, s62
    s_cmp_eq_u32 s61, s101
    v_mfma_f32_16x16x32_bf16 v[32:35], v[144:147], a[80:83], v[32:35]
    s_cselect_b32 s61, s100, s61
    ds_read_b64_tr_b16 v[140:141], v224 offset:43008
    v_mfma_f32_16x16x32_bf16 v[32:35], v[148:151], a[84:87], v[32:35]
    buffer_load_dwordx4 v220, s[32:35], s61 offen offset:0 sc1 lds
    v_mfma_f32_16x16x32_bf16 v[48:51], v[144:147], a[88:91], v[48:51]
    ds_read_b64_tr_b16 v[142:143], v224 offset:43520
    v_mfma_f32_16x16x32_bf16 v[48:51], v[148:151], a[92:95], v[48:51]
    s_waitcnt lgkmcnt(4)
    v_mfma_f32_16x16x32_bf16 v[4:7], v[128:131], a[64:67], v[4:7]
    ds_read_b64_tr_b16 v[144:145], v225 offset:40960
    v_mfma_f32_16x16x32_bf16 v[4:7], v[132:135], a[68:71], v[4:7]
    buffer_load_dwordx4 v221, s[32:35], s61 offen offset:1024 sc1 lds
    v_mfma_f32_16x16x32_bf16 v[20:23], v[128:131], a[72:75], v[20:23]
    ds_read_b64_tr_b16 v[146:147], v225 offset:41472
    v_mfma_f32_16x16x32_bf16 v[20:23], v[132:135], a[76:79], v[20:23]
    v_permlane16_swap_b32 v197, v199
    v_mfma_f32_16x16x32_bf16 v[36:39], v[128:131], a[80:83], v[36:39]
    ds_read_b64_tr_b16 v[148:149], v225 offset:43008
    v_mfma_f32_16x16x32_bf16 v[36:39], v[132:135], a[84:87], v[36:39]
    buffer_load_dwordx4 v222, s[32:35], s61 offen offset:2048 sc1 lds
    v_mfma_f32_16x16x32_bf16 v[52:55], v[128:131], a[88:91], v[52:55]
    ds_read_b64_tr_b16 v[150:151], v225 offset:43520
    buffer_store_dwordx4 v[196:199], v230, s[44:47], s78 offen offset:256 sc1
    v_mfma_f32_16x16x32_bf16 v[52:55], v[132:135], a[92:95], v[52:55]
    s_waitcnt lgkmcnt(4)
    v_mfma_f32_16x16x32_bf16 v[8:11], v[136:139], a[64:67], v[8:11]
    s_waitcnt vmcnt(9)
    s_barrier
    v_mfma_f32_16x16x32_bf16 v[8:11], v[140:143], a[68:71], v[8:11]
    v_permlane16_swap_b32 v184, v186
    v_mfma_f32_16x16x32_bf16 v[24:27], v[136:139], a[72:75], v[24:27]
    ds_read_b64_tr_b16 v[128:129], v226 offset:0
    ds_read_b64_tr_b16 v[130:131], v226 offset:512
    ds_read_b64_tr_b16 v[208:209], v236 offset:16384
    v_mfma_f32_16x16x32_bf16 v[24:27], v[140:143], a[76:79], v[24:27]
    v_permlane16_swap_b32 v185, v187
    v_mfma_f32_16x16x32_bf16 v[40:43], v[136:139], a[80:83], v[40:43]
    ds_read_b64_tr_b16 v[132:133], v226 offset:2048
    buffer_load_dwordx4 v223, s[32:35], s61 offen offset:3072 sc1 lds
    v_mfma_f32_16x16x32_bf16 v[40:43], v[140:143], a[84:87], v[40:43]
    ds_read_b64_tr_b16 v[210:211], v236 offset:16896
    v_cvt_pk_bf16_f32 v196, v120, v121
    v_mfma_f32_16x16x32_bf16 v[56:59], v[136:139], a[88:91], v[56:59]
    ds_read_b64_tr_b16 v[134:135], v226 offset:2560
    s_add_u32 m0, s68, 114688
    s_add_u32 s61, s61, s62
    v_mfma_f32_16x16x32_bf16 v[56:59], v[140:143], a[92:95], v[56:59]
    s_cmp_eq_u32 s61, s101
    s_cselect_b32 s61, s100, s61
    s_waitcnt lgkmcnt(6)
    v_mfma_f32_16x16x32_bf16 v[12:15], v[144:147], a[64:67], v[12:15]
    ds_read_b64_tr_b16 v[136:137], v227 offset:0
    v_cvt_pk_bf16_f32 v198, v124, v125
    v_mfma_f32_16x16x32_bf16 v[12:15], v[148:151], a[68:71], v[12:15]
    buffer_load_dwordx4 v220, s[32:35], s61 offen offset:0 sc1 lds
    v_mfma_f32_16x16x32_bf16 v[28:31], v[144:147], a[72:75], v[28:31]
    ds_read_b64_tr_b16 v[138:139], v227 offset:512
    ds_read_b64_tr_b16 v[212:213], v236 offset:16448
    v_mfma_f32_16x16x32_bf16 v[28:31], v[148:151], a[76:79], v[28:31]
    ds_read_b64_tr_b16 v[214:215], v236 offset:16960
    v_cvt_pk_bf16_f32 v197, v122, v123
    v_mfma_f32_16x16x32_bf16 v[44:47], v[144:147], a[80:83], v[44:47]
    ds_read_b64_tr_b16 v[140:141], v227 offset:2048
    v_cvt_pk_bf16_f32 v199, v126, v127
    v_mfma_f32_16x16x32_bf16 v[44:47], v[148:151], a[84:87], v[44:47]
    buffer_load_dwordx4 v221, s[32:35], s61 offen offset:1024 sc1 lds
    v_mfma_f32_16x16x32_bf16 v[60:63], v[144:147], a[88:91], v[60:63]
    ds_read_b64_tr_b16 v[142:143], v227 offset:2560
    v_mfma_f32_16x16x32_bf16 v[60:63], v[148:151], a[92:95], v[60:63]
    s_waitcnt lgkmcnt(6)
    v_mfma_f32_16x16x32_bf16 v[0:3], v[128:131], a[96:99], v[0:3]
    ds_read_b64_tr_b16 v[144:145], v226 offset:8192
    v_mfma_f32_16x16x32_bf16 v[0:3], v[132:135], a[100:103], v[0:3]
    buffer_store_dwordx4 v[184:187], v230, s[44:47], s77 offen offset:0 sc1
    v_mfma_f32_16x16x32_bf16 v[16:19], v[128:131], a[104:107], v[16:19]
    ds_read_b64_tr_b16 v[146:147], v226 offset:8704
    v_mfma_f32_16x16x32_bf16 v[16:19], v[132:135], a[108:111], v[16:19]
    v_permlane16_swap_b32 v188, v190
    v_mfma_f32_16x16x32_bf16 v[32:35], v[128:131], a[112:115], v[32:35]
    ds_read_b64_tr_b16 v[148:149], v226 offset:10240
    v_mfma_f32_16x16x32_bf16 v[32:35], v[132:135], a[116:119], v[32:35]
    buffer_load_dwordx4 v222, s[32:35], s61 offen offset:2048 sc1 lds
    v_mfma_f32_16x16x32_bf16 v[48:51], v[128:131], a[120:123], v[48:51]
    ds_read_b64_tr_b16 v[150:151], v226 offset:10752
    v_mfma_f32_16x16x32_bf16 v[48:51], v[132:135], a[124:127], v[48:51]
    s_waitcnt lgkmcnt(4)
    v_mfma_f32_16x16x32_bf16 v[4:7], v[136:139], a[96:99], v[4:7]
    ds_read_b64_tr_b16 v[128:129], v227 offset:8192
    v_permlane16_swap_b32 v189, v191
    v_mfma_f32_16x16x32_bf16 v[4:7], v[140:143], a[100:103], v[4:7]
    buffer_load_dwordx4 v223, s[32:35], s61 offen offset:3072 sc1 lds
    v_mfma_f32_16x16x32_bf16 v[20:23], v[136:139], a[104:107], v[20:23]
    ds_read_b64_tr_b16 v[130:131], v227 offset:8704
    s_add_u32 m0, s68, 131072
    v_mfma_f32_16x16x32_bf16 v[20:23], v[140:143], a[108:111], v[20:23]
    s_add_u32 s61, s61, s62
    s_cmp_eq_u32 s61, s101
    v_mfma_f32_16x16x32_bf16 v[36:39], v[136:139], a[112:115], v[36:39]
    s_cselect_b32 s61, s100, s61
    ds_read_b64_tr_b16 v[132:133], v227 offset:10240
    v_mfma_f32_16x16x32_bf16 v[36:39], v[140:143], a[116:119], v[36:39]
    buffer_load_dwordx4 v220, s[32:35], s61 offen offset:0 sc1 lds
    v_mfma_f32_16x16x32_bf16 v[52:55], v[136:139], a[120:123], v[52:55]
    ds_read_b64_tr_b16 v[134:135], v227 offset:10752
    buffer_store_dwordx4 v[188:191], v230, s[44:47], s80 offen offset:0 sc1
    v_mfma_f32_16x16x32_bf16 v[52:55], v[140:143], a[124:127], v[52:55]
    s_waitcnt lgkmcnt(4)
    v_mfma_f32_16x16x32_bf16 v[8:11], v[144:147], a[96:99], v[8:11]
    ds_read_b64_tr_b16 v[136:137], v226 offset:16384
    v_mfma_f32_16x16x32_bf16 v[8:11], v[148:151], a[100:103], v[8:11]
    buffer_store_dwordx4 v[208:211], v233, s[56:59], s72 offen offset:2048 sc1
    v_mfma_f32_16x16x32_bf16 v[24:27], v[144:147], a[104:107], v[24:27]
    ds_read_b64_tr_b16 v[138:139], v226 offset:16896
    v_permlane16_swap_b32 v192, v194
    v_mfma_f32_16x16x32_bf16 v[24:27], v[148:151], a[108:111], v[24:27]
    v_permlane16_swap_b32 v193, v195
    v_mfma_f32_16x16x32_bf16 v[40:43], v[144:147], a[112:115], v[40:43]
    ds_read_b64_tr_b16 v[140:141], v226 offset:18432
    v_mfma_f32_16x16x32_bf16 v[40:43], v[148:151], a[116:119], v[40:43]
    buffer_load_dwordx4 v221, s[32:35], s61 offen offset:1024 sc1 lds
    v_mfma_f32_16x16x32_bf16 v[56:59], v[144:147], a[120:123], v[56:59]
    ds_read_b64_tr_b16 v[142:143], v226 offset:18944
    buffer_store_dwordx4 v[192:195], v230, s[44:47], s77 offen offset:256 sc1
    v_mfma_f32_16x16x32_bf16 v[56:59], v[148:151], a[124:127], v[56:59]
    s_waitcnt lgkmcnt(4)
    v_mfma_f32_16x16x32_bf16 v[12:15], v[128:131], a[96:99], v[12:15]
    ds_read_b64_tr_b16 v[144:145], v227 offset:16384
    v_mfma_f32_16x16x32_bf16 v[12:15], v[132:135], a[100:103], v[12:15]
    buffer_load_dwordx4 v222, s[32:35], s61 offen offset:2048 sc1 lds
    v_mfma_f32_16x16x32_bf16 v[28:31], v[128:131], a[104:107], v[28:31]
    ds_read_b64_tr_b16 v[146:147], v227 offset:16896
    v_permlane16_swap_b32 v196, v198
    v_mfma_f32_16x16x32_bf16 v[28:31], v[132:135], a[108:111], v[28:31]
    v_permlane16_swap_b32 v197, v199
    v_mfma_f32_16x16x32_bf16 v[44:47], v[128:131], a[112:115], v[44:47]
    ds_read_b64_tr_b16 v[148:149], v227 offset:18432
    buffer_load_dwordx4 v223, s[32:35], s61 offen offset:3072 sc1 lds
    v_mfma_f32_16x16x32_bf16 v[44:47], v[132:135], a[116:119], v[44:47]
    buffer_store_dwordx4 v[196:199], v230, s[44:47], s80 offen offset:256 sc1
    v_mfma_f32_16x16x32_bf16 v[60:63], v[128:131], a[120:123], v[60:63]
    ds_read_b64_tr_b16 v[150:151], v227 offset:18944
    s_mov_b64 s[32:33], s[36:37]
    s_mov_b32 s34, s38
    v_mfma_f32_16x16x32_bf16 v[60:63], v[132:135], a[124:127], v[60:63]
    s_mov_b32 s62, s63
    v_mov_b32 v220, v231
    s_waitcnt lgkmcnt(4)
    v_mfma_f32_16x16x32_bf16 v[0:3], v[136:139], a[128:131], v[0:3]
    ds_read_b64_tr_b16 v[128:129], v226 offset:24576
    s_mov_b32 s100, s88
    v_mfma_f32_16x16x32_bf16 v[0:3], v[140:143], a[132:135], v[0:3]
    s_lshl3_add_u32 s101, s63, s88
    v_mfma_f32_16x16x32_bf16 v[16:19], v[136:139], a[136:139], v[16:19]
    ds_read_b64_tr_b16 v[130:131], v226 offset:25088
    s_add_u32 m0, s68, 0
    v_mfma_f32_16x16x32_bf16 v[16:19], v[140:143], a[140:143], v[16:19]
    s_mov_b32 s61, s101
    v_mfma_f32_16x16x32_bf16 v[32:35], v[136:139], a[144:147], v[32:35]
    ds_read_b64_tr_b16 v[132:133], v226 offset:26624
    v_mfma_f32_16x16x32_bf16 v[32:35], v[140:143], a[148:151], v[32:35]
    buffer_load_dwordx4 v220, s[32:35], s61 offen offset:0 sc1 lds
    v_mfma_f32_16x16x32_bf16 v[48:51], v[136:139], a[152:155], v[48:51]
    ds_read_b64_tr_b16 v[134:135], v226 offset:27136
    v_add_u32 v221, s75, v220
    v_add_u32 v222, s75, v221
    v_mfma_f32_16x16x32_bf16 v[48:51], v[140:143], a[156:159], v[48:51]
    v_add_u32 v223, s75, v222
    s_waitcnt lgkmcnt(4)
    v_mfma_f32_16x16x32_bf16 v[4:7], v[144:147], a[128:131], v[4:7]
    ds_read_b64_tr_b16 v[136:137], v227 offset:24576
    v_mfma_f32_16x16x32_bf16 v[4:7], v[148:151], a[132:135], v[4:7]
    buffer_load_dwordx4 v221, s[32:35], s61 offen offset:1024 sc1 lds
    v_mfma_f32_16x16x32_bf16 v[20:23], v[144:147], a[136:139], v[20:23]
    ds_read_b64_tr_b16 v[138:139], v227 offset:25088
    v_mfma_f32_16x16x32_bf16 v[20:23], v[148:151], a[140:143], v[20:23]
    v_mfma_f32_16x16x32_bf16 v[36:39], v[144:147], a[144:147], v[36:39]
    ds_read_b64_tr_b16 v[140:141], v227 offset:26624
    v_mfma_f32_16x16x32_bf16 v[36:39], v[148:151], a[148:151], v[36:39]
    buffer_load_dwordx4 v222, s[32:35], s61 offen offset:2048 sc1 lds
    v_mfma_f32_16x16x32_bf16 v[52:55], v[144:147], a[152:155], v[52:55]
    ds_read_b64_tr_b16 v[142:143], v227 offset:27136
    v_mfma_f32_16x16x32_bf16 v[52:55], v[148:151], a[156:159], v[52:55]
    s_waitcnt lgkmcnt(4)
    v_mfma_f32_16x16x32_bf16 v[8:11], v[128:131], a[128:131], v[8:11]
    s_waitcnt vmcnt(11)
    s_barrier
    v_mfma_f32_16x16x32_bf16 v[8:11], v[132:135], a[132:135], v[8:11]
    v_mfma_f32_16x16x32_bf16 v[24:27], v[128:131], a[136:139], v[24:27]
    ds_read_b64_tr_b16 v[144:145], v226 offset:32768
    ds_read_b64_tr_b16 v[146:147], v226 offset:33280
    v_mfma_f32_16x16x32_bf16 v[24:27], v[132:135], a[140:143], v[24:27]
    v_mfma_f32_16x16x32_bf16 v[40:43], v[128:131], a[144:147], v[40:43]
    ds_read_b64_tr_b16 v[148:149], v226 offset:34816
    v_mfma_f32_16x16x32_bf16 v[40:43], v[132:135], a[148:151], v[40:43]
    buffer_load_dwordx4 v223, s[32:35], s61 offen offset:3072 sc1 lds
    v_mfma_f32_16x16x32_bf16 v[56:59], v[128:131], a[152:155], v[56:59]
    ds_read_b64_tr_b16 v[150:151], v226 offset:35328
    s_add_u32 m0, s68, 16384
    v_mfma_f32_16x16x32_bf16 v[56:59], v[132:135], a[156:159], v[56:59]
    s_mov_b32 s61, s31
    s_waitcnt lgkmcnt(4)
    v_mfma_f32_16x16x32_bf16 v[12:15], v[136:139], a[128:131], v[12:15]
    ds_read_b64_tr_b16 v[128:129], v227 offset:32768
    v_mfma_f32_16x16x32_bf16 v[12:15], v[140:143], a[132:135], v[12:15]
    buffer_load_dwordx4 v220, s[32:35], s61 offen offset:0 sc1 lds
    v_mfma_f32_16x16x32_bf16 v[28:31], v[136:139], a[136:139], v[28:31]
    ds_read_b64_tr_b16 v[130:131], v227 offset:33280
    s_lshr_b64 s[66:67], s[66:67], 8
    v_mfma_f32_16x16x32_bf16 v[28:31], v[140:143], a[140:143], v[28:31]
    v_mfma_f32_16x16x32_bf16 v[44:47], v[136:139], a[144:147], v[44:47]
    ds_read_b64_tr_b16 v[132:133], v227 offset:34816
    v_mfma_f32_16x16x32_bf16 v[44:47], v[140:143], a[148:151], v[44:47]
    buffer_load_dwordx4 v221, s[32:35], s61 offen offset:1024 sc1 lds
    v_mfma_f32_16x16x32_bf16 v[60:63], v[136:139], a[152:155], v[60:63]
    ds_read_b64_tr_b16 v[134:135], v227 offset:35328
    v_mfma_f32_16x16x32_bf16 v[60:63], v[140:143], a[156:159], v[60:63]
    s_waitcnt lgkmcnt(4)
    v_mfma_f32_16x16x32_bf16 v[0:3], v[144:147], a[160:163], v[0:3]
    ds_read_b64_tr_b16 v[136:137], v226 offset:40960
    v_mfma_f32_16x16x32_bf16 v[0:3], v[148:151], a[164:167], v[0:3]
    buffer_store_dwordx4 v[212:215], v233, s[56:59], s73 offen offset:0 sc1
    v_mfma_f32_16x16x32_bf16 v[16:19], v[144:147], a[168:171], v[16:19]
    ds_read_b64_tr_b16 v[138:139], v226 offset:41472
    v_mfma_f32_16x16x32_bf16 v[16:19], v[148:151], a[172:175], v[16:19]
    v_mfma_f32_16x16x32_bf16 v[32:35], v[144:147], a[176:179], v[32:35]
    ds_read_b64_tr_b16 v[140:141], v226 offset:43008
    v_mfma_f32_16x16x32_bf16 v[32:35], v[148:151], a[180:183], v[32:35]
    buffer_load_dwordx4 v222, s[32:35], s61 offen offset:2048 sc1 lds
    v_mfma_f32_16x16x32_bf16 v[48:51], v[144:147], a[184:187], v[48:51]
    ds_read_b64_tr_b16 v[142:143], v226 offset:43520
    v_mfma_f32_16x16x32_bf16 v[48:51], v[148:151], a[188:191], v[48:51]
    s_waitcnt lgkmcnt(4)
    v_mfma_f32_16x16x32_bf16 v[4:7], v[128:131], a[160:163], v[4:7]
    ds_read_b64_tr_b16 v[144:145], v227 offset:40960
    v_mfma_f32_16x16x32_bf16 v[4:7], v[132:135], a[164:167], v[4:7]
    buffer_load_dwordx4 v223, s[32:35], s61 offen offset:3072 sc1 lds
    v_mfma_f32_16x16x32_bf16 v[20:23], v[128:131], a[168:171], v[20:23]
    ds_read_b64_tr_b16 v[146:147], v227 offset:41472
    s_add_u32 m0, s68, 32768
    v_mfma_f32_16x16x32_bf16 v[20:23], v[132:135], a[172:175], v[20:23]
    s_add_u32 s61, s61, s62
    s_cmp_eq_u32 s61, s101
    v_mfma_f32_16x16x32_bf16 v[36:39], v[128:131], a[176:179], v[36:39]
    s_cselect_b32 s61, s100, s61
    ds_read_b64_tr_b16 v[148:149], v227 offset:43008
    v_mfma_f32_16x16x32_bf16 v[36:39], v[132:135], a[180:183], v[36:39]
    buffer_load_dwordx4 v220, s[32:35], s61 offen offset:0 sc1 lds
    v_mfma_f32_16x16x32_bf16 v[52:55], v[128:131], a[184:187], v[52:55]
    ds_read_b64_tr_b16 v[150:151], v227 offset:43520
    v_mfma_f32_16x16x32_bf16 v[52:55], v[132:135], a[188:191], v[52:55]
    s_waitcnt lgkmcnt(4)
    v_mfma_f32_16x16x32_bf16 v[8:11], v[136:139], a[160:163], v[8:11]
    ds_read_b64_tr_b16 v[128:129], v228 offset:0
    v_mfma_f32_16x16x32_bf16 v[8:11], v[140:143], a[164:167], v[8:11]
    v_mfma_f32_16x16x32_bf16 v[24:27], v[136:139], a[168:171], v[24:27]
    ds_read_b64_tr_b16 v[130:131], v228 offset:512
    v_mfma_f32_16x16x32_bf16 v[24:27], v[140:143], a[172:175], v[24:27]
    v_mfma_f32_16x16x32_bf16 v[40:43], v[136:139], a[176:179], v[40:43]
    ds_read_b64_tr_b16 v[132:133], v228 offset:2048
    v_mfma_f32_16x16x32_bf16 v[40:43], v[140:143], a[180:183], v[40:43]
    buffer_load_dwordx4 v221, s[32:35], s61 offen offset:1024 sc1 lds
    v_mfma_f32_16x16x32_bf16 v[56:59], v[136:139], a[184:187], v[56:59]
    ds_read_b64_tr_b16 v[134:135], v228 offset:2560
    v_mfma_f32_16x16x32_bf16 v[56:59], v[140:143], a[188:191], v[56:59]
    s_waitcnt lgkmcnt(4)
    v_mfma_f32_16x16x32_bf16 v[12:15], v[144:147], a[160:163], v[12:15]
    ds_read_b64_tr_b16 v[136:137], v229 offset:0
    v_mfma_f32_16x16x32_bf16 v[12:15], v[148:151], a[164:167], v[12:15]
    buffer_load_dwordx4 v222, s[32:35], s61 offen offset:2048 sc1 lds
    v_mfma_f32_16x16x32_bf16 v[28:31], v[144:147], a[168:171], v[28:31]
    ds_read_b64_tr_b16 v[138:139], v229 offset:512
    v_mfma_f32_16x16x32_bf16 v[28:31], v[148:151], a[172:175], v[28:31]
    v_mfma_f32_16x16x32_bf16 v[44:47], v[144:147], a[176:179], v[44:47]
    ds_read_b64_tr_b16 v[140:141], v229 offset:2048
    v_mfma_f32_16x16x32_bf16 v[44:47], v[148:151], a[180:183], v[44:47]
    buffer_load_dwordx4 v223, s[32:35], s61 offen offset:3072 sc1 lds
    v_mfma_f32_16x16x32_bf16 v[60:63], v[144:147], a[184:187], v[60:63]
    ds_read_b64_tr_b16 v[142:143], v229 offset:2560
    v_mfma_f32_16x16x32_bf16 v[60:63], v[148:151], a[188:191], v[60:63]
    s_waitcnt lgkmcnt(4)
    v_mfma_f32_16x16x32_bf16 v[0:3], v[128:131], a[192:195], v[0:3]
    ds_read_b64_tr_b16 v[144:145], v228 offset:8192
    v_mfma_f32_16x16x32_bf16 v[0:3], v[132:135], a[196:199], v[0:3]
    v_mfma_f32_16x16x32_bf16 v[16:19], v[128:131], a[200:203], v[16:19]
    ds_read_b64_tr_b16 v[146:147], v228 offset:8704
    v_mfma_f32_16x16x32_bf16 v[16:19], v[132:135], a[204:207], v[16:19]
    v_mfma_f32_16x16x32_bf16 v[32:35], v[128:131], a[208:211], v[32:35]
    ds_read_b64_tr_b16 v[148:149], v228 offset:10240
    s_add_u32 m0, s68, 147456
    v_mfma_f32_16x16x32_bf16 v[32:35], v[132:135], a[212:215], v[32:35]
    s_add_u32 s70, s70, 128
    v_mfma_f32_16x16x32_bf16 v[48:51], v[128:131], a[216:219], v[48:51]
    buffer_load_dwordx4 v235, s[52:55], s70 offen offset:0 nt lds
    v_mfma_f32_16x16x32_bf16 v[48:51], v[132:135], a[220:223], v[48:51]
    ds_read_b64_tr_b16 v[150:151], v228 offset:10752
    s_waitcnt lgkmcnt(4)
    v_mfma_f32_16x16x32_bf16 v[4:7], v[136:139], a[192:195], v[4:7]
    ds_read_b64_tr_b16 v[128:129], v229 offset:8192
    s_add_u32 s71, s71, 128
    v_mfma_f32_16x16x32_bf16 v[4:7], v[140:143], a[196:199], v[4:7]
    buffer_load_dwordx4 v235, s[52:55], s71 offen offset:1024 nt lds
    v_mfma_f32_16x16x32_bf16 v[20:23], v[136:139], a[200:203], v[20:23]
    ds_read_b64_tr_b16 v[130:131], v229 offset:8704
    v_mfma_f32_16x16x32_bf16 v[20:23], v[140:143], a[204:207], v[20:23]
    v_mfma_f32_16x16x32_bf16 v[36:39], v[136:139], a[208:211], v[36:39]
    ds_read_b64_tr_b16 v[132:133], v229 offset:10240
    v_mfma_f32_16x16x32_bf16 v[36:39], v[140:143], a[212:215], v[36:39]
    v_mfma_f32_16x16x32_bf16 v[52:55], v[136:139], a[216:219], v[52:55]
    ds_read_b64_tr_b16 v[134:135], v229 offset:10752
    v_mfma_f32_16x16x32_bf16 v[52:55], v[140:143], a[220:223], v[52:55]
    s_waitcnt lgkmcnt(4)
    v_mfma_f32_16x16x32_bf16 v[8:11], v[144:147], a[192:195], v[8:11]
    ds_read_b64_tr_b16 v[136:137], v228 offset:16384
    v_mfma_f32_16x16x32_bf16 v[8:11], v[148:151], a[196:199], v[8:11]
    v_mfma_f32_16x16x32_bf16 v[24:27], v[144:147], a[200:203], v[24:27]
    ds_read_b64_tr_b16 v[138:139], v228 offset:16896
    v_mfma_f32_16x16x32_bf16 v[24:27], v[148:151], a[204:207], v[24:27]
    v_mfma_f32_16x16x32_bf16 v[40:43], v[144:147], a[208:211], v[40:43]
    ds_read_b64_tr_b16 v[140:141], v228 offset:18432
    v_mfma_f32_16x16x32_bf16 v[40:43], v[148:151], a[212:215], v[40:43]
    v_mfma_f32_16x16x32_bf16 v[56:59], v[144:147], a[216:219], v[56:59]
    ds_read_b64_tr_b16 v[142:143], v228 offset:18944
    v_mfma_f32_16x16x32_bf16 v[56:59], v[148:151], a[220:223], v[56:59]
    s_waitcnt lgkmcnt(4)
    v_mfma_f32_16x16x32_bf16 v[12:15], v[128:131], a[192:195], v[12:15]
    ds_read_b64_tr_b16 v[144:145], v229 offset:16384
    v_mfma_f32_16x16x32_bf16 v[12:15], v[132:135], a[196:199], v[12:15]
    v_mfma_f32_16x16x32_bf16 v[28:31], v[128:131], a[200:203], v[28:31]
    ds_read_b64_tr_b16 v[146:147], v229 offset:16896
    v_mfma_f32_16x16x32_bf16 v[28:31], v[132:135], a[204:207], v[28:31]
    v_mfma_f32_16x16x32_bf16 v[44:47], v[128:131], a[208:211], v[44:47]
    ds_read_b64_tr_b16 v[148:149], v229 offset:18432
    v_mfma_f32_16x16x32_bf16 v[44:47], v[132:135], a[212:215], v[44:47]
    v_mfma_f32_16x16x32_bf16 v[60:63], v[128:131], a[216:219], v[60:63]
    ds_read_b64_tr_b16 v[150:151], v229 offset:18944
    v_mfma_f32_16x16x32_bf16 v[60:63], v[132:135], a[220:223], v[60:63]
    s_waitcnt lgkmcnt(4)
    v_mfma_f32_16x16x32_bf16 v[0:3], v[136:139], a[224:227], v[0:3]
    ds_read_b64_tr_b16 v[128:129], v228 offset:24576
    v_mfma_f32_16x16x32_bf16 v[0:3], v[140:143], a[228:231], v[0:3]
    v_mfma_f32_16x16x32_bf16 v[16:19], v[136:139], a[232:235], v[16:19]
    ds_read_b64_tr_b16 v[130:131], v228 offset:25088
    v_mfma_f32_16x16x32_bf16 v[16:19], v[140:143], a[236:239], v[16:19]
    v_mfma_f32_16x16x32_bf16 v[32:35], v[136:139], a[240:243], v[32:35]
    ds_read_b64_tr_b16 v[132:133], v228 offset:26624
    v_mfma_f32_16x16x32_bf16 v[32:35], v[140:143], a[244:247], v[32:35]
    v_mfma_f32_16x16x32_bf16 v[48:51], v[136:139], a[248:251], v[48:51]
    ds_read_b64_tr_b16 v[134:135], v228 offset:27136
    v_mfma_f32_16x16x32_bf16 v[48:51], v[140:143], a[252:255], v[48:51]
    s_waitcnt lgkmcnt(4)
    v_mfma_f32_16x16x32_bf16 v[4:7], v[144:147], a[224:227], v[4:7]
    ds_read_b64_tr_b16 v[136:137], v229 offset:24576
    v_mfma_f32_16x16x32_bf16 v[4:7], v[148:151], a[228:231], v[4:7]
    v_mfma_f32_16x16x32_bf16 v[20:23], v[144:147], a[232:235], v[20:23]
    ds_read_b64_tr_b16 v[138:139], v229 offset:25088
    v_mfma_f32_16x16x32_bf16 v[20:23], v[148:151], a[236:239], v[20:23]
    v_mfma_f32_16x16x32_bf16 v[36:39], v[144:147], a[240:243], v[36:39]
    ds_read_b64_tr_b16 v[140:141], v229 offset:26624
    v_mfma_f32_16x16x32_bf16 v[36:39], v[148:151], a[244:247], v[36:39]
    v_mfma_f32_16x16x32_bf16 v[52:55], v[144:147], a[248:251], v[52:55]
    ds_read_b64_tr_b16 v[142:143], v229 offset:27136
    v_mfma_f32_16x16x32_bf16 v[52:55], v[148:151], a[252:255], v[52:55]
    s_waitcnt lgkmcnt(4)
    v_mfma_f32_16x16x32_bf16 v[8:11], v[128:131], a[224:227], v[8:11]
    s_waitcnt vmcnt(2)
    s_barrier
    v_mfma_f32_16x16x32_bf16 v[8:11], v[132:135], a[228:231], v[8:11]
    v_mfma_f32_16x16x32_bf16 v[24:27], v[128:131], a[232:235], v[24:27]
    ds_read_b64_tr_b16 v[144:145], v228 offset:32768
    v_mfma_f32_16x16x32_bf16 v[24:27], v[132:135], a[236:239], v[24:27]
    ds_read_b64_tr_b16 v[146:147], v228 offset:33280
    v_mfma_f32_16x16x32_bf16 v[40:43], v[128:131], a[240:243], v[40:43]
    ds_read_b64_tr_b16 v[148:149], v228 offset:34816
    v_mfma_f32_16x16x32_bf16 v[40:43], v[132:135], a[244:247], v[40:43]
    v_mfma_f32_16x16x32_bf16 v[56:59], v[128:131], a[248:251], v[56:59]
    ds_read_b64_tr_b16 v[150:151], v228 offset:35328
    v_mfma_f32_16x16x32_bf16 v[56:59], v[132:135], a[252:255], v[56:59]
    s_waitcnt lgkmcnt(4)
    v_mfma_f32_16x16x32_bf16 v[12:15], v[136:139], a[224:227], v[12:15]
    ds_read_b64_tr_b16 v[128:129], v229 offset:32768
    v_mfma_f32_16x16x32_bf16 v[12:15], v[140:143], a[228:231], v[12:15]
    v_mfma_f32_16x16x32_bf16 v[28:31], v[136:139], a[232:235], v[28:31]
    ds_read_b64_tr_b16 v[130:131], v229 offset:33280
    v_mfma_f32_16x16x32_bf16 v[28:31], v[140:143], a[236:239], v[28:31]
    v_mfma_f32_16x16x32_bf16 v[44:47], v[136:139], a[240:243], v[44:47]
    ds_read_b64_tr_b16 v[132:133], v229 offset:34816
    v_mfma_f32_16x16x32_bf16 v[44:47], v[140:143], a[244:247], v[44:47]
    v_mfma_f32_16x16x32_bf16 v[60:63], v[136:139], a[248:251], v[60:63]
    ds_read_b64_tr_b16 v[134:135], v229 offset:35328
    v_mfma_f32_16x16x32_bf16 v[60:63], v[140:143], a[252:255], v[60:63]
    s_waitcnt lgkmcnt(4)
    v_mfma_f32_16x16x32_bf16 v[0:3], v[144:147], v[152:155], v[0:3]
    ds_read_b64_tr_b16 v[136:137], v228 offset:40960
    v_mfma_f32_16x16x32_bf16 v[0:3], v[148:151], v[156:159], v[0:3]
    v_mfma_f32_16x16x32_bf16 v[16:19], v[144:147], v[160:163], v[16:19]
    ds_read_b64_tr_b16 v[138:139], v228 offset:41472
    v_mfma_f32_16x16x32_bf16 v[16:19], v[148:151], v[164:167], v[16:19]
    v_mfma_f32_16x16x32_bf16 v[32:35], v[144:147], v[168:171], v[32:35]
    ds_read_b64_tr_b16 v[140:141], v228 offset:43008
    v_mfma_f32_16x16x32_bf16 v[32:35], v[148:151], v[172:175], v[32:35]
    v_mfma_f32_16x16x32_bf16 v[48:51], v[144:147], v[176:179], v[48:51]
    ds_read_b64_tr_b16 v[142:143], v228 offset:43520
    v_mfma_f32_16x16x32_bf16 v[48:51], v[148:151], v[180:183], v[48:51]
    s_waitcnt lgkmcnt(4)
    v_mfma_f32_16x16x32_bf16 v[4:7], v[128:131], v[152:155], v[4:7]
    ds_read_b64_tr_b16 v[144:145], v229 offset:40960
    v_mfma_f32_16x16x32_bf16 v[4:7], v[132:135], v[156:159], v[4:7]
    v_mfma_f32_16x16x32_bf16 v[20:23], v[128:131], v[160:163], v[20:23]
    ds_read_b64_tr_b16 v[146:147], v229 offset:41472
    v_mfma_f32_16x16x32_bf16 v[20:23], v[132:135], v[164:167], v[20:23]
    v_mfma_f32_16x16x32_bf16 v[36:39], v[128:131], v[168:171], v[36:39]
    ds_read_b64_tr_b16 v[148:149], v229 offset:43008
    v_mfma_f32_16x16x32_bf16 v[36:39], v[132:135], v[172:175], v[36:39]
    v_mfma_f32_16x16x32_bf16 v[52:55], v[128:131], v[176:179], v[52:55]
    ds_read_b64_tr_b16 v[150:151], v229 offset:43520
    v_mfma_f32_16x16x32_bf16 v[52:55], v[132:135], v[180:183], v[52:55]
    s_waitcnt lgkmcnt(4)
    v_mfma_f32_16x16x32_bf16 v[8:11], v[136:139], v[152:155], v[8:11]
    ds_read_b64_tr_b16 v[128:129], v224 offset:0
    v_mfma_f32_16x16x32_bf16 v[8:11], v[140:143], v[156:159], v[8:11]
    v_mfma_f32_16x16x32_bf16 v[24:27], v[136:139], v[160:163], v[24:27]
    ds_read_b64_tr_b16 v[130:131], v224 offset:512
    v_mfma_f32_16x16x32_bf16 v[24:27], v[140:143], v[164:167], v[24:27]
    v_mfma_f32_16x16x32_bf16 v[40:43], v[136:139], v[168:171], v[40:43]
    ds_read_b64_tr_b16 v[132:133], v224 offset:2048
    v_mfma_f32_16x16x32_bf16 v[40:43], v[140:143], v[172:175], v[40:43]
    v_mfma_f32_16x16x32_bf16 v[56:59], v[136:139], v[176:179], v[56:59]
    ds_read_b64_tr_b16 v[134:135], v224 offset:2560
    v_mfma_f32_16x16x32_bf16 v[56:59], v[140:143], v[180:183], v[56:59]
    s_waitcnt lgkmcnt(4)
    v_mfma_f32_16x16x32_bf16 v[12:15], v[144:147], v[152:155], v[12:15]
    ds_read_b64_tr_b16 v[136:137], v225 offset:0
    v_mfma_f32_16x16x32_bf16 v[12:15], v[148:151], v[156:159], v[12:15]
    v_mfma_f32_16x16x32_bf16 v[28:31], v[144:147], v[160:163], v[28:31]
    ds_read_b64_tr_b16 v[138:139], v225 offset:512
    v_mfma_f32_16x16x32_bf16 v[28:31], v[148:151], v[164:167], v[28:31]
    v_mfma_f32_16x16x32_bf16 v[44:47], v[144:147], v[168:171], v[44:47]
    ds_read_b64_tr_b16 v[140:141], v225 offset:2048
    v_mfma_f32_16x16x32_bf16 v[44:47], v[148:151], v[172:175], v[44:47]
    v_mfma_f32_16x16x32_bf16 v[60:63], v[144:147], v[176:179], v[60:63]
    ds_read_b64_tr_b16 v[142:143], v225 offset:2560
    v_mfma_f32_16x16x32_bf16 v[60:63], v[148:151], v[180:183], v[60:63]
    s_call_b64 s[82:83], L_special
    s_waitcnt lgkmcnt(4)
    v_mfma_f32_16x16x32_bf16 v[64:67], v[128:131], a[0:3], 0
    ds_read_b64_tr_b16 v[144:145], v224 offset:8192
    v_mfma_f32_16x16x32_bf16 v[64:67], v[132:135], a[4:7], v[64:67]
    v_mfma_f32_16x16x32_bf16 v[80:83], v[128:131], a[8:11], 0
    ds_read_b64_tr_b16 v[146:147], v224 offset:8704
    s_add_u32 m0, s68, 49152
    v_mfma_f32_16x16x32_bf16 v[80:83], v[132:135], a[12:15], v[80:83]
    s_add_u32 s61, s61, s62
    s_cmp_eq_u32 s61, s101
    v_mfma_f32_16x16x32_bf16 v[96:99], v[128:131], a[16:19], 0
    s_cselect_b32 s61, s100, s61
    ds_read_b64_tr_b16 v[148:149], v224 offset:10240
    v_mfma_f32_16x16x32_bf16 v[96:99], v[132:135], a[20:23], v[96:99]
    buffer_load_dwordx4 v220, s[32:35], s61 offen offset:0 sc1 lds
    v_mfma_f32_16x16x32_bf16 v[112:115], v[128:131], a[24:27], 0
    ds_read_b64_tr_b16 v[150:151], v224 offset:10752
    v_mfma_f32_16x16x32_bf16 v[112:115], v[132:135], a[28:31], v[112:115]
    s_waitcnt lgkmcnt(4)
    v_mfma_f32_16x16x32_bf16 v[68:71], v[136:139], a[0:3], 0
    ds_read_b64_tr_b16 v[128:129], v225 offset:8192
    v_cvt_pk_bf16_f32 v184, v0, v1
    v_mfma_f32_16x16x32_bf16 v[68:71], v[140:143], a[4:7], v[68:71]
    buffer_load_dwordx4 v221, s[32:35], s61 offen offset:1024 sc1 lds
    v_mfma_f32_16x16x32_bf16 v[84:87], v[136:139], a[8:11], 0
    ds_read_b64_tr_b16 v[130:131], v225 offset:8704
    v_cvt_pk_bf16_f32 v186, v4, v5
    v_mfma_f32_16x16x32_bf16 v[84:87], v[140:143], a[12:15], v[84:87]
    v_cvt_pk_bf16_f32 v185, v2, v3
    v_cvt_pk_bf16_f32 v187, v6, v7
    v_mfma_f32_16x16x32_bf16 v[100:103], v[136:139], a[16:19], 0
    ds_read_b64_tr_b16 v[132:133], v225 offset:10240
    v_cvt_pk_bf16_f32 v188, v8, v9
    v_mfma_f32_16x16x32_bf16 v[100:103], v[140:143], a[20:23], v[100:103]
    buffer_load_dwordx4 v222, s[32:35], s61 offen offset:2048 sc1 lds
    v_mfma_f32_16x16x32_bf16 v[116:119], v[136:139], a[24:27], 0
    ds_read_b64_tr_b16 v[134:135], v225 offset:10752
    v_cvt_pk_bf16_f32 v190, v12, v13
    v_mfma_f32_16x16x32_bf16 v[116:119], v[140:143], a[28:31], v[116:119]
    v_cvt_pk_bf16_f32 v189, v10, v11
    s_waitcnt lgkmcnt(4)
    v_mfma_f32_16x16x32_bf16 v[72:75], v[144:147], a[0:3], 0
    ds_read_b64_tr_b16 v[136:137], v224 offset:16384
    s_mov_b32 s74, 31784960
    v_mfma_f32_16x16x32_bf16 v[72:75], v[148:151], a[4:7], v[72:75]
    buffer_load_dwordx4 v[244:247], v233, s[44:47], s74 offen sc1
    v_mfma_f32_16x16x32_bf16 v[88:91], v[144:147], a[8:11], 0
    ds_read_b64_tr_b16 v[138:139], v224 offset:16896
    v_permlane16_swap_b32 v184, v186
    v_mfma_f32_16x16x32_bf16 v[88:91], v[148:151], a[12:15], v[88:91]
    v_permlane16_swap_b32 v185, v187
    v_mfma_f32_16x16x32_bf16 v[104:107], v[144:147], a[16:19], 0
    ds_read_b64_tr_b16 v[140:141], v224 offset:18432
    buffer_load_dwordx4 v223, s[32:35], s61 offen offset:3072 sc1 lds
    v_mfma_f32_16x16x32_bf16 v[104:107], v[148:151], a[20:23], v[104:107]
    buffer_store_dwordx4 v[184:187], v230, s[44:47], s76 offen offset:0 sc1
    v_mfma_f32_16x16x32_bf16 v[120:123], v[144:147], a[24:27], 0
    ds_read_b64_tr_b16 v[142:143], v224 offset:18944
    s_add_u32 m0, s68, 65536
    s_add_u32 s61, s61, s62
    v_mfma_f32_16x16x32_bf16 v[120:123], v[148:151], a[28:31], v[120:123]
    s_cmp_eq_u32 s61, s101
    s_cselect_b32 s61, s100, s61
    s_waitcnt lgkmcnt(4)
    v_mfma_f32_16x16x32_bf16 v[76:79], v[128:131], a[0:3], 0
    ds_read_b64_tr_b16 v[144:145], v225 offset:16384
    v_cvt_pk_bf16_f32 v191, v14, v15
    v_mfma_f32_16x16x32_bf16 v[76:79], v[132:135], a[4:7], v[76:79]
    buffer_load_dwordx4 v220, s[32:35], s61 offen offset:0 sc1 lds
    v_mfma_f32_16x16x32_bf16 v[92:95], v[128:131], a[8:11], 0
    ds_read_b64_tr_b16 v[146:147], v225 offset:16896
    v_cvt_pk_bf16_f32 v192, v16, v17
    v_mfma_f32_16x16x32_bf16 v[92:95], v[132:135], a[12:15], v[92:95]
    v_permlane16_swap_b32 v188, v190
    v_mfma_f32_16x16x32_bf16 v[108:111], v[128:131], a[16:19], 0
    ds_read_b64_tr_b16 v[148:149], v225 offset:18432
    v_cvt_pk_bf16_f32 v194, v20, v21
    v_mfma_f32_16x16x32_bf16 v[108:111], v[132:135], a[20:23], v[108:111]
    buffer_load_dwordx4 v221, s[32:35], s61 offen offset:1024 sc1 lds
    v_mfma_f32_16x16x32_bf16 v[124:127], v[128:131], a[24:27], 0
    ds_read_b64_tr_b16 v[150:151], v225 offset:18944
    v_cvt_pk_bf16_f32 v193, v18, v19
    v_mfma_f32_16x16x32_bf16 v[124:127], v[132:135], a[28:31], v[124:127]
    v_cvt_pk_bf16_f32 v195, v22, v23
    s_waitcnt lgkmcnt(4)
    v_mfma_f32_16x16x32_bf16 v[64:67], v[136:139], a[32:35], v[64:67]
    ds_read_b64_tr_b16 v[128:129], v224 offset:24576
    v_permlane16_swap_b32 v189, v191
    v_mfma_f32_16x16x32_bf16 v[64:67], v[140:143], a[36:39], v[64:67]
    buffer_store_dwordx4 v[188:191], v230, s[44:47], s78 offen offset:0 sc1
    v_cvt_pk_bf16_f32 v196, v24, v25
    v_mfma_f32_16x16x32_bf16 v[80:83], v[136:139], a[40:43], v[80:83]
    ds_read_b64_tr_b16 v[130:131], v224 offset:25088
    v_cvt_pk_bf16_f32 v198, v28, v29
    v_mfma_f32_16x16x32_bf16 v[80:83], v[140:143], a[44:47], v[80:83]
    v_permlane16_swap_b32 v192, v194
    v_mfma_f32_16x16x32_bf16 v[96:99], v[136:139], a[48:51], v[96:99]
    ds_read_b64_tr_b16 v[132:133], v224 offset:26624
    v_cvt_pk_bf16_f32 v197, v26, v27
    v_mfma_f32_16x16x32_bf16 v[96:99], v[140:143], a[52:55], v[96:99]
    buffer_load_dwordx4 v222, s[32:35], s61 offen offset:2048 sc1 lds
    v_mfma_f32_16x16x32_bf16 v[112:115], v[136:139], a[56:59], v[112:115]
    ds_read_b64_tr_b16 v[134:135], v224 offset:27136
    v_permlane16_swap_b32 v193, v195
    v_mfma_f32_16x16x32_bf16 v[112:115], v[140:143], a[60:63], v[112:115]
    buffer_store_dwordx4 v[192:195], v230, s[44:47], s76 offen offset:256 sc1
    s_waitcnt lgkmcnt(4)
    v_mfma_f32_16x16x32_bf16 v[68:71], v[144:147], a[32:35], v[68:71]
    ds_read_b64_tr_b16 v[136:137], v225 offset:24576
    v_cvt_pk_bf16_f32 v199, v30, v31
    v_mfma_f32_16x16x32_bf16 v[68:71], v[148:151], a[36:39], v[68:71]
    buffer_load_dwordx4 v223, s[32:35], s61 offen offset:3072 sc1 lds
    v_mfma_f32_16x16x32_bf16 v[84:87], v[144:147], a[40:43], v[84:87]
    ds_read_b64_tr_b16 v[138:139], v225 offset:25088
    s_add_u32 m0, s68, 81920
    v_mfma_f32_16x16x32_bf16 v[84:87], v[148:151], a[44:47], v[84:87]
    s_add_u32 s61, s61, s62
    s_cmp_eq_u32 s61, s101
    v_mfma_f32_16x16x32_bf16 v[100:103], v[144:147], a[48:51], v[100:103]
    s_cselect_b32 s61, s100, s61
    ds_read_b64_tr_b16 v[140:141], v225 offset:26624
    v_cvt_pk_bf16_f32 v184, v32, v33
    v_mfma_f32_16x16x32_bf16 v[100:103], v[148:151], a[52:55], v[100:103]
    buffer_load_dwordx4 v220, s[32:35], s61 offen offset:0 sc1 lds
    v_mfma_f32_16x16x32_bf16 v[116:119], v[144:147], a[56:59], v[116:119]
    ds_read_b64_tr_b16 v[142:143], v225 offset:27136
    v_permlane16_swap_b32 v196, v198
    v_mfma_f32_16x16x32_bf16 v[116:119], v[148:151], a[60:63], v[116:119]
    v_cvt_pk_bf16_f32 v186, v36, v37
    s_waitcnt lgkmcnt(4)
    v_mfma_f32_16x16x32_bf16 v[72:75], v[128:131], a[32:35], v[72:75]
    ds_read_b64_tr_b16 v[144:145], v224 offset:32768
    v_cvt_pk_bf16_f32 v185, v34, v35
    v_mfma_f32_16x16x32_bf16 v[72:75], v[132:135], a[36:39], v[72:75]
    v_permlane16_swap_b32 v197, v199
    v_cvt_pk_bf16_f32 v187, v38, v39
    v_mfma_f32_16x16x32_bf16 v[88:91], v[128:131], a[40:43], v[88:91]
    ds_read_b64_tr_b16 v[146:147], v224 offset:33280
    v_cvt_pk_bf16_f32 v188, v40, v41
    v_mfma_f32_16x16x32_bf16 v[88:91], v[132:135], a[44:47], v[88:91]
    buffer_store_dwordx4 v[196:199], v230, s[44:47], s78 offen offset:256 sc1
    v_mfma_f32_16x16x32_bf16 v[104:107], v[128:131], a[48:51], v[104:107]
    ds_read_b64_tr_b16 v[148:149], v224 offset:34816
    v_cvt_pk_bf16_f32 v190, v44, v45
    v_mfma_f32_16x16x32_bf16 v[104:107], v[132:135], a[52:55], v[104:107]
    buffer_load_dwordx4 v221, s[32:35], s61 offen offset:1024 sc1 lds
    v_mfma_f32_16x16x32_bf16 v[120:123], v[128:131], a[56:59], v[120:123]
    ds_read_b64_tr_b16 v[150:151], v224 offset:35328
    v_permlane16_swap_b32 v184, v186
    v_mfma_f32_16x16x32_bf16 v[120:123], v[132:135], a[60:63], v[120:123]
    v_permlane16_swap_b32 v185, v187
    s_waitcnt lgkmcnt(4)
    v_mfma_f32_16x16x32_bf16 v[76:79], v[136:139], a[32:35], v[76:79]
    ds_read_b64_tr_b16 v[128:129], v225 offset:32768
    buffer_store_dwordx4 v[184:187], v230, s[44:47], s77 offen offset:0 sc1
    v_mfma_f32_16x16x32_bf16 v[76:79], v[140:143], a[36:39], v[76:79]
    buffer_load_dwordx4 v222, s[32:35], s61 offen offset:2048 sc1 lds
    v_mfma_f32_16x16x32_bf16 v[92:95], v[136:139], a[40:43], v[92:95]
    ds_read_b64_tr_b16 v[130:131], v225 offset:33280
    v_permlane16_swap_b32 v188, v190
    v_mfma_f32_16x16x32_bf16 v[92:95], v[140:143], a[44:47], v[92:95]
    v_cvt_pk_bf16_f32 v189, v42, v43
    v_cvt_pk_bf16_f32 v191, v46, v47
    v_mfma_f32_16x16x32_bf16 v[108:111], v[136:139], a[48:51], v[108:111]
    ds_read_b64_tr_b16 v[132:133], v225 offset:34816
    v_cvt_pk_bf16_f32 v192, v48, v49
    v_mfma_f32_16x16x32_bf16 v[108:111], v[140:143], a[52:55], v[108:111]
    buffer_load_dwordx4 v223, s[32:35], s61 offen offset:3072 sc1 lds
    v_mfma_f32_16x16x32_bf16 v[124:127], v[136:139], a[56:59], v[124:127]
    ds_read_b64_tr_b16 v[134:135], v225 offset:35328
    v_permlane16_swap_b32 v189, v191
    v_mfma_f32_16x16x32_bf16 v[124:127], v[140:143], a[60:63], v[124:127]
    v_cvt_pk_bf16_f32 v194, v52, v53
    s_waitcnt lgkmcnt(4)
    v_mfma_f32_16x16x32_bf16 v[64:67], v[144:147], a[64:67], v[64:67]
    ds_read_b64_tr_b16 v[136:137], v224 offset:40960
    v_cvt_pk_bf16_f32 v193, v50, v51
    v_mfma_f32_16x16x32_bf16 v[64:67], v[148:151], a[68:71], v[64:67]
    buffer_store_dwordx4 v[188:191], v230, s[44:47], s80 offen offset:0 sc1
    v_mfma_f32_16x16x32_bf16 v[80:83], v[144:147], a[72:75], v[80:83]
    ds_read_b64_tr_b16 v[138:139], v224 offset:41472
    s_add_u32 m0, s68, 98304
    v_mfma_f32_16x16x32_bf16 v[80:83], v[148:151], a[76:79], v[80:83]
    s_add_u32 s61, s61, s62
    s_cmp_eq_u32 s61, s101
    v_mfma_f32_16x16x32_bf16 v[96:99], v[144:147], a[80:83], v[96:99]
    s_cselect_b32 s61, s100, s61
    ds_read_b64_tr_b16 v[140:141], v224 offset:43008
    v_cvt_pk_bf16_f32 v195, v54, v55
    v_mfma_f32_16x16x32_bf16 v[96:99], v[148:151], a[84:87], v[96:99]
    buffer_load_dwordx4 v220, s[32:35], s61 offen offset:0 sc1 lds
    v_cvt_pk_bf16_f32 v196, v56, v57
    v_mfma_f32_16x16x32_bf16 v[112:115], v[144:147], a[88:91], v[112:115]
    ds_read_b64_tr_b16 v[142:143], v224 offset:43520
    v_permlane16_swap_b32 v192, v194
    v_mfma_f32_16x16x32_bf16 v[112:115], v[148:151], a[92:95], v[112:115]
    v_cvt_pk_bf16_f32 v198, v60, v61
    s_waitcnt lgkmcnt(4)
    v_mfma_f32_16x16x32_bf16 v[68:71], v[128:131], a[64:67], v[68:71]
    ds_read_b64_tr_b16 v[144:145], v225 offset:40960
    v_cvt_pk_bf16_f32 v197, v58, v59
    v_mfma_f32_16x16x32_bf16 v[68:71], v[132:135], a[68:71], v[68:71]
    buffer_load_dwordx4 v221, s[32:35], s61 offen offset:1024 sc1 lds
    v_mfma_f32_16x16x32_bf16 v[84:87], v[128:131], a[72:75], v[84:87]
    ds_read_b64_tr_b16 v[146:147], v225 offset:41472
    v_permlane16_swap_b32 v193, v195
    v_mfma_f32_16x16x32_bf16 v[84:87], v[132:135], a[76:79], v[84:87]
    buffer_store_dwordx4 v[192:195], v230, s[44:47], s77 offen offset:256 sc1
    v_mfma_f32_16x16x32_bf16 v[100:103], v[128:131], a[80:83], v[100:103]
    ds_read_b64_tr_b16 v[148:149], v225 offset:43008
    v_cvt_pk_bf16_f32 v199, v62, v63
    v_mfma_f32_16x16x32_bf16 v[100:103], v[132:135], a[84:87], v[100:103]
    buffer_load_dwordx4 v222, s[32:35], s61 offen offset:2048 sc1 lds
    v_mfma_f32_16x16x32_bf16 v[116:119], v[128:131], a[88:91], v[116:119]
    ds_read_b64_tr_b16 v[150:151], v225 offset:43520
    v_permlane16_swap_b32 v196, v198
    v_mfma_f32_16x16x32_bf16 v[116:119], v[132:135], a[92:95], v[116:119]
    s_waitcnt lgkmcnt(4)
    v_mfma_f32_16x16x32_bf16 v[72:75], v[136:139], a[64:67], v[72:75]
    s_waitcnt vmcnt(11)
    s_barrier
    v_mfma_f32_16x16x32_bf16 v[72:75], v[140:143], a[68:71], v[72:75]
    v_permlane16_swap_b32 v197, v199
    v_mfma_f32_16x16x32_bf16 v[88:91], v[136:139], a[72:75], v[88:91]
    ds_read_b64_tr_b16 v[128:129], v226 offset:0
    ds_read_b64_tr_b16 v[130:131], v226 offset:512
    ds_read_b64_tr_b16 v[208:209], v236 offset:16384
    v_mfma_f32_16x16x32_bf16 v[88:91], v[140:143], a[76:79], v[88:91]
    buffer_store_dwordx4 v[196:199], v230, s[44:47], s80 offen offset:256 sc1
    v_mfma_f32_16x16x32_bf16 v[104:107], v[136:139], a[80:83], v[104:107]
    ds_read_b64_tr_b16 v[132:133], v226 offset:2048
    buffer_load_dwordx4 v223, s[32:35], s61 offen offset:3072 sc1 lds
    v_mfma_f32_16x16x32_bf16 v[104:107], v[140:143], a[84:87], v[104:107]
    ds_read_b64_tr_b16 v[210:211], v236 offset:16896
    v_mfma_f32_16x16x32_bf16 v[120:123], v[136:139], a[88:91], v[120:123]
    ds_read_b64_tr_b16 v[134:135], v226 offset:2560
    s_add_u32 m0, s68, 114688
    s_add_u32 s61, s61, s62
    v_mfma_f32_16x16x32_bf16 v[120:123], v[140:143], a[92:95], v[120:123]
    s_cmp_eq_u32 s61, s101
    s_cselect_b32 s61, s100, s61
    s_waitcnt lgkmcnt(6)
    v_mfma_f32_16x16x32_bf16 v[76:79], v[144:147], a[64:67], v[76:79]
    ds_read_b64_tr_b16 v[136:137], v227 offset:0
    v_mfma_f32_16x16x32_bf16 v[76:79], v[148:151], a[68:71], v[76:79]
    buffer_load_dwordx4 v220, s[32:35], s61 offen offset:0 sc1 lds
    v_mfma_f32_16x16x32_bf16 v[92:95], v[144:147], a[72:75], v[92:95]
    ds_read_b64_tr_b16 v[138:139], v227 offset:512
    ds_read_b64_tr_b16 v[212:213], v236 offset:16448
    v_mfma_f32_16x16x32_bf16 v[92:95], v[148:151], a[76:79], v[92:95]
    ds_read_b64_tr_b16 v[214:215], v236 offset:16960
    v_mfma_f32_16x16x32_bf16 v[108:111], v[144:147], a[80:83], v[108:111]
    ds_read_b64_tr_b16 v[140:141], v227 offset:2048
    v_mfma_f32_16x16x32_bf16 v[108:111], v[148:151], a[84:87], v[108:111]
    buffer_load_dwordx4 v221, s[32:35], s61 offen offset:1024 sc1 lds
    v_mfma_f32_16x16x32_bf16 v[124:127], v[144:147], a[88:91], v[124:127]
    ds_read_b64_tr_b16 v[142:143], v227 offset:2560
    v_mfma_f32_16x16x32_bf16 v[124:127], v[148:151], a[92:95], v[124:127]
    s_waitcnt lgkmcnt(6)
    v_mfma_f32_16x16x32_bf16 v[64:67], v[128:131], a[96:99], v[64:67]
    ds_read_b64_tr_b16 v[144:145], v226 offset:8192
    s_mov_b64 s[40:41], s[28:29]
    v_mfma_f32_16x16x32_bf16 v[64:67], v[132:135], a[100:103], v[64:67]
    s_mov_b32 s42, 31610880
    v_mfma_f32_16x16x32_bf16 v[80:83], v[128:131], a[104:107], v[80:83]
    ds_read_b64_tr_b16 v[146:147], v226 offset:8704
    s_waitcnt lgkmcnt(4)
    v_mfma_f32_16x16x32_bf16 v[80:83], v[132:135], a[108:111], v[80:83]
    buffer_store_dwordx4 v[208:211], v233, s[56:59], s73 offen offset:1024 sc1
    v_mfma_f32_16x16x32_bf16 v[96:99], v[128:131], a[112:115], v[96:99]
    ds_read_b64_tr_b16 v[148:149], v226 offset:10240
    v_mfma_f32_16x16x32_bf16 v[96:99], v[132:135], a[116:119], v[96:99]
    buffer_load_dwordx4 v222, s[32:35], s61 offen offset:2048 sc1 lds
    v_mfma_f32_16x16x32_bf16 v[112:115], v[128:131], a[120:123], v[112:115]
    ds_read_b64_tr_b16 v[150:151], v226 offset:10752
    v_mfma_f32_16x16x32_bf16 v[112:115], v[132:135], a[124:127], v[112:115]
    buffer_store_dwordx4 v[212:215], v233, s[56:59], s73 offen offset:2048 sc1
    s_waitcnt lgkmcnt(4)
    v_mfma_f32_16x16x32_bf16 v[68:71], v[136:139], a[96:99], v[68:71]
    ds_read_b64_tr_b16 v[128:129], v227 offset:8192
    v_mfma_f32_16x16x32_bf16 v[68:71], v[140:143], a[100:103], v[68:71]
    buffer_load_dwordx4 v223, s[32:35], s61 offen offset:3072 sc1 lds
    v_mfma_f32_16x16x32_bf16 v[84:87], v[136:139], a[104:107], v[84:87]
    ds_read_b64_tr_b16 v[130:131], v227 offset:8704
    s_add_u32 m0, s68, 131072
    v_mfma_f32_16x16x32_bf16 v[84:87], v[140:143], a[108:111], v[84:87]
    s_add_u32 s61, s61, s62
    s_cmp_eq_u32 s61, s101
    v_mfma_f32_16x16x32_bf16 v[100:103], v[136:139], a[112:115], v[100:103]
    s_cselect_b32 s61, s100, s61
    ds_read_b64_tr_b16 v[132:133], v227 offset:10240
    v_mfma_f32_16x16x32_bf16 v[100:103], v[140:143], a[116:119], v[100:103]
    buffer_load_dwordx4 v220, s[32:35], s61 offen offset:0 sc1 lds
    v_mfma_f32_16x16x32_bf16 v[116:119], v[136:139], a[120:123], v[116:119]
    ds_read_b64_tr_b16 v[134:135], v227 offset:10752
    v_mfma_f32_16x16x32_bf16 v[116:119], v[140:143], a[124:127], v[116:119]
    s_waitcnt lgkmcnt(4)
    v_mfma_f32_16x16x32_bf16 v[72:75], v[144:147], a[96:99], v[72:75]
    ds_read_b64_tr_b16 v[136:137], v226 offset:16384
    v_min3_u32 v244, v244, v245, v246
    v_mfma_f32_16x16x32_bf16 v[72:75], v[148:151], a[100:103], v[72:75]
    v_min_u32 v244, v244, v247
    v_cmp_eq_u32 vcc, 0, v244
    v_mfma_f32_16x16x32_bf16 v[88:91], v[144:147], a[104:107], v[88:91]
    ds_read_b64_tr_b16 v[138:139], v226 offset:16896
    s_cbranch_vccnz L_kvspins
L_kvoks:
    v_mfma_f32_16x16x32_bf16 v[88:91], v[148:151], a[108:111], v[88:91]
    v_mfma_f32_16x16x32_bf16 v[104:107], v[144:147], a[112:115], v[104:107]
    ds_read_b64_tr_b16 v[140:141], v226 offset:18432
    v_mfma_f32_16x16x32_bf16 v[104:107], v[148:151], a[116:119], v[104:107]
    buffer_load_dwordx4 v221, s[32:35], s61 offen offset:1024 sc1 lds
    v_mfma_f32_16x16x32_bf16 v[120:123], v[144:147], a[120:123], v[120:123]
    ds_read_b64_tr_b16 v[142:143], v226 offset:18944
    v_mfma_f32_16x16x32_bf16 v[120:123], v[148:151], a[124:127], v[120:123]
    s_waitcnt lgkmcnt(4)
    v_mfma_f32_16x16x32_bf16 v[76:79], v[128:131], a[96:99], v[76:79]
    ds_read_b64_tr_b16 v[144:145], v227 offset:16384
    v_mfma_f32_16x16x32_bf16 v[76:79], v[132:135], a[100:103], v[76:79]
    buffer_load_dwordx4 v222, s[32:35], s61 offen offset:2048 sc1 lds
    v_mfma_f32_16x16x32_bf16 v[92:95], v[128:131], a[104:107], v[92:95]
    ds_read_b64_tr_b16 v[146:147], v227 offset:16896
    v_mfma_f32_16x16x32_bf16 v[92:95], v[132:135], a[108:111], v[92:95]
    v_mfma_f32_16x16x32_bf16 v[108:111], v[128:131], a[112:115], v[108:111]
    ds_read_b64_tr_b16 v[148:149], v227 offset:18432
    v_mfma_f32_16x16x32_bf16 v[108:111], v[132:135], a[116:119], v[108:111]
    buffer_load_dwordx4 v223, s[32:35], s61 offen offset:3072 sc1 lds
    v_mfma_f32_16x16x32_bf16 v[124:127], v[128:131], a[120:123], v[124:127]
    ds_read_b64_tr_b16 v[150:151], v227 offset:18944
    v_mfma_f32_16x16x32_bf16 v[124:127], v[132:135], a[124:127], v[124:127]
    s_waitcnt lgkmcnt(4)
    v_mfma_f32_16x16x32_bf16 v[64:67], v[136:139], a[128:131], v[64:67]
    ds_read_b64_tr_b16 v[128:129], v226 offset:24576
    s_lshl_b32 s76, s87, 7
    v_mfma_f32_16x16x32_bf16 v[64:67], v[140:143], a[132:135], v[64:67]
    s_add_u32 s76, s76, 31789056
    v_mfma_f32_16x16x32_bf16 v[80:83], v[136:139], a[136:139], v[80:83]
    ds_read_b64_tr_b16 v[130:131], v226 offset:25088
    s_add_u32 m0, s68, 0
    v_mfma_f32_16x16x32_bf16 v[80:83], v[140:143], a[140:143], v[80:83]
    s_add_u32 s101, s68, 31457280
    v_mfma_f32_16x16x32_bf16 v[96:99], v[136:139], a[144:147], v[96:99]
    ds_read_b64_tr_b16 v[132:133], v226 offset:26624
    v_mfma_f32_16x16x32_bf16 v[96:99], v[140:143], a[148:151], v[96:99]
    buffer_load_dwordx4 v233, s[40:43], s101 offen offset:0 sc1 lds
    v_mfma_f32_16x16x32_bf16 v[112:115], v[136:139], a[152:155], v[112:115]
    ds_read_b64_tr_b16 v[134:135], v226 offset:27136
    v_mfma_f32_16x16x32_bf16 v[112:115], v[140:143], a[156:159], v[112:115]
    s_waitcnt lgkmcnt(4)
    v_mfma_f32_16x16x32_bf16 v[68:71], v[144:147], a[128:131], v[68:71]
    ds_read_b64_tr_b16 v[136:137], v227 offset:24576
    v_mfma_f32_16x16x32_bf16 v[68:71], v[148:151], a[132:135], v[68:71]
    buffer_load_dwordx4 v233, s[40:43], s101 offen offset:1024 sc1 lds
    v_mfma_f32_16x16x32_bf16 v[84:87], v[144:147], a[136:139], v[84:87]
    ds_read_b64_tr_b16 v[138:139], v227 offset:25088
    s_lshl_b32 s92, s2, 2
    v_mfma_f32_16x16x32_bf16 v[84:87], v[148:151], a[140:143], v[84:87]
    s_add_u32 s92, s92, 31785984
    v_mfma_f32_16x16x32_bf16 v[100:103], v[144:147], a[144:147], v[100:103]
    ds_read_b64_tr_b16 v[140:141], v227 offset:26624
    v_mfma_f32_16x16x32_bf16 v[100:103], v[148:151], a[148:151], v[100:103]
    buffer_load_dwordx4 v233, s[40:43], s101 offen offset:2048 sc1 lds
    v_mfma_f32_16x16x32_bf16 v[116:119], v[144:147], a[152:155], v[116:119]
    ds_read_b64_tr_b16 v[142:143], v227 offset:27136
    s_and_b32 s78, s2, 2
    v_mfma_f32_16x16x32_bf16 v[116:119], v[148:151], a[156:159], v[116:119]
    s_lshl1_add_u32 s78, s78, s76
    s_waitcnt lgkmcnt(4)
    v_mfma_f32_16x16x32_bf16 v[72:75], v[128:131], a[128:131], v[72:75]
    s_waitcnt vmcnt(7)
    s_barrier
    v_mfma_f32_16x16x32_bf16 v[72:75], v[132:135], a[132:135], v[72:75]
    v_mfma_f32_16x16x32_bf16 v[88:91], v[128:131], a[136:139], v[88:91]
    ds_read_b64_tr_b16 v[144:145], v226 offset:32768
    ds_read_b64_tr_b16 v[146:147], v226 offset:33280
    v_mfma_f32_16x16x32_bf16 v[88:91], v[132:135], a[140:143], v[88:91]
    buffer_store_dword v240, v239, s[44:47], s92 offen sc1
    v_mfma_f32_16x16x32_bf16 v[104:107], v[128:131], a[144:147], v[104:107]
    ds_read_b64_tr_b16 v[148:149], v226 offset:34816
    buffer_load_dwordx4 v233, s[40:43], s101 offen offset:3072 sc1 lds
    v_mfma_f32_16x16x32_bf16 v[104:107], v[132:135], a[148:151], v[104:107]
    v_mfma_f32_16x16x32_bf16 v[120:123], v[128:131], a[152:155], v[120:123]
    buffer_store_dword v240, v239, s[44:47], s78 offen sc1
    ds_read_b64_tr_b16 v[150:151], v226 offset:35328
    v_mfma_f32_16x16x32_bf16 v[120:123], v[132:135], a[156:159], v[120:123]
    s_add_u32 m0, s68, 16384
    s_add_u32 s101, s68, 31473664
    s_waitcnt lgkmcnt(4)
    v_mfma_f32_16x16x32_bf16 v[76:79], v[136:139], a[128:131], v[76:79]
    ds_read_b64_tr_b16 v[128:129], v227 offset:32768
    v_mfma_f32_16x16x32_bf16 v[76:79], v[140:143], a[132:135], v[76:79]
    buffer_load_dwordx4 v233, s[40:43], s101 offen offset:0 sc1 lds
    v_mfma_f32_16x16x32_bf16 v[92:95], v[136:139], a[136:139], v[92:95]
    ds_read_b64_tr_b16 v[130:131], v227 offset:33280
    v_mfma_f32_16x16x32_bf16 v[92:95], v[140:143], a[140:143], v[92:95]
    v_mfma_f32_16x16x32_bf16 v[108:111], v[136:139], a[144:147], v[108:111]
    ds_read_b64_tr_b16 v[132:133], v227 offset:34816
    v_mfma_f32_16x16x32_bf16 v[108:111], v[140:143], a[148:151], v[108:111]
    buffer_load_dwordx4 v233, s[40:43], s101 offen offset:1024 sc1 lds
    v_mfma_f32_16x16x32_bf16 v[124:127], v[136:139], a[152:155], v[124:127]
    ds_read_b64_tr_b16 v[134:135], v227 offset:35328
    v_mfma_f32_16x16x32_bf16 v[124:127], v[140:143], a[156:159], v[124:127]
    s_waitcnt lgkmcnt(4)
    v_mfma_f32_16x16x32_bf16 v[64:67], v[144:147], a[160:163], v[64:67]
    ds_read_b64_tr_b16 v[136:137], v226 offset:40960
    v_mfma_f32_16x16x32_bf16 v[64:67], v[148:151], a[164:167], v[64:67]
    v_mfma_f32_16x16x32_bf16 v[80:83], v[144:147], a[168:171], v[80:83]
    ds_read_b64_tr_b16 v[138:139], v226 offset:41472
    v_mfma_f32_16x16x32_bf16 v[80:83], v[148:151], a[172:175], v[80:83]
    v_mfma_f32_16x16x32_bf16 v[96:99], v[144:147], a[176:179], v[96:99]
    ds_read_b64_tr_b16 v[140:141], v226 offset:43008
    v_mfma_f32_16x16x32_bf16 v[96:99], v[148:151], a[180:183], v[96:99]
    buffer_load_dwordx4 v233, s[40:43], s101 offen offset:2048 sc1 lds
    v_mfma_f32_16x16x32_bf16 v[112:115], v[144:147], a[184:187], v[112:115]
    ds_read_b64_tr_b16 v[142:143], v226 offset:43520
    v_mfma_f32_16x16x32_bf16 v[112:115], v[148:151], a[188:191], v[112:115]
    s_waitcnt lgkmcnt(4)
    v_mfma_f32_16x16x32_bf16 v[68:71], v[128:131], a[160:163], v[68:71]
    ds_read_b64_tr_b16 v[144:145], v227 offset:40960
    v_mfma_f32_16x16x32_bf16 v[68:71], v[132:135], a[164:167], v[68:71]
    buffer_load_dwordx4 v233, s[40:43], s101 offen offset:3072 sc1 lds
    v_mfma_f32_16x16x32_bf16 v[84:87], v[128:131], a[168:171], v[84:87]
    ds_read_b64_tr_b16 v[146:147], v227 offset:41472
    s_add_u32 m0, s68, 32768
    v_mfma_f32_16x16x32_bf16 v[84:87], v[132:135], a[172:175], v[84:87]
    s_add_u32 s101, s68, 31490048
    v_mfma_f32_16x16x32_bf16 v[100:103], v[128:131], a[176:179], v[100:103]
    ds_read_b64_tr_b16 v[148:149], v227 offset:43008
    v_mfma_f32_16x16x32_bf16 v[100:103], v[132:135], a[180:183], v[100:103]
    buffer_load_dwordx4 v233, s[40:43], s101 offen offset:0 sc1 lds
    v_mfma_f32_16x16x32_bf16 v[116:119], v[128:131], a[184:187], v[116:119]
    ds_read_b64_tr_b16 v[150:151], v227 offset:43520
    v_mfma_f32_16x16x32_bf16 v[116:119], v[132:135], a[188:191], v[116:119]
    s_waitcnt lgkmcnt(4)
    v_mfma_f32_16x16x32_bf16 v[72:75], v[136:139], a[160:163], v[72:75]
    ds_read_b64_tr_b16 v[128:129], v228 offset:0
    v_mfma_f32_16x16x32_bf16 v[72:75], v[140:143], a[164:167], v[72:75]
    v_mfma_f32_16x16x32_bf16 v[88:91], v[136:139], a[168:171], v[88:91]
    ds_read_b64_tr_b16 v[130:131], v228 offset:512
    v_lshl_add_u32 v249, s60, 2, v233
    v_mfma_f32_16x16x32_bf16 v[88:91], v[140:143], a[172:175], v[88:91]
    s_add_u32 s77, s22, 36864
    v_mfma_f32_16x16x32_bf16 v[104:107], v[136:139], a[176:179], v[104:107]
    ds_read_b64_tr_b16 v[132:133], v228 offset:2048
    v_mfma_f32_16x16x32_bf16 v[104:107], v[140:143], a[180:183], v[104:107]
    buffer_load_dwordx4 v233, s[40:43], s101 offen offset:1024 sc1 lds
    v_mfma_f32_16x16x32_bf16 v[120:123], v[136:139], a[184:187], v[120:123]
    ds_read_b64_tr_b16 v[134:135], v228 offset:2560
    v_mfma_f32_16x16x32_bf16 v[120:123], v[140:143], a[188:191], v[120:123]
    s_waitcnt lgkmcnt(4)
    v_mfma_f32_16x16x32_bf16 v[76:79], v[144:147], a[160:163], v[76:79]
    ds_read_b64_tr_b16 v[136:137], v229 offset:0
    v_mfma_f32_16x16x32_bf16 v[76:79], v[148:151], a[164:167], v[76:79]
    buffer_load_dwordx4 v233, s[40:43], s101 offen offset:2048 sc1 lds
    v_mfma_f32_16x16x32_bf16 v[92:95], v[144:147], a[168:171], v[92:95]
    ds_read_b64_tr_b16 v[138:139], v229 offset:512
    v_mfma_f32_16x16x32_bf16 v[92:95], v[148:151], a[172:175], v[92:95]
    v_mfma_f32_16x16x32_bf16 v[108:111], v[144:147], a[176:179], v[108:111]
    ds_read_b64_tr_b16 v[140:141], v229 offset:2048
    v_mfma_f32_16x16x32_bf16 v[108:111], v[148:151], a[180:183], v[108:111]
    buffer_load_dwordx4 v233, s[40:43], s101 offen offset:3072 sc1 lds
    v_mfma_f32_16x16x32_bf16 v[124:127], v[144:147], a[184:187], v[124:127]
    ds_read_b64_tr_b16 v[142:143], v229 offset:2560
    v_mfma_f32_16x16x32_bf16 v[124:127], v[148:151], a[188:191], v[124:127]
    s_waitcnt lgkmcnt(4)
    v_mfma_f32_16x16x32_bf16 v[64:67], v[128:131], a[192:195], v[64:67]
    ds_read_b64_tr_b16 v[144:145], v228 offset:8192
    v_mfma_f32_16x16x32_bf16 v[64:67], v[132:135], a[196:199], v[64:67]
    v_mfma_f32_16x16x32_bf16 v[80:83], v[128:131], a[200:203], v[80:83]
    ds_read_b64_tr_b16 v[146:147], v228 offset:8704
    s_add_u32 m0, s68, 49152
    v_mfma_f32_16x16x32_bf16 v[80:83], v[132:135], a[204:207], v[80:83]
    s_add_u32 s101, s68, 31506432
    v_mfma_f32_16x16x32_bf16 v[96:99], v[128:131], a[208:211], v[96:99]
    ds_read_b64_tr_b16 v[148:149], v228 offset:10240
    v_mfma_f32_16x16x32_bf16 v[96:99], v[132:135], a[212:215], v[96:99]
    buffer_load_dwordx4 v233, s[40:43], s101 offen offset:0 sc1 lds
    v_mfma_f32_16x16x32_bf16 v[112:115], v[128:131], a[216:219], v[112:115]
    ds_read_b64_tr_b16 v[150:151], v228 offset:10752
    v_mfma_f32_16x16x32_bf16 v[112:115], v[132:135], a[220:223], v[112:115]
    s_waitcnt lgkmcnt(4)
    v_mfma_f32_16x16x32_bf16 v[68:71], v[136:139], a[192:195], v[68:71]
    ds_read_b64_tr_b16 v[128:129], v229 offset:8192
    v_mfma_f32_16x16x32_bf16 v[68:71], v[140:143], a[196:199], v[68:71]
    buffer_load_dwordx4 v233, s[40:43], s101 offen offset:1024 sc1 lds
    v_mfma_f32_16x16x32_bf16 v[84:87], v[136:139], a[200:203], v[84:87]
    ds_read_b64_tr_b16 v[130:131], v229 offset:8704
    v_mfma_f32_16x16x32_bf16 v[84:87], v[140:143], a[204:207], v[84:87]
    v_mfma_f32_16x16x32_bf16 v[100:103], v[136:139], a[208:211], v[100:103]
    ds_read_b64_tr_b16 v[132:133], v229 offset:10240
    v_mfma_f32_16x16x32_bf16 v[100:103], v[140:143], a[212:215], v[100:103]
    buffer_load_dwordx4 v233, s[40:43], s101 offen offset:2048 sc1 lds
    v_mfma_f32_16x16x32_bf16 v[116:119], v[136:139], a[216:219], v[116:119]
    ds_read_b64_tr_b16 v[134:135], v229 offset:10752
    v_mfma_f32_16x16x32_bf16 v[116:119], v[140:143], a[220:223], v[116:119]
    s_waitcnt lgkmcnt(4)
    v_mfma_f32_16x16x32_bf16 v[72:75], v[144:147], a[192:195], v[72:75]
    s_waitcnt vmcnt(17)
    s_barrier
    v_mfma_f32_16x16x32_bf16 v[72:75], v[148:151], a[196:199], v[72:75]
    v_mfma_f32_16x16x32_bf16 v[88:91], v[144:147], a[200:203], v[88:91]
    ds_read_b64_tr_b16 v[136:137], v228 offset:16384
    ds_read_b64_tr_b16 v[138:139], v228 offset:16896
    v_mfma_f32_16x16x32_bf16 v[88:91], v[148:151], a[204:207], v[88:91]
    v_mfma_f32_16x16x32_bf16 v[104:107], v[144:147], a[208:211], v[104:107]
    ds_read_b64_tr_b16 v[140:141], v228 offset:18432
    v_mfma_f32_16x16x32_bf16 v[104:107], v[148:151], a[212:215], v[104:107]
    buffer_load_dwordx4 v233, s[40:43], s101 offen offset:3072 sc1 lds
    v_mfma_f32_16x16x32_bf16 v[120:123], v[144:147], a[216:219], v[120:123]
    ds_read_b64_tr_b16 v[142:143], v228 offset:18944
    s_add_u32 m0, s68, 65536
    v_mfma_f32_16x16x32_bf16 v[120:123], v[148:151], a[220:223], v[120:123]
    s_add_u32 s101, s68, 31522816
    s_waitcnt lgkmcnt(4)
    v_mfma_f32_16x16x32_bf16 v[76:79], v[128:131], a[192:195], v[76:79]
    ds_read_b64_tr_b16 v[144:145], v229 offset:16384
    v_mfma_f32_16x16x32_bf16 v[76:79], v[132:135], a[196:199], v[76:79]
    buffer_load_dwordx4 v233, s[40:43], s101 offen offset:0 sc1 lds
    v_mfma_f32_16x16x32_bf16 v[92:95], v[128:131], a[200:203], v[92:95]
    ds_read_b64_tr_b16 v[146:147], v229 offset:16896
    v_mfma_f32_16x16x32_bf16 v[92:95], v[132:135], a[204:207], v[92:95]
    v_mfma_f32_16x16x32_bf16 v[108:111], v[128:131], a[208:211], v[108:111]
    ds_read_b64_tr_b16 v[148:149], v229 offset:18432
    v_mfma_f32_16x16x32_bf16 v[108:111], v[132:135], a[212:215], v[108:111]
    buffer_load_dwordx4 v233, s[40:43], s101 offen offset:1024 sc1 lds
    v_mfma_f32_16x16x32_bf16 v[124:127], v[128:131], a[216:219], v[124:127]
    ds_read_b64_tr_b16 v[150:151], v229 offset:18944
    v_mfma_f32_16x16x32_bf16 v[124:127], v[132:135], a[220:223], v[124:127]
    s_waitcnt lgkmcnt(4)
    v_mfma_f32_16x16x32_bf16 v[64:67], v[136:139], a[224:227], v[64:67]
    ds_read_b64_tr_b16 v[128:129], v228 offset:24576
    v_mfma_f32_16x16x32_bf16 v[64:67], v[140:143], a[228:231], v[64:67]
    v_mfma_f32_16x16x32_bf16 v[80:83], v[136:139], a[232:235], v[80:83]
    ds_read_b64_tr_b16 v[130:131], v228 offset:25088
    v_mfma_f32_16x16x32_bf16 v[80:83], v[140:143], a[236:239], v[80:83]
    v_mfma_f32_16x16x32_bf16 v[96:99], v[136:139], a[240:243], v[96:99]
    ds_read_b64_tr_b16 v[132:133], v228 offset:26624
    v_mfma_f32_16x16x32_bf16 v[96:99], v[140:143], a[244:247], v[96:99]
    buffer_load_dwordx4 v233, s[40:43], s101 offen offset:2048 sc1 lds
    v_mfma_f32_16x16x32_bf16 v[112:115], v[136:139], a[248:251], v[112:115]
    ds_read_b64_tr_b16 v[134:135], v228 offset:27136
    v_mfma_f32_16x16x32_bf16 v[112:115], v[140:143], a[252:255], v[112:115]
    s_waitcnt lgkmcnt(4)
    v_mfma_f32_16x16x32_bf16 v[68:71], v[144:147], a[224:227], v[68:71]
    ds_read_b64_tr_b16 v[136:137], v229 offset:24576
    v_mfma_f32_16x16x32_bf16 v[68:71], v[148:151], a[228:231], v[68:71]
    buffer_load_dwordx4 v233, s[40:43], s101 offen offset:3072 sc1 lds
    v_mfma_f32_16x16x32_bf16 v[84:87], v[144:147], a[232:235], v[84:87]
    ds_read_b64_tr_b16 v[138:139], v229 offset:25088
    s_add_u32 m0, s68, 81920
    v_mfma_f32_16x16x32_bf16 v[84:87], v[148:151], a[236:239], v[84:87]
    s_add_u32 s101, s68, 31539200
    v_mfma_f32_16x16x32_bf16 v[100:103], v[144:147], a[240:243], v[100:103]
    ds_read_b64_tr_b16 v[140:141], v229 offset:26624
    v_mfma_f32_16x16x32_bf16 v[100:103], v[148:151], a[244:247], v[100:103]
    buffer_load_dwordx4 v233, s[40:43], s101 offen offset:0 sc1 lds
    v_mfma_f32_16x16x32_bf16 v[116:119], v[144:147], a[248:251], v[116:119]
    ds_read_b64_tr_b16 v[142:143], v229 offset:27136
    v_mfma_f32_16x16x32_bf16 v[116:119], v[148:151], a[252:255], v[116:119]
    s_waitcnt lgkmcnt(4)
    v_mfma_f32_16x16x32_bf16 v[72:75], v[128:131], a[224:227], v[72:75]
    ds_read_b64_tr_b16 v[144:145], v228 offset:32768
    v_mfma_f32_16x16x32_bf16 v[72:75], v[132:135], a[228:231], v[72:75]
    v_mfma_f32_16x16x32_bf16 v[88:91], v[128:131], a[232:235], v[88:91]
    ds_read_b64_tr_b16 v[146:147], v228 offset:33280
    v_mfma_f32_16x16x32_bf16 v[88:91], v[132:135], a[236:239], v[88:91]
    v_mfma_f32_16x16x32_bf16 v[104:107], v[128:131], a[240:243], v[104:107]
    ds_read_b64_tr_b16 v[148:149], v228 offset:34816
    v_mfma_f32_16x16x32_bf16 v[104:107], v[132:135], a[244:247], v[104:107]
    buffer_load_dwordx4 v233, s[40:43], s101 offen offset:1024 sc1 lds
    v_mfma_f32_16x16x32_bf16 v[120:123], v[128:131], a[248:251], v[120:123]
    ds_read_b64_tr_b16 v[150:151], v228 offset:35328
    v_mfma_f32_16x16x32_bf16 v[120:123], v[132:135], a[252:255], v[120:123]
    s_waitcnt lgkmcnt(4)
    v_mfma_f32_16x16x32_bf16 v[76:79], v[136:139], a[224:227], v[76:79]
    ds_read_b64_tr_b16 v[128:129], v229 offset:32768
    v_mfma_f32_16x16x32_bf16 v[76:79], v[140:143], a[228:231], v[76:79]
    buffer_load_dwordx4 v233, s[40:43], s101 offen offset:2048 sc1 lds
    v_mfma_f32_16x16x32_bf16 v[92:95], v[136:139], a[232:235], v[92:95]
    ds_read_b64_tr_b16 v[130:131], v229 offset:33280
    v_mfma_f32_16x16x32_bf16 v[92:95], v[140:143], a[236:239], v[92:95]
    v_mfma_f32_16x16x32_bf16 v[108:111], v[136:139], a[240:243], v[108:111]
    ds_read_b64_tr_b16 v[132:133], v229 offset:34816
    v_mfma_f32_16x16x32_bf16 v[108:111], v[140:143], a[244:247], v[108:111]
    buffer_load_dwordx4 v233, s[40:43], s101 offen offset:3072 sc1 lds
    v_mfma_f32_16x16x32_bf16 v[124:127], v[136:139], a[248:251], v[124:127]
    ds_read_b64_tr_b16 v[134:135], v229 offset:35328
    v_mfma_f32_16x16x32_bf16 v[124:127], v[140:143], a[252:255], v[124:127]
    s_waitcnt lgkmcnt(4)
    v_mfma_f32_16x16x32_bf16 v[64:67], v[144:147], v[152:155], v[64:67]
    s_waitcnt vmcnt(16)
    s_barrier
    v_mfma_f32_16x16x32_bf16 v[64:67], v[148:151], v[156:159], v[64:67]
    v_mfma_f32_16x16x32_bf16 v[80:83], v[144:147], v[160:163], v[80:83]
    ds_read_b64_tr_b16 v[136:137], v228 offset:40960
    ds_read_b64_tr_b16 v[138:139], v228 offset:41472
    v_mfma_f32_16x16x32_bf16 v[80:83], v[148:151], v[164:167], v[80:83]
    s_add_u32 m0, s68, 98304
    s_add_u32 s101, s68, 31555584
    v_mfma_f32_16x16x32_bf16 v[96:99], v[144:147], v[168:171], v[96:99]
    ds_read_b64_tr_b16 v[140:141], v228 offset:43008
    v_mfma_f32_16x16x32_bf16 v[96:99], v[148:151], v[172:175], v[96:99]
    buffer_load_dwordx4 v233, s[40:43], s101 offen offset:0 sc1 lds
    v_mfma_f32_16x16x32_bf16 v[112:115], v[144:147], v[176:179], v[112:115]
    ds_read_b64_tr_b16 v[142:143], v228 offset:43520
    v_mfma_f32_16x16x32_bf16 v[112:115], v[148:151], v[180:183], v[112:115]
    s_waitcnt lgkmcnt(4)
    v_mfma_f32_16x16x32_bf16 v[68:71], v[128:131], v[152:155], v[68:71]
    ds_read_b64_tr_b16 v[144:145], v229 offset:40960
    v_mfma_f32_16x16x32_bf16 v[68:71], v[132:135], v[156:159], v[68:71]
    v_mfma_f32_16x16x32_bf16 v[84:87], v[128:131], v[160:163], v[84:87]
    ds_read_b64_tr_b16 v[146:147], v229 offset:41472
    v_mfma_f32_16x16x32_bf16 v[84:87], v[132:135], v[164:167], v[84:87]
    v_mfma_f32_16x16x32_bf16 v[100:103], v[128:131], v[168:171], v[100:103]
    ds_read_b64_tr_b16 v[148:149], v229 offset:43008
    v_mfma_f32_16x16x32_bf16 v[100:103], v[132:135], v[172:175], v[100:103]
    buffer_load_dwordx4 v233, s[40:43], s101 offen offset:1024 sc1 lds
    v_mfma_f32_16x16x32_bf16 v[116:119], v[128:131], v[176:179], v[116:119]
    ds_read_b64_tr_b16 v[150:151], v229 offset:43520
    v_mfma_f32_16x16x32_bf16 v[116:119], v[132:135], v[180:183], v[116:119]
    s_waitcnt lgkmcnt(4)
    v_mfma_f32_16x16x32_bf16 v[72:75], v[136:139], v[152:155], v[72:75]
    v_mfma_f32_16x16x32_bf16 v[72:75], v[140:143], v[156:159], v[72:75]
    v_mfma_f32_16x16x32_bf16 v[88:91], v[136:139], v[160:163], v[88:91]
    v_mfma_f32_16x16x32_bf16 v[88:91], v[140:143], v[164:167], v[88:91]
    v_mfma_f32_16x16x32_bf16 v[104:107], v[136:139], v[168:171], v[104:107]
    buffer_load_dwordx4 v233, s[40:43], s101 offen offset:2048 sc1 lds
    v_mfma_f32_16x16x32_bf16 v[104:107], v[140:143], v[172:175], v[104:107]
    v_mfma_f32_16x16x32_bf16 v[120:123], v[136:139], v[176:179], v[120:123]
    v_mfma_f32_16x16x32_bf16 v[120:123], v[140:143], v[180:183], v[120:123]
    s_waitcnt lgkmcnt(0)
    v_mfma_f32_16x16x32_bf16 v[76:79], v[144:147], v[152:155], v[76:79]
    v_mfma_f32_16x16x32_bf16 v[76:79], v[148:151], v[156:159], v[76:79]
    v_mfma_f32_16x16x32_bf16 v[92:95], v[144:147], v[160:163], v[92:95]
    v_mfma_f32_16x16x32_bf16 v[92:95], v[148:151], v[164:167], v[92:95]
    v_mfma_f32_16x16x32_bf16 v[108:111], v[144:147], v[168:171], v[108:111]
    buffer_load_dwordx4 v233, s[40:43], s101 offen offset:3072 sc1 lds
    v_mfma_f32_16x16x32_bf16 v[108:111], v[148:151], v[172:175], v[108:111]
    v_mfma_f32_16x16x32_bf16 v[124:127], v[144:147], v[176:179], v[124:127]
    v_mfma_f32_16x16x32_bf16 v[124:127], v[148:151], v[180:183], v[124:127]
    s_nop 7
    v_mov_b32 v0, v64
    v_mov_b32 v1, v65
    v_mov_b32 v2, v66
    v_mov_b32 v3, v67
    v_mov_b32 v4, v68
    v_mov_b32 v5, v69
    v_mov_b32 v6, v70
    v_mov_b32 v7, v71
    v_mov_b32 v8, v72
    v_mov_b32 v9, v73
    v_mov_b32 v10, v74
    v_mov_b32 v11, v75
    v_mov_b32 v12, v76
    v_mov_b32 v13, v77
    v_mov_b32 v14, v78
    v_mov_b32 v15, v79
    v_mov_b32 v16, v80
    v_mov_b32 v17, v81
    v_mov_b32 v18, v82
    v_mov_b32 v19, v83
    v_mov_b32 v20, v84
    v_mov_b32 v21, v85
    v_mov_b32 v22, v86
    v_mov_b32 v23, v87
    v_mov_b32 v24, v88
    v_mov_b32 v25, v89
    v_mov_b32 v26, v90
    v_mov_b32 v27, v91
    v_mov_b32 v28, v92
    v_mov_b32 v29, v93
    v_mov_b32 v30, v94
    v_mov_b32 v31, v95
    v_mov_b32 v32, v96
    v_mov_b32 v33, v97
    v_mov_b32 v34, v98
    v_mov_b32 v35, v99
    v_mov_b32 v36, v100
    v_mov_b32 v37, v101
    v_mov_b32 v38, v102
    v_mov_b32 v39, v103
    v_mov_b32 v40, v104
    v_mov_b32 v41, v105
    v_mov_b32 v42, v106
    v_mov_b32 v43, v107
    v_mov_b32 v44, v108
    v_mov_b32 v45, v109
    v_mov_b32 v46, v110
    v_mov_b32 v47, v111
    v_mov_b32 v48, v112
    v_mov_b32 v49, v113
    v_mov_b32 v50, v114
    v_mov_b32 v51, v115
    v_mov_b32 v52, v116
    v_mov_b32 v53, v117
    v_mov_b32 v54, v118
    v_mov_b32 v55, v119
    v_mov_b32 v56, v120
    v_mov_b32 v57, v121
    v_mov_b32 v58, v122
    v_mov_b32 v59, v123
    v_mov_b32 v60, v124
    v_mov_b32 v61, v125
    v_mov_b32 v62, v126
    v_mov_b32 v63, v127
L_fqspins:
    s_mov_b32 s81, 0x40000
L_fqspins_l:
    buffer_load_dwordx2 v[244:245], off, s[44:47], s76 sc1
    s_sub_u32 s81, s81, 1
    s_cbranch_scc1 L_fqoks
    s_waitcnt vmcnt(0)
    v_min_u32 v244, v244, v245
    v_cmp_eq_u32 vcc, 0, v244
    s_cbranch_vccz L_fqoks
    s_sleep 8
    s_branch L_fqspins_l
L_fqoks:
    buffer_load_dwordx4 v[208:211], v233, s[44:47], s22 offen sc1
    buffer_load_dwordx4 v[212:215], v233, s[44:47], s22 offen offset:512 sc1
    buffer_load_dword v236, v249, s[44:47], s22 offen offset:1024 sc1
    buffer_load_dwordx4 v[192:195], v233, s[44:47], s77 offen sc1
    buffer_load_dwordx4 v[196:199], v233, s[44:47], s77 offen offset:512 sc1
    buffer_load_dword v237, v249, s[44:47], s77 offen offset:1024 sc1
    s_waitcnt vmcnt(0)
    s_branch L_trans
L_sp_touch:
    s_bfe_u32 s76, s2, 0x30003
    s_and_b32 s77, s60, 1
    s_mul_i32 s76, s76, 72
    s_mul_i32 s77, s77, 28
    s_add_u32 s76, s76, s77
    s_mov_b32 exec_hi, 15
    v_mul_u32_u24 v120, 1152, v241
    v_mul_u32_u24 v121, 9216, v241
    s_mul_i32 s77, s76, 1152
    s_add_u32 s77, s77, s88
    s_mov_b32 s39, 131072
    buffer_load_dword v251, v120, s[36:39], s77 offen
    buffer_load_dword v251, v120, s[36:39], s77 offen offset:256
    s_mul_i32 s76, s76, 9216
    s_and_b32 s77, s67, 0xff
    s_lshl_b32 s77, s77, 7
    s_add_u32 s76, s76, s77
    s_add_u32 s76, s76, s69
    v_add_u32 v121, s76, v121
    global_load_dword v251, v121, s[90:91]
    s_mov_b64 exec, -1
    s_branch L_sp_touch_ret
L_special:
    s_bfe_u32 s76, s66, 0x80010
    s_call_b64 s[84:85], L_setup
    s_and_b32 s79, s66, 0xff
    s_cmp_eq_u32 s79, 77
    s_cbranch_scc1 L_special_kv
    s_lshr_b32 s78, s60, 1
    s_lshl1_add_u32 s76, s87, s78
    s_mul_i32 s76, s76, 73728
    s_sub_u32 s78, s79, 72
    s_lshl_b32 s78, s78, 13
    s_add_u32 s76, s76, s78
    s_and_b32 s78, s60, 1
    s_lshl_b32 s78, s78, 11
    s_add_u32 s76, s76, s78
    s_add_u32 s76, s76, 28311552
    s_add_u32 s77, s76, 36864
    s_add_u32 s78, s76, 4096
    s_cmp_eq_u32 s79, 76
    s_cselect_b32 s78, 1073741824, s78
    s_add_u32 s80, s78, 36864
    s_setpc_b64 s[82:83]
L_special_kv:
    s_barrier
    v_and_b32 v244, 15, v241
    v_lshrrev_b32 v245, 4, v241
    s_lshr_b32 s78, s60, 1
    s_mul_i32 s81, s78, 2432
    s_add_u32 s81, s81, 152080
    s_and_b32 s79, s60, 1
    s_cmp_eq_u32 s79, 0
    s_cbranch_scc1 L_special_kv0
    v_and_b32 v244, 3, v241
    v_mul_u32_u24 v244, 608, v244
    v_and_b32 v245, 4, v241
    v_lshl_add_u32 v244, v245, 2, v244
    v_cmp_eq_u32 vcc, 0, v245
    v_add_u32 v244, s81, v244
    v_mov_b32 v65, 0x3f803f80
    v_cndmask_b32 v64, 0, v65, vcc
    v_add_u32 v244, 576, v244
    v_mov_b32 v245, 152064
    v_cmp_eq_u32 vcc, 8, v241
    v_mov_b32 v65, v64
    v_mov_b32 v66, v64
    v_cndmask_b32 v244, v244, v245, vcc
    v_mov_b32 v67, v64
    s_mov_b64 exec, 0x1ff
    ds_write_b128 v244, v[64:67]
    s_mov_b64 exec, -1
    s_branch L_special_kv1
L_special_kv0:
    s_mov_b32 s79, 0x3eae1a93
    v_mul_f32 v0, s79, v0
    v_mul_f32 v1, s79, v1
    v_mul_f32 v2, s79, v2
    v_mul_f32 v3, s79, v3
    v_mul_f32 v4, s79, v4
    v_mul_f32 v5, s79, v5
    v_mul_f32 v16, s79, v16
    v_mul_f32 v17, s79, v17
    v_mul_f32 v18, s79, v18
    v_mul_f32 v19, s79, v19
    v_mul_f32 v20, s79, v20
    v_mul_f32 v21, s79, v21
    v_mul_f32 v32, s79, v32
    v_mul_f32 v33, s79, v33
    v_mul_f32 v34, s79, v34
    v_mul_f32 v35, s79, v35
    v_mul_f32 v36, s79, v36
    v_mul_f32 v37, s79, v37
    v_mul_f32 v48, s79, v48
    v_mul_f32 v49, s79, v49
    v_mul_f32 v50, s79, v50
    v_mul_f32 v51, s79, v51
    v_mul_f32 v52, s79, v52
    v_mul_f32 v53, s79, v53
    v_cvt_pk_bf16_f32 v64, v0, v1
    v_cvt_pk_bf16_f32 v65, v2, v3
    v_cvt_pk_bf16_f32 v66, v4, v5
    v_cvt_pk_bf16_f32 v67, v6, v7
    v_cvt_pk_bf16_f32 v68, v8, v9
    v_cvt_pk_bf16_f32 v69, v10, v11
    v_cvt_pk_bf16_f32 v70, v12, v13
    v_cvt_pk_bf16_f32 v71, v14, v15
    v_cvt_pk_bf16_f32 v72, v16, v17
    v_cvt_pk_bf16_f32 v73, v18, v19
    v_cvt_pk_bf16_f32 v74, v20, v21
    v_cvt_pk_bf16_f32 v75, v22, v23
    v_cvt_pk_bf16_f32 v76, v24, v25
    v_cvt_pk_bf16_f32 v77, v26, v27
    v_cvt_pk_bf16_f32 v78, v28, v29
    v_cvt_pk_bf16_f32 v79, v30, v31
    v_cvt_pk_bf16_f32 v80, v32, v33
    v_cvt_pk_bf16_f32 v81, v34, v35
    v_cvt_pk_bf16_f32 v82, v36, v37
    v_cvt_pk_bf16_f32 v83, v38, v39
    v_cvt_pk_bf16_f32 v84, v40, v41
    v_cvt_pk_bf16_f32 v85, v42, v43
    v_cvt_pk_bf16_f32 v86, v44, v45
    v_cvt_pk_bf16_f32 v87, v46, v47
    v_cvt_pk_bf16_f32 v88, v48, v49
    v_cvt_pk_bf16_f32 v89, v50, v51
    v_cvt_pk_bf16_f32 v90, v52, v53
    v_cvt_pk_bf16_f32 v91, v54, v55
    v_cvt_pk_bf16_f32 v92, v56, v57
    v_cvt_pk_bf16_f32 v93, v58, v59
    v_cvt_pk_bf16_f32 v94, v60, v61
    v_cvt_pk_bf16_f32 v95, v62, v63
    s_lshl_b32 s79, s78, 11
    s_add_u32 s79, s79, 147456
    s_lshl_b32 s80, s78, 3
    s_add_u32 s80, s80, 151552
    v_bfe_u32 v246, v244, 2, 1
    v_mul_u32_u24 v246, 288, v246
    v_and_b32 v247, 3, v244
    v_lshl_add_u32 v246, v247, 1, v246
    v_and_b32 v247, 8, v244
    v_add3_u32 v246, v246, v247, s81
    v_lshl_add_u32 v247, v245, 6, v246
    v_lshlrev_b32 v244, 4, v244
    v_add_u32 v249, s80, v244
    v_lshrrev_b32 v248, 1, v245
    v_lshl_add_u32 v244, v248, 9, v244
    v_and_b32 v248, 1, v245
    v_lshlrev_b32 v248, 3, v248
    v_add3_u32 v248, v248, v244, s79
    ds_write_b64 v248, v[64:65] offset:0
    ds_write_b16 v247, v68 offset:0
    ds_write_b16_d16_hi v247, v68 offset:16
    ds_write_b16 v247, v69 offset:32
    ds_write_b16_d16_hi v247, v69 offset:48
    ds_write_b64 v248, v[72:73] offset:256
    ds_write_b16 v247, v76 offset:608
    ds_write_b16_d16_hi v247, v76 offset:624
    ds_write_b16 v247, v77 offset:640
    ds_write_b16_d16_hi v247, v77 offset:656
    ds_write_b64 v248, v[80:81] offset:1024
    ds_write_b16 v247, v84 offset:1216
    ds_write_b16_d16_hi v247, v84 offset:1232
    ds_write_b16 v247, v85 offset:1248
    ds_write_b16_d16_hi v247, v85 offset:1264
    ds_write_b64 v248, v[88:89] offset:1280
    ds_write_b16 v247, v92 offset:1824
    ds_write_b16_d16_hi v247, v92 offset:1840
    ds_write_b16 v247, v93 offset:1856
    ds_write_b16_d16_hi v247, v93 offset:1872
    s_mov_b64 exec, 0xffff
    ds_write_b32 v249, v66 offset:0
    ds_write_b16 v246, v70 offset:256
    ds_write_b16_d16_hi v246, v70 offset:272
    ds_write_b32 v249, v74 offset:256
    ds_write_b16 v246, v78 offset:864
    ds_write_b16_d16_hi v246, v78 offset:880
    ds_write_b32 v249, v82 offset:4
    ds_write_b16 v246, v86 offset:1472
    ds_write_b16_d16_hi v246, v86 offset:1488
    ds_write_b32 v249, v90 offset:260
    ds_write_b16 v246, v94 offset:2080
    ds_write_b16_d16_hi v246, v94 offset:2096
    s_mov_b64 exec, -1
L_special_kv1:
    s_lshl_b32 s78, s60, 10
    v_add_u32 v244, s78, v233
    v_add_u32 v245, 147456, v244
    v_cmp_gt_u32 vcc, 1408, v244
    v_mov_b32 v246, 0x40000000
    s_mul_i32 s77, s87, 9600
    v_cndmask_b32 v246, v246, v244, vcc
    s_add_u32 s77, s77, 31457280
    s_add_u32 s78, s77, 4096
    s_add_u32 s79, s77, 8192
    s_waitcnt lgkmcnt(0)
    s_barrier
    ds_read_b128 v[64:67], v245
    ds_read_b128 v[68:71], v245 offset:4096
    ds_read_b128 v[72:75], v245 offset:8192
    s_waitcnt lgkmcnt(0)
    buffer_store_dwordx4 v[64:67], v244, s[44:47], s77 offen sc1
    buffer_store_dwordx4 v[68:71], v244, s[44:47], s78 offen sc1
    buffer_store_dwordx4 v[72:75], v246, s[44:47], s79 offen sc1
    s_mov_b32 s76, 1073741824
    s_mov_b32 s77, s76
    s_mov_b32 s78, s76
    s_mov_b32 s80, s76
    s_setpc_b64 s[82:83]
L_kvspin:
    s_mov_b32 s81, 0x40000
L_kvspin_l:
    buffer_load_dwordx4 v[244:247], v233, s[44:47], s74 offen sc1
    s_sub_u32 s81, s81, 1
    s_cbranch_scc1 L_kvok
    s_waitcnt vmcnt(0)
    v_min3_u32 v244, v244, v245, v246
    v_min_u32 v244, v244, v247
    v_cmp_eq_u32 vcc, 0, v244
    s_cbranch_vccz L_kvok
    s_sleep 8
    s_branch L_kvspin_l
L_kvspins:
    s_mov_b32 s81, 0x40000
L_kvspins_l:
    buffer_load_dwordx4 v[244:247], v233, s[44:47], s74 offen sc1
    s_sub_u32 s81, s81, 1
    s_cbranch_scc1 L_kvoks
    s_waitcnt vmcnt(0)
    v_min3_u32 v244, v244, v245, v246
    v_min_u32 v244, v244, v247
    v_cmp_eq_u32 vcc, 0, v244
    s_cbranch_vccz L_kvoks
    s_sleep 8
    s_branch L_kvspins_l
L_fqspin:
    s_mov_b32 s81, 0x40000
L_fqspin_l:
    buffer_load_dwordx2 v[244:245], off, s[44:47], s76 sc1
    s_sub_u32 s81, s81, 1
    s_cbranch_scc1 L_fqok
    s_waitcnt vmcnt(0)
    v_min_u32 v244, v244, v245
    v_cmp_eq_u32 vcc, 0, v244
    s_cbranch_vccz L_fqok
    s_sleep 8
    s_branch L_fqspin_l
L_flaginit:
    v_cmp_lt_u32 vcc, 3, v241
    v_mov_b32 v12, 0
    v_mov_b32 v13, 0
    v_cndmask_b32 v8, 0, 1, vcc
    v_mov_b32 v14, 0
    v_mov_b32 v15, 0
    v_mov_b32 v9, v8
    v_mov_b32 v10, v8
    v_mov_b32 v11, v8
    s_mov_b32 s76, 31784960
    buffer_store_dwordx4 v[8:11], v233, s[44:47], s76 offen sc1
    buffer_store_dwordx4 v[12:15], v233, s[44:47], s76 offen offset:1024 sc1
    buffer_store_dwordx4 v[12:15], v233, s[44:47], s76 offen offset:2048 sc1
    buffer_store_dwordx4 v[12:15], v233, s[44:47], s76 offen offset:3072 sc1
    s_add_u32 s76, s76, 4096
    buffer_store_dwordx4 v[12:15], v233, s[44:47], s76 offen sc1
    buffer_store_dwordx4 v[12:15], v233, s[44:47], s76 offen offset:1024 sc1
    v_mul_u32_u24 v16, 24704, v241
    s_mov_b32 s76, 32530432
    buffer_store_dword v12, v16, s[44:47], s76 offen sc1
    s_add_u32 s76, s76, 1581056
    buffer_store_dword v12, v16, s[44:47], s76 offen sc1
    s_add_u32 s76, s76, 1581056
    buffer_store_dword v12, v16, s[44:47], s76 offen sc1
    s_add_u32 s76, s76, 1581056
    buffer_store_dword v12, v16, s[44:47], s76 offen sc1
    s_waitcnt vmcnt(0)
    buffer_store_dword v240, off, s[96:99], 0 sc1
    s_branch L_flaginit_ret
L_inispin:
    s_mov_b32 s81, 0x40000
L_inispin_l:
    buffer_load_dword v114, off, s[96:99], 0 sc1
    s_sub_u32 s81, s81, 1
    s_cbranch_scc1 L_iniok
    s_waitcnt vmcnt(0)
    v_cmp_eq_u32 vcc, 0, v114
    s_cbranch_vccz L_iniok
    s_sleep 8
    s_branch L_inispin_l
L_codeend:
.p2align 3
.type L_jobtab,@object
L_jobtab:
.byte 254, 31, 3, 61, 65, 67, 255, 255
.byte 254, 18, 19, 68, 71, 21, 255, 255
.byte 254, 48, 54, 35, 10, 41, 255, 255
.byte 254, 36, 17, 26, 51, 58, 255, 255
.byte 254, 1, 45, 8, 55, 39, 255, 255
.byte 254, 38, 30, 4, 64, 56, 255, 255
.byte 254, 37, 9, 53, 20, 57, 255, 255
.byte 254, 77, 72, 73, 42, 255, 255, 255
.byte 254, 13, 11, 70, 60, 24, 255, 255
.byte 254, 34, 47, 27, 23, 14, 255, 255
.byte 254, 16, 32, 29, 43, 50, 255, 255
.byte 254, 15, 33, 44, 6, 59, 255, 255
.byte 254, 12, 2, 62, 63, 7, 255, 255
.byte 254, 25, 49, 40, 22, 66, 255, 255
.byte 254, 46, 0, 5, 69, 28, 255, 255
.byte 254, 74, 75, 76, 52, 255, 255, 255
.size L_jobtab, 128

.section .rodata,"a"
.p2align 6
.amdhsa_kernel gated_mix__grouped_kv_mqa__glu_gated_geglu__prompt_kernel
  .amdhsa_next_free_vgpr 512
  .amdhsa_next_free_sgpr 102
  .amdhsa_accum_offset 256
  .amdhsa_group_segment_fixed_size 0
  .amdhsa_kernarg_size 104
  .amdhsa_user_sgpr_count 2
  .amdhsa_user_sgpr_kernarg_segment_ptr 1
  .amdhsa_system_sgpr_workgroup_id_x 1
.end_amdhsa_kernel
```
